```python
import torch

def _softmax(x, axis=-1):
    return torch.softmax(x, dim=axis)

def _gelu(x):
    return torch.nn.functional.gelu(x, approximate='tanh')

def _silu(x):
    return torch.nn.functional.silu(x)

def _sigmoid(x):
    return torch.sigmoid(x)

def _layernorm(x, axis=-1, eps=1e-05):
    m = x.mean(dim=axis, keepdim=True)
    v = x.var(dim=axis, keepdim=True, unbiased=False)
    return (x - m) / torch.sqrt(v + eps)

def _scatter_add(tgt, idx, src, axis=0):
    return tgt.clone().index_add_(axis, idx, src)

def _segment_sum(src, seg, n):
    out = torch.zeros((n,) + src.shape[1:], dtype=src.dtype)
    return out.index_add_(0, seg, src)

def _pad(x, pw):
    flat = tuple((v for pair in reversed(pw) for v in pair))
    return torch.nn.functional.pad(x, flat)
kernel_name = 'gated_mix__memory_aug_recurrent_mem_tr__mixer_token_mlp__prompt'

def setup_inputs():

    _w = lambda a: (lambda t: t.to(torch.bfloat16) if t.is_floating_point() else t)(torch.as_tensor(a))

    def _A_setup():
        B, S, Dm = (1, 2048, 512)
        H, Dh = (32, 128)
        M, seg = (8, 32)
        seg = min(seg, S)
        S = S // seg * seg
        return {'x': _w((lambda *s: torch.randn(*s, dtype=torch.bfloat16) * 0.05)(B, S, Dm)), 'mem0': _w((lambda *s: torch.randn(*s, dtype=torch.bfloat16) * 0.8)(B, M, Dm)), 'Wq': _w((lambda *s: torch.randn(*s, dtype=torch.bfloat16) * 3.2)(Dm, H, Dh) * Dm ** (-0.5)), 'Wk': _w((lambda *s: torch.randn(*s, dtype=torch.bfloat16) * 3.2)(Dm, H, Dh) * Dm ** (-0.5)), 'Wv': _w((lambda *s: torch.randn(*s, dtype=torch.bfloat16) * 0.8)(Dm, H, Dh) * Dm ** (-0.5)), 'Wo': _w((lambda *s: torch.randn(*s, dtype=torch.bfloat16) * 0.8)(H, Dh, Dm) * (H * Dh) ** (-0.5)), 'seg_len': seg}
    _A_in = _A_setup()

    def _B_setup():
        B, S, D, F = (1, 2048, 512, 1792)
        return {'x': _w((lambda *s: torch.randn(*s, dtype=torch.bfloat16) * 0.05)(B, S, D)), 'w1': _w((lambda *s: torch.randn(*s, dtype=torch.bfloat16) * 0.4)(S, F) * S ** (-0.5)), 'b1': _w((lambda *s: torch.randn(*s, dtype=torch.bfloat16) * 3.2)(F) * 0.02), 'w2': _w((lambda *s: torch.randn(*s, dtype=torch.bfloat16) * 0.8)(F, S) * F ** (-0.5)), 'b2': _w((lambda *s: torch.randn(*s, dtype=torch.bfloat16) * 3.2)(S) * 0.02)}
    _B_in = _B_setup()
    return {'A_x': _A_in['x'], 'A_mem0': _A_in['mem0'], 'A_Wq': _A_in['Wq'], 'A_Wk': _A_in['Wk'], 'A_Wv': _A_in['Wv'], 'A_Wo': _A_in['Wo'], 'A_seg_len': _A_in['seg_len'], 'B_x': _B_in['x'], 'B_w1': _B_in['w1'], 'B_b1': _B_in['b1'], 'B_w2': _B_in['w2'], 'B_b2': _B_in['b2'], 'gate_w': _w((lambda *s: torch.randn(*s, dtype=torch.bfloat16) * 0.05)(512) * 16.0)}

def reference(A_x, A_mem0, A_Wq, A_Wk, A_Wv, A_Wo, A_seg_len, B_x, B_w1, B_b1, B_w2, B_b2, gate_w):

    def _A_ref(x, mem0, Wq, Wk, Wv, Wo, seg_len):
        B, S, Dm = x.shape
        H, Dh = (Wq.shape[1], Wq.shape[2])
        M = mem0.shape[1]
        scale = Dh ** (-0.5)
        n_seg = S // seg_len
        L = M + seg_len
        idx = torch.arange(L)
        mask = (idx[:, None] < M) | (idx[:, None] >= idx[None, :])
        mem = mem0
        outs = []
        for s in range(n_seg):
            xs = x[:, s * seg_len:(s + 1) * seg_len, :].clone()
            h = torch.concatenate([mem, xs], axis=1)
            q = torch.einsum('btd,dhe->bhte', h, Wq)
            k = torch.einsum('btd,dhe->bhte', h, Wk)
            v = torch.einsum('btd,dhe->bhte', h, Wv)
            scores = torch.einsum('bhqe,bhke->bhqk', q, k) * scale
            scores = torch.where(mask[None, None], scores, -1000000000.0)
            p = _softmax(scores, axis=-1)
            o = torch.einsum('bhqk,bhke->bhqe', p, v)
            o = torch.einsum('bhte,hed->btd', o, Wo)
            mem = o[:, :M, :].clone()
            outs.append(o[:, M:, :])
        return torch.concatenate(outs, axis=1)

    def _B_ref(x, w1, b1, w2, b2):
        B, S, D = x.shape
        h = _layernorm(x, axis=-1)
        u = torch.einsum('bsd,sf->bdf', h, w1) + b1
        u = _gelu(u)
        y = torch.einsum('bdf,fs->bds', u, w2) + b2
        return (lambda x, *d: x.permute(*d))(y, 0, 2, 1)
    x = A_x
    g = _sigmoid((x * gate_w).sum(-1, keepdims=True))
    a = _A_ref(x, A_mem0, A_Wq, A_Wk, A_Wv, A_Wo, A_seg_len)
    b = _B_ref(x, B_w1, B_b1, B_w2, B_b2)
    return g * a + (1 - g) * b
```

```asm
; @launch grid=(256,1,1) block=(256,1,1) lds=163840
.amdgcn_target "amdgcn-amd-amdhsa--gfx950"
.text
.globl gated_mix__memory_aug_recurrent_mem_tr__mixer_token_mlp__prompt_kernel
.p2align 8
.type gated_mix__memory_aug_recurrent_mem_tr__mixer_token_mlp__prompt_kernel,@function
gated_mix__memory_aug_recurrent_mem_tr__mixer_token_mlp__prompt_kernel:
  s_cmp_ge_u32 s2, 256
  s_cbranch_scc1 L_done
  s_load_dwordx2 s[4:5], s[0:1], 120
  s_mov_b32 s6, 268435456
  s_mov_b32 s7, 0x20000
  s_load_dwordx2 s[36:37], s[0:1], 112
  s_mov_b32 s38, 256
  s_mov_b32 s39, 0x20000
  s_load_dwordx2 s[48:49], s[0:1], 16
  s_mov_b32 s50, 4194304
  s_mov_b32 s51, 0x20000
  s_load_dwordx2 s[52:53], s[0:1], 24
  s_mov_b32 s54, 4194304
  s_mov_b32 s55, 0x20000
  s_load_dwordx2 s[56:57], s[0:1], 32
  s_mov_b32 s58, 4194304
  s_mov_b32 s59, 0x20000
  s_load_dwordx2 s[60:61], s[0:1], 40
  s_mov_b32 s62, 4194304
  s_mov_b32 s63, 0x20000
  v_lshrrev_b32 v1, 6, v0
  s_getreg_b32 s82, hwreg(HW_REG_XCC_ID)
  s_and_b32 s82, s82, 15
  s_and_b32 s24, s82, 7
  s_lshl_b32 s24, s24, 2
  s_lshr_b32 s24, 0x36250714, s24
  s_and_b32 s24, s24, 7
  s_and_b32 s82, s82, 8
  s_or_b32 s82, s82, s24
  v_readfirstlane_b32 s13, v1
  s_mov_b32 s33, 131072
  s_waitcnt lgkmcnt(0)
  s_lshl_b32 s25, s82, 2
  s_add_u32 s25, s25, 64
  s_cmp_eq_u32 s82, 0
  s_cselect_b32 s25, 0, s25
  v_mov_b32 v1, 1
  v_lshlrev_b32 v2, 10, v0
  s_lshr_b32 s24, s2, 3
  buffer_atomic_add v1, v2, s[36:39], s25 offen sc0
  s_waitcnt vmcnt(0)
  v_lshlrev_b32 v2, 2, v0
  ds_write_b32 v2, v1
  s_waitcnt lgkmcnt(0)
  s_barrier
  v_mov_b32 v2, 0
  ds_read_b32 v1, v2
  s_waitcnt lgkmcnt(0)
  v_readfirstlane_b32 s83, v1
  s_barrier
  s_lshl_b32 s3, s82, 5
  s_add_u32 s3, s3, s83
  s_cmp_eq_u32 s82, 0
  s_cbranch_scc1 L_role
  s_cmp_lt_u32 s83, 32
  s_cselect_b32 s24, s82, 8
  s_cmp_lt_u32 s24, 8
  s_cbranch_scc1 L_role
  s_cmp_eq_u32 s13, 0
  s_cbranch_scc0 L_e2
  v_and_b32 v2, 15, v0
  v_lshl_add_u32 v3, v2, 2, 64
  v_cmp_eq_u32 vcc, 0, v2
  s_nop 1
  v_cndmask_b32 v3, v3, 0, vcc
  buffer_load_dword v4, v3, s[36:39], 0 offen sc1
L_cen_1:
  v_cmp_gt_u32 vcc, s82, v2
  s_waitcnt vmcnt(0)
  s_nop 0
  v_cndmask_b32 v5, 0, v4, vcc
  v_add_u32_dpp v4, v4, v4 row_ror:8 row_mask:0xf bank_mask:0xf
  s_nop 0
  v_add_u32_dpp v5, v5, v5 row_ror:8 row_mask:0xf bank_mask:0xf
  v_add_u32_dpp v4, v4, v4 row_ror:4 row_mask:0xf bank_mask:0xf
  s_nop 0
  v_add_u32_dpp v5, v5, v5 row_ror:4 row_mask:0xf bank_mask:0xf
  v_add_u32_dpp v4, v4, v4 row_ror:2 row_mask:0xf bank_mask:0xf
  s_nop 0
  v_add_u32_dpp v5, v5, v5 row_ror:2 row_mask:0xf bank_mask:0xf
  v_add_u32_dpp v4, v4, v4 row_ror:1 row_mask:0xf bank_mask:0xf
  s_nop 0
  v_add_u32_dpp v5, v5, v5 row_ror:1 row_mask:0xf bank_mask:0xf
  v_readfirstlane_b32 s24, v4
  v_readfirstlane_b32 s25, v5
  s_cmp_ge_u32 s24, 256
  s_cbranch_scc1 L_cen_1_x
  s_sub_u32 s33, s33, 1
  s_cbranch_scc1 L_done
  s_sleep 8
  buffer_load_dword v4, v3, s[36:39], 0 offen sc1
  s_branch L_cen_1
L_cen_1_x:
  s_add_u32 s25, s25, s83
L_e2:
  s_barrier
  v_and_b32 v2, 15, v0
  v_lshl_add_u32 v3, v2, 2, 64
  v_cmp_eq_u32 vcc, 0, v2
  s_nop 1
  v_cndmask_b32 v3, v3, 0, vcc
  buffer_load_dword v4, v3, s[36:39], 0 offen sc1
L_cen_2:
  v_cmp_gt_u32 vcc, s82, v2
  s_waitcnt vmcnt(0)
  s_nop 0
  v_cndmask_b32 v5, 0, v4, vcc
  v_add_u32_dpp v4, v4, v4 row_ror:8 row_mask:0xf bank_mask:0xf
  s_nop 0
  v_add_u32_dpp v5, v5, v5 row_ror:8 row_mask:0xf bank_mask:0xf
  v_add_u32_dpp v4, v4, v4 row_ror:4 row_mask:0xf bank_mask:0xf
  s_nop 0
  v_add_u32_dpp v5, v5, v5 row_ror:4 row_mask:0xf bank_mask:0xf
  v_add_u32_dpp v4, v4, v4 row_ror:2 row_mask:0xf bank_mask:0xf
  s_nop 0
  v_add_u32_dpp v5, v5, v5 row_ror:2 row_mask:0xf bank_mask:0xf
  v_add_u32_dpp v4, v4, v4 row_ror:1 row_mask:0xf bank_mask:0xf
  s_nop 0
  v_add_u32_dpp v5, v5, v5 row_ror:1 row_mask:0xf bank_mask:0xf
  v_readfirstlane_b32 s24, v4
  v_readfirstlane_b32 s25, v5
  s_cmp_ge_u32 s24, 256
  s_cbranch_scc1 L_cen_2_x
  s_sub_u32 s33, s33, 1
  s_cbranch_scc1 L_done
  s_sleep 8
  buffer_load_dword v4, v3, s[36:39], 0 offen sc1
  s_branch L_cen_2
L_cen_2_x:
  s_add_u32 s25, s25, s83
  s_mov_b32 s3, s25
L_role:
  s_cmp_ge_u32 s3, 128
  s_cbranch_scc1 L_B
  s_cmp_ge_u32 s3, 32
  s_cbranch_scc1 L_Q
  s_mov_b32 s12, s3
  v_and_b32 v20, 63, v0
  v_and_b32 v21, 15, v20
  v_lshrrev_b32 v22, 4, v20
  v_and_b32 v23, 1, v22
  v_lshrrev_b32 v14, 1, v22
  v_lshlrev_b32 v27, 14, v23
  v_lshl_add_u32 v27, v14, 12, v27
  v_lshl_add_u32 v27, v21, 4, v27
  s_lshl_b32 s24, s12, 17
  s_lshl_b32 s25, s13, 8
  s_add_u32 s24, s24, s25
  v_add_u32 v27, s24, v27
  s_xor_b32 s70, s13, 0
  s_lshl_b32 s70, s70, 15
  s_add_u32 s71, s70, 8192
  buffer_load_dwordx4 v[32:35], v27, s[60:63], s70 offen offset:0
  s_mov_b32 s26, 0x05040100
  s_mov_b32 s27, 0x07060302
  s_mul_i32 s72, s13, 36864
  s_add_u32 s72, s72, 16384
  v_lshlrev_b32 v2, 4, v20
  v_add_u32 v6, s72, v2
  v_lshlrev_b32 v26, 17, v14
  v_lshl_add_u32 v26, v23, 18, v26
  v_bfe_u32 v15, v20, 3, 1
  buffer_load_dwordx4 v[36:39], v27, s[60:63], s70 offen offset:1024
  v_lshl_add_u32 v26, v15, 13, v26
  v_lshlrev_b32 v15, 1, v22
  v_xor_b32 v15, v15, v20
  v_and_b32 v15, 7, v15
  v_lshl_add_u32 v26, v15, 4, v26
  s_lshl_b32 s24, s12, 8
  s_lshr_b32 s25, s13, 1
  s_lshl_b32 s25, s25, 7
  s_add_u32 s24, s24, s25
  buffer_load_dwordx4 v[40:43], v27, s[60:63], s70 offen offset:2048
  v_add_u32 v26, s24, v26
  v_lshrrev_b32 v15, 2, v20
  v_lshlrev_b32 v28, 7, v15
  v_and_b32 v15, 3, v20
  v_lshl_add_u32 v28, v15, 3, v28
  v_bfe_u32 v15, v20, 3, 2
  v_lshl_add_u32 v28, v15, 5, v28
  s_and_b32 s24, s13, 1
  s_lshl_b32 s24, s24, 6
  buffer_load_dwordx4 v[44:47], v27, s[60:63], s70 offen offset:3072
  v_xor_b32 v28, s24, v28
  s_xor_b32 s25, s13, 1
  s_mul_i32 s25, s25, 36864
  s_add_u32 s25, s25, 16384
  v_add_u32 v30, s25, v28
  v_add_u32 v28, s72, v28
  v_xor_b32 v29, 32, v28
  v_xor_b32 v31, 32, v30
  v_and_b32 v15, 1, v20
  buffer_load_dwordx4 v[48:51], v27, s[60:63], s71 offen offset:0
  v_mul_u32_u24 v1, 0xaaaa, v15
  v_add_u32 v1, 0x4444, v1
  v_lshlrev_b32 v7, 3, v20
  v_lshlrev_b32 v15, 6, v14
  v_xor_b32 v7, v7, v15
  s_lshl_b32 s24, s13, 9
  v_add_u32 v7, s24, v7
  v_and_b32 v15, 0xff0, v7
  v_xor_b32 v3, 512, v15
  buffer_load_dwordx4 v[52:55], v27, s[60:63], s71 offen offset:1024
  v_xor_b32 v4, 1024, v15
  v_xor_b32 v5, 1536, v15
  v_lshrrev_b32 v15, 2, v20
  v_lshlrev_b32 v8, 3, v15
  v_bfe_u32 v15, v20, 1, 1
  v_lshlrev_b32 v15, 6, v15
  v_xor_b32 v8, v8, v15
  v_and_b32 v15, 3, v20
  v_lshl_add_u32 v8, v15, 7, v8
  buffer_load_dwordx4 v[56:59], v27, s[60:63], s71 offen offset:2048
  s_mov_b32 s66, 0x55555555
  s_mov_b32 s67, 0x55555555
  v_and_b32 v15, 0x3e0, v2
  v_mov_b32 v12, 1056
  v_cndmask_b32 v9, v12, v15, s[66:67]
  v_cndmask_b32 v10, v15, v12, s[66:67]
  v_lshlrev_b32 v11, 13, v22
  v_lshrrev_b32 v15, 3, v21
  v_lshl_add_u32 v11, v15, 15, v11
  buffer_load_dwordx4 v[60:63], v27, s[60:63], s71 offen offset:3072
  v_and_b32 v15, 7, v21
  v_lshl_add_u32 v11, v15, 3, v11
  s_lshl_b32 s24, s13, 16
  s_lshl_b32 s25, s12, 6
  s_add_u32 s24, s24, s25
  s_xor_b32 s70, s13, 1
  s_lshl_b32 s70, s70, 15
  s_add_u32 s71, s70, 8192
  buffer_load_dwordx4 v[64:67], v27, s[60:63], s70 offen offset:0
  v_add_u32 v11, s24, v11
  s_lshr_b32 s24, s13, 1
  s_lshl_b32 s87, s24, 12
  s_and_b32 s24, s13, 1
  s_lshl_b32 s24, s24, 9
  s_add_u32 s87, s87, s24
  s_lshr_b32 s24, s12, 3
  s_lshl_b32 s24, s24, 10
  s_add_u32 s87, s87, s24
  buffer_load_dwordx4 v[68:71], v27, s[60:63], s70 offen offset:1024
  s_and_b32 s24, s12, 7
  s_lshl_b32 s24, s24, 6
  s_add_u32 s87, s87, s24
  v_bfe_u32 v24, v2, 1, 5
  v_bfe_u32 v15, v2, 6, 2
  v_lshl_add_u32 v24, v15, 29, v24
  v_bfe_u32 v15, v2, 8, 1
  v_lshl_add_u32 v24, v15, 2, v24
  v_lshrrev_b32 v15, 9, v2
  buffer_load_dwordx4 v[72:75], v27, s[60:63], s70 offen offset:2048
  v_lshl_add_u32 v24, v15, 5, v24
  v_and_b32 v15, 1, v21
  v_lshlrev_b32 v15, 4, v15
  v_mov_b32 v132, 0x5f80
  v_lshlrev_b32 v132, v15, v132
  v_bfe_u32 v15, v21, 2, 1
  v_lshrrev_b32 v133, 3, v21
  v_lshl_add_u32 v133, v15, 1, v133
  v_and_b32 v15, 2, v21
  buffer_load_dwordx4 v[76:79], v27, s[60:63], s70 offen offset:3072
  v_lshl_add_u32 v133, v15, 2, v133
  v_cmp_eq_u32 vcc, 0, v133
  v_mov_b32 v16, 0x1f801f80
  s_nop 0
  v_cndmask_b32 v128, 0, v132, vcc
  v_cmp_eq_u32 vcc, 1, v133
  v_mov_b32 v17, 0x1f801f80
  s_nop 0
  v_cndmask_b32 v129, 0, v132, vcc
  v_cmp_eq_u32 vcc, 2, v133
  v_mov_b32 v18, 0x1f801f80
  buffer_load_dwordx4 v[80:83], v27, s[60:63], s71 offen offset:0
  v_cndmask_b32 v130, 0, v132, vcc
  v_cmp_eq_u32 vcc, 3, v133
  v_mov_b32 v19, 0x1f801f80
  s_nop 0
  v_cndmask_b32 v131, 0, v132, vcc
  ds_write_b128 v2, v[128:131] offset:15360
  s_mov_b32 s64, 0x3e0293ee
  s_mov_b32 s29, 0x4b800000
  s_mov_b32 s90, 671088640
  s_lshl_b32 s40, s13, 10
  buffer_load_dwordx4 v[84:87], v27, s[60:63], s71 offen offset:1024
  s_add_u32 s16, s40, 4096
  s_mov_b32 s14, 0
  s_add_u32 s15, s40, 1310720
  s_add_u32 s23, s16, 1310720
  s_lshl_b32 s43, s13, 2
  s_lshl_b32 s25, s13, 11
  s_lshl_b32 s30, s12, 14
  s_add_u32 s30, s30, 33554432
  s_add_u32 s30, s30, s25
  buffer_load_dwordx4 v[88:91], v27, s[60:63], s71 offen offset:2048
  s_add_u32 s65, s30, 8192
  s_lshl_b32 s22, s12, 13
  s_add_u32 s22, s22, s25
  s_add_u32 s22, s22, 0
  s_add_u32 s31, s87, 1835008
  s_add_u32 s17, s87, 1048576
  s_mov_b32 s28, s17
  s_lshl_b32 s32, s12, 8
  s_add_u32 s32, s32, 1114112
  buffer_load_dwordx4 v[92:95], v27, s[60:63], s71 offen offset:3072
  s_mov_b32 s18, 0
  s_mov_b32 s19, 4096
  s_mov_b32 s89, 0x40004000
  v_add_u32 v13, s43, v2
  v_bfe_u32 v12, v2, 2, 6
  s_waitcnt vmcnt(8) lgkmcnt(0)
  s_xor_b32 s70, s13, 2
  s_lshl_b32 s70, s70, 15
  s_add_u32 s71, s70, 8192
  buffer_load_dwordx4 v[96:99], v27, s[60:63], s70 offen offset:0
  v_perm_b32 v144, v36, v32, s26
  v_perm_b32 v145, v36, v32, s27
  v_perm_b32 v146, v44, v40, s26
  v_perm_b32 v147, v44, v40, s27
  buffer_load_dwordx4 v[100:103], v27, s[60:63], s70 offen offset:1024
  v_perm_b32 v148, v52, v48, s26
  v_perm_b32 v149, v52, v48, s27
  v_perm_b32 v150, v60, v56, s26
  v_perm_b32 v151, v60, v56, s27
  buffer_load_dwordx4 v[104:107], v27, s[60:63], s70 offen offset:2048
  v_perm_b32 v152, v37, v33, s26
  v_perm_b32 v153, v37, v33, s27
  v_perm_b32 v154, v45, v41, s26
  v_perm_b32 v155, v45, v41, s27
  buffer_load_dwordx4 v[108:111], v27, s[60:63], s70 offen offset:3072
  v_perm_b32 v156, v53, v49, s26
  v_perm_b32 v157, v53, v49, s27
  v_perm_b32 v158, v61, v57, s26
  v_perm_b32 v159, v61, v57, s27
  buffer_load_dwordx4 v[112:115], v27, s[60:63], s71 offen offset:0
  v_perm_b32 v160, v38, v34, s26
  v_perm_b32 v161, v38, v34, s27
  v_perm_b32 v162, v46, v42, s26
  v_perm_b32 v163, v46, v42, s27
  buffer_load_dwordx4 v[116:119], v27, s[60:63], s71 offen offset:1024
  v_perm_b32 v164, v54, v50, s26
  v_perm_b32 v165, v54, v50, s27
  v_perm_b32 v166, v62, v58, s26
  v_perm_b32 v167, v62, v58, s27
  buffer_load_dwordx4 v[120:123], v27, s[60:63], s71 offen offset:2048
  v_perm_b32 v168, v39, v35, s26
  v_perm_b32 v169, v39, v35, s27
  v_perm_b32 v170, v47, v43, s26
  v_perm_b32 v171, v47, v43, s27
  buffer_load_dwordx4 v[124:127], v27, s[60:63], s71 offen offset:3072
  v_perm_b32 v172, v55, v51, s26
  v_perm_b32 v173, v55, v51, s27
  v_perm_b32 v174, v63, v59, s26
  v_perm_b32 v175, v63, v59, s27
  s_waitcnt vmcnt(8) lgkmcnt(0)
  s_xor_b32 s70, s13, 3
  s_lshl_b32 s70, s70, 15
  s_add_u32 s71, s70, 8192
  buffer_load_dwordx4 v[32:35], v27, s[60:63], s70 offen offset:0
  v_perm_b32 v176, v68, v64, s26
  v_perm_b32 v177, v68, v64, s27
  v_perm_b32 v178, v76, v72, s26
  v_perm_b32 v179, v76, v72, s27
  v_perm_b32 v180, v84, v80, s26
  buffer_load_dwordx4 v[36:39], v27, s[60:63], s70 offen offset:1024
  v_perm_b32 v181, v84, v80, s27
  v_perm_b32 v182, v92, v88, s26
  v_perm_b32 v183, v92, v88, s27
  v_perm_b32 v184, v69, v65, s26
  v_perm_b32 v185, v69, v65, s27
  buffer_load_dwordx4 v[40:43], v27, s[60:63], s70 offen offset:2048
  v_perm_b32 v186, v77, v73, s26
  v_perm_b32 v187, v77, v73, s27
  v_perm_b32 v188, v85, v81, s26
  v_perm_b32 v189, v85, v81, s27
  v_perm_b32 v190, v93, v89, s26
  buffer_load_dwordx4 v[44:47], v27, s[60:63], s70 offen offset:3072
  v_perm_b32 v191, v93, v89, s27
  v_perm_b32 v128, v70, v66, s26
  v_perm_b32 v129, v70, v66, s27
  v_perm_b32 v130, v78, v74, s26
  v_perm_b32 v131, v78, v74, s27
  buffer_load_dwordx4 v[48:51], v27, s[60:63], s71 offen offset:0
  v_perm_b32 v132, v86, v82, s26
  v_perm_b32 v133, v86, v82, s27
  v_perm_b32 v134, v94, v90, s26
  v_perm_b32 v135, v94, v90, s27
  ds_write_b128 v6, v[128:131] offset:24576
  buffer_load_dwordx4 v[52:55], v27, s[60:63], s71 offen offset:1024
  ds_write_b128 v6, v[132:135] offset:25600
  v_perm_b32 v136, v71, v67, s26
  v_perm_b32 v137, v71, v67, s27
  v_perm_b32 v138, v79, v75, s26
  v_perm_b32 v139, v79, v75, s27
  buffer_load_dwordx4 v[56:59], v27, s[60:63], s71 offen offset:2048
  v_perm_b32 v140, v87, v83, s26
  v_perm_b32 v141, v87, v83, s27
  v_perm_b32 v142, v95, v91, s26
  v_perm_b32 v143, v95, v91, s27
  ds_write_b128 v6, v[136:139] offset:30720
  buffer_load_dwordx4 v[60:63], v27, s[60:63], s71 offen offset:3072
  ds_write_b128 v6, v[140:143] offset:31744
  s_waitcnt vmcnt(8) lgkmcnt(0)
  s_xor_b32 s70, s13, 0
  s_lshl_b32 s70, s70, 20
  s_add_u32 m0, s72, 0
  s_add_u32 s71, s70, 0
  buffer_load_dwordx4 v26, s[56:59], s71 offen lds
  v_perm_b32 v192, v100, v96, s26
  v_perm_b32 v193, v100, v96, s27
  v_perm_b32 v194, v108, v104, s26
  v_perm_b32 v195, v108, v104, s27
  v_perm_b32 v196, v116, v112, s26
  s_add_u32 m0, s72, 1024
  s_add_u32 s71, s70, 524288
  buffer_load_dwordx4 v26, s[56:59], s71 offen lds
  v_perm_b32 v197, v116, v112, s27
  v_perm_b32 v198, v124, v120, s26
  v_perm_b32 v199, v124, v120, s27
  v_perm_b32 v200, v101, v97, s26
  v_perm_b32 v201, v101, v97, s27
  s_add_u32 m0, s72, 2048
  s_add_u32 s71, s70, 65536
  buffer_load_dwordx4 v26, s[56:59], s71 offen lds
  v_perm_b32 v202, v109, v105, s26
  v_perm_b32 v203, v109, v105, s27
  v_perm_b32 v204, v117, v113, s26
  v_perm_b32 v205, v117, v113, s27
  v_perm_b32 v206, v125, v121, s26
  s_add_u32 m0, s72, 3072
  s_add_u32 s71, s70, 589824
  buffer_load_dwordx4 v26, s[56:59], s71 offen lds
  v_perm_b32 v207, v125, v121, s27
  v_perm_b32 v128, v102, v98, s26
  v_perm_b32 v129, v102, v98, s27
  v_perm_b32 v130, v110, v106, s26
  v_perm_b32 v131, v110, v106, s27
  s_add_u32 m0, s72, 4096
  s_add_u32 s71, s70, 16384
  buffer_load_dwordx4 v26, s[56:59], s71 offen lds
  v_perm_b32 v132, v118, v114, s26
  v_perm_b32 v133, v118, v114, s27
  v_perm_b32 v134, v126, v122, s26
  v_perm_b32 v135, v126, v122, s27
  ds_write_b128 v6, v[128:131] offset:26624
  s_add_u32 m0, s72, 5120
  s_add_u32 s71, s70, 540672
  buffer_load_dwordx4 v26, s[56:59], s71 offen lds
  ds_write_b128 v6, v[132:135] offset:27648
  v_perm_b32 v136, v103, v99, s26
  v_perm_b32 v137, v103, v99, s27
  v_perm_b32 v138, v111, v107, s26
  v_perm_b32 v139, v111, v107, s27
  s_add_u32 m0, s72, 6144
  s_add_u32 s71, s70, 81920
  buffer_load_dwordx4 v26, s[56:59], s71 offen lds
  v_perm_b32 v140, v119, v115, s26
  v_perm_b32 v141, v119, v115, s27
  v_perm_b32 v142, v127, v123, s26
  v_perm_b32 v143, v127, v123, s27
  ds_write_b128 v6, v[136:139] offset:32768
  s_add_u32 m0, s72, 7168
  s_add_u32 s71, s70, 606208
  buffer_load_dwordx4 v26, s[56:59], s71 offen lds
  ds_write_b128 v6, v[140:143] offset:33792
  s_waitcnt vmcnt(8) lgkmcnt(0)
  s_xor_b32 s70, s13, 2
  s_lshl_b32 s70, s70, 20
  s_add_u32 m0, s72, 8192
  s_add_u32 s71, s70, 0
  buffer_load_dwordx4 v26, s[56:59], s71 offen lds
  v_perm_b32 v208, v36, v32, s26
  v_perm_b32 v209, v36, v32, s27
  v_perm_b32 v210, v44, v40, s26
  v_perm_b32 v211, v44, v40, s27
  v_perm_b32 v212, v52, v48, s26
  s_add_u32 m0, s72, 9216
  s_add_u32 s71, s70, 524288
  buffer_load_dwordx4 v26, s[56:59], s71 offen lds
  v_perm_b32 v213, v52, v48, s27
  v_perm_b32 v214, v60, v56, s26
  v_perm_b32 v215, v60, v56, s27
  v_perm_b32 v216, v37, v33, s26
  v_perm_b32 v217, v37, v33, s27
  s_add_u32 m0, s72, 10240
  s_add_u32 s71, s70, 65536
  buffer_load_dwordx4 v26, s[56:59], s71 offen lds
  v_perm_b32 v218, v45, v41, s26
  v_perm_b32 v219, v45, v41, s27
  v_perm_b32 v220, v53, v49, s26
  v_perm_b32 v221, v53, v49, s27
  v_perm_b32 v222, v61, v57, s26
  s_add_u32 m0, s72, 11264
  s_add_u32 s71, s70, 589824
  buffer_load_dwordx4 v26, s[56:59], s71 offen lds
  v_perm_b32 v223, v61, v57, s27
  v_perm_b32 v128, v38, v34, s26
  v_perm_b32 v129, v38, v34, s27
  v_perm_b32 v130, v46, v42, s26
  v_perm_b32 v131, v46, v42, s27
  s_add_u32 m0, s72, 12288
  s_add_u32 s71, s70, 16384
  buffer_load_dwordx4 v26, s[56:59], s71 offen lds
  v_perm_b32 v132, v54, v50, s26
  v_perm_b32 v133, v54, v50, s27
  v_perm_b32 v134, v62, v58, s26
  v_perm_b32 v135, v62, v58, s27
  ds_write_b128 v6, v[128:131] offset:28672
  s_add_u32 m0, s72, 13312
  s_add_u32 s71, s70, 540672
  buffer_load_dwordx4 v26, s[56:59], s71 offen lds
  ds_write_b128 v6, v[132:135] offset:29696
  v_perm_b32 v136, v39, v35, s26
  v_perm_b32 v137, v39, v35, s27
  v_perm_b32 v138, v47, v43, s26
  v_perm_b32 v139, v47, v43, s27
  s_add_u32 m0, s72, 14336
  s_add_u32 s71, s70, 81920
  buffer_load_dwordx4 v26, s[56:59], s71 offen lds
  v_perm_b32 v140, v55, v51, s26
  v_perm_b32 v141, v55, v51, s27
  v_perm_b32 v142, v63, v59, s26
  v_perm_b32 v143, v63, v59, s27
  ds_write_b128 v6, v[136:139] offset:34816
  s_add_u32 m0, s72, 15360
  s_add_u32 s71, s70, 606208
  buffer_load_dwordx4 v26, s[56:59], s71 offen lds
  ds_write_b128 v6, v[140:143] offset:35840
  s_waitcnt vmcnt(8) lgkmcnt(0)
  s_barrier
  s_xor_b32 s70, s13, 0
  s_lshl_b32 s70, s70, 20
  s_add_u32 m0, s72, 16384
  s_add_u32 s71, s70, 32768
  buffer_load_dwordx4 v26, s[56:59], s71 offen lds
  ds_read_b64_tr_b16 a[128:129], v28 offset:0
  ds_read_b64_tr_b16 a[130:131], v28 offset:2048
  ds_read_b64_tr_b16 a[132:133], v28 offset:4096
  s_add_u32 m0, s72, 17408
  s_add_u32 s71, s70, 557056
  buffer_load_dwordx4 v26, s[56:59], s71 offen lds
  ds_read_b64_tr_b16 a[134:135], v28 offset:6144
  ds_read_b64_tr_b16 a[136:137], v29 offset:0
  ds_read_b64_tr_b16 a[138:139], v29 offset:2048
  s_add_u32 m0, s72, 18432
  s_add_u32 s71, s70, 98304
  buffer_load_dwordx4 v26, s[56:59], s71 offen lds
  ds_read_b64_tr_b16 a[140:141], v29 offset:4096
  ds_read_b64_tr_b16 a[142:143], v29 offset:6144
  s_waitcnt lgkmcnt(4)
  s_add_u32 m0, s72, 19456
  s_add_u32 s71, s70, 622592
  buffer_load_dwordx4 v26, s[56:59], s71 offen lds
  ds_read_b64_tr_b16 a[160:161], v30 offset:0
  ds_read_b64_tr_b16 a[162:163], v30 offset:2048
  ds_read_b64_tr_b16 a[164:165], v30 offset:4096
  s_add_u32 m0, s72, 20480
  s_add_u32 s71, s70, 49152
  buffer_load_dwordx4 v26, s[56:59], s71 offen lds
  ds_read_b64_tr_b16 a[166:167], v30 offset:6144
  ds_read_b64_tr_b16 a[168:169], v31 offset:0
  ds_read_b64_tr_b16 a[170:171], v31 offset:2048
  s_add_u32 m0, s72, 21504
  s_add_u32 s71, s70, 573440
  buffer_load_dwordx4 v26, s[56:59], s71 offen lds
  ds_read_b64_tr_b16 a[172:173], v31 offset:4096
  ds_read_b64_tr_b16 a[174:175], v31 offset:6144
  s_add_u32 m0, s72, 22528
  s_add_u32 s71, s70, 114688
  buffer_load_dwordx4 v26, s[56:59], s71 offen lds
  s_add_u32 m0, s72, 23552
  s_add_u32 s71, s70, 638976
  buffer_load_dwordx4 v26, s[56:59], s71 offen lds
  s_waitcnt vmcnt(8) lgkmcnt(0)
  s_barrier
  s_xor_b32 s70, s13, 2
  s_lshl_b32 s70, s70, 20
  s_add_u32 m0, s72, 0
  s_add_u32 s71, s70, 32768
  buffer_load_dwordx4 v26, s[56:59], s71 offen lds
  ds_read_b64_tr_b16 a[176:177], v28 offset:8192
  ds_read_b64_tr_b16 a[178:179], v28 offset:10240
  ds_read_b64_tr_b16 a[180:181], v28 offset:12288
  s_add_u32 m0, s72, 1024
  s_add_u32 s71, s70, 557056
  buffer_load_dwordx4 v26, s[56:59], s71 offen lds
  ds_read_b64_tr_b16 a[182:183], v28 offset:14336
  ds_read_b64_tr_b16 a[184:185], v29 offset:8192
  ds_read_b64_tr_b16 a[186:187], v29 offset:10240
  s_add_u32 m0, s72, 2048
  s_add_u32 s71, s70, 98304
  buffer_load_dwordx4 v26, s[56:59], s71 offen lds
  ds_read_b64_tr_b16 a[188:189], v29 offset:12288
  ds_read_b64_tr_b16 a[190:191], v29 offset:14336
  s_waitcnt lgkmcnt(4)
  s_add_u32 m0, s72, 3072
  s_add_u32 s71, s70, 622592
  buffer_load_dwordx4 v26, s[56:59], s71 offen lds
  ds_read_b64_tr_b16 a[192:193], v30 offset:8192
  ds_read_b64_tr_b16 a[194:195], v30 offset:10240
  ds_read_b64_tr_b16 a[196:197], v30 offset:12288
  s_add_u32 m0, s72, 4096
  s_add_u32 s71, s70, 49152
  buffer_load_dwordx4 v26, s[56:59], s71 offen lds
  ds_read_b64_tr_b16 a[198:199], v30 offset:14336
  ds_read_b64_tr_b16 a[200:201], v31 offset:8192
  ds_read_b64_tr_b16 a[202:203], v31 offset:10240
  s_add_u32 m0, s72, 5120
  s_add_u32 s71, s70, 573440
  buffer_load_dwordx4 v26, s[56:59], s71 offen lds
  ds_read_b64_tr_b16 a[204:205], v31 offset:12288
  ds_read_b64_tr_b16 a[206:207], v31 offset:14336
  s_add_u32 m0, s72, 6144
  s_add_u32 s71, s70, 114688
  buffer_load_dwordx4 v26, s[56:59], s71 offen lds
  s_add_u32 m0, s72, 7168
  s_add_u32 s71, s70, 638976
  buffer_load_dwordx4 v26, s[56:59], s71 offen lds
  s_waitcnt vmcnt(8) lgkmcnt(0)
  s_barrier
  s_xor_b32 s70, s13, 2
  s_lshl_b32 s70, s70, 20
  s_add_u32 m0, s72, 8192
  s_add_u32 s71, s70, 0
  buffer_load_dwordx4 v26, s[48:51], s71 offen lds
  ds_read_b64_tr_b16 a[144:145], v28 offset:16384
  ds_read_b64_tr_b16 a[146:147], v28 offset:18432
  ds_read_b64_tr_b16 a[148:149], v28 offset:20480
  s_add_u32 m0, s72, 9216
  s_add_u32 s71, s70, 524288
  buffer_load_dwordx4 v26, s[48:51], s71 offen lds
  ds_read_b64_tr_b16 a[150:151], v28 offset:22528
  ds_read_b64_tr_b16 a[152:153], v29 offset:16384
  ds_read_b64_tr_b16 a[154:155], v29 offset:18432
  s_add_u32 m0, s72, 10240
  s_add_u32 s71, s70, 65536
  buffer_load_dwordx4 v26, s[48:51], s71 offen lds
  ds_read_b64_tr_b16 a[156:157], v29 offset:20480
  ds_read_b64_tr_b16 a[158:159], v29 offset:22528
  s_waitcnt lgkmcnt(4)
  s_add_u32 m0, s72, 11264
  s_add_u32 s71, s70, 589824
  buffer_load_dwordx4 v26, s[48:51], s71 offen lds
  ds_read_b64_tr_b16 a[208:209], v30 offset:16384
  ds_read_b64_tr_b16 a[210:211], v30 offset:18432
  ds_read_b64_tr_b16 a[212:213], v30 offset:20480
  s_add_u32 m0, s72, 12288
  s_add_u32 s71, s70, 16384
  buffer_load_dwordx4 v26, s[48:51], s71 offen lds
  ds_read_b64_tr_b16 a[214:215], v30 offset:22528
  ds_read_b64_tr_b16 a[216:217], v31 offset:16384
  ds_read_b64_tr_b16 a[218:219], v31 offset:18432
  s_add_u32 m0, s72, 13312
  s_add_u32 s71, s70, 540672
  buffer_load_dwordx4 v26, s[48:51], s71 offen lds
  ds_read_b64_tr_b16 a[220:221], v31 offset:20480
  ds_read_b64_tr_b16 a[222:223], v31 offset:22528
  s_add_u32 m0, s72, 14336
  s_add_u32 s71, s70, 81920
  buffer_load_dwordx4 v26, s[48:51], s71 offen lds
  s_add_u32 m0, s72, 15360
  s_add_u32 s71, s70, 606208
  buffer_load_dwordx4 v26, s[48:51], s71 offen lds
  s_waitcnt vmcnt(8) lgkmcnt(0)
  s_barrier
  s_xor_b32 s70, s13, 2
  s_lshl_b32 s70, s70, 20
  s_add_u32 m0, s72, 16384
  s_add_u32 s71, s70, 32768
  buffer_load_dwordx4 v26, s[48:51], s71 offen lds
  ds_read_b64_tr_b16 a[224:225], v28 offset:0
  ds_read_b64_tr_b16 a[226:227], v28 offset:2048
  ds_read_b64_tr_b16 a[228:229], v28 offset:4096
  s_add_u32 m0, s72, 17408
  s_add_u32 s71, s70, 557056
  buffer_load_dwordx4 v26, s[48:51], s71 offen lds
  ds_read_b64_tr_b16 a[230:231], v28 offset:6144
  ds_read_b64_tr_b16 a[232:233], v29 offset:0
  ds_read_b64_tr_b16 a[234:235], v29 offset:2048
  s_add_u32 m0, s72, 18432
  s_add_u32 s71, s70, 98304
  buffer_load_dwordx4 v26, s[48:51], s71 offen lds
  ds_read_b64_tr_b16 a[236:237], v29 offset:4096
  ds_read_b64_tr_b16 a[238:239], v29 offset:6144
  s_waitcnt lgkmcnt(4)
  s_add_u32 m0, s72, 19456
  s_add_u32 s71, s70, 622592
  buffer_load_dwordx4 v26, s[48:51], s71 offen lds
  ds_read_b64_tr_b16 a[240:241], v30 offset:0
  ds_read_b64_tr_b16 a[242:243], v30 offset:2048
  ds_read_b64_tr_b16 a[244:245], v30 offset:4096
  s_add_u32 m0, s72, 20480
  s_add_u32 s71, s70, 49152
  buffer_load_dwordx4 v26, s[48:51], s71 offen lds
  ds_read_b64_tr_b16 a[246:247], v30 offset:6144
  ds_read_b64_tr_b16 a[248:249], v31 offset:0
  ds_read_b64_tr_b16 a[250:251], v31 offset:2048
  s_add_u32 m0, s72, 21504
  s_add_u32 s71, s70, 573440
  buffer_load_dwordx4 v26, s[48:51], s71 offen lds
  ds_read_b64_tr_b16 a[252:253], v31 offset:4096
  ds_read_b64_tr_b16 a[254:255], v31 offset:6144
  s_add_u32 m0, s72, 22528
  s_add_u32 s71, s70, 114688
  buffer_load_dwordx4 v26, s[48:51], s71 offen lds
  s_add_u32 m0, s72, 23552
  s_add_u32 s71, s70, 638976
  buffer_load_dwordx4 v26, s[48:51], s71 offen lds
  s_waitcnt vmcnt(8) lgkmcnt(0)
  s_barrier
  s_xor_b32 s70, s13, 2
  s_lshl_b32 s70, s70, 20
  s_add_u32 m0, s72, 0
  s_add_u32 s71, s70, 0
  buffer_load_dwordx4 v26, s[52:55], s71 offen lds
  ds_read_b64_tr_b16 a[48:49], v28 offset:8192
  ds_read_b64_tr_b16 a[50:51], v28 offset:10240
  ds_read_b64_tr_b16 a[52:53], v28 offset:12288
  s_add_u32 m0, s72, 1024
  s_add_u32 s71, s70, 524288
  buffer_load_dwordx4 v26, s[52:55], s71 offen lds
  ds_read_b64_tr_b16 a[54:55], v28 offset:14336
  ds_read_b64_tr_b16 a[56:57], v29 offset:8192
  ds_read_b64_tr_b16 a[58:59], v29 offset:10240
  s_add_u32 m0, s72, 2048
  s_add_u32 s71, s70, 65536
  buffer_load_dwordx4 v26, s[52:55], s71 offen lds
  ds_read_b64_tr_b16 a[60:61], v29 offset:12288
  ds_read_b64_tr_b16 a[62:63], v29 offset:14336
  s_waitcnt lgkmcnt(4)
  s_add_u32 m0, s72, 3072
  s_add_u32 s71, s70, 589824
  buffer_load_dwordx4 v26, s[52:55], s71 offen lds
  ds_read_b64_tr_b16 a[64:65], v30 offset:8192
  ds_read_b64_tr_b16 a[66:67], v30 offset:10240
  ds_read_b64_tr_b16 a[68:69], v30 offset:12288
  s_add_u32 m0, s72, 4096
  s_add_u32 s71, s70, 16384
  buffer_load_dwordx4 v26, s[52:55], s71 offen lds
  ds_read_b64_tr_b16 a[70:71], v30 offset:14336
  ds_read_b64_tr_b16 a[72:73], v31 offset:8192
  ds_read_b64_tr_b16 a[74:75], v31 offset:10240
  s_add_u32 m0, s72, 5120
  s_add_u32 s71, s70, 540672
  buffer_load_dwordx4 v26, s[52:55], s71 offen lds
  ds_read_b64_tr_b16 a[76:77], v31 offset:12288
  ds_read_b64_tr_b16 a[78:79], v31 offset:14336
  s_add_u32 m0, s72, 6144
  s_add_u32 s71, s70, 81920
  buffer_load_dwordx4 v26, s[52:55], s71 offen lds
  s_add_u32 m0, s72, 7168
  s_add_u32 s71, s70, 606208
  buffer_load_dwordx4 v26, s[52:55], s71 offen lds
  s_waitcnt vmcnt(8) lgkmcnt(0)
  s_barrier
  s_xor_b32 s70, s13, 2
  s_lshl_b32 s70, s70, 20
  s_add_u32 m0, s72, 8192
  s_add_u32 s71, s70, 32768
  buffer_load_dwordx4 v26, s[52:55], s71 offen lds
  ds_read_b64_tr_b16 a[96:97], v28 offset:16384
  ds_read_b64_tr_b16 a[98:99], v28 offset:18432
  ds_read_b64_tr_b16 a[100:101], v28 offset:20480
  s_add_u32 m0, s72, 9216
  s_add_u32 s71, s70, 557056
  buffer_load_dwordx4 v26, s[52:55], s71 offen lds
  ds_read_b64_tr_b16 a[102:103], v28 offset:22528
  ds_read_b64_tr_b16 a[104:105], v29 offset:16384
  ds_read_b64_tr_b16 a[106:107], v29 offset:18432
  s_add_u32 m0, s72, 10240
  s_add_u32 s71, s70, 98304
  buffer_load_dwordx4 v26, s[52:55], s71 offen lds
  ds_read_b64_tr_b16 a[108:109], v29 offset:20480
  ds_read_b64_tr_b16 a[110:111], v29 offset:22528
  s_waitcnt lgkmcnt(4)
  s_add_u32 m0, s72, 11264
  s_add_u32 s71, s70, 622592
  buffer_load_dwordx4 v26, s[52:55], s71 offen lds
  ds_read_b64_tr_b16 a[112:113], v30 offset:16384
  ds_read_b64_tr_b16 a[114:115], v30 offset:18432
  ds_read_b64_tr_b16 a[116:117], v30 offset:20480
  s_add_u32 m0, s72, 12288
  s_add_u32 s71, s70, 49152
  buffer_load_dwordx4 v26, s[52:55], s71 offen lds
  ds_read_b64_tr_b16 a[118:119], v30 offset:22528
  ds_read_b64_tr_b16 a[120:121], v31 offset:16384
  ds_read_b64_tr_b16 a[122:123], v31 offset:18432
  s_add_u32 m0, s72, 13312
  s_add_u32 s71, s70, 573440
  buffer_load_dwordx4 v26, s[52:55], s71 offen lds
  ds_read_b64_tr_b16 a[124:125], v31 offset:20480
  ds_read_b64_tr_b16 a[126:127], v31 offset:22528
  s_add_u32 m0, s72, 14336
  s_add_u32 s71, s70, 114688
  buffer_load_dwordx4 v26, s[52:55], s71 offen lds
  s_add_u32 m0, s72, 15360
  s_add_u32 s71, s70, 638976
  buffer_load_dwordx4 v26, s[52:55], s71 offen lds
  buffer_load_dword v0, v12, s[36:39], 0 offen sc1
  s_waitcnt vmcnt(9) lgkmcnt(0)
  s_barrier
  s_xor_b32 s70, s13, 0
  s_lshl_b32 s70, s70, 20
  s_add_u32 m0, s72, 16384
  s_add_u32 s71, s70, 0
  buffer_load_dwordx4 v26, s[48:51], s71 offen lds
  ds_read_b64_tr_b16 v[224:225], v28 offset:0
  ds_read_b64_tr_b16 v[226:227], v28 offset:2048
  ds_read_b64_tr_b16 v[228:229], v28 offset:4096
  s_add_u32 m0, s72, 17408
  s_add_u32 s71, s70, 524288
  buffer_load_dwordx4 v26, s[48:51], s71 offen lds
  ds_read_b64_tr_b16 v[230:231], v28 offset:6144
  ds_read_b64_tr_b16 v[232:233], v29 offset:0
  ds_read_b64_tr_b16 v[234:235], v29 offset:2048
  s_add_u32 m0, s72, 18432
  s_add_u32 s71, s70, 65536
  buffer_load_dwordx4 v26, s[48:51], s71 offen lds
  ds_read_b64_tr_b16 v[236:237], v29 offset:4096
  ds_read_b64_tr_b16 v[238:239], v29 offset:6144
  s_waitcnt lgkmcnt(4)
  s_add_u32 m0, s72, 19456
  s_add_u32 s71, s70, 589824
  buffer_load_dwordx4 v26, s[48:51], s71 offen lds
  ds_read_b64_tr_b16 v[240:241], v30 offset:0
  ds_read_b64_tr_b16 v[242:243], v30 offset:2048
  ds_read_b64_tr_b16 v[244:245], v30 offset:4096
  s_add_u32 m0, s72, 20480
  s_add_u32 s71, s70, 16384
  buffer_load_dwordx4 v26, s[48:51], s71 offen lds
  ds_read_b64_tr_b16 v[246:247], v30 offset:6144
  ds_read_b64_tr_b16 v[248:249], v31 offset:0
  ds_read_b64_tr_b16 v[250:251], v31 offset:2048
  s_add_u32 m0, s72, 21504
  s_add_u32 s71, s70, 540672
  buffer_load_dwordx4 v26, s[48:51], s71 offen lds
  ds_read_b64_tr_b16 v[252:253], v31 offset:4096
  ds_read_b64_tr_b16 v[254:255], v31 offset:6144
  s_add_u32 m0, s72, 22528
  s_add_u32 s71, s70, 81920
  buffer_load_dwordx4 v26, s[48:51], s71 offen lds
  s_add_u32 m0, s72, 23552
  s_add_u32 s71, s70, 606208
  buffer_load_dwordx4 v26, s[48:51], s71 offen lds
  s_waitcnt vmcnt(8) lgkmcnt(0)
  s_barrier
  s_xor_b32 s70, s13, 0
  s_lshl_b32 s70, s70, 20
  s_add_u32 m0, s72, 0
  s_add_u32 s71, s70, 0
  buffer_load_dwordx4 v26, s[52:55], s71 offen lds
  ds_read_b64_tr_b16 a[0:1], v28 offset:8192
  ds_read_b64_tr_b16 a[2:3], v28 offset:10240
  ds_read_b64_tr_b16 a[4:5], v28 offset:12288
  s_add_u32 m0, s72, 1024
  s_add_u32 s71, s70, 524288
  buffer_load_dwordx4 v26, s[52:55], s71 offen lds
  ds_read_b64_tr_b16 a[6:7], v28 offset:14336
  ds_read_b64_tr_b16 a[8:9], v29 offset:8192
  ds_read_b64_tr_b16 a[10:11], v29 offset:10240
  s_add_u32 m0, s72, 2048
  s_add_u32 s71, s70, 65536
  buffer_load_dwordx4 v26, s[52:55], s71 offen lds
  ds_read_b64_tr_b16 a[12:13], v29 offset:12288
  ds_read_b64_tr_b16 a[14:15], v29 offset:14336
  s_waitcnt lgkmcnt(4)
  s_add_u32 m0, s72, 3072
  s_add_u32 s71, s70, 589824
  buffer_load_dwordx4 v26, s[52:55], s71 offen lds
  ds_read_b64_tr_b16 a[16:17], v30 offset:8192
  ds_read_b64_tr_b16 a[18:19], v30 offset:10240
  ds_read_b64_tr_b16 a[20:21], v30 offset:12288
  s_add_u32 m0, s72, 4096
  s_add_u32 s71, s70, 16384
  buffer_load_dwordx4 v26, s[52:55], s71 offen lds
  ds_read_b64_tr_b16 a[22:23], v30 offset:14336
  ds_read_b64_tr_b16 a[24:25], v31 offset:8192
  ds_read_b64_tr_b16 a[26:27], v31 offset:10240
  s_add_u32 m0, s72, 5120
  s_add_u32 s71, s70, 540672
  buffer_load_dwordx4 v26, s[52:55], s71 offen lds
  ds_read_b64_tr_b16 a[28:29], v31 offset:12288
  ds_read_b64_tr_b16 a[30:31], v31 offset:14336
  s_add_u32 m0, s72, 6144
  s_add_u32 s71, s70, 81920
  buffer_load_dwordx4 v26, s[52:55], s71 offen lds
  s_add_u32 m0, s72, 7168
  s_add_u32 s71, s70, 606208
  buffer_load_dwordx4 v26, s[52:55], s71 offen lds
  s_waitcnt vmcnt(8) lgkmcnt(0)
  s_barrier
  s_xor_b32 s70, s13, 0
  s_lshl_b32 s70, s70, 20
  s_add_u32 m0, s72, 8192
  s_add_u32 s71, s70, 32768
  buffer_load_dwordx4 v26, s[48:51], s71 offen lds
  ds_read_b64_tr_b16 v[56:57], v28 offset:16384
  ds_read_b64_tr_b16 v[58:59], v28 offset:18432
  ds_read_b64_tr_b16 v[60:61], v28 offset:20480
  s_add_u32 m0, s72, 9216
  s_add_u32 s71, s70, 557056
  buffer_load_dwordx4 v26, s[48:51], s71 offen lds
  ds_read_b64_tr_b16 v[62:63], v28 offset:22528
  ds_read_b64_tr_b16 v[64:65], v29 offset:16384
  ds_read_b64_tr_b16 v[66:67], v29 offset:18432
  s_add_u32 m0, s72, 10240
  s_add_u32 s71, s70, 98304
  buffer_load_dwordx4 v26, s[48:51], s71 offen lds
  ds_read_b64_tr_b16 v[68:69], v29 offset:20480
  ds_read_b64_tr_b16 v[70:71], v29 offset:22528
  s_waitcnt lgkmcnt(4)
  s_add_u32 m0, s72, 11264
  s_add_u32 s71, s70, 622592
  buffer_load_dwordx4 v26, s[48:51], s71 offen lds
  ds_read_b64_tr_b16 a[32:33], v30 offset:16384
  ds_read_b64_tr_b16 a[34:35], v30 offset:18432
  ds_read_b64_tr_b16 a[36:37], v30 offset:20480
  s_add_u32 m0, s72, 12288
  s_add_u32 s71, s70, 49152
  buffer_load_dwordx4 v26, s[48:51], s71 offen lds
  ds_read_b64_tr_b16 a[38:39], v30 offset:22528
  ds_read_b64_tr_b16 a[40:41], v31 offset:16384
  ds_read_b64_tr_b16 a[42:43], v31 offset:18432
  s_add_u32 m0, s72, 13312
  s_add_u32 s71, s70, 573440
  buffer_load_dwordx4 v26, s[48:51], s71 offen lds
  ds_read_b64_tr_b16 a[44:45], v31 offset:20480
  ds_read_b64_tr_b16 a[46:47], v31 offset:22528
  s_add_u32 m0, s72, 14336
  s_add_u32 s71, s70, 114688
  buffer_load_dwordx4 v26, s[48:51], s71 offen lds
  s_add_u32 m0, s72, 15360
  s_add_u32 s71, s70, 638976
  buffer_load_dwordx4 v26, s[48:51], s71 offen lds
L_rdy_3:
  v_readlane_b32 s24, v0, 8
  v_readlane_b32 s73, v0, 0
  s_cmp_ge_u32 s24, 1
  s_cbranch_scc1 L_rdyx_4
  s_sub_u32 s33, s33, 1
  s_cbranch_scc1 L_done
  s_sleep 8
  buffer_load_dword v0, v12, s[36:39], 0 offen sc1
  s_waitcnt vmcnt(0)
  s_branch L_rdy_3
L_rdyx_4:
  s_cmp_ge_u32 s73, 32
  s_cbranch_scc1 L_rdyx_4_f
  v_lshrrev_b32 v0, 4, v2
  v_and_b32 v33, 15, v0
  v_lshl_add_u32 v32, v33, 2, 64
  v_cmp_eq_u32 vcc, 0, v33
  s_nop 1
  v_cndmask_b32 v32, v32, 0, vcc
  buffer_load_dword v34, v32, s[36:39], 0 offen sc1
L_cen_5:
  v_cmp_gt_u32 vcc, s82, v33
  s_waitcnt vmcnt(0)
  s_nop 0
  v_cndmask_b32 v35, 0, v34, vcc
  v_add_u32_dpp v34, v34, v34 row_ror:8 row_mask:0xf bank_mask:0xf
  s_nop 0
  v_add_u32_dpp v35, v35, v35 row_ror:8 row_mask:0xf bank_mask:0xf
  v_add_u32_dpp v34, v34, v34 row_ror:4 row_mask:0xf bank_mask:0xf
  s_nop 0
  v_add_u32_dpp v35, v35, v35 row_ror:4 row_mask:0xf bank_mask:0xf
  v_add_u32_dpp v34, v34, v34 row_ror:2 row_mask:0xf bank_mask:0xf
  s_nop 0
  v_add_u32_dpp v35, v35, v35 row_ror:2 row_mask:0xf bank_mask:0xf
  v_add_u32_dpp v34, v34, v34 row_ror:1 row_mask:0xf bank_mask:0xf
  s_nop 0
  v_add_u32_dpp v35, v35, v35 row_ror:1 row_mask:0xf bank_mask:0xf
  v_readfirstlane_b32 s24, v34
  v_readfirstlane_b32 s25, v35
  s_cmp_ge_u32 s24, 256
  s_cbranch_scc1 L_cen_5_x
  s_sub_u32 s33, s33, 1
  s_cbranch_scc1 L_done
  s_sleep 8
  buffer_load_dword v34, v32, s[36:39], 0 offen sc1
  s_branch L_cen_5
L_cen_5_x:
  s_add_u32 s25, s25, s83
  buffer_load_dword v0, v12, s[36:39], 0 offen sc1
  s_waitcnt vmcnt(0)
  v_readlane_b32 s73, v0, 0
L_rdyx_4_f:
  v_lshlrev_b32 v12, 3, v2
  s_lshl_b32 s24, s13, 13
  s_add_u32 s24, s24, 1048576
  buffer_load_dword v0, v12, s[4:7], s24 offen sc1
  v_lshlrev_b32 v12, 1, v2
  buffer_load_dword v0, v12, s[4:7], s22 offen sc1
  v_lshrrev_b32 v12, 2, v2
  buffer_load_dword v0, v12, s[4:7], s32 offen sc1
  s_waitcnt vmcnt(11) lgkmcnt(0)
  s_barrier
  s_xor_b32 s70, s13, 0
  s_lshl_b32 s70, s70, 20
  s_add_u32 m0, s72, 16384
  s_add_u32 s71, s70, 32768
  buffer_load_dwordx4 v26, s[52:55], s71 offen lds
  ds_read_b64_tr_b16 v[72:73], v28 offset:0
  ds_read_b64_tr_b16 v[74:75], v28 offset:2048
  ds_read_b64_tr_b16 v[76:77], v28 offset:4096
  s_add_u32 m0, s72, 17408
  s_add_u32 s71, s70, 557056
  buffer_load_dwordx4 v26, s[52:55], s71 offen lds
  ds_read_b64_tr_b16 v[78:79], v28 offset:6144
  ds_read_b64_tr_b16 v[80:81], v29 offset:0
  ds_read_b64_tr_b16 v[82:83], v29 offset:2048
  s_add_u32 m0, s72, 18432
  s_add_u32 s71, s70, 98304
  buffer_load_dwordx4 v26, s[52:55], s71 offen lds
  ds_read_b64_tr_b16 v[84:85], v29 offset:4096
  ds_read_b64_tr_b16 v[86:87], v29 offset:6144
  s_waitcnt lgkmcnt(4)
  s_add_u32 m0, s72, 19456
  s_add_u32 s71, s70, 622592
  buffer_load_dwordx4 v26, s[52:55], s71 offen lds
  ds_read_b64_tr_b16 v[88:89], v30 offset:0
  ds_read_b64_tr_b16 v[90:91], v30 offset:2048
  ds_read_b64_tr_b16 v[92:93], v30 offset:4096
  s_add_u32 m0, s72, 20480
  s_add_u32 s71, s70, 49152
  buffer_load_dwordx4 v26, s[52:55], s71 offen lds
  ds_read_b64_tr_b16 v[94:95], v30 offset:6144
  ds_read_b64_tr_b16 v[96:97], v31 offset:0
  ds_read_b64_tr_b16 v[98:99], v31 offset:2048
  s_add_u32 m0, s72, 21504
  s_add_u32 s71, s70, 573440
  buffer_load_dwordx4 v26, s[52:55], s71 offen lds
  ds_read_b64_tr_b16 v[100:101], v31 offset:4096
  ds_read_b64_tr_b16 v[102:103], v31 offset:6144
  s_add_u32 m0, s72, 22528
  s_add_u32 s71, s70, 114688
  buffer_load_dwordx4 v26, s[52:55], s71 offen lds
  s_add_u32 m0, s72, 23552
  s_add_u32 s71, s70, 638976
  buffer_load_dwordx4 v26, s[52:55], s71 offen lds
  s_waitcnt vmcnt(8) lgkmcnt(0)
  s_barrier
L_kv01_6:
  v_cmp_ne_u32 vcc, 0, v0
  s_and_b32 vcc_lo, vcc_lo, 3
  s_cmp_eq_u32 vcc_lo, 3
  s_cbranch_scc1 L_kv01_6_x
  s_sub_u32 s33, s33, 1
  s_cbranch_scc1 L_done
  buffer_load_dword v0, v12, s[4:7], s32 offen sc1
  s_waitcnt vmcnt(0)
  s_branch L_kv01_6
L_kv01_6_x:
  buffer_load_dwordx4 v[48:51], v2, s[4:7], s15 offen sc1
  buffer_load_dwordx4 v[52:55], v2, s[4:7], s23 offen sc1
  buffer_load_dwordx4 v[40:43], v2, s[4:7], s30 offen offset:0 sc1
  buffer_load_dwordx4 v[44:47], v2, s[4:7], s30 offen offset:1024 sc1
  buffer_load_dwordx4 v[32:35], v2, s[4:7], s65 offen offset:0 sc1
  buffer_load_dwordx4 v[36:39], v2, s[4:7], s65 offen offset:1024 sc1
  ds_write_b128 v6, v[56:59] offset:0
  ds_write_b128 v6, v[60:63] offset:1024
  ds_write_b128 v6, v[64:67] offset:2048
  ds_write_b128 v6, v[68:71] offset:3072
  ds_write_b128 v6, v[72:75] offset:4096
  ds_write_b128 v6, v[76:79] offset:5120
  ds_write_b128 v6, v[80:83] offset:6144
  ds_write_b128 v6, v[84:87] offset:7168
  s_waitcnt lgkmcnt(0)
  ds_read_b64_tr_b16 v[104:105], v28 offset:8192
  ds_read_b64_tr_b16 v[106:107], v28 offset:10240
  ds_read_b64_tr_b16 v[108:109], v28 offset:12288
  ds_read_b64_tr_b16 v[110:111], v28 offset:14336
  ds_read_b64_tr_b16 v[112:113], v29 offset:8192
  ds_read_b64_tr_b16 v[114:115], v29 offset:10240
  ds_read_b64_tr_b16 v[116:117], v29 offset:12288
  ds_read_b64_tr_b16 v[118:119], v29 offset:14336
  s_waitcnt lgkmcnt(4)
  ds_read_b64_tr_b16 a[80:81], v30 offset:8192
  ds_read_b64_tr_b16 a[82:83], v30 offset:10240
  ds_read_b64_tr_b16 a[84:85], v30 offset:12288
  ds_read_b64_tr_b16 a[86:87], v30 offset:14336
  ds_read_b64_tr_b16 a[88:89], v31 offset:8192
  ds_read_b64_tr_b16 a[90:91], v31 offset:10240
  ds_read_b64_tr_b16 a[92:93], v31 offset:12288
  ds_read_b64_tr_b16 a[94:95], v31 offset:14336
  s_waitcnt vmcnt(6) lgkmcnt(0)
  s_barrier
  ds_read_b64_tr_b16 v[120:121], v28 offset:16384
  ds_read_b64_tr_b16 v[122:123], v28 offset:18432
  ds_read_b64_tr_b16 v[124:125], v28 offset:20480
  ds_read_b64_tr_b16 v[126:127], v28 offset:22528
  ds_read_b64_tr_b16 v[128:129], v29 offset:16384
  ds_read_b64_tr_b16 v[130:131], v29 offset:18432
  ds_read_b64_tr_b16 v[132:133], v29 offset:20480
  ds_read_b64_tr_b16 v[134:135], v29 offset:22528
  s_waitcnt lgkmcnt(4)
  ds_read_b64_tr_b16 v[136:137], v30 offset:16384
  ds_read_b64_tr_b16 v[138:139], v30 offset:18432
  ds_read_b64_tr_b16 v[140:141], v30 offset:20480
  ds_read_b64_tr_b16 v[142:143], v30 offset:22528
  ds_read_b64_tr_b16 v[56:57], v31 offset:16384
  ds_read_b64_tr_b16 v[58:59], v31 offset:18432
  ds_read_b64_tr_b16 v[60:61], v31 offset:20480
  ds_read_b64_tr_b16 v[62:63], v31 offset:22528
  s_waitcnt lgkmcnt(6)
  ds_write_b128 v6, v[88:91] offset:8192
  ds_write_b128 v6, v[92:95] offset:9216
  ds_write_b128 v6, v[96:99] offset:10240
  ds_write_b128 v6, v[100:103] offset:11264
  ds_write_b128 v6, v[104:107] offset:12288
  ds_write_b128 v6, v[108:111] offset:13312
  ds_write_b128 v6, v[112:115] offset:14336
  ds_write_b128 v6, v[116:119] offset:15360
  s_add_u32 s30, s30, 524288
  s_add_u32 s65, s65, 524288
  s_waitcnt lgkmcnt(0)
  s_barrier
  ds_write_b128 v6, v[120:123] offset:16384
  ds_write_b128 v6, v[124:127] offset:17408
  ds_write_b128 v6, v[128:131] offset:18432
  ds_write_b128 v6, v[132:135] offset:19456
  ds_write_b128 v6, v[136:139] offset:20480
  ds_write_b128 v6, v[140:143] offset:21504
  ds_write_b128 v6, v[56:59] offset:22528
  ds_write_b128 v6, v[60:63] offset:23552
  s_xor_b32 s24, s40, 1024
  v_add_u32 v25, s24, v2
  s_xor_b32 s24, s40, 2048
  v_add_u32 v26, s24, v2
  s_xor_b32 s24, s40, 3072
  v_add_u32 v27, s24, v2
  v_lshrrev_b32 v12, 2, v2
  v_add_u32 v14, s40, v2
  s_mov_b32 s91, 1
  s_waitcnt lgkmcnt(0)
  ds_read_b128 v[56:59], v6 offset:0
  ds_read_b128 v[60:63], v6 offset:1024
  ds_read_b128 v[64:67], v6 offset:2048
  ds_read_b128 v[68:71], v6 offset:3072
  ds_read_b128 v[72:75], v6 offset:4096
  ds_read_b128 v[76:79], v6 offset:5120
  ds_read_b128 v[104:107], v6 offset:6144
  ds_read_b128 v[108:111], v6 offset:7168
  s_waitcnt lgkmcnt(4)
  ds_read_b128 v[112:115], v6 offset:12288
  ds_read_b128 v[116:119], v6 offset:13312
  ds_read_b128 v[120:123], v6 offset:14336
  ds_read_b128 v[124:127], v6 offset:15360
  ds_read_b128 v[128:131], v6 offset:16384
  ds_read_b128 v[132:135], v6 offset:17408
  ds_read_b128 v[136:139], v6 offset:18432
  ds_read_b128 v[140:143], v6 offset:19456
  v_mov_b64 v[80:81], 0
  v_mov_b64 v[82:83], 0
  v_mov_b64 v[84:85], 0
  v_mov_b64 v[86:87], 0
  v_mov_b64 v[88:89], 0
  v_mov_b64 v[90:91], 0
  v_mov_b64 v[92:93], 0
  v_mov_b64 v[94:95], 0
  v_mov_b64 v[96:97], 0
  v_mov_b64 v[98:99], 0
  v_mov_b64 v[100:101], 0
  v_mov_b64 v[102:103], 0
  s_waitcnt vmcnt(4) lgkmcnt(0)
  s_cmp_ge_u32 s73, 32
  s_cbranch_scc0 L_Aslow
  s_cmp_eq_u32 s13, 1
  s_cbranch_scc1 L_wave1_8
  s_cmp_eq_u32 s13, 2
  s_cbranch_scc1 L_wave2_9
  s_cmp_eq_u32 s13, 3
  s_cbranch_scc1 L_wave3_10
L_wave0_7:
  s_branch L_got_12
  s_nop 0
  s_nop 0
  s_nop 0
  s_nop 0
  s_nop 0
  s_nop 0
  s_nop 0
L_top_11:
  s_barrier
  v_mov_b64 v[32:33], v[128:129]
  v_mov_b64 v[34:35], v[130:131]
  v_mov_b64 v[36:37], v[132:133]
  v_mov_b64 v[38:39], v[134:135]
  ds_read_b128 v[128:131], v6 offset:16384
  buffer_load_dwordx4 v[48:51], v2, s[4:7], s15 offen sc1
  ds_read_b128 v[132:135], v6 offset:17408
  v_mov_b64 v[40:41], v[136:137]
  v_mov_b64 v[42:43], v[138:139]
  v_mov_b64 v[44:45], v[140:141]
  v_mov_b64 v[46:47], v[142:143]
  ds_read_b128 v[136:139], v6 offset:18432
  ds_read_b128 v[140:143], v6 offset:19456
  buffer_load_dwordx4 v[52:55], v2, s[4:7], s23 offen sc1
  v_mov_b64 v[80:81], 0
  v_mov_b64 v[82:83], 0
  v_mov_b64 v[84:85], 0
  v_mov_b64 v[86:87], 0
  v_mov_b64 v[88:89], 0
  v_mov_b64 v[90:91], 0
  v_mov_b64 v[92:93], 0
  v_mov_b64 v[94:95], 0
  v_mov_b64_e64 v[96:97], 0
  v_mov_b64_e64 v[98:99], 0
  v_mov_b64_e64 v[100:101], 0
  v_mov_b64_e64 v[102:103], 0
  v_add_u32_e64 v14, s40, v2
  v_xor_b32 v16, 0x40004000, v16
  buffer_load_dwordx4 v[48:51], v2, s[4:7], s15 offen sc1
  v_xor_b32 v17, 0x40004000, v17
  v_xor_b32 v18, 0x40004000, v18
  v_xor_b32 v19, 0x40004000, v19
  s_xor_b32 s89, s89, 0x40004000
  s_nop 5
  buffer_load_dwordx4 v[52:55], v2, s[4:7], s23 offen sc1
  s_waitcnt lgkmcnt(0)
L_got_12_w:
  s_waitcnt vmcnt(3)
L_got_12:
  v_cmp_eq_u32_e64 vcc, -1, v51
  v_smfmac_f32_16x16x64_bf16 v[88:91], v[48:51], v[56:63], v1
  ds_write_b128 v14, v[48:51] offset:0
  v_smfmac_f32_16x16x64_bf16 v[92:95], v[48:51], v[64:71], v1
  s_cbranch_vccnz L_re_16
  s_waitcnt vmcnt(2)
  v_cmp_eq_u32_e64 vcc, -1, v55
  v_smfmac_f32_16x16x64_bf16 v[80:83], v[48:51], v[72:79], v1
  v_smfmac_f32_16x16x64_bf16 v[84:87], v[48:51], v[104:111], v1
  s_cbranch_vccnz L_rl_17
L_rl_17_b:
  v_smfmac_f32_16x16x64_bf16 v[88:91], v[52:55], v[112:119], v1
  ds_write_b128 v14, v[52:55] offset:4096
  v_smfmac_f32_16x16x64_bf16 v[92:95], v[52:55], v[120:127], v1
  s_waitcnt lgkmcnt(1)
  s_barrier
  ds_read_b128 v[56:59], v25 offset:0
  v_smfmac_f32_16x16x64_bf16 v[80:83], v[52:55], v[128:135], v1
  ds_read_b128 v[60:63], v26 offset:0
  v_smfmac_f32_16x16x64_bf16 v[84:87], v[52:55], v[136:143], v1
  ds_read_b128 v[64:67], v27 offset:0
  buffer_load_dwordx4 v[136:139], v2, s[4:7], s30 offen offset:0 sc1
  s_waitcnt lgkmcnt(2)
  v_smfmac_f32_16x16x64_bf16 v[88:91], v[56:59], a[32:39], v1
  s_barrier
  v_smfmac_f32_16x16x64_bf16 v[92:95], v[56:59], a[40:47], v1
  ds_read_b128 v[68:71], v25 offset:4096
  s_waitcnt lgkmcnt(2)
  v_smfmac_f32_16x16x64_bf16 v[88:91], v[60:63], a[48:55], v1
  ds_read_b128 v[72:75], v26 offset:4096
  v_smfmac_f32_16x16x64_bf16 v[92:95], v[60:63], a[56:63], v1
  ds_read_b128 v[76:79], v27 offset:4096
  s_waitcnt lgkmcnt(3)
  v_smfmac_f32_16x16x64_bf16 v[88:91], v[64:67], a[64:71], v1
  ds_read_b128 v[104:107], v6 offset:8192
  v_smfmac_f32_16x16x64_bf16 v[92:95], v[64:67], a[72:79], v1
  ds_read_b128 v[108:111], v6 offset:9216
  s_waitcnt lgkmcnt(4)
  v_smfmac_f32_16x16x64_bf16 v[88:91], v[68:71], a[80:87], v1
  ds_read_b128 v[112:115], v6 offset:10240
  v_smfmac_f32_16x16x64_bf16 v[92:95], v[68:71], a[88:95], v1
  ds_read_b128 v[116:119], v6 offset:11264
  s_waitcnt lgkmcnt(4)
  v_smfmac_f32_16x16x64_bf16 v[88:91], v[72:75], a[96:103], v1
  buffer_load_dwordx4 v[140:143], v2, s[4:7], s30 offen offset:1024 sc1
  v_smfmac_f32_16x16x64_bf16 v[88:91], v[76:79], a[112:119], v1
  s_nop 0
  ds_read_b128 v[120:123], v6 offset:20480
  v_smfmac_f32_16x16x64_bf16 v[92:95], v[72:75], a[104:111], v1
  buffer_load_dwordx4 v[128:131], v2, s[4:7], s65 offen offset:0 sc1
  v_smfmac_f32_16x16x64_bf16 v[92:95], v[76:79], a[120:127], v1
  s_waitcnt lgkmcnt(1)
  s_nop 1
  v_add_f32 v88, v88, v89
  v_smfmac_f32_16x16x64_bf16 v[80:83], v[56:59], v[104:111], v1
  ds_read_b128 v[124:127], v6 offset:21504
  v_add_f32 v90, v90, v91
  v_smfmac_f32_16x16x64_bf16 v[84:87], v[56:59], v[112:119], v1
  ds_read_b128 v[104:107], v6 offset:22528
  v_add_f32 v92, v92, v93
  v_smfmac_f32_16x16x64_bf16 v[80:83], v[60:63], v[224:231], v1
  ds_read_b128 v[108:111], v6 offset:23552
  v_add_f32 v94, v94, v95
  v_smfmac_f32_16x16x64_bf16 v[84:87], v[60:63], v[232:239], v1
  v_cvt_pk_bf16_f32 v28, v88, v92
  v_cvt_pk_bf16_f32 v29, v90, v94
  v_smfmac_f32_16x16x64_bf16 v[80:83], v[64:67], v[240:247], v1
  ds_write_b64 v7, v[28:29] offset:8192
  v_smfmac_f32_16x16x64_bf16 v[84:87], v[64:67], v[248:255], v1
  buffer_store_dword v15, v24, s[4:7], s31 offen sc1
  v_smfmac_f32_16x16x64_bf16 v[80:83], v[72:75], a[0:7], v1
  ds_read_b128 v[112:115], v6 offset:24576
  v_smfmac_f32_16x16x64_bf16 v[84:87], v[72:75], a[8:15], v1
  ds_read_b128 v[116:119], v6 offset:25600
  s_waitcnt lgkmcnt(3)
  v_smfmac_f32_16x16x64_bf16 v[80:83], v[68:71], v[120:127], v1
  s_waitcnt lgkmcnt(2)
  s_barrier
  v_smfmac_f32_16x16x64_bf16 v[80:83], v[76:79], a[16:23], v1
  s_nop 0
  ds_read_b64_tr_b16 v[88:89], v8 offset:8192
  v_smfmac_f32_16x16x64_bf16 v[84:87], v[68:71], v[104:111], v1
  ds_read_b64_tr_b16 v[90:91], v8 offset:8704
  v_smfmac_f32_16x16x64_bf16 v[84:87], v[76:79], a[24:31], v1
  ds_read_b64_tr_b16 v[92:93], v8 offset:9216
  v_smfmac_f32_16x16x64_bf16 v[96:99], v[48:51], a[128:135], v1
  ds_read_b64_tr_b16 v[94:95], v8 offset:9728
  v_add_f32 v80, v80, v81
  v_smfmac_f32_16x16x64_bf16 v[100:103], v[48:51], a[136:143], v1
  ds_read_b128 v[120:123], v6 offset:26624
  v_add_f32 v82, v82, v83
  v_smfmac_f32_16x16x64_bf16 v[96:99], v[52:55], a[144:151], v1
  v_add_f32 v84, v84, v85
  v_add_f32 v86, v86, v87
  v_cvt_pk_bf16_f32 v22, v80, v84
  v_cvt_pk_bf16_f32 v23, v82, v86
  v_smfmac_f32_16x16x64_bf16 v[100:103], v[52:55], a[152:159], v1
  ds_write_b64 v7, v[22:23] offset:10240
  s_waitcnt lgkmcnt(2)
  v_mfma_f32_16x16x32_bf16 v[28:31], v[40:43], v[88:91], 0
  buffer_load_dwordx4 v[132:135], v2, s[4:7], s65 offen offset:1024 sc1
  v_mfma_f32_16x16x32_bf16 v[28:31], v[44:47], v[92:95], v[28:31]
  s_nop 0
  ds_read_b128 v[124:127], v6 offset:27648
  v_smfmac_f32_16x16x64_bf16 v[96:99], v[56:59], a[160:167], v1
  buffer_load_dword v0, v12, s[4:7], s32 offen sc1
  v_smfmac_f32_16x16x64_bf16 v[100:103], v[56:59], a[168:175], v1
  s_waitcnt lgkmcnt(1)
  s_barrier
  s_nop 0
  v_add_f32_dpp v14, v29, v28 quad_perm:[1,1,3,3] row_mask:0xf bank_mask:0xf
  v_smfmac_f32_16x16x64_bf16 v[96:99], v[60:63], a[176:183], v1
  ds_read_b64_tr_b16 v[80:81], v8 offset:10240
  v_add_f32_dpp v15, v31, v30 quad_perm:[1,1,3,3] row_mask:0xf bank_mask:0xf
  v_smfmac_f32_16x16x64_bf16 v[100:103], v[60:63], a[184:191], v1
  ds_read_b64_tr_b16 v[82:83], v8 offset:10752
  v_exp_f32 v28, v14
  v_smfmac_f32_16x16x64_bf16 v[96:99], v[64:67], a[192:199], v1
  ds_read_b64_tr_b16 v[84:85], v8 offset:11264
  v_exp_f32 v29, v15
  v_smfmac_f32_16x16x64_bf16 v[100:103], v[64:67], a[200:207], v1
  ds_read_b64_tr_b16 v[86:87], v8 offset:11776
  v_cvt_pk_bf16_f32 v30, v28, v29
  v_smfmac_f32_16x16x64_bf16 v[96:99], v[68:71], a[208:215], v1
  ds_write_b32 v13, v30 offset:14336
  v_smfmac_f32_16x16x64_bf16 v[100:103], v[68:71], a[216:223], v1
  ds_read_b128 v[104:107], v6 offset:28672
  s_waitcnt lgkmcnt(2)
  v_mfma_f32_16x16x32_bf16 v[44:47], v[80:83], v[88:91], 0
  ds_read_b128 v[108:111], v6 offset:29696
  v_mfma_f32_16x16x32_bf16 v[44:47], v[84:87], v[92:95], v[44:47]
  s_nop 0
  s_waitcnt vmcnt(6)
  v_mov_b64 v[48:49], 0
  v_smfmac_f32_16x16x64_bf16 v[96:99], v[72:75], a[224:231], v1
  s_waitcnt lgkmcnt(2)
  s_barrier
  v_smfmac_f32_16x16x64_bf16 v[96:99], v[76:79], a[240:247], v1
  ds_read_b128 v[28:31], v9 offset:14336
  v_add_f32_dpp v44, v45, v44 quad_perm:[1,1,3,3] row_mask:0xf bank_mask:0xf
  v_add_f32_dpp v46, v47, v46 quad_perm:[1,1,3,3] row_mask:0xf bank_mask:0xf
  v_smfmac_f32_16x16x64_bf16 v[100:103], v[72:75], a[232:239], v1
  ds_read_b128 v[40:43], v10 offset:14336
  v_mul_f32 v44, s64, v44
  v_mul_f32 v46, s64, v46
  v_smfmac_f32_16x16x64_bf16 v[100:103], v[76:79], a[248:255], v1
  ds_read_b128 v[64:67], v6 offset:30720
  v_add_f32 v96, v96, v97
  v_exp_f32_dpp v45, v44 quad_perm:[0,0,2,2] row_mask:0xf bank_mask:0xf
  v_exp_f32_dpp v47, v46 quad_perm:[0,0,2,2] row_mask:0xf bank_mask:0xf
  s_waitcnt lgkmcnt(2)
  v_mfma_f32_16x16x32_bf16 v[88:91], v[16:19], v[28:31], 0
  v_cvt_pk_bf16_f32 v23, v45, v47
  v_cndmask_b32 v22, 0, v23, s[66:67]
  v_mfma_f32_16x16x32_bf16 v[84:87], v[32:35], v[28:31], 0
  s_waitcnt lgkmcnt(1)
  v_cndmask_b32 v23, v23, 0, s[66:67]
  v_add_f32 v98, v98, v99
  v_mfma_f32_16x16x32_bf16 v[84:87], v[36:39], v[40:43], v[84:87]
  v_add_f32 v100, v100, v101
  v_add_f32 v102, v102, v103
  v_cvt_pk_bf16_f32 v21, v100, v102
  v_cvt_pk_bf16_f32 v20, v96, v98
  v_mfma_f32_16x16x16_bf16 v[88:91], v[16:17], v[22:23], v[88:91]
  v_mov_b64 v[50:51], 0
  v_mov_b64 v[52:53], 0
  v_mfma_f32_16x16x16_bf16 v[84:87], v[20:21], v[22:23], v[84:87]
  v_mov_b64 v[54:55], 0
  v_mov_b64 v[56:57], 0
  v_mov_b64 v[58:59], 0
  v_mov_b64 v[60:61], 0
  v_mov_b64 v[62:63], 0
  v_rcp_f32_dpp v96, v88 quad_perm:[0,0,2,2] row_mask:0xf bank_mask:0xf
  s_nop 0
  v_subrev_u32 v97, s29, v96
  v_cmp_lt_u32 vcc, s90, v97
  v_mul_f32 v84, v84, v96
  v_mul_f32 v85, v85, v96
  v_mul_f32 v86, v86, v96
  v_mul_f32_e64 v87, v87, v96
  v_cvt_pk_bf16_f32 v98, v84, v85
  v_cvt_pk_bf16_f32 v99, v86, v87
  ds_write_b64 v7, v[98:99] offset:12288
  s_cbranch_vccnz L_slow_13
L_back_14:
  v_mov_b32_dpp v80, v98 quad_perm:[0,0,2,2] row_mask:0xf bank_mask:0xf
  v_mov_b32_dpp v81, v99 quad_perm:[0,0,2,2] row_mask:0xf bank_mask:0xf
  v_mov_b32_dpp v82, v98 quad_perm:[1,1,3,3] row_mask:0xf bank_mask:0xf
  v_mov_b32_dpp v83, v99 quad_perm:[1,1,3,3] row_mask:0xf bank_mask:0xf
  s_nop 1
  v_smfmac_f32_16x16x64_bf16 v[48:51], v[80:83], v[144:151], v1
  s_waitcnt lgkmcnt(0)
  s_barrier
  ds_read_b128 v[92:95], v3 offset:12288
  v_smfmac_f32_16x16x64_bf16 v[52:55], v[80:83], v[152:159], v1
  ds_read_b128 v[28:31], v4 offset:12288
  v_smfmac_f32_16x16x64_bf16 v[56:59], v[80:83], v[160:167], v1
  ds_read_b128 v[40:43], v5 offset:12288
  v_smfmac_f32_16x16x64_bf16 v[60:63], v[80:83], v[168:175], v1
  ds_read_b128 v[68:71], v6 offset:31744
  s_waitcnt lgkmcnt(3)
  v_smfmac_f32_16x16x64_bf16 v[48:51], v[92:95], v[176:183], v1
  ds_read_b128 v[72:75], v6 offset:32768
  s_waitcnt lgkmcnt(3)
  v_smfmac_f32_16x16x64_bf16 v[48:51], v[28:31], v[192:199], v1
  ds_read_b128 v[76:79], v6 offset:33792
  s_waitcnt lgkmcnt(3)
  v_smfmac_f32_16x16x64_bf16 v[48:51], v[40:43], v[208:215], v1
  s_nop 0
  ds_read_b128 v[32:35], v6 offset:34816
  v_smfmac_f32_16x16x64_bf16 v[52:55], v[92:95], v[184:191], v1
  s_nop 0
  ds_read_b128 v[36:39], v6 offset:35840
  v_smfmac_f32_16x16x64_bf16 v[52:55], v[28:31], v[200:207], v1
  s_nop 1
  v_cvt_pk_bf16_f32 v96, v48, v49
  v_smfmac_f32_16x16x64_bf16 v[52:55], v[40:43], v[216:223], v1
  s_nop 0
  s_waitcnt lgkmcnt(12)
  v_cvt_pk_bf16_f32 v97, v50, v51
  v_smfmac_f32_16x16x64_bf16 v[56:59], v[92:95], v[112:119], v1
  buffer_store_dwordx2 v[96:97], v11, s[4:7], s18 offen offset:0
  v_smfmac_f32_16x16x64_bf16 v[56:59], v[28:31], v[120:127], v1
  s_nop 1
  v_cvt_pk_bf16_f32 v98, v52, v53
  v_smfmac_f32_16x16x64_bf16 v[56:59], v[40:43], v[104:111], v1
  s_nop 0
  s_waitcnt lgkmcnt(0)
  v_cvt_pk_bf16_f32 v99, v54, v55
  v_smfmac_f32_16x16x64_bf16 v[60:63], v[92:95], v[64:71], v1
  buffer_store_dwordx2 v[98:99], v11, s[4:7], s18 offen offset:2048
  v_smfmac_f32_16x16x64_bf16 v[60:63], v[28:31], v[72:79], v1
  s_nop 1
  v_cvt_pk_bf16_f32 v100, v56, v57
  v_smfmac_f32_16x16x64_bf16 v[60:63], v[40:43], v[32:39], v1
  v_cvt_pk_bf16_f32 v101, v58, v59
  buffer_store_dwordx2 v[100:101], v11, s[4:7], s19 offen offset:0
  s_add_u32 s14, s14, 1
  s_and_b32 s24, s14, 3
  s_lshl_b32 s24, s24, 13
  s_add_u32 s24, s24, 1048576
  v_mov_b32 v15, -1
  s_nop 0
  v_cvt_pk_bf16_f32 v102, v60, v61
  v_cvt_pk_bf16_f32 v103, v62, v63
  buffer_store_dwordx2 v[102:103], v11, s[4:7], s19 offen offset:2048
  buffer_store_dword v15, v24, s[4:7], s28 offen
  ds_read_b128 v[88:91], v2 offset:15360
  v_and_b32 v14, v96, v97
  v_bitop3_b32 v14, v14, v98, v99 bitop3:0x80
  v_bitop3_b32 v14, v14, v100, v101 bitop3:0x80
  v_bitop3_b32 v14, v14, v102, v103 bitop3:0x80
  v_bfi_b32 v14, v14, 0, s89
  v_cmp_lt_u32 vcc, 0xffff, v14
  ds_read_b128 v[56:59], v6 offset:0
  ds_read_b128 v[60:63], v6 offset:1024
  ds_read_b128 v[64:67], v6 offset:2048
  ds_read_b128 v[68:71], v6 offset:3072
  s_cbranch_vccnz L_fix_18
L_fix_18_b:
  ds_read_b128 v[72:75], v6 offset:4096
  ds_read_b128 v[76:79], v6 offset:5120
  ds_read_b128 v[104:107], v6 offset:6144
  ds_read_b128 v[108:111], v6 offset:7168
  ds_read_b128 v[112:115], v6 offset:12288
  ds_read_b128 v[116:119], v6 offset:13312
  ds_read_b128 v[120:123], v6 offset:14336
  ds_read_b128 v[124:127], v6 offset:15360
  s_waitcnt vmcnt(3)
  buffer_load_dwordx4 v[80:83], v2, s[4:7], s22 offen offset:0 sc1
  buffer_load_dwordx4 v[84:87], v2, s[4:7], s22 offen offset:1024 sc1
  s_mov_b32 s28, s17
  s_add_u32 s17, s24, s87
  s_add_u32 s15, s24, s40
  s_add_u32 s23, s24, s16
  s_lshl_b32 s31, s14, 13
  s_add_u32 s31, s31, s87
  s_add_u32 s31, s31, 1310720
  s_xor_b32 s29, s29, 0x40000000
  s_mov_b32 s91, 0
  s_add_u32 s30, s30, 524288
  s_add_u32 s65, s65, 524288
  s_add_u32 s26, s14, 1
  s_and_b32 s26, s26, 63
  s_waitcnt lgkmcnt(12)
  v_bfi_b32 v88, s89, 0, v88
  v_bfi_b32 v89, s89, 0, v89
  v_bfi_b32 v90, s89, 0, v90
  v_bfi_b32 v91, s89, 0, v91
  s_waitcnt vmcnt(1)
L_red_15_b:
  s_nop 0
  v_mfma_f32_16x16x32_bf16 v[92:95], v[88:91], v[80:83], 0
  v_bitop3_b32 v29, v80, v81, s89 bitop3:0x7e
  v_bitop3_b32 v30, v82, v83, s89 bitop3:0x7e
  v_or_b32 v14, v29, v30
  s_waitcnt vmcnt(0)
  v_mfma_f32_16x16x32_bf16 v[92:95], v[88:91], v[84:87], v[92:95]
  v_bitop3_b32 v29, v84, v85, s89 bitop3:0x7e
  v_bitop3_b32 v30, v86, v87, s89 bitop3:0x7e
  v_or3_b32 v14, v14, v29, v30
  v_lshlrev_b32 v14, 1, v14
  v_cmp_gt_i32 vcc, 0, v14
  v_cmp_ne_u32 s[34:35], 0, v0
  s_nop 1
  v_add_f32_dpp v92, v92, v92 row_ror:4 row_mask:0xf bank_mask:0xf
  v_add_f32_dpp v93, v93, v93 row_ror:4 row_mask:0xf bank_mask:0xf
  s_cbranch_vccnz L_red_15
  v_add_f32_dpp v92, v92, v92 row_ror:8 row_mask:0xf bank_mask:0xf
  v_add_f32_dpp v93, v93, v93 row_ror:8 row_mask:0xf bank_mask:0xf
  v_cvt_pk_bf16_f32 v15, v92, v93
  buffer_store_dword v15, v24, s[4:7], s17 offen
  s_bitset0_b64 s[34:35], 0
  s_bitcmp1_b64 s[34:35], s26
  s_cbranch_scc1 L_top_11
  s_cmp_eq_u32 s14, 63
  s_cbranch_scc1 L_end_19
L_flag_20:
  s_sub_u32 s33, s33, 1
  s_cbranch_scc1 L_done
  v_lshrrev_b32 v0, 2, v2
  buffer_load_dword v0, v0, s[4:7], s32 offen sc1
  s_waitcnt vmcnt(0)
  v_cmp_ne_u32 s[34:35], 0, v0
  s_nop 3
  s_bitcmp1_b64 s[34:35], s26
  s_cbranch_scc0 L_flag_20
  s_branch L_top_11
L_end_19:
  buffer_store_dword v15, v24, s[4:7], s31 offen sc1
  s_branch L_done
L_fix_18:
  v_or_b32 v96, 0x40000000, v96
  v_or_b32 v97, 0x40000000, v97
  v_or_b32 v98, 0x40000000, v98
  v_or_b32 v99, 0x40000000, v99
  v_or_b32 v100, 0x40000000, v100
  v_or_b32 v101, 0x40000000, v101
  v_or_b32 v102, 0x40000000, v102
  v_or_b32 v103, 0x40000000, v103
  buffer_store_dwordx2 v[96:97], v11, s[4:7], s18 offen offset:0
  buffer_store_dwordx2 v[98:99], v11, s[4:7], s18 offen offset:2048
  buffer_store_dwordx2 v[100:101], v11, s[4:7], s19 offen offset:0
  buffer_store_dwordx2 v[102:103], v11, s[4:7], s19 offen offset:2048
  s_branch L_fix_18_b
L_red_15:
  buffer_load_dwordx4 v[80:83], v2, s[4:7], s22 offen offset:0 sc1
  buffer_load_dwordx4 v[84:87], v2, s[4:7], s22 offen offset:1024 sc1
  s_sub_u32 s33, s33, 1
  s_cbranch_scc1 L_done
  s_waitcnt vmcnt(0)
  s_branch L_red_15_b
L_re_16:
  buffer_load_dwordx4 v[48:51], v2, s[4:7], s15 offen sc1
  s_sub_u32 s33, s33, 1
  buffer_load_dwordx4 v[52:55], v2, s[4:7], s23 offen sc1
  s_nop 1
  v_mov_b64 v[88:89], 0
  v_mov_b64 v[90:91], 0
  v_mov_b64 v[92:93], 0
  v_mov_b64 v[94:95], 0
  s_cbranch_scc0 L_got_12_w
  s_branch L_done
L_rl_17:
  buffer_load_dwordx4 v[52:55], v2, s[4:7], s23 offen sc1
  s_waitcnt vmcnt(1)
  v_cmp_eq_u32 vcc, -1, v55
  s_cbranch_vccz L_rl_17_b
  s_sub_u32 s33, s33, 1
  s_cbranch_scc1 L_done
  s_branch L_rl_17
L_slow_13:
  v_cmp_u_f32 vcc, v96, v96
  s_cbranch_vccz L_slow_13_m
  s_bitcmp1_b32 s91, 0
  s_cbranch_scc1 L_slow_13_m
  s_mov_b32 s91, 1
  s_sub_u32 s24, s30, 524288
  buffer_load_dwordx4 v[40:43], v2, s[4:7], s24 offen offset:0 sc1
  buffer_load_dwordx4 v[44:47], v2, s[4:7], s24 offen offset:1024 sc1
L_slow_13_f:
  buffer_load_dwordx4 v[48:51], v2, s[4:7], s15 offen sc1
  buffer_load_dwordx4 v[52:55], v2, s[4:7], s23 offen sc1
  s_sub_u32 s33, s33, 1
  s_cbranch_scc1 L_done
  s_waitcnt vmcnt(0)
  v_max3_u32 v22, v48, v49, v50
  v_max_u32 v22, v22, v51
  v_max3_u32 v23, v52, v53, v54
  v_max_u32 v23, v23, v55
  v_max_u32 v22, v22, v23
  v_cmp_eq_u32 vcc, -1, v22
  s_cbranch_vccnz L_slow_13_f
  s_waitcnt lgkmcnt(0)
  ds_read_b128 v[56:59], v6 offset:0
  ds_read_b128 v[60:63], v6 offset:1024
  ds_read_b128 v[64:67], v6 offset:2048
  ds_read_b128 v[68:71], v6 offset:3072
  ds_read_b128 v[72:75], v6 offset:4096
  ds_read_b128 v[76:79], v6 offset:5120
  ds_read_b128 v[104:107], v6 offset:6144
  ds_read_b128 v[108:111], v6 offset:7168
  s_waitcnt lgkmcnt(0)
  ds_read_b128 v[112:115], v6 offset:12288
  ds_read_b128 v[116:119], v6 offset:13312
  ds_read_b128 v[120:123], v6 offset:14336
  ds_read_b128 v[124:127], v6 offset:15360
  ds_read_b128 v[128:131], v6 offset:16384
  ds_read_b128 v[132:135], v6 offset:17408
  ds_read_b128 v[136:139], v6 offset:18432
  ds_read_b128 v[140:143], v6 offset:19456
  v_mov_b64 v[80:81], 0
  v_mov_b64 v[82:83], 0
  v_mov_b64 v[84:85], 0
  v_mov_b64 v[86:87], 0
  v_mov_b64 v[88:89], 0
  v_mov_b64 v[90:91], 0
  v_mov_b64 v[92:93], 0
  v_mov_b64 v[94:95], 0
  v_mov_b64 v[96:97], 0
  v_mov_b64 v[98:99], 0
  v_mov_b64 v[100:101], 0
  v_mov_b64 v[102:103], 0
  v_add_u32 v14, s40, v2
  s_mov_b32 s31, 1835008
  s_waitcnt lgkmcnt(0)
  s_barrier
  s_branch L_got_12
L_slow_13_m:
  v_max3_f32 v96, v14, v15, v44
  v_max_f32 v96, v96, v46
  v_mov_b32 v97, v96
  s_nop 1
  v_permlane32_swap_b32 v96, v97
  v_max_f32 v96, v96, v97
  v_mov_b32 v97, v96
  s_nop 1
  v_permlane16_swap_b32 v96, v97
  v_max_f32 v96, v96, v97
  s_barrier
  ds_write_b32 v13, v96 offset:14336
  s_waitcnt lgkmcnt(0)
  s_barrier
  ds_read_b128 v[28:31], v9 offset:14336
  s_waitcnt lgkmcnt(0)
  s_barrier
  v_max3_f32 v96, v28, v29, v30
  v_max_f32 v96, v96, v31
  v_sub_f32 v14, v14, v96
  v_sub_f32 v15, v15, v96
  v_sub_f32 v44, v44, v96
  v_sub_f32 v46, v46, v96
  v_exp_f32 v28, v14
  v_exp_f32 v29, v15
  v_exp_f32_dpp v45, v44 quad_perm:[0,0,2,2] row_mask:0xf bank_mask:0xf
  v_exp_f32_dpp v47, v46 quad_perm:[0,0,2,2] row_mask:0xf bank_mask:0xf
  v_cvt_pk_bf16_f32 v30, v28, v29
  v_cvt_pk_bf16_f32 v23, v45, v47
  v_cndmask_b32 v22, 0, v23, s[66:67]
  v_cndmask_b32 v23, v23, 0, s[66:67]
  ds_write_b32 v13, v30 offset:14336
  s_waitcnt lgkmcnt(0)
  s_barrier
  ds_read_b128 v[28:31], v9 offset:14336
  ds_read_b128 v[40:43], v10 offset:14336
  s_waitcnt lgkmcnt(0)
  v_mfma_f32_16x16x32_bf16 v[88:91], v[16:19], v[28:31], 0
  s_nop 2
  v_mfma_f32_16x16x32_bf16 v[84:87], v[32:35], v[28:31], 0
  s_nop 0
  v_mfma_f32_16x16x32_bf16 v[84:87], v[36:39], v[40:43], v[84:87]
  s_nop 2
  v_mfma_f32_16x16x16_bf16 v[88:91], v[16:17], v[22:23], v[88:91]
  s_nop 2
  v_mfma_f32_16x16x16_bf16 v[84:87], v[20:21], v[22:23], v[84:87]
  s_nop 3
  v_rcp_f32_dpp v96, v88 quad_perm:[0,0,2,2] row_mask:0xf bank_mask:0xf
  s_nop 2
  v_mul_f32 v84, v84, v96
  v_mul_f32 v85, v85, v96
  v_mul_f32 v86, v86, v96
  v_mul_f32 v87, v87, v96
  v_cvt_pk_bf16_f32 v98, v84, v85
  v_cvt_pk_bf16_f32 v99, v86, v87
  ds_write_b64 v7, v[98:99] offset:12288
  s_branch L_back_14
L_wave1_8:
  s_branch L_got_22
  s_nop 0
  s_nop 0
  s_nop 0
  s_nop 0
  s_nop 0
  s_nop 0
  s_nop 0
L_top_21:
  s_barrier
  v_mov_b64 v[32:33], v[128:129]
  v_mov_b64 v[34:35], v[130:131]
  v_mov_b64 v[36:37], v[132:133]
  v_mov_b64 v[38:39], v[134:135]
  ds_read_b128 v[128:131], v6 offset:16384
  buffer_load_dwordx4 v[48:51], v2, s[4:7], s15 offen sc1
  ds_read_b128 v[132:135], v6 offset:17408
  v_mov_b64 v[40:41], v[136:137]
  v_mov_b64 v[42:43], v[138:139]
  v_mov_b64 v[44:45], v[140:141]
  v_mov_b64 v[46:47], v[142:143]
  ds_read_b128 v[136:139], v6 offset:18432
  ds_read_b128 v[140:143], v6 offset:19456
  buffer_load_dwordx4 v[52:55], v2, s[4:7], s23 offen sc1
  v_mov_b64 v[80:81], 0
  v_mov_b64 v[82:83], 0
  v_mov_b64 v[84:85], 0
  v_mov_b64 v[86:87], 0
  v_mov_b64 v[88:89], 0
  v_mov_b64 v[90:91], 0
  v_mov_b64 v[92:93], 0
  v_mov_b64 v[94:95], 0
  v_mov_b64_e64 v[96:97], 0
  v_mov_b64_e64 v[98:99], 0
  v_mov_b64_e64 v[100:101], 0
  v_mov_b64_e64 v[102:103], 0
  v_add_u32_e64 v14, s40, v2
  v_xor_b32 v16, 0x40004000, v16
  buffer_load_dwordx4 v[48:51], v2, s[4:7], s15 offen sc1
  v_xor_b32 v17, 0x40004000, v17
  v_xor_b32 v18, 0x40004000, v18
  v_xor_b32 v19, 0x40004000, v19
  s_xor_b32 s89, s89, 0x40004000
  s_nop 5
  buffer_load_dwordx4 v[52:55], v2, s[4:7], s23 offen sc1
  s_waitcnt lgkmcnt(0)
L_got_22_w:
  s_waitcnt vmcnt(3)
L_got_22:
  v_cmp_eq_u32_e64 vcc, -1, v51
  v_smfmac_f32_16x16x64_bf16 v[88:91], v[48:51], v[56:63], v1
  ds_write_b128 v14, v[48:51] offset:0
  v_smfmac_f32_16x16x64_bf16 v[92:95], v[48:51], v[64:71], v1
  s_cbranch_vccnz L_re_26
  s_waitcnt vmcnt(2)
  v_cmp_eq_u32_e64 vcc, -1, v55
  v_smfmac_f32_16x16x64_bf16 v[80:83], v[48:51], v[72:79], v1
  v_smfmac_f32_16x16x64_bf16 v[84:87], v[48:51], v[104:111], v1
  s_cbranch_vccnz L_rl_27
L_rl_27_b:
  v_smfmac_f32_16x16x64_bf16 v[88:91], v[52:55], v[112:119], v1
  ds_write_b128 v14, v[52:55] offset:4096
  v_smfmac_f32_16x16x64_bf16 v[92:95], v[52:55], v[120:127], v1
  s_waitcnt lgkmcnt(1)
  s_barrier
  ds_read_b128 v[56:59], v25 offset:0
  v_smfmac_f32_16x16x64_bf16 v[80:83], v[52:55], v[128:135], v1
  ds_read_b128 v[60:63], v26 offset:0
  v_smfmac_f32_16x16x64_bf16 v[84:87], v[52:55], v[136:143], v1
  ds_read_b128 v[64:67], v27 offset:0
  buffer_load_dwordx4 v[136:139], v2, s[4:7], s30 offen offset:0 sc1
  s_waitcnt lgkmcnt(2)
  v_smfmac_f32_16x16x64_bf16 v[88:91], v[56:59], a[32:39], v1
  s_barrier
  v_smfmac_f32_16x16x64_bf16 v[92:95], v[56:59], a[40:47], v1
  ds_read_b128 v[68:71], v25 offset:4096
  s_waitcnt lgkmcnt(2)
  v_smfmac_f32_16x16x64_bf16 v[88:91], v[60:63], a[48:55], v1
  ds_read_b128 v[72:75], v26 offset:4096
  v_smfmac_f32_16x16x64_bf16 v[92:95], v[60:63], a[56:63], v1
  ds_read_b128 v[76:79], v27 offset:4096
  s_waitcnt lgkmcnt(3)
  v_smfmac_f32_16x16x64_bf16 v[88:91], v[64:67], a[64:71], v1
  buffer_load_dwordx4 v[140:143], v2, s[4:7], s30 offen offset:1024 sc1
  v_smfmac_f32_16x16x64_bf16 v[92:95], v[64:67], a[72:79], v1
  ds_read_b128 v[104:107], v6 offset:8192
  s_waitcnt lgkmcnt(3)
  v_smfmac_f32_16x16x64_bf16 v[88:91], v[68:71], a[80:87], v1
  ds_read_b128 v[108:111], v6 offset:9216
  v_smfmac_f32_16x16x64_bf16 v[92:95], v[68:71], a[88:95], v1
  ds_read_b128 v[112:115], v6 offset:10240
  s_waitcnt lgkmcnt(3)
  v_smfmac_f32_16x16x64_bf16 v[88:91], v[72:75], a[96:103], v1
  ds_read_b128 v[116:119], v6 offset:11264
  v_smfmac_f32_16x16x64_bf16 v[88:91], v[76:79], a[112:119], v1
  buffer_load_dwordx4 v[128:131], v2, s[4:7], s65 offen offset:0 sc1
  v_smfmac_f32_16x16x64_bf16 v[92:95], v[72:75], a[104:111], v1
  s_nop 0
  ds_read_b128 v[120:123], v6 offset:20480
  v_smfmac_f32_16x16x64_bf16 v[92:95], v[76:79], a[120:127], v1
  s_waitcnt lgkmcnt(1)
  s_nop 1
  v_add_f32 v88, v88, v89
  v_smfmac_f32_16x16x64_bf16 v[80:83], v[56:59], v[104:111], v1
  ds_read_b128 v[124:127], v6 offset:21504
  v_add_f32 v90, v90, v91
  v_smfmac_f32_16x16x64_bf16 v[84:87], v[56:59], v[112:119], v1
  ds_read_b128 v[104:107], v6 offset:22528
  v_add_f32 v92, v92, v93
  v_smfmac_f32_16x16x64_bf16 v[80:83], v[60:63], v[224:231], v1
  ds_read_b128 v[108:111], v6 offset:23552
  v_add_f32 v94, v94, v95
  v_smfmac_f32_16x16x64_bf16 v[84:87], v[60:63], v[232:239], v1
  v_cvt_pk_bf16_f32 v28, v88, v92
  v_cvt_pk_bf16_f32 v29, v90, v94
  v_smfmac_f32_16x16x64_bf16 v[80:83], v[64:67], v[240:247], v1
  ds_write_b64 v7, v[28:29] offset:8192
  v_smfmac_f32_16x16x64_bf16 v[84:87], v[64:67], v[248:255], v1
  ds_read_b128 v[112:115], v6 offset:24576
  v_smfmac_f32_16x16x64_bf16 v[80:83], v[72:75], a[0:7], v1
  buffer_store_dword v15, v24, s[4:7], s31 offen sc1
  v_smfmac_f32_16x16x64_bf16 v[84:87], v[72:75], a[8:15], v1
  ds_read_b128 v[116:119], v6 offset:25600
  s_waitcnt lgkmcnt(3)
  v_smfmac_f32_16x16x64_bf16 v[80:83], v[68:71], v[120:127], v1
  s_waitcnt lgkmcnt(2)
  s_barrier
  v_smfmac_f32_16x16x64_bf16 v[80:83], v[76:79], a[16:23], v1
  s_nop 0
  ds_read_b64_tr_b16 v[88:89], v8 offset:8192
  v_smfmac_f32_16x16x64_bf16 v[84:87], v[68:71], v[104:111], v1
  ds_read_b64_tr_b16 v[90:91], v8 offset:8704
  v_smfmac_f32_16x16x64_bf16 v[84:87], v[76:79], a[24:31], v1
  ds_read_b64_tr_b16 v[92:93], v8 offset:9216
  v_smfmac_f32_16x16x64_bf16 v[96:99], v[48:51], a[128:135], v1
  ds_read_b64_tr_b16 v[94:95], v8 offset:9728
  v_add_f32 v80, v80, v81
  v_smfmac_f32_16x16x64_bf16 v[100:103], v[48:51], a[136:143], v1
  ds_read_b128 v[120:123], v6 offset:26624
  v_add_f32 v82, v82, v83
  v_smfmac_f32_16x16x64_bf16 v[96:99], v[52:55], a[144:151], v1
  v_add_f32 v84, v84, v85
  v_add_f32 v86, v86, v87
  v_cvt_pk_bf16_f32 v22, v80, v84
  v_cvt_pk_bf16_f32 v23, v82, v86
  v_smfmac_f32_16x16x64_bf16 v[100:103], v[52:55], a[152:159], v1
  ds_write_b64 v7, v[22:23] offset:10240
  s_waitcnt lgkmcnt(2)
  v_mfma_f32_16x16x32_bf16 v[28:31], v[40:43], v[88:91], 0
  ds_read_b128 v[124:127], v6 offset:27648
  v_mfma_f32_16x16x32_bf16 v[28:31], v[44:47], v[92:95], v[28:31]
  buffer_load_dwordx4 v[132:135], v2, s[4:7], s65 offen offset:1024 sc1
  v_smfmac_f32_16x16x64_bf16 v[96:99], v[56:59], a[160:167], v1
  s_nop 0
  ds_read_b128 v[104:107], v6 offset:28672
  v_smfmac_f32_16x16x64_bf16 v[100:103], v[56:59], a[168:175], v1
  s_waitcnt lgkmcnt(2)
  s_barrier
  s_nop 0
  v_add_f32_dpp v14, v29, v28 quad_perm:[1,1,3,3] row_mask:0xf bank_mask:0xf
  v_smfmac_f32_16x16x64_bf16 v[96:99], v[60:63], a[176:183], v1
  ds_read_b64_tr_b16 v[80:81], v8 offset:10240
  v_add_f32_dpp v15, v31, v30 quad_perm:[1,1,3,3] row_mask:0xf bank_mask:0xf
  v_smfmac_f32_16x16x64_bf16 v[100:103], v[60:63], a[184:191], v1
  ds_read_b64_tr_b16 v[82:83], v8 offset:10752
  v_exp_f32 v28, v14
  v_smfmac_f32_16x16x64_bf16 v[96:99], v[64:67], a[192:199], v1
  ds_read_b64_tr_b16 v[84:85], v8 offset:11264
  v_exp_f32 v29, v15
  v_smfmac_f32_16x16x64_bf16 v[100:103], v[64:67], a[200:207], v1
  ds_read_b64_tr_b16 v[86:87], v8 offset:11776
  v_cvt_pk_bf16_f32 v30, v28, v29
  v_smfmac_f32_16x16x64_bf16 v[96:99], v[68:71], a[208:215], v1
  ds_write_b32 v13, v30 offset:14336
  v_smfmac_f32_16x16x64_bf16 v[100:103], v[68:71], a[216:223], v1
  ds_read_b128 v[108:111], v6 offset:29696
  s_waitcnt lgkmcnt(2)
  v_mfma_f32_16x16x32_bf16 v[44:47], v[80:83], v[88:91], 0
  ds_read_b128 v[64:67], v6 offset:30720
  v_mfma_f32_16x16x32_bf16 v[44:47], v[84:87], v[92:95], v[44:47]
  s_nop 0
  s_waitcnt vmcnt(5)
  v_mov_b64 v[48:49], 0
  v_smfmac_f32_16x16x64_bf16 v[96:99], v[72:75], a[224:231], v1
  s_waitcnt lgkmcnt(2)
  s_barrier
  v_smfmac_f32_16x16x64_bf16 v[96:99], v[76:79], a[240:247], v1
  ds_read_b128 v[28:31], v9 offset:14336
  v_add_f32_dpp v44, v45, v44 quad_perm:[1,1,3,3] row_mask:0xf bank_mask:0xf
  v_add_f32_dpp v46, v47, v46 quad_perm:[1,1,3,3] row_mask:0xf bank_mask:0xf
  v_smfmac_f32_16x16x64_bf16 v[100:103], v[72:75], a[232:239], v1
  ds_read_b128 v[40:43], v10 offset:14336
  v_mul_f32 v44, s64, v44
  v_mul_f32 v46, s64, v46
  v_smfmac_f32_16x16x64_bf16 v[100:103], v[76:79], a[248:255], v1
  ds_read_b128 v[68:71], v6 offset:31744
  v_add_f32 v96, v96, v97
  v_exp_f32_dpp v45, v44 quad_perm:[0,0,2,2] row_mask:0xf bank_mask:0xf
  v_exp_f32_dpp v47, v46 quad_perm:[0,0,2,2] row_mask:0xf bank_mask:0xf
  s_waitcnt lgkmcnt(2)
  v_mfma_f32_16x16x32_bf16 v[88:91], v[16:19], v[28:31], 0
  v_cvt_pk_bf16_f32 v23, v45, v47
  v_cndmask_b32 v22, 0, v23, s[66:67]
  v_mfma_f32_16x16x32_bf16 v[84:87], v[32:35], v[28:31], 0
  s_waitcnt lgkmcnt(1)
  v_cndmask_b32 v23, v23, 0, s[66:67]
  v_add_f32 v98, v98, v99
  v_mfma_f32_16x16x32_bf16 v[84:87], v[36:39], v[40:43], v[84:87]
  v_add_f32 v100, v100, v101
  v_add_f32 v102, v102, v103
  v_cvt_pk_bf16_f32 v21, v100, v102
  v_cvt_pk_bf16_f32 v20, v96, v98
  v_mfma_f32_16x16x16_bf16 v[88:91], v[16:17], v[22:23], v[88:91]
  v_mov_b64 v[50:51], 0
  v_mov_b64 v[52:53], 0
  v_mfma_f32_16x16x16_bf16 v[84:87], v[20:21], v[22:23], v[84:87]
  v_mov_b64 v[54:55], 0
  v_mov_b64 v[56:57], 0
  v_mov_b64 v[58:59], 0
  v_mov_b64 v[60:61], 0
  v_mov_b64 v[62:63], 0
  v_rcp_f32_dpp v96, v88 quad_perm:[0,0,2,2] row_mask:0xf bank_mask:0xf
  s_nop 0
  v_subrev_u32 v97, s29, v96
  v_cmp_lt_u32 vcc, s90, v97
  v_mul_f32 v84, v84, v96
  v_mul_f32 v85, v85, v96
  v_mul_f32 v86, v86, v96
  v_mul_f32_e64 v87, v87, v96
  v_cvt_pk_bf16_f32 v98, v84, v85
  v_cvt_pk_bf16_f32 v99, v86, v87
  ds_write_b64 v7, v[98:99] offset:12288
  s_cbranch_vccnz L_slow_23
L_back_24:
  v_mov_b32_dpp v80, v98 quad_perm:[0,0,2,2] row_mask:0xf bank_mask:0xf
  v_mov_b32_dpp v81, v99 quad_perm:[0,0,2,2] row_mask:0xf bank_mask:0xf
  v_mov_b32_dpp v82, v98 quad_perm:[1,1,3,3] row_mask:0xf bank_mask:0xf
  v_mov_b32_dpp v83, v99 quad_perm:[1,1,3,3] row_mask:0xf bank_mask:0xf
  s_nop 1
  v_smfmac_f32_16x16x64_bf16 v[48:51], v[80:83], v[144:151], v1
  s_waitcnt lgkmcnt(0)
  s_barrier
  ds_read_b128 v[92:95], v3 offset:12288
  v_smfmac_f32_16x16x64_bf16 v[52:55], v[80:83], v[152:159], v1
  ds_read_b128 v[28:31], v4 offset:12288
  v_smfmac_f32_16x16x64_bf16 v[56:59], v[80:83], v[160:167], v1
  ds_read_b128 v[40:43], v5 offset:12288
  v_smfmac_f32_16x16x64_bf16 v[60:63], v[80:83], v[168:175], v1
  ds_read_b128 v[72:75], v6 offset:32768
  s_waitcnt lgkmcnt(3)
  v_smfmac_f32_16x16x64_bf16 v[48:51], v[92:95], v[176:183], v1
  ds_read_b128 v[76:79], v6 offset:33792
  s_waitcnt lgkmcnt(3)
  v_smfmac_f32_16x16x64_bf16 v[48:51], v[28:31], v[192:199], v1
  ds_read_b128 v[32:35], v6 offset:34816
  s_waitcnt lgkmcnt(3)
  v_smfmac_f32_16x16x64_bf16 v[48:51], v[40:43], v[208:215], v1
  s_nop 0
  ds_read_b128 v[36:39], v6 offset:35840
  v_smfmac_f32_16x16x64_bf16 v[52:55], v[92:95], v[184:191], v1
  s_nop 2
  v_smfmac_f32_16x16x64_bf16 v[52:55], v[28:31], v[200:207], v1
  s_nop 0
  v_cvt_pk_bf16_f32 v96, v48, v49
  v_smfmac_f32_16x16x64_bf16 v[52:55], v[40:43], v[216:223], v1
  s_nop 0
  s_waitcnt lgkmcnt(12)
  v_cvt_pk_bf16_f32 v97, v50, v51
  v_smfmac_f32_16x16x64_bf16 v[56:59], v[92:95], v[112:119], v1
  buffer_store_dwordx2 v[96:97], v11, s[4:7], s18 offen offset:0
  v_smfmac_f32_16x16x64_bf16 v[56:59], v[28:31], v[120:127], v1
  s_nop 1
  v_cvt_pk_bf16_f32 v98, v52, v53
  v_smfmac_f32_16x16x64_bf16 v[56:59], v[40:43], v[104:111], v1
  s_nop 0
  s_waitcnt lgkmcnt(0)
  v_cvt_pk_bf16_f32 v99, v54, v55
  v_smfmac_f32_16x16x64_bf16 v[60:63], v[92:95], v[64:71], v1
  buffer_store_dwordx2 v[98:99], v11, s[4:7], s18 offen offset:2048
  v_smfmac_f32_16x16x64_bf16 v[60:63], v[28:31], v[72:79], v1
  s_nop 1
  v_cvt_pk_bf16_f32 v100, v56, v57
  v_smfmac_f32_16x16x64_bf16 v[60:63], v[40:43], v[32:39], v1
  v_cvt_pk_bf16_f32 v101, v58, v59
  buffer_store_dwordx2 v[100:101], v11, s[4:7], s19 offen offset:0
  s_add_u32 s14, s14, 1
  s_and_b32 s24, s14, 3
  s_lshl_b32 s24, s24, 13
  s_add_u32 s24, s24, 1048576
  v_mov_b32_e64 v15, -1
  s_nop 0
  v_cvt_pk_bf16_f32 v102, v60, v61
  v_cvt_pk_bf16_f32 v103, v62, v63
  buffer_store_dwordx2 v[102:103], v11, s[4:7], s19 offen offset:2048
  buffer_store_dword v15, v24, s[4:7], s28 offen
  ds_read_b128 v[88:91], v2 offset:15360
  v_and_b32_e64 v14, v96, v97
  v_bitop3_b32 v14, v14, v98, v99 bitop3:0x80
  v_bitop3_b32 v14, v14, v100, v101 bitop3:0x80
  v_bitop3_b32 v14, v14, v102, v103 bitop3:0x80
  v_bfi_b32 v14, v14, 0, s89
  v_cmp_lt_u32 vcc, 0xffff, v14
  ds_read_b128 v[56:59], v6 offset:0
  ds_read_b128 v[60:63], v6 offset:1024
  ds_read_b128 v[64:67], v6 offset:2048
  ds_read_b128 v[68:71], v6 offset:3072
  s_cbranch_vccnz L_fix_28
L_fix_28_b:
  ds_read_b128 v[72:75], v6 offset:4096
  ds_read_b128 v[76:79], v6 offset:5120
  ds_read_b128 v[104:107], v6 offset:6144
  ds_read_b128 v[108:111], v6 offset:7168
  ds_read_b128 v[112:115], v6 offset:12288
  ds_read_b128 v[116:119], v6 offset:13312
  ds_read_b128 v[120:123], v6 offset:14336
  ds_read_b128 v[124:127], v6 offset:15360
  s_waitcnt vmcnt(2)
  buffer_load_dwordx4 v[80:83], v2, s[4:7], s22 offen offset:0 sc1
  buffer_load_dwordx4 v[84:87], v2, s[4:7], s22 offen offset:1024 sc1
  s_mov_b32 s28, s17
  s_add_u32 s17, s24, s87
  s_add_u32 s15, s24, s40
  s_add_u32 s23, s24, s16
  s_lshl_b32 s31, s14, 13
  s_add_u32 s31, s31, s87
  s_add_u32 s31, s31, 1310720
  s_xor_b32 s29, s29, 0x40000000
  s_mov_b32 s91, 0
  s_add_u32 s30, s30, 524288
  s_add_u32 s65, s65, 524288
  s_waitcnt lgkmcnt(12)
  v_bfi_b32 v88, s89, 0, v88
  v_bfi_b32 v89, s89, 0, v89
  v_bfi_b32 v90, s89, 0, v90
  v_bfi_b32 v91, s89, 0, v91
  s_waitcnt vmcnt(1)
L_red_25_b:
  s_nop 0
  v_mfma_f32_16x16x32_bf16 v[92:95], v[88:91], v[80:83], 0
  s_nop 0
  v_bitop3_b32 v29, v80, v81, s89 bitop3:0x7e
  v_bitop3_b32 v30, v82, v83, s89 bitop3:0x7e
  v_or_b32_e64 v14, v29, v30
  s_waitcnt vmcnt(0)
  v_mfma_f32_16x16x32_bf16 v[92:95], v[88:91], v[84:87], v[92:95]
  v_bitop3_b32 v29, v84, v85, s89 bitop3:0x7e
  v_bitop3_b32 v30, v86, v87, s89 bitop3:0x7e
  v_or3_b32 v14, v14, v29, v30
  v_lshlrev_b32_e64 v14, 1, v14
  v_cmp_gt_i32_e64 vcc, 0, v14
  s_nop 2
  v_add_f32_dpp v92, v92, v92 row_ror:4 row_mask:0xf bank_mask:0xf
  v_add_f32_dpp v93, v93, v93 row_ror:4 row_mask:0xf bank_mask:0xf
  s_cbranch_vccnz L_red_25
  v_add_f32_dpp v92, v92, v92 row_ror:8 row_mask:0xf bank_mask:0xf
  v_add_f32_dpp v93, v93, v93 row_ror:8 row_mask:0xf bank_mask:0xf
  v_cvt_pk_bf16_f32 v15, v92, v93
  buffer_store_dword v15, v24, s[4:7], s17 offen
  s_cmp_lt_u32 s14, 63
  s_cbranch_scc1 L_top_21
L_end_29:
  buffer_store_dword v15, v24, s[4:7], s31 offen sc1
  s_branch L_done
L_fix_28:
  v_or_b32 v96, 0x40000000, v96
  v_or_b32 v97, 0x40000000, v97
  v_or_b32 v98, 0x40000000, v98
  v_or_b32 v99, 0x40000000, v99
  v_or_b32 v100, 0x40000000, v100
  v_or_b32 v101, 0x40000000, v101
  v_or_b32 v102, 0x40000000, v102
  v_or_b32 v103, 0x40000000, v103
  buffer_store_dwordx2 v[96:97], v11, s[4:7], s18 offen offset:0
  buffer_store_dwordx2 v[98:99], v11, s[4:7], s18 offen offset:2048
  buffer_store_dwordx2 v[100:101], v11, s[4:7], s19 offen offset:0
  buffer_store_dwordx2 v[102:103], v11, s[4:7], s19 offen offset:2048
  s_branch L_fix_28_b
L_red_25:
  buffer_load_dwordx4 v[80:83], v2, s[4:7], s22 offen offset:0 sc1
  buffer_load_dwordx4 v[84:87], v2, s[4:7], s22 offen offset:1024 sc1
  s_sub_u32 s33, s33, 1
  s_cbranch_scc1 L_done
  s_waitcnt vmcnt(0)
  s_branch L_red_25_b
L_re_26:
  buffer_load_dwordx4 v[48:51], v2, s[4:7], s15 offen sc1
  s_sub_u32 s33, s33, 1
  buffer_load_dwordx4 v[52:55], v2, s[4:7], s23 offen sc1
  s_nop 1
  v_mov_b64 v[88:89], 0
  v_mov_b64 v[90:91], 0
  v_mov_b64 v[92:93], 0
  v_mov_b64 v[94:95], 0
  s_cbranch_scc0 L_got_22_w
  s_branch L_done
L_rl_27:
  buffer_load_dwordx4 v[52:55], v2, s[4:7], s23 offen sc1
  s_waitcnt vmcnt(1)
  v_cmp_eq_u32 vcc, -1, v55
  s_cbranch_vccz L_rl_27_b
  s_sub_u32 s33, s33, 1
  s_cbranch_scc1 L_done
  s_branch L_rl_27
L_slow_23:
  v_cmp_u_f32 vcc, v96, v96
  s_cbranch_vccz L_slow_23_m
  s_bitcmp1_b32 s91, 0
  s_cbranch_scc1 L_slow_23_m
  s_mov_b32 s91, 1
  s_sub_u32 s24, s30, 524288
  buffer_load_dwordx4 v[40:43], v2, s[4:7], s24 offen offset:0 sc1
  buffer_load_dwordx4 v[44:47], v2, s[4:7], s24 offen offset:1024 sc1
L_slow_23_f:
  buffer_load_dwordx4 v[48:51], v2, s[4:7], s15 offen sc1
  buffer_load_dwordx4 v[52:55], v2, s[4:7], s23 offen sc1
  s_sub_u32 s33, s33, 1
  s_cbranch_scc1 L_done
  s_waitcnt vmcnt(0)
  v_max3_u32 v22, v48, v49, v50
  v_max_u32 v22, v22, v51
  v_max3_u32 v23, v52, v53, v54
  v_max_u32 v23, v23, v55
  v_max_u32 v22, v22, v23
  v_cmp_eq_u32 vcc, -1, v22
  s_cbranch_vccnz L_slow_23_f
  s_waitcnt lgkmcnt(0)
  ds_read_b128 v[56:59], v6 offset:0
  ds_read_b128 v[60:63], v6 offset:1024
  ds_read_b128 v[64:67], v6 offset:2048
  ds_read_b128 v[68:71], v6 offset:3072
  ds_read_b128 v[72:75], v6 offset:4096
  ds_read_b128 v[76:79], v6 offset:5120
  ds_read_b128 v[104:107], v6 offset:6144
  ds_read_b128 v[108:111], v6 offset:7168
  s_waitcnt lgkmcnt(0)
  ds_read_b128 v[112:115], v6 offset:12288
  ds_read_b128 v[116:119], v6 offset:13312
  ds_read_b128 v[120:123], v6 offset:14336
  ds_read_b128 v[124:127], v6 offset:15360
  ds_read_b128 v[128:131], v6 offset:16384
  ds_read_b128 v[132:135], v6 offset:17408
  ds_read_b128 v[136:139], v6 offset:18432
  ds_read_b128 v[140:143], v6 offset:19456
  v_mov_b64 v[80:81], 0
  v_mov_b64 v[82:83], 0
  v_mov_b64 v[84:85], 0
  v_mov_b64 v[86:87], 0
  v_mov_b64 v[88:89], 0
  v_mov_b64 v[90:91], 0
  v_mov_b64 v[92:93], 0
  v_mov_b64 v[94:95], 0
  v_mov_b64 v[96:97], 0
  v_mov_b64 v[98:99], 0
  v_mov_b64 v[100:101], 0
  v_mov_b64 v[102:103], 0
  v_add_u32 v14, s40, v2
  s_mov_b32 s31, 1835008
  s_waitcnt lgkmcnt(0)
  s_barrier
  s_branch L_got_22
L_slow_23_m:
  v_max3_f32 v96, v14, v15, v44
  v_max_f32 v96, v96, v46
  v_mov_b32 v97, v96
  s_nop 1
  v_permlane32_swap_b32 v96, v97
  v_max_f32 v96, v96, v97
  v_mov_b32 v97, v96
  s_nop 1
  v_permlane16_swap_b32 v96, v97
  v_max_f32 v96, v96, v97
  s_barrier
  ds_write_b32 v13, v96 offset:14336
  s_waitcnt lgkmcnt(0)
  s_barrier
  ds_read_b128 v[28:31], v9 offset:14336
  s_waitcnt lgkmcnt(0)
  s_barrier
  v_max3_f32 v96, v28, v29, v30
  v_max_f32 v96, v96, v31
  v_sub_f32 v14, v14, v96
  v_sub_f32 v15, v15, v96
  v_sub_f32 v44, v44, v96
  v_sub_f32 v46, v46, v96
  v_exp_f32 v28, v14
  v_exp_f32 v29, v15
  v_exp_f32_dpp v45, v44 quad_perm:[0,0,2,2] row_mask:0xf bank_mask:0xf
  v_exp_f32_dpp v47, v46 quad_perm:[0,0,2,2] row_mask:0xf bank_mask:0xf
  v_cvt_pk_bf16_f32 v30, v28, v29
  v_cvt_pk_bf16_f32 v23, v45, v47
  v_cndmask_b32 v22, 0, v23, s[66:67]
  v_cndmask_b32 v23, v23, 0, s[66:67]
  ds_write_b32 v13, v30 offset:14336
  s_waitcnt lgkmcnt(0)
  s_barrier
  ds_read_b128 v[28:31], v9 offset:14336
  ds_read_b128 v[40:43], v10 offset:14336
  s_waitcnt lgkmcnt(0)
  v_mfma_f32_16x16x32_bf16 v[88:91], v[16:19], v[28:31], 0
  s_nop 2
  v_mfma_f32_16x16x32_bf16 v[84:87], v[32:35], v[28:31], 0
  s_nop 0
  v_mfma_f32_16x16x32_bf16 v[84:87], v[36:39], v[40:43], v[84:87]
  s_nop 2
  v_mfma_f32_16x16x16_bf16 v[88:91], v[16:17], v[22:23], v[88:91]
  s_nop 2
  v_mfma_f32_16x16x16_bf16 v[84:87], v[20:21], v[22:23], v[84:87]
  s_nop 3
  v_rcp_f32_dpp v96, v88 quad_perm:[0,0,2,2] row_mask:0xf bank_mask:0xf
  s_nop 2
  v_mul_f32 v84, v84, v96
  v_mul_f32 v85, v85, v96
  v_mul_f32 v86, v86, v96
  v_mul_f32 v87, v87, v96
  v_cvt_pk_bf16_f32 v98, v84, v85
  v_cvt_pk_bf16_f32 v99, v86, v87
  ds_write_b64 v7, v[98:99] offset:12288
  s_branch L_back_24
L_wave2_9:
  s_branch L_got_31
  s_nop 0
  s_nop 0
  s_nop 0
  s_nop 0
  s_nop 0
  s_nop 0
L_top_30:
  s_barrier
  v_mov_b64 v[32:33], v[128:129]
  v_mov_b64 v[34:35], v[130:131]
  v_mov_b64 v[36:37], v[132:133]
  v_mov_b64 v[38:39], v[134:135]
  ds_read_b128 v[128:131], v6 offset:16384
  buffer_load_dwordx4 v[48:51], v2, s[4:7], s15 offen sc1
  ds_read_b128 v[132:135], v6 offset:17408
  v_mov_b64 v[40:41], v[136:137]
  v_mov_b64 v[42:43], v[138:139]
  v_mov_b64 v[44:45], v[140:141]
  v_mov_b64 v[46:47], v[142:143]
  ds_read_b128 v[136:139], v6 offset:18432
  ds_read_b128 v[140:143], v6 offset:19456
  buffer_load_dwordx4 v[52:55], v2, s[4:7], s23 offen sc1
  v_mov_b64 v[80:81], 0
  v_mov_b64 v[82:83], 0
  v_mov_b64 v[84:85], 0
  v_mov_b64 v[86:87], 0
  v_mov_b64 v[88:89], 0
  v_mov_b64 v[90:91], 0
  v_mov_b64 v[92:93], 0
  v_mov_b64 v[94:95], 0
  v_mov_b64_e64 v[96:97], 0
  v_mov_b64_e64 v[98:99], 0
  v_mov_b64_e64 v[100:101], 0
  v_mov_b64_e64 v[102:103], 0
  v_add_u32_e64 v14, s40, v2
  v_xor_b32 v16, 0x40004000, v16
  buffer_load_dwordx4 v[48:51], v2, s[4:7], s15 offen sc1
  v_xor_b32 v17, 0x40004000, v17
  v_xor_b32 v18, 0x40004000, v18
  v_xor_b32 v19, 0x40004000, v19
  s_xor_b32 s89, s89, 0x40004000
  s_nop 5
  buffer_load_dwordx4 v[52:55], v2, s[4:7], s23 offen sc1
  s_waitcnt lgkmcnt(0)
L_got_31_w:
  s_waitcnt vmcnt(3)
L_got_31:
  v_cmp_eq_u32_e64 vcc, -1, v51
  v_smfmac_f32_16x16x64_bf16 v[88:91], v[48:51], v[56:63], v1
  ds_write_b128 v14, v[48:51] offset:0
  v_smfmac_f32_16x16x64_bf16 v[92:95], v[48:51], v[64:71], v1
  s_cbranch_vccnz L_re_35
  s_waitcnt vmcnt(2)
  v_cmp_eq_u32_e64 vcc, -1, v55
  v_smfmac_f32_16x16x64_bf16 v[80:83], v[48:51], v[72:79], v1
  v_smfmac_f32_16x16x64_bf16 v[84:87], v[48:51], v[104:111], v1
  s_cbranch_vccnz L_rl_36
L_rl_36_b:
  v_smfmac_f32_16x16x64_bf16 v[88:91], v[52:55], v[112:119], v1
  ds_write_b128 v14, v[52:55] offset:4096
  v_smfmac_f32_16x16x64_bf16 v[92:95], v[52:55], v[120:127], v1
  s_waitcnt lgkmcnt(1)
  s_barrier
  ds_read_b128 v[56:59], v25 offset:0
  v_smfmac_f32_16x16x64_bf16 v[80:83], v[52:55], v[128:135], v1
  ds_read_b128 v[60:63], v26 offset:0
  v_smfmac_f32_16x16x64_bf16 v[84:87], v[52:55], v[136:143], v1
  ds_read_b128 v[64:67], v27 offset:0
  buffer_load_dwordx4 v[136:139], v2, s[4:7], s30 offen offset:0 sc1
  s_waitcnt lgkmcnt(2)
  v_smfmac_f32_16x16x64_bf16 v[88:91], v[56:59], a[32:39], v1
  s_barrier
  v_smfmac_f32_16x16x64_bf16 v[92:95], v[56:59], a[40:47], v1
  ds_read_b128 v[68:71], v25 offset:4096
  s_waitcnt lgkmcnt(2)
  v_smfmac_f32_16x16x64_bf16 v[88:91], v[60:63], a[48:55], v1
  ds_read_b128 v[72:75], v26 offset:4096
  v_smfmac_f32_16x16x64_bf16 v[92:95], v[60:63], a[56:63], v1
  ds_read_b128 v[76:79], v27 offset:4096
  s_waitcnt lgkmcnt(3)
  v_smfmac_f32_16x16x64_bf16 v[88:91], v[64:67], a[64:71], v1
  ds_read_b128 v[104:107], v6 offset:8192
  v_smfmac_f32_16x16x64_bf16 v[92:95], v[64:67], a[72:79], v1
  ds_read_b128 v[108:111], v6 offset:9216
  s_waitcnt lgkmcnt(4)
  v_smfmac_f32_16x16x64_bf16 v[88:91], v[68:71], a[80:87], v1
  ds_read_b128 v[112:115], v6 offset:10240
  v_smfmac_f32_16x16x64_bf16 v[92:95], v[68:71], a[88:95], v1
  ds_read_b128 v[116:119], v6 offset:11264
  s_waitcnt lgkmcnt(4)
  v_smfmac_f32_16x16x64_bf16 v[88:91], v[72:75], a[96:103], v1
  buffer_load_dwordx4 v[140:143], v2, s[4:7], s30 offen offset:1024 sc1
  v_smfmac_f32_16x16x64_bf16 v[88:91], v[76:79], a[112:119], v1
  s_nop 0
  ds_read_b128 v[120:123], v6 offset:20480
  v_smfmac_f32_16x16x64_bf16 v[92:95], v[72:75], a[104:111], v1
  buffer_load_dwordx4 v[128:131], v2, s[4:7], s65 offen offset:0 sc1
  v_smfmac_f32_16x16x64_bf16 v[92:95], v[76:79], a[120:127], v1
  s_waitcnt lgkmcnt(1)
  s_nop 1
  v_add_f32 v88, v88, v89
  v_smfmac_f32_16x16x64_bf16 v[80:83], v[56:59], v[104:111], v1
  ds_read_b128 v[124:127], v6 offset:21504
  v_add_f32 v90, v90, v91
  v_smfmac_f32_16x16x64_bf16 v[84:87], v[56:59], v[112:119], v1
  ds_read_b128 v[104:107], v6 offset:22528
  v_add_f32 v92, v92, v93
  v_smfmac_f32_16x16x64_bf16 v[80:83], v[60:63], v[224:231], v1
  ds_read_b128 v[108:111], v6 offset:23552
  v_add_f32 v94, v94, v95
  v_smfmac_f32_16x16x64_bf16 v[84:87], v[60:63], v[232:239], v1
  v_cvt_pk_bf16_f32 v28, v88, v92
  v_cvt_pk_bf16_f32 v29, v90, v94
  v_smfmac_f32_16x16x64_bf16 v[80:83], v[64:67], v[240:247], v1
  ds_write_b64 v7, v[28:29] offset:8192
  v_smfmac_f32_16x16x64_bf16 v[84:87], v[64:67], v[248:255], v1
  buffer_store_dword v15, v24, s[4:7], s31 offen sc1
  v_smfmac_f32_16x16x64_bf16 v[80:83], v[72:75], a[0:7], v1
  ds_read_b128 v[112:115], v6 offset:24576
  v_smfmac_f32_16x16x64_bf16 v[84:87], v[72:75], a[8:15], v1
  ds_read_b128 v[116:119], v6 offset:25600
  s_waitcnt lgkmcnt(3)
  v_smfmac_f32_16x16x64_bf16 v[80:83], v[68:71], v[120:127], v1
  s_waitcnt lgkmcnt(2)
  s_barrier
  v_smfmac_f32_16x16x64_bf16 v[80:83], v[76:79], a[16:23], v1
  s_nop 0
  ds_read_b64_tr_b16 v[88:89], v8 offset:8192
  v_smfmac_f32_16x16x64_bf16 v[84:87], v[68:71], v[104:111], v1
  ds_read_b64_tr_b16 v[90:91], v8 offset:8704
  v_smfmac_f32_16x16x64_bf16 v[84:87], v[76:79], a[24:31], v1
  ds_read_b64_tr_b16 v[92:93], v8 offset:9216
  v_smfmac_f32_16x16x64_bf16 v[96:99], v[48:51], a[128:135], v1
  ds_read_b64_tr_b16 v[94:95], v8 offset:9728
  v_add_f32 v80, v80, v81
  v_smfmac_f32_16x16x64_bf16 v[100:103], v[48:51], a[136:143], v1
  ds_read_b128 v[120:123], v6 offset:26624
  v_add_f32 v82, v82, v83
  v_smfmac_f32_16x16x64_bf16 v[96:99], v[52:55], a[144:151], v1
  v_add_f32 v84, v84, v85
  v_add_f32 v86, v86, v87
  v_cvt_pk_bf16_f32 v22, v80, v84
  v_cvt_pk_bf16_f32 v23, v82, v86
  v_smfmac_f32_16x16x64_bf16 v[100:103], v[52:55], a[152:159], v1
  ds_write_b64 v7, v[22:23] offset:10240
  s_waitcnt lgkmcnt(2)
  v_mfma_f32_16x16x32_bf16 v[28:31], v[40:43], v[88:91], 0
  buffer_load_dwordx4 v[132:135], v2, s[4:7], s65 offen offset:1024 sc1
  v_mfma_f32_16x16x32_bf16 v[28:31], v[44:47], v[92:95], v[28:31]
  s_nop 0
  ds_read_b128 v[124:127], v6 offset:27648
  v_smfmac_f32_16x16x64_bf16 v[96:99], v[56:59], a[160:167], v1
  s_nop 0
  ds_read_b128 v[104:107], v6 offset:28672
  v_smfmac_f32_16x16x64_bf16 v[100:103], v[56:59], a[168:175], v1
  s_waitcnt lgkmcnt(2)
  s_barrier
  v_add_f32_dpp v14, v29, v28 quad_perm:[1,1,3,3] row_mask:0xf bank_mask:0xf
  v_smfmac_f32_16x16x64_bf16 v[96:99], v[60:63], a[176:183], v1
  ds_read_b64_tr_b16 v[80:81], v8 offset:10240
  v_add_f32_dpp v15, v31, v30 quad_perm:[1,1,3,3] row_mask:0xf bank_mask:0xf
  v_smfmac_f32_16x16x64_bf16 v[100:103], v[60:63], a[184:191], v1
  ds_read_b64_tr_b16 v[82:83], v8 offset:10752
  v_exp_f32 v28, v14
  v_smfmac_f32_16x16x64_bf16 v[96:99], v[64:67], a[192:199], v1
  ds_read_b64_tr_b16 v[84:85], v8 offset:11264
  v_exp_f32 v29, v15
  v_smfmac_f32_16x16x64_bf16 v[100:103], v[64:67], a[200:207], v1
  ds_read_b64_tr_b16 v[86:87], v8 offset:11776
  v_cvt_pk_bf16_f32 v30, v28, v29
  v_smfmac_f32_16x16x64_bf16 v[96:99], v[68:71], a[208:215], v1
  ds_write_b32 v13, v30 offset:14336
  v_smfmac_f32_16x16x64_bf16 v[100:103], v[68:71], a[216:223], v1
  ds_read_b128 v[108:111], v6 offset:29696
  s_waitcnt lgkmcnt(2)
  v_mfma_f32_16x16x32_bf16 v[44:47], v[80:83], v[88:91], 0
  ds_read_b128 v[64:67], v6 offset:30720
  v_mfma_f32_16x16x32_bf16 v[44:47], v[84:87], v[92:95], v[44:47]
  s_nop 0
  s_waitcnt vmcnt(5)
  v_mov_b64 v[48:49], 0
  v_smfmac_f32_16x16x64_bf16 v[96:99], v[72:75], a[224:231], v1
  s_waitcnt lgkmcnt(2)
  s_barrier
  v_smfmac_f32_16x16x64_bf16 v[96:99], v[76:79], a[240:247], v1
  ds_read_b128 v[28:31], v9 offset:14336
  v_add_f32_dpp v44, v45, v44 quad_perm:[1,1,3,3] row_mask:0xf bank_mask:0xf
  v_add_f32_dpp v46, v47, v46 quad_perm:[1,1,3,3] row_mask:0xf bank_mask:0xf
  v_smfmac_f32_16x16x64_bf16 v[100:103], v[72:75], a[232:239], v1
  ds_read_b128 v[40:43], v10 offset:14336
  v_mul_f32 v44, s64, v44
  v_mul_f32 v46, s64, v46
  v_smfmac_f32_16x16x64_bf16 v[100:103], v[76:79], a[248:255], v1
  ds_read_b128 v[68:71], v6 offset:31744
  v_add_f32 v96, v96, v97
  v_exp_f32_dpp v45, v44 quad_perm:[0,0,2,2] row_mask:0xf bank_mask:0xf
  v_exp_f32_dpp v47, v46 quad_perm:[0,0,2,2] row_mask:0xf bank_mask:0xf
  s_waitcnt lgkmcnt(2)
  v_mfma_f32_16x16x32_bf16 v[88:91], v[16:19], v[28:31], 0
  v_cvt_pk_bf16_f32 v23, v45, v47
  v_cndmask_b32 v22, 0, v23, s[66:67]
  v_mfma_f32_16x16x32_bf16 v[84:87], v[32:35], v[28:31], 0
  s_waitcnt lgkmcnt(1)
  v_cndmask_b32 v23, v23, 0, s[66:67]
  v_add_f32 v98, v98, v99
  v_mfma_f32_16x16x32_bf16 v[84:87], v[36:39], v[40:43], v[84:87]
  v_add_f32 v100, v100, v101
  v_add_f32 v102, v102, v103
  v_cvt_pk_bf16_f32 v21, v100, v102
  v_cvt_pk_bf16_f32 v20, v96, v98
  v_mfma_f32_16x16x16_bf16 v[88:91], v[16:17], v[22:23], v[88:91]
  v_mov_b64 v[50:51], 0
  v_mov_b64 v[52:53], 0
  v_mfma_f32_16x16x16_bf16 v[84:87], v[20:21], v[22:23], v[84:87]
  v_mov_b64 v[54:55], 0
  v_mov_b64 v[56:57], 0
  v_mov_b64 v[58:59], 0
  v_mov_b64 v[60:61], 0
  v_mov_b64 v[62:63], 0
  v_rcp_f32_dpp v96, v88 quad_perm:[0,0,2,2] row_mask:0xf bank_mask:0xf
  s_nop 0
  v_subrev_u32 v97, s29, v96
  v_cmp_lt_u32 vcc, s90, v97
  v_mul_f32 v84, v84, v96
  v_mul_f32 v85, v85, v96
  v_mul_f32 v86, v86, v96
  v_mul_f32_e64 v87, v87, v96
  v_cvt_pk_bf16_f32 v98, v84, v85
  v_cvt_pk_bf16_f32 v99, v86, v87
  ds_write_b64 v7, v[98:99] offset:12288
  s_cbranch_vccnz L_slow_32
L_back_33:
  v_mov_b32_dpp v80, v98 quad_perm:[0,0,2,2] row_mask:0xf bank_mask:0xf
  v_mov_b32_dpp v81, v99 quad_perm:[0,0,2,2] row_mask:0xf bank_mask:0xf
  v_mov_b32_dpp v82, v98 quad_perm:[1,1,3,3] row_mask:0xf bank_mask:0xf
  v_mov_b32_dpp v83, v99 quad_perm:[1,1,3,3] row_mask:0xf bank_mask:0xf
  s_nop 1
  v_smfmac_f32_16x16x64_bf16 v[48:51], v[80:83], v[144:151], v1
  s_waitcnt lgkmcnt(0)
  s_barrier
  ds_read_b128 v[92:95], v3 offset:12288
  v_smfmac_f32_16x16x64_bf16 v[52:55], v[80:83], v[152:159], v1
  ds_read_b128 v[28:31], v4 offset:12288
  v_smfmac_f32_16x16x64_bf16 v[56:59], v[80:83], v[160:167], v1
  ds_read_b128 v[40:43], v5 offset:12288
  v_smfmac_f32_16x16x64_bf16 v[60:63], v[80:83], v[168:175], v1
  ds_read_b128 v[72:75], v6 offset:32768
  s_waitcnt lgkmcnt(3)
  v_smfmac_f32_16x16x64_bf16 v[48:51], v[92:95], v[176:183], v1
  ds_read_b128 v[76:79], v6 offset:33792
  s_waitcnt lgkmcnt(3)
  v_smfmac_f32_16x16x64_bf16 v[48:51], v[28:31], v[192:199], v1
  ds_read_b128 v[32:35], v6 offset:34816
  s_waitcnt lgkmcnt(3)
  v_smfmac_f32_16x16x64_bf16 v[48:51], v[40:43], v[208:215], v1
  s_nop 0
  ds_read_b128 v[36:39], v6 offset:35840
  v_smfmac_f32_16x16x64_bf16 v[52:55], v[92:95], v[184:191], v1
  s_nop 2
  v_smfmac_f32_16x16x64_bf16 v[52:55], v[28:31], v[200:207], v1
  s_nop 0
  v_cvt_pk_bf16_f32 v96, v48, v49
  v_smfmac_f32_16x16x64_bf16 v[52:55], v[40:43], v[216:223], v1
  s_nop 0
  s_waitcnt lgkmcnt(12)
  v_cvt_pk_bf16_f32 v97, v50, v51
  v_smfmac_f32_16x16x64_bf16 v[56:59], v[92:95], v[112:119], v1
  buffer_store_dwordx2 v[96:97], v11, s[4:7], s18 offen offset:0
  v_smfmac_f32_16x16x64_bf16 v[56:59], v[28:31], v[120:127], v1
  s_nop 1
  v_cvt_pk_bf16_f32 v98, v52, v53
  v_smfmac_f32_16x16x64_bf16 v[56:59], v[40:43], v[104:111], v1
  s_nop 0
  s_waitcnt lgkmcnt(0)
  v_cvt_pk_bf16_f32 v99, v54, v55
  v_smfmac_f32_16x16x64_bf16 v[60:63], v[92:95], v[64:71], v1
  buffer_store_dwordx2 v[98:99], v11, s[4:7], s18 offen offset:2048
  v_smfmac_f32_16x16x64_bf16 v[60:63], v[28:31], v[72:79], v1
  s_nop 1
  v_cvt_pk_bf16_f32 v100, v56, v57
  v_smfmac_f32_16x16x64_bf16 v[60:63], v[40:43], v[32:39], v1
  v_cvt_pk_bf16_f32 v101, v58, v59
  buffer_store_dwordx2 v[100:101], v11, s[4:7], s19 offen offset:0
  s_add_u32 s14, s14, 1
  s_and_b32 s24, s14, 3
  s_lshl_b32 s24, s24, 13
  s_add_u32 s24, s24, 1048576
  v_mov_b32_e64 v15, -1
  s_nop 0
  v_cvt_pk_bf16_f32 v102, v60, v61
  v_cvt_pk_bf16_f32 v103, v62, v63
  buffer_store_dwordx2 v[102:103], v11, s[4:7], s19 offen offset:2048
  buffer_store_dword v15, v24, s[4:7], s28 offen
  ds_read_b128 v[88:91], v2 offset:15360
  v_and_b32_e64 v14, v96, v97
  v_bitop3_b32 v14, v14, v98, v99 bitop3:0x80
  v_bitop3_b32 v14, v14, v100, v101 bitop3:0x80
  v_bitop3_b32 v14, v14, v102, v103 bitop3:0x80
  v_bfi_b32 v14, v14, 0, s89
  v_cmp_lt_u32 vcc, 0xffff, v14
  ds_read_b128 v[56:59], v6 offset:0
  ds_read_b128 v[60:63], v6 offset:1024
  ds_read_b128 v[64:67], v6 offset:2048
  ds_read_b128 v[68:71], v6 offset:3072
  s_cbranch_vccnz L_fix_37
L_fix_37_b:
  ds_read_b128 v[72:75], v6 offset:4096
  ds_read_b128 v[76:79], v6 offset:5120
  ds_read_b128 v[104:107], v6 offset:6144
  ds_read_b128 v[108:111], v6 offset:7168
  ds_read_b128 v[112:115], v6 offset:12288
  ds_read_b128 v[116:119], v6 offset:13312
  ds_read_b128 v[120:123], v6 offset:14336
  ds_read_b128 v[124:127], v6 offset:15360
  s_waitcnt vmcnt(1)
  buffer_load_dwordx4 v[80:83], v2, s[4:7], s22 offen offset:0 sc1
  buffer_load_dwordx4 v[84:87], v2, s[4:7], s22 offen offset:1024 sc1
  s_mov_b32 s28, s17
  s_add_u32 s17, s24, s87
  s_add_u32 s15, s24, s40
  s_add_u32 s23, s24, s16
  s_lshl_b32 s31, s14, 13
  s_add_u32 s31, s31, s87
  s_add_u32 s31, s31, 1310720
  s_xor_b32 s29, s29, 0x40000000
  s_mov_b32 s91, 0
  s_add_u32 s30, s30, 524288
  s_add_u32 s65, s65, 524288
  s_waitcnt lgkmcnt(12)
  v_bfi_b32 v88, s89, 0, v88
  v_bfi_b32 v89, s89, 0, v89
  v_bfi_b32 v90, s89, 0, v90
  v_bfi_b32 v91, s89, 0, v91
  s_waitcnt vmcnt(1)
L_red_34_b:
  s_nop 0
  v_mfma_f32_16x16x32_bf16 v[92:95], v[88:91], v[80:83], 0
  s_nop 0
  v_bitop3_b32 v29, v80, v81, s89 bitop3:0x7e
  v_bitop3_b32 v30, v82, v83, s89 bitop3:0x7e
  v_or_b32_e64 v14, v29, v30
  s_waitcnt vmcnt(0)
  v_mfma_f32_16x16x32_bf16 v[92:95], v[88:91], v[84:87], v[92:95]
  v_bitop3_b32 v29, v84, v85, s89 bitop3:0x7e
  v_bitop3_b32 v30, v86, v87, s89 bitop3:0x7e
  v_or3_b32 v14, v14, v29, v30
  v_lshlrev_b32_e64 v14, 1, v14
  v_cmp_gt_i32_e64 vcc, 0, v14
  s_nop 2
  v_add_f32_dpp v92, v92, v92 row_ror:4 row_mask:0xf bank_mask:0xf
  v_add_f32_dpp v93, v93, v93 row_ror:4 row_mask:0xf bank_mask:0xf
  s_cbranch_vccnz L_red_34
  v_add_f32_dpp v92, v92, v92 row_ror:8 row_mask:0xf bank_mask:0xf
  v_add_f32_dpp v93, v93, v93 row_ror:8 row_mask:0xf bank_mask:0xf
  v_cvt_pk_bf16_f32 v15, v92, v93
  buffer_store_dword v15, v24, s[4:7], s17 offen
  s_cmp_lt_u32 s14, 63
  s_cbranch_scc1 L_top_30
L_end_38:
  buffer_store_dword v15, v24, s[4:7], s31 offen sc1
  s_branch L_done
L_fix_37:
  v_or_b32 v96, 0x40000000, v96
  v_or_b32 v97, 0x40000000, v97
  v_or_b32 v98, 0x40000000, v98
  v_or_b32 v99, 0x40000000, v99
  v_or_b32 v100, 0x40000000, v100
  v_or_b32 v101, 0x40000000, v101
  v_or_b32 v102, 0x40000000, v102
  v_or_b32 v103, 0x40000000, v103
  buffer_store_dwordx2 v[96:97], v11, s[4:7], s18 offen offset:0
  buffer_store_dwordx2 v[98:99], v11, s[4:7], s18 offen offset:2048
  buffer_store_dwordx2 v[100:101], v11, s[4:7], s19 offen offset:0
  buffer_store_dwordx2 v[102:103], v11, s[4:7], s19 offen offset:2048
  s_branch L_fix_37_b
L_red_34:
  buffer_load_dwordx4 v[80:83], v2, s[4:7], s22 offen offset:0 sc1
  buffer_load_dwordx4 v[84:87], v2, s[4:7], s22 offen offset:1024 sc1
  s_sub_u32 s33, s33, 1
  s_cbranch_scc1 L_done
  s_waitcnt vmcnt(0)
  s_branch L_red_34_b
L_re_35:
  buffer_load_dwordx4 v[48:51], v2, s[4:7], s15 offen sc1
  s_sub_u32 s33, s33, 1
  buffer_load_dwordx4 v[52:55], v2, s[4:7], s23 offen sc1
  s_nop 1
  v_mov_b64 v[88:89], 0
  v_mov_b64 v[90:91], 0
  v_mov_b64 v[92:93], 0
  v_mov_b64 v[94:95], 0
  s_cbranch_scc0 L_got_31_w
  s_branch L_done
L_rl_36:
  buffer_load_dwordx4 v[52:55], v2, s[4:7], s23 offen sc1
  s_waitcnt vmcnt(1)
  v_cmp_eq_u32 vcc, -1, v55
  s_cbranch_vccz L_rl_36_b
  s_sub_u32 s33, s33, 1
  s_cbranch_scc1 L_done
  s_branch L_rl_36
L_slow_32:
  v_cmp_u_f32 vcc, v96, v96
  s_cbranch_vccz L_slow_32_m
  s_bitcmp1_b32 s91, 0
  s_cbranch_scc1 L_slow_32_m
  s_mov_b32 s91, 1
  s_sub_u32 s24, s30, 524288
  buffer_load_dwordx4 v[40:43], v2, s[4:7], s24 offen offset:0 sc1
  buffer_load_dwordx4 v[44:47], v2, s[4:7], s24 offen offset:1024 sc1
L_slow_32_f:
  buffer_load_dwordx4 v[48:51], v2, s[4:7], s15 offen sc1
  buffer_load_dwordx4 v[52:55], v2, s[4:7], s23 offen sc1
  s_sub_u32 s33, s33, 1
  s_cbranch_scc1 L_done
  s_waitcnt vmcnt(0)
  v_max3_u32 v22, v48, v49, v50
  v_max_u32 v22, v22, v51
  v_max3_u32 v23, v52, v53, v54
  v_max_u32 v23, v23, v55
  v_max_u32 v22, v22, v23
  v_cmp_eq_u32 vcc, -1, v22
  s_cbranch_vccnz L_slow_32_f
  s_waitcnt lgkmcnt(0)
  ds_read_b128 v[56:59], v6 offset:0
  ds_read_b128 v[60:63], v6 offset:1024
  ds_read_b128 v[64:67], v6 offset:2048
  ds_read_b128 v[68:71], v6 offset:3072
  ds_read_b128 v[72:75], v6 offset:4096
  ds_read_b128 v[76:79], v6 offset:5120
  ds_read_b128 v[104:107], v6 offset:6144
  ds_read_b128 v[108:111], v6 offset:7168
  s_waitcnt lgkmcnt(0)
  ds_read_b128 v[112:115], v6 offset:12288
  ds_read_b128 v[116:119], v6 offset:13312
  ds_read_b128 v[120:123], v6 offset:14336
  ds_read_b128 v[124:127], v6 offset:15360
  ds_read_b128 v[128:131], v6 offset:16384
  ds_read_b128 v[132:135], v6 offset:17408
  ds_read_b128 v[136:139], v6 offset:18432
  ds_read_b128 v[140:143], v6 offset:19456
  v_mov_b64 v[80:81], 0
  v_mov_b64 v[82:83], 0
  v_mov_b64 v[84:85], 0
  v_mov_b64 v[86:87], 0
  v_mov_b64 v[88:89], 0
  v_mov_b64 v[90:91], 0
  v_mov_b64 v[92:93], 0
  v_mov_b64 v[94:95], 0
  v_mov_b64 v[96:97], 0
  v_mov_b64 v[98:99], 0
  v_mov_b64 v[100:101], 0
  v_mov_b64 v[102:103], 0
  v_add_u32 v14, s40, v2
  s_mov_b32 s31, 1835008
  s_waitcnt lgkmcnt(0)
  s_barrier
  s_branch L_got_31
L_slow_32_m:
  v_max3_f32 v96, v14, v15, v44
  v_max_f32 v96, v96, v46
  v_mov_b32 v97, v96
  s_nop 1
  v_permlane32_swap_b32 v96, v97
  v_max_f32 v96, v96, v97
  v_mov_b32 v97, v96
  s_nop 1
  v_permlane16_swap_b32 v96, v97
  v_max_f32 v96, v96, v97
  s_barrier
  ds_write_b32 v13, v96 offset:14336
  s_waitcnt lgkmcnt(0)
  s_barrier
  ds_read_b128 v[28:31], v9 offset:14336
  s_waitcnt lgkmcnt(0)
  s_barrier
  v_max3_f32 v96, v28, v29, v30
  v_max_f32 v96, v96, v31
  v_sub_f32 v14, v14, v96
  v_sub_f32 v15, v15, v96
  v_sub_f32 v44, v44, v96
  v_sub_f32 v46, v46, v96
  v_exp_f32 v28, v14
  v_exp_f32 v29, v15
  v_exp_f32_dpp v45, v44 quad_perm:[0,0,2,2] row_mask:0xf bank_mask:0xf
  v_exp_f32_dpp v47, v46 quad_perm:[0,0,2,2] row_mask:0xf bank_mask:0xf
  v_cvt_pk_bf16_f32 v30, v28, v29
  v_cvt_pk_bf16_f32 v23, v45, v47
  v_cndmask_b32 v22, 0, v23, s[66:67]
  v_cndmask_b32 v23, v23, 0, s[66:67]
  ds_write_b32 v13, v30 offset:14336
  s_waitcnt lgkmcnt(0)
  s_barrier
  ds_read_b128 v[28:31], v9 offset:14336
  ds_read_b128 v[40:43], v10 offset:14336
  s_waitcnt lgkmcnt(0)
  v_mfma_f32_16x16x32_bf16 v[88:91], v[16:19], v[28:31], 0
  s_nop 2
  v_mfma_f32_16x16x32_bf16 v[84:87], v[32:35], v[28:31], 0
  s_nop 0
  v_mfma_f32_16x16x32_bf16 v[84:87], v[36:39], v[40:43], v[84:87]
  s_nop 2
  v_mfma_f32_16x16x16_bf16 v[88:91], v[16:17], v[22:23], v[88:91]
  s_nop 2
  v_mfma_f32_16x16x16_bf16 v[84:87], v[20:21], v[22:23], v[84:87]
  s_nop 3
  v_rcp_f32_dpp v96, v88 quad_perm:[0,0,2,2] row_mask:0xf bank_mask:0xf
  s_nop 2
  v_mul_f32 v84, v84, v96
  v_mul_f32 v85, v85, v96
  v_mul_f32 v86, v86, v96
  v_mul_f32 v87, v87, v96
  v_cvt_pk_bf16_f32 v98, v84, v85
  v_cvt_pk_bf16_f32 v99, v86, v87
  ds_write_b64 v7, v[98:99] offset:12288
  s_branch L_back_33
L_wave3_10:
  s_branch L_got_40
  s_nop 0
  s_nop 0
  s_nop 0
  s_nop 0
  s_nop 0
  s_nop 0
L_top_39:
  s_barrier
  v_mov_b64 v[32:33], v[128:129]
  v_mov_b64 v[34:35], v[130:131]
  v_mov_b64 v[36:37], v[132:133]
  v_mov_b64 v[38:39], v[134:135]
  ds_read_b128 v[128:131], v6 offset:16384
  buffer_load_dwordx4 v[48:51], v2, s[4:7], s15 offen sc1
  ds_read_b128 v[132:135], v6 offset:17408
  v_mov_b64 v[40:41], v[136:137]
  v_mov_b64 v[42:43], v[138:139]
  v_mov_b64 v[44:45], v[140:141]
  v_mov_b64 v[46:47], v[142:143]
  ds_read_b128 v[136:139], v6 offset:18432
  ds_read_b128 v[140:143], v6 offset:19456
  buffer_load_dwordx4 v[52:55], v2, s[4:7], s23 offen sc1
  v_mov_b64 v[80:81], 0
  v_mov_b64 v[82:83], 0
  v_mov_b64 v[84:85], 0
  v_mov_b64 v[86:87], 0
  v_mov_b64 v[88:89], 0
  v_mov_b64 v[90:91], 0
  v_mov_b64 v[92:93], 0
  v_mov_b64 v[94:95], 0
  v_mov_b64_e64 v[96:97], 0
  v_mov_b64_e64 v[98:99], 0
  v_mov_b64_e64 v[100:101], 0
  v_mov_b64_e64 v[102:103], 0
  v_add_u32_e64 v14, s40, v2
  v_xor_b32 v16, 0x40004000, v16
  buffer_load_dwordx4 v[48:51], v2, s[4:7], s15 offen sc1
  v_xor_b32 v17, 0x40004000, v17
  v_xor_b32 v18, 0x40004000, v18
  v_xor_b32 v19, 0x40004000, v19
  s_xor_b32 s89, s89, 0x40004000
  s_nop 5
  buffer_load_dwordx4 v[52:55], v2, s[4:7], s23 offen sc1
  s_waitcnt lgkmcnt(0)
L_got_40_w:
  s_waitcnt vmcnt(3)
L_got_40:
  v_cmp_eq_u32_e64 vcc, -1, v51
  v_smfmac_f32_16x16x64_bf16 v[88:91], v[48:51], v[56:63], v1
  ds_write_b128 v14, v[48:51] offset:0
  v_smfmac_f32_16x16x64_bf16 v[92:95], v[48:51], v[64:71], v1
  s_cbranch_vccnz L_re_44
  s_waitcnt vmcnt(2)
  v_cmp_eq_u32_e64 vcc, -1, v55
  v_smfmac_f32_16x16x64_bf16 v[80:83], v[48:51], v[72:79], v1
  v_smfmac_f32_16x16x64_bf16 v[84:87], v[48:51], v[104:111], v1
  s_cbranch_vccnz L_rl_45
L_rl_45_b:
  v_smfmac_f32_16x16x64_bf16 v[88:91], v[52:55], v[112:119], v1
  ds_write_b128 v14, v[52:55] offset:4096
  v_smfmac_f32_16x16x64_bf16 v[92:95], v[52:55], v[120:127], v1
  s_waitcnt lgkmcnt(1)
  s_barrier
  ds_read_b128 v[56:59], v25 offset:0
  v_smfmac_f32_16x16x64_bf16 v[80:83], v[52:55], v[128:135], v1
  ds_read_b128 v[60:63], v26 offset:0
  v_smfmac_f32_16x16x64_bf16 v[84:87], v[52:55], v[136:143], v1
  ds_read_b128 v[64:67], v27 offset:0
  buffer_load_dwordx4 v[136:139], v2, s[4:7], s30 offen offset:0 sc1
  s_waitcnt lgkmcnt(2)
  v_smfmac_f32_16x16x64_bf16 v[88:91], v[56:59], a[32:39], v1
  s_barrier
  v_smfmac_f32_16x16x64_bf16 v[92:95], v[56:59], a[40:47], v1
  ds_read_b128 v[68:71], v25 offset:4096
  s_waitcnt lgkmcnt(2)
  v_smfmac_f32_16x16x64_bf16 v[88:91], v[60:63], a[48:55], v1
  ds_read_b128 v[72:75], v26 offset:4096
  v_smfmac_f32_16x16x64_bf16 v[92:95], v[60:63], a[56:63], v1
  ds_read_b128 v[76:79], v27 offset:4096
  s_waitcnt lgkmcnt(3)
  v_smfmac_f32_16x16x64_bf16 v[88:91], v[64:67], a[64:71], v1
  buffer_load_dwordx4 v[140:143], v2, s[4:7], s30 offen offset:1024 sc1
  v_smfmac_f32_16x16x64_bf16 v[92:95], v[64:67], a[72:79], v1
  ds_read_b128 v[104:107], v6 offset:8192
  s_waitcnt lgkmcnt(3)
  v_smfmac_f32_16x16x64_bf16 v[88:91], v[68:71], a[80:87], v1
  ds_read_b128 v[108:111], v6 offset:9216
  v_smfmac_f32_16x16x64_bf16 v[92:95], v[68:71], a[88:95], v1
  ds_read_b128 v[112:115], v6 offset:10240
  s_waitcnt lgkmcnt(3)
  v_smfmac_f32_16x16x64_bf16 v[88:91], v[72:75], a[96:103], v1
  ds_read_b128 v[116:119], v6 offset:11264
  v_smfmac_f32_16x16x64_bf16 v[88:91], v[76:79], a[112:119], v1
  buffer_load_dwordx4 v[128:131], v2, s[4:7], s65 offen offset:0 sc1
  v_smfmac_f32_16x16x64_bf16 v[92:95], v[72:75], a[104:111], v1
  s_nop 0
  ds_read_b128 v[120:123], v6 offset:20480
  v_smfmac_f32_16x16x64_bf16 v[92:95], v[76:79], a[120:127], v1
  s_waitcnt lgkmcnt(1)
  s_nop 1
  v_add_f32 v88, v88, v89
  v_smfmac_f32_16x16x64_bf16 v[80:83], v[56:59], v[104:111], v1
  ds_read_b128 v[124:127], v6 offset:21504
  v_add_f32 v90, v90, v91
  v_smfmac_f32_16x16x64_bf16 v[84:87], v[56:59], v[112:119], v1
  ds_read_b128 v[104:107], v6 offset:22528
  v_add_f32 v92, v92, v93
  v_smfmac_f32_16x16x64_bf16 v[80:83], v[60:63], v[224:231], v1
  ds_read_b128 v[108:111], v6 offset:23552
  v_add_f32 v94, v94, v95
  v_smfmac_f32_16x16x64_bf16 v[84:87], v[60:63], v[232:239], v1
  v_cvt_pk_bf16_f32 v28, v88, v92
  v_cvt_pk_bf16_f32 v29, v90, v94
  v_smfmac_f32_16x16x64_bf16 v[80:83], v[64:67], v[240:247], v1
  ds_write_b64 v7, v[28:29] offset:8192
  v_smfmac_f32_16x16x64_bf16 v[84:87], v[64:67], v[248:255], v1
  ds_read_b128 v[112:115], v6 offset:24576
  v_smfmac_f32_16x16x64_bf16 v[80:83], v[72:75], a[0:7], v1
  buffer_store_dword v15, v24, s[4:7], s31 offen sc1
  v_smfmac_f32_16x16x64_bf16 v[84:87], v[72:75], a[8:15], v1
  ds_read_b128 v[116:119], v6 offset:25600
  s_waitcnt lgkmcnt(3)
  v_smfmac_f32_16x16x64_bf16 v[80:83], v[68:71], v[120:127], v1
  s_waitcnt lgkmcnt(2)
  s_barrier
  v_smfmac_f32_16x16x64_bf16 v[80:83], v[76:79], a[16:23], v1
  s_nop 0
  ds_read_b64_tr_b16 v[88:89], v8 offset:8192
  v_smfmac_f32_16x16x64_bf16 v[84:87], v[68:71], v[104:111], v1
  ds_read_b64_tr_b16 v[90:91], v8 offset:8704
  v_smfmac_f32_16x16x64_bf16 v[84:87], v[76:79], a[24:31], v1
  ds_read_b64_tr_b16 v[92:93], v8 offset:9216
  v_smfmac_f32_16x16x64_bf16 v[96:99], v[48:51], a[128:135], v1
  ds_read_b64_tr_b16 v[94:95], v8 offset:9728
  v_add_f32 v80, v80, v81
  v_smfmac_f32_16x16x64_bf16 v[100:103], v[48:51], a[136:143], v1
  ds_read_b128 v[120:123], v6 offset:26624
  v_add_f32 v82, v82, v83
  v_smfmac_f32_16x16x64_bf16 v[96:99], v[52:55], a[144:151], v1
  v_add_f32 v84, v84, v85
  v_add_f32 v86, v86, v87
  v_cvt_pk_bf16_f32 v22, v80, v84
  v_cvt_pk_bf16_f32 v23, v82, v86
  v_smfmac_f32_16x16x64_bf16 v[100:103], v[52:55], a[152:159], v1
  ds_write_b64 v7, v[22:23] offset:10240
  s_waitcnt lgkmcnt(2)
  v_mfma_f32_16x16x32_bf16 v[28:31], v[40:43], v[88:91], 0
  ds_read_b128 v[124:127], v6 offset:27648
  v_mfma_f32_16x16x32_bf16 v[28:31], v[44:47], v[92:95], v[28:31]
  buffer_load_dwordx4 v[132:135], v2, s[4:7], s65 offen offset:1024 sc1
  v_smfmac_f32_16x16x64_bf16 v[96:99], v[56:59], a[160:167], v1
  s_nop 0
  ds_read_b128 v[104:107], v6 offset:28672
  v_smfmac_f32_16x16x64_bf16 v[100:103], v[56:59], a[168:175], v1
  s_waitcnt lgkmcnt(2)
  s_barrier
  s_nop 0
  v_add_f32_dpp v14, v29, v28 quad_perm:[1,1,3,3] row_mask:0xf bank_mask:0xf
  v_smfmac_f32_16x16x64_bf16 v[96:99], v[60:63], a[176:183], v1
  ds_read_b64_tr_b16 v[80:81], v8 offset:10240
  v_add_f32_dpp v15, v31, v30 quad_perm:[1,1,3,3] row_mask:0xf bank_mask:0xf
  v_smfmac_f32_16x16x64_bf16 v[100:103], v[60:63], a[184:191], v1
  ds_read_b64_tr_b16 v[82:83], v8 offset:10752
  v_exp_f32 v28, v14
  v_smfmac_f32_16x16x64_bf16 v[96:99], v[64:67], a[192:199], v1
  ds_read_b64_tr_b16 v[84:85], v8 offset:11264
  v_exp_f32 v29, v15
  v_smfmac_f32_16x16x64_bf16 v[100:103], v[64:67], a[200:207], v1
  ds_read_b64_tr_b16 v[86:87], v8 offset:11776
  v_cvt_pk_bf16_f32 v30, v28, v29
  v_smfmac_f32_16x16x64_bf16 v[96:99], v[68:71], a[208:215], v1
  ds_write_b32 v13, v30 offset:14336
  v_smfmac_f32_16x16x64_bf16 v[100:103], v[68:71], a[216:223], v1
  ds_read_b128 v[108:111], v6 offset:29696
  s_waitcnt lgkmcnt(2)
  v_mfma_f32_16x16x32_bf16 v[44:47], v[80:83], v[88:91], 0
  ds_read_b128 v[64:67], v6 offset:30720
  v_mfma_f32_16x16x32_bf16 v[44:47], v[84:87], v[92:95], v[44:47]
  s_nop 0
  s_waitcnt vmcnt(5)
  v_mov_b64 v[48:49], 0
  v_smfmac_f32_16x16x64_bf16 v[96:99], v[72:75], a[224:231], v1
  s_waitcnt lgkmcnt(2)
  s_barrier
  v_smfmac_f32_16x16x64_bf16 v[96:99], v[76:79], a[240:247], v1
  ds_read_b128 v[28:31], v9 offset:14336
  v_add_f32_dpp v44, v45, v44 quad_perm:[1,1,3,3] row_mask:0xf bank_mask:0xf
  v_add_f32_dpp v46, v47, v46 quad_perm:[1,1,3,3] row_mask:0xf bank_mask:0xf
  v_smfmac_f32_16x16x64_bf16 v[100:103], v[72:75], a[232:239], v1
  ds_read_b128 v[40:43], v10 offset:14336
  v_mul_f32 v44, s64, v44
  v_mul_f32 v46, s64, v46
  v_smfmac_f32_16x16x64_bf16 v[100:103], v[76:79], a[248:255], v1
  ds_read_b128 v[68:71], v6 offset:31744
  v_add_f32 v96, v96, v97
  v_exp_f32_dpp v45, v44 quad_perm:[0,0,2,2] row_mask:0xf bank_mask:0xf
  v_exp_f32_dpp v47, v46 quad_perm:[0,0,2,2] row_mask:0xf bank_mask:0xf
  s_waitcnt lgkmcnt(2)
  v_mfma_f32_16x16x32_bf16 v[88:91], v[16:19], v[28:31], 0
  v_cvt_pk_bf16_f32 v23, v45, v47
  v_cndmask_b32 v22, 0, v23, s[66:67]
  v_mfma_f32_16x16x32_bf16 v[84:87], v[32:35], v[28:31], 0
  s_waitcnt lgkmcnt(1)
  v_cndmask_b32 v23, v23, 0, s[66:67]
  v_add_f32 v98, v98, v99
  v_mfma_f32_16x16x32_bf16 v[84:87], v[36:39], v[40:43], v[84:87]
  v_add_f32 v100, v100, v101
  v_add_f32 v102, v102, v103
  v_cvt_pk_bf16_f32 v21, v100, v102
  v_cvt_pk_bf16_f32 v20, v96, v98
  v_mfma_f32_16x16x16_bf16 v[88:91], v[16:17], v[22:23], v[88:91]
  v_mov_b64 v[50:51], 0
  v_mov_b64 v[52:53], 0
  v_mfma_f32_16x16x16_bf16 v[84:87], v[20:21], v[22:23], v[84:87]
  v_mov_b64 v[54:55], 0
  v_mov_b64 v[56:57], 0
  v_mov_b64 v[58:59], 0
  v_mov_b64 v[60:61], 0
  v_mov_b64 v[62:63], 0
  v_rcp_f32_dpp v96, v88 quad_perm:[0,0,2,2] row_mask:0xf bank_mask:0xf
  s_nop 0
  v_subrev_u32 v97, s29, v96
  v_cmp_lt_u32 vcc, s90, v97
  v_mul_f32 v84, v84, v96
  v_mul_f32 v85, v85, v96
  v_mul_f32 v86, v86, v96
  v_mul_f32_e64 v87, v87, v96
  v_cvt_pk_bf16_f32 v98, v84, v85
  v_cvt_pk_bf16_f32 v99, v86, v87
  ds_write_b64 v7, v[98:99] offset:12288
  s_cbranch_vccnz L_slow_41
L_back_42:
  v_mov_b32_dpp v80, v98 quad_perm:[0,0,2,2] row_mask:0xf bank_mask:0xf
  v_mov_b32_dpp v81, v99 quad_perm:[0,0,2,2] row_mask:0xf bank_mask:0xf
  v_mov_b32_dpp v82, v98 quad_perm:[1,1,3,3] row_mask:0xf bank_mask:0xf
  v_mov_b32_dpp v83, v99 quad_perm:[1,1,3,3] row_mask:0xf bank_mask:0xf
  s_nop 1
  v_smfmac_f32_16x16x64_bf16 v[48:51], v[80:83], v[144:151], v1
  s_waitcnt lgkmcnt(0)
  s_barrier
  ds_read_b128 v[92:95], v3 offset:12288
  v_smfmac_f32_16x16x64_bf16 v[52:55], v[80:83], v[152:159], v1
  ds_read_b128 v[28:31], v4 offset:12288
  v_smfmac_f32_16x16x64_bf16 v[56:59], v[80:83], v[160:167], v1
  ds_read_b128 v[40:43], v5 offset:12288
  v_smfmac_f32_16x16x64_bf16 v[60:63], v[80:83], v[168:175], v1
  ds_read_b128 v[72:75], v6 offset:32768
  s_waitcnt lgkmcnt(3)
  v_smfmac_f32_16x16x64_bf16 v[48:51], v[92:95], v[176:183], v1
  ds_read_b128 v[76:79], v6 offset:33792
  s_waitcnt lgkmcnt(3)
  v_smfmac_f32_16x16x64_bf16 v[48:51], v[28:31], v[192:199], v1
  ds_read_b128 v[32:35], v6 offset:34816
  s_waitcnt lgkmcnt(3)
  v_smfmac_f32_16x16x64_bf16 v[48:51], v[40:43], v[208:215], v1
  s_nop 0
  ds_read_b128 v[36:39], v6 offset:35840
  v_smfmac_f32_16x16x64_bf16 v[52:55], v[92:95], v[184:191], v1
  s_nop 2
  v_smfmac_f32_16x16x64_bf16 v[52:55], v[28:31], v[200:207], v1
  s_nop 0
  v_cvt_pk_bf16_f32 v96, v48, v49
  v_smfmac_f32_16x16x64_bf16 v[52:55], v[40:43], v[216:223], v1
  s_nop 0
  s_waitcnt lgkmcnt(12)
  v_cvt_pk_bf16_f32 v97, v50, v51
  v_smfmac_f32_16x16x64_bf16 v[56:59], v[92:95], v[112:119], v1
  buffer_store_dwordx2 v[96:97], v11, s[4:7], s18 offen offset:0
  v_smfmac_f32_16x16x64_bf16 v[56:59], v[28:31], v[120:127], v1
  s_nop 1
  v_cvt_pk_bf16_f32 v98, v52, v53
  v_smfmac_f32_16x16x64_bf16 v[56:59], v[40:43], v[104:111], v1
  s_nop 0
  s_waitcnt lgkmcnt(0)
  v_cvt_pk_bf16_f32 v99, v54, v55
  v_smfmac_f32_16x16x64_bf16 v[60:63], v[92:95], v[64:71], v1
  buffer_store_dwordx2 v[98:99], v11, s[4:7], s18 offen offset:2048
  v_smfmac_f32_16x16x64_bf16 v[60:63], v[28:31], v[72:79], v1
  s_nop 1
  v_cvt_pk_bf16_f32 v100, v56, v57
  v_smfmac_f32_16x16x64_bf16 v[60:63], v[40:43], v[32:39], v1
  v_cvt_pk_bf16_f32 v101, v58, v59
  buffer_store_dwordx2 v[100:101], v11, s[4:7], s19 offen offset:0
  s_add_u32 s14, s14, 1
  s_and_b32 s24, s14, 3
  s_lshl_b32 s24, s24, 13
  s_add_u32 s24, s24, 1048576
  v_mov_b32_e64 v15, -1
  s_nop 0
  v_cvt_pk_bf16_f32 v102, v60, v61
  v_cvt_pk_bf16_f32 v103, v62, v63
  buffer_store_dwordx2 v[102:103], v11, s[4:7], s19 offen offset:2048
  buffer_store_dword v15, v24, s[4:7], s28 offen
  ds_read_b128 v[88:91], v2 offset:15360
  v_and_b32_e64 v14, v96, v97
  v_bitop3_b32 v14, v14, v98, v99 bitop3:0x80
  v_bitop3_b32 v14, v14, v100, v101 bitop3:0x80
  v_bitop3_b32 v14, v14, v102, v103 bitop3:0x80
  v_bfi_b32 v14, v14, 0, s89
  v_cmp_lt_u32 vcc, 0xffff, v14
  ds_read_b128 v[56:59], v6 offset:0
  ds_read_b128 v[60:63], v6 offset:1024
  ds_read_b128 v[64:67], v6 offset:2048
  ds_read_b128 v[68:71], v6 offset:3072
  s_cbranch_vccnz L_fix_46
L_fix_46_b:
  ds_read_b128 v[72:75], v6 offset:4096
  ds_read_b128 v[76:79], v6 offset:5120
  ds_read_b128 v[104:107], v6 offset:6144
  ds_read_b128 v[108:111], v6 offset:7168
  ds_read_b128 v[112:115], v6 offset:12288
  ds_read_b128 v[116:119], v6 offset:13312
  ds_read_b128 v[120:123], v6 offset:14336
  ds_read_b128 v[124:127], v6 offset:15360
  s_waitcnt vmcnt(1)
  s_mov_b32 s28, s17
  s_add_u32 s17, s24, s87
  s_add_u32 s15, s24, s40
  s_add_u32 s23, s24, s16
  s_lshl_b32 s31, s14, 13
  s_add_u32 s31, s31, s87
  buffer_load_dwordx4 v[80:83], v2, s[4:7], s22 offen offset:0 sc1
  buffer_load_dwordx4 v[84:87], v2, s[4:7], s22 offen offset:1024 sc1
  s_add_u32 s31, s31, 1310720
  s_xor_b32 s29, s29, 0x40000000
  s_mov_b32 s91, 0
  s_add_u32 s30, s30, 524288
  s_add_u32 s65, s65, 524288
  s_waitcnt lgkmcnt(12)
  v_bfi_b32 v88, s89, 0, v88
  v_bfi_b32 v89, s89, 0, v89
  v_bfi_b32 v90, s89, 0, v90
  v_bfi_b32 v91, s89, 0, v91
  s_waitcnt vmcnt(1)
L_red_43_b:
  s_nop 0
  v_mfma_f32_16x16x32_bf16 v[92:95], v[88:91], v[80:83], 0
  s_nop 0
  v_bitop3_b32 v29, v80, v81, s89 bitop3:0x7e
  v_bitop3_b32 v30, v82, v83, s89 bitop3:0x7e
  v_or_b32_e64 v14, v29, v30
  s_waitcnt vmcnt(0)
  v_mfma_f32_16x16x32_bf16 v[92:95], v[88:91], v[84:87], v[92:95]
  v_bitop3_b32 v29, v84, v85, s89 bitop3:0x7e
  v_bitop3_b32 v30, v86, v87, s89 bitop3:0x7e
  v_or3_b32 v14, v14, v29, v30
  v_lshlrev_b32_e64 v14, 1, v14
  v_cmp_gt_i32_e64 vcc, 0, v14
  s_nop 2
  v_add_f32_dpp v92, v92, v92 row_ror:4 row_mask:0xf bank_mask:0xf
  v_add_f32_dpp v93, v93, v93 row_ror:4 row_mask:0xf bank_mask:0xf
  s_cbranch_vccnz L_red_43
  v_add_f32_dpp v92, v92, v92 row_ror:8 row_mask:0xf bank_mask:0xf
  v_add_f32_dpp v93, v93, v93 row_ror:8 row_mask:0xf bank_mask:0xf
  v_cvt_pk_bf16_f32 v15, v92, v93
  buffer_store_dword v15, v24, s[4:7], s17 offen
  s_cmp_lt_u32 s14, 63
  s_cbranch_scc1 L_top_39
L_end_47:
  buffer_store_dword v15, v24, s[4:7], s31 offen sc1
  s_branch L_done
L_fix_46:
  v_or_b32 v96, 0x40000000, v96
  v_or_b32 v97, 0x40000000, v97
  v_or_b32 v98, 0x40000000, v98
  v_or_b32 v99, 0x40000000, v99
  v_or_b32 v100, 0x40000000, v100
  v_or_b32 v101, 0x40000000, v101
  v_or_b32 v102, 0x40000000, v102
  v_or_b32 v103, 0x40000000, v103
  buffer_store_dwordx2 v[96:97], v11, s[4:7], s18 offen offset:0
  buffer_store_dwordx2 v[98:99], v11, s[4:7], s18 offen offset:2048
  buffer_store_dwordx2 v[100:101], v11, s[4:7], s19 offen offset:0
  buffer_store_dwordx2 v[102:103], v11, s[4:7], s19 offen offset:2048
  s_branch L_fix_46_b
L_red_43:
  buffer_load_dwordx4 v[80:83], v2, s[4:7], s22 offen offset:0 sc1
  buffer_load_dwordx4 v[84:87], v2, s[4:7], s22 offen offset:1024 sc1
  s_sub_u32 s33, s33, 1
  s_cbranch_scc1 L_done
  s_waitcnt vmcnt(0)
  s_branch L_red_43_b
L_re_44:
  buffer_load_dwordx4 v[48:51], v2, s[4:7], s15 offen sc1
  s_sub_u32 s33, s33, 1
  buffer_load_dwordx4 v[52:55], v2, s[4:7], s23 offen sc1
  s_nop 1
  v_mov_b64 v[88:89], 0
  v_mov_b64 v[90:91], 0
  v_mov_b64 v[92:93], 0
  v_mov_b64 v[94:95], 0
  s_cbranch_scc0 L_got_40_w
  s_branch L_done
L_rl_45:
  buffer_load_dwordx4 v[52:55], v2, s[4:7], s23 offen sc1
  s_waitcnt vmcnt(1)
  v_cmp_eq_u32 vcc, -1, v55
  s_cbranch_vccz L_rl_45_b
  s_sub_u32 s33, s33, 1
  s_cbranch_scc1 L_done
  s_branch L_rl_45
L_slow_41:
  v_cmp_u_f32 vcc, v96, v96
  s_cbranch_vccz L_slow_41_m
  s_bitcmp1_b32 s91, 0
  s_cbranch_scc1 L_slow_41_m
  s_mov_b32 s91, 1
  s_sub_u32 s24, s30, 524288
  buffer_load_dwordx4 v[40:43], v2, s[4:7], s24 offen offset:0 sc1
  buffer_load_dwordx4 v[44:47], v2, s[4:7], s24 offen offset:1024 sc1
L_slow_41_f:
  buffer_load_dwordx4 v[48:51], v2, s[4:7], s15 offen sc1
  buffer_load_dwordx4 v[52:55], v2, s[4:7], s23 offen sc1
  s_sub_u32 s33, s33, 1
  s_cbranch_scc1 L_done
  s_waitcnt vmcnt(0)
  v_max3_u32 v22, v48, v49, v50
  v_max_u32 v22, v22, v51
  v_max3_u32 v23, v52, v53, v54
  v_max_u32 v23, v23, v55
  v_max_u32 v22, v22, v23
  v_cmp_eq_u32 vcc, -1, v22
  s_cbranch_vccnz L_slow_41_f
  s_waitcnt lgkmcnt(0)
  ds_read_b128 v[56:59], v6 offset:0
  ds_read_b128 v[60:63], v6 offset:1024
  ds_read_b128 v[64:67], v6 offset:2048
  ds_read_b128 v[68:71], v6 offset:3072
  ds_read_b128 v[72:75], v6 offset:4096
  ds_read_b128 v[76:79], v6 offset:5120
  ds_read_b128 v[104:107], v6 offset:6144
  ds_read_b128 v[108:111], v6 offset:7168
  s_waitcnt lgkmcnt(0)
  ds_read_b128 v[112:115], v6 offset:12288
  ds_read_b128 v[116:119], v6 offset:13312
  ds_read_b128 v[120:123], v6 offset:14336
  ds_read_b128 v[124:127], v6 offset:15360
  ds_read_b128 v[128:131], v6 offset:16384
  ds_read_b128 v[132:135], v6 offset:17408
  ds_read_b128 v[136:139], v6 offset:18432
  ds_read_b128 v[140:143], v6 offset:19456
  v_mov_b64 v[80:81], 0
  v_mov_b64 v[82:83], 0
  v_mov_b64 v[84:85], 0
  v_mov_b64 v[86:87], 0
  v_mov_b64 v[88:89], 0
  v_mov_b64 v[90:91], 0
  v_mov_b64 v[92:93], 0
  v_mov_b64 v[94:95], 0
  v_mov_b64 v[96:97], 0
  v_mov_b64 v[98:99], 0
  v_mov_b64 v[100:101], 0
  v_mov_b64 v[102:103], 0
  v_add_u32 v14, s40, v2
  s_mov_b32 s31, 1835008
  s_waitcnt lgkmcnt(0)
  s_barrier
  s_branch L_got_40
L_slow_41_m:
  v_max3_f32 v96, v14, v15, v44
  v_max_f32 v96, v96, v46
  v_mov_b32 v97, v96
  s_nop 1
  v_permlane32_swap_b32 v96, v97
  v_max_f32 v96, v96, v97
  v_mov_b32 v97, v96
  s_nop 1
  v_permlane16_swap_b32 v96, v97
  v_max_f32 v96, v96, v97
  s_barrier
  ds_write_b32 v13, v96 offset:14336
  s_waitcnt lgkmcnt(0)
  s_barrier
  ds_read_b128 v[28:31], v9 offset:14336
  s_waitcnt lgkmcnt(0)
  s_barrier
  v_max3_f32 v96, v28, v29, v30
  v_max_f32 v96, v96, v31
  v_sub_f32 v14, v14, v96
  v_sub_f32 v15, v15, v96
  v_sub_f32 v44, v44, v96
  v_sub_f32 v46, v46, v96
  v_exp_f32 v28, v14
  v_exp_f32 v29, v15
  v_exp_f32_dpp v45, v44 quad_perm:[0,0,2,2] row_mask:0xf bank_mask:0xf
  v_exp_f32_dpp v47, v46 quad_perm:[0,0,2,2] row_mask:0xf bank_mask:0xf
  v_cvt_pk_bf16_f32 v30, v28, v29
  v_cvt_pk_bf16_f32 v23, v45, v47
  v_cndmask_b32 v22, 0, v23, s[66:67]
  v_cndmask_b32 v23, v23, 0, s[66:67]
  ds_write_b32 v13, v30 offset:14336
  s_waitcnt lgkmcnt(0)
  s_barrier
  ds_read_b128 v[28:31], v9 offset:14336
  ds_read_b128 v[40:43], v10 offset:14336
  s_waitcnt lgkmcnt(0)
  v_mfma_f32_16x16x32_bf16 v[88:91], v[16:19], v[28:31], 0
  s_nop 2
  v_mfma_f32_16x16x32_bf16 v[84:87], v[32:35], v[28:31], 0
  s_nop 0
  v_mfma_f32_16x16x32_bf16 v[84:87], v[36:39], v[40:43], v[84:87]
  s_nop 2
  v_mfma_f32_16x16x16_bf16 v[88:91], v[16:17], v[22:23], v[88:91]
  s_nop 2
  v_mfma_f32_16x16x16_bf16 v[84:87], v[20:21], v[22:23], v[84:87]
  s_nop 3
  v_rcp_f32_dpp v96, v88 quad_perm:[0,0,2,2] row_mask:0xf bank_mask:0xf
  s_nop 2
  v_mul_f32 v84, v84, v96
  v_mul_f32 v85, v85, v96
  v_mul_f32 v86, v86, v96
  v_mul_f32 v87, v87, v96
  v_cvt_pk_bf16_f32 v98, v84, v85
  v_cvt_pk_bf16_f32 v99, v86, v87
  ds_write_b64 v7, v[98:99] offset:12288
  s_branch L_back_42
L_Q:
  s_load_dwordx2 s[8:9], s[0:1], 0
  s_mov_b32 s10, 2097152
  s_mov_b32 s11, 0x20000
  s_sub_u32 s24, s3, 32
  s_mul_i32 s12, s24, 171
  s_lshr_b32 s12, s12, 9
  s_mul_i32 s25, s12, 3
  s_sub_u32 s14, s24, s25
  v_and_b32 v100, 63, v0
  v_and_b32 v101, 15, v100
  v_lshrrev_b32 v102, 4, v100
  v_lshlrev_b32 v1, 4, v100
  v_lshlrev_b32 v103, 1, v102
  v_xor_b32 v103, v103, v101
  v_lshlrev_b32 v103, 4, v103
  v_lshl_add_u32 v103, v102, 13, v103
  s_lshl_b32 s24, s12, 8
  s_lshl_b32 s25, s13, 17
  s_add_u32 s24, s24, s25
  v_add_u32 v106, s24, v103
  v_xor_b32 v107, 128, v106
  s_lshl_b32 s27, s13, 12
  s_lshl_b32 s31, s14, 20
  s_waitcnt lgkmcnt(0)
  s_add_u32 m0, s27, 0
  s_xor_b32 s25, s31, 0
  buffer_load_dwordx4 v106, s[52:55], s25 offen lds
  s_add_u32 m0, s27, 1024
  s_xor_b32 s25, s31, 32768
  buffer_load_dwordx4 v106, s[52:55], s25 offen lds
  s_add_u32 m0, s27, 2048
  s_xor_b32 s25, s31, 65536
  buffer_load_dwordx4 v107, s[52:55], s25 offen lds
  s_add_u32 m0, s27, 3072
  s_xor_b32 s25, s31, 98304
  buffer_load_dwordx4 v107, s[52:55], s25 offen lds
  s_add_u32 m0, s27, 16384
  s_xor_b32 s25, s31, 524288
  buffer_load_dwordx4 v106, s[52:55], s25 offen lds
  s_add_u32 m0, s27, 17408
  s_xor_b32 s25, s31, 557056
  buffer_load_dwordx4 v106, s[52:55], s25 offen lds
  s_add_u32 m0, s27, 18432
  s_xor_b32 s25, s31, 589824
  buffer_load_dwordx4 v107, s[52:55], s25 offen lds
  s_add_u32 m0, s27, 19456
  s_xor_b32 s25, s31, 622592
  buffer_load_dwordx4 v107, s[52:55], s25 offen lds
  s_add_u32 m0, s27, 32768
  s_xor_b32 s25, s31, 1048576
  buffer_load_dwordx4 v106, s[52:55], s25 offen lds
  s_add_u32 m0, s27, 33792
  s_xor_b32 s25, s31, 1081344
  buffer_load_dwordx4 v106, s[52:55], s25 offen lds
  s_add_u32 m0, s27, 34816
  s_xor_b32 s25, s31, 1114112
  buffer_load_dwordx4 v107, s[52:55], s25 offen lds
  s_add_u32 m0, s27, 35840
  s_xor_b32 s25, s31, 1146880
  buffer_load_dwordx4 v107, s[52:55], s25 offen lds
  s_add_u32 m0, s27, 49152
  s_xor_b32 s25, s31, 1572864
  buffer_load_dwordx4 v106, s[52:55], s25 offen lds
  s_add_u32 m0, s27, 50176
  s_xor_b32 s25, s31, 1605632
  buffer_load_dwordx4 v106, s[52:55], s25 offen lds
  s_add_u32 m0, s27, 51200
  s_xor_b32 s25, s31, 1638400
  buffer_load_dwordx4 v107, s[52:55], s25 offen lds
  s_add_u32 m0, s27, 52224
  s_xor_b32 s25, s31, 1671168
  buffer_load_dwordx4 v107, s[52:55], s25 offen lds
  s_add_u32 m0, s27, 65536
  s_xor_b32 s25, s31, 2097152
  buffer_load_dwordx4 v106, s[52:55], s25 offen lds
  s_add_u32 m0, s27, 66560
  s_xor_b32 s25, s31, 2129920
  buffer_load_dwordx4 v106, s[52:55], s25 offen lds
  s_add_u32 m0, s27, 67584
  s_xor_b32 s25, s31, 2162688
  buffer_load_dwordx4 v107, s[52:55], s25 offen lds
  s_add_u32 m0, s27, 68608
  s_xor_b32 s25, s31, 2195456
  buffer_load_dwordx4 v107, s[52:55], s25 offen lds
  s_add_u32 m0, s27, 81920
  s_xor_b32 s25, s31, 2621440
  buffer_load_dwordx4 v106, s[52:55], s25 offen lds
  s_add_u32 m0, s27, 82944
  s_xor_b32 s25, s31, 2654208
  buffer_load_dwordx4 v106, s[52:55], s25 offen lds
  s_add_u32 m0, s27, 83968
  s_xor_b32 s25, s31, 2686976
  buffer_load_dwordx4 v107, s[52:55], s25 offen lds
  s_add_u32 m0, s27, 84992
  s_xor_b32 s25, s31, 2719744
  buffer_load_dwordx4 v107, s[52:55], s25 offen lds
  s_add_u32 m0, s27, 98304
  s_xor_b32 s25, s31, 3145728
  buffer_load_dwordx4 v106, s[52:55], s25 offen lds
  s_add_u32 m0, s27, 99328
  s_xor_b32 s25, s31, 3178496
  buffer_load_dwordx4 v106, s[52:55], s25 offen lds
  s_add_u32 m0, s27, 100352
  s_xor_b32 s25, s31, 3211264
  buffer_load_dwordx4 v107, s[52:55], s25 offen lds
  s_add_u32 m0, s27, 101376
  s_xor_b32 s25, s31, 3244032
  buffer_load_dwordx4 v107, s[52:55], s25 offen lds
  s_and_b32 s24, s13, 1
  s_lshl_b32 s25, s24, 7
  s_lshl_b32 s26, s14, 8
  s_add_u32 s25, s25, s26
  v_xor_b32 v7, s25, v1
  s_lshl_b32 s24, s24, 12
  s_lshr_b32 s25, s13, 1
  s_lshl_b32 s25, s25, 14
  s_add_u32 s19, s24, s25
  s_lshl_b32 s24, s14, 15
  s_add_u32 s19, s19, s24
  s_lshl_b32 s18, s13, 13
  s_add_u32 s18, s18, 131072
  v_xor_b32 v14, 0, v7
  s_add_u32 m0, s18, 0
  s_add_u32 s24, s19, 0
  buffer_load_dwordx4 v14, s[8:11], s24 offen lds
  v_xor_b32 v15, 16, v7
  s_add_u32 m0, s18, 1024
  s_add_u32 s24, s19, 1024
  buffer_load_dwordx4 v15, s[8:11], s24 offen lds
  v_xor_b32 v14, 32, v7
  s_add_u32 m0, s18, 2048
  s_add_u32 s24, s19, 8192
  buffer_load_dwordx4 v14, s[8:11], s24 offen lds
  v_xor_b32 v15, 48, v7
  s_add_u32 m0, s18, 3072
  s_add_u32 s24, s19, 9216
  buffer_load_dwordx4 v15, s[8:11], s24 offen lds
  v_xor_b32 v14, 64, v7
  s_add_u32 m0, s18, 4096
  s_add_u32 s24, s19, 2048
  buffer_load_dwordx4 v14, s[8:11], s24 offen lds
  v_xor_b32 v15, 80, v7
  s_add_u32 m0, s18, 5120
  s_add_u32 s24, s19, 3072
  buffer_load_dwordx4 v15, s[8:11], s24 offen lds
  v_xor_b32 v14, 96, v7
  s_add_u32 m0, s18, 6144
  s_add_u32 s24, s19, 10240
  buffer_load_dwordx4 v14, s[8:11], s24 offen lds
  v_xor_b32 v15, 112, v7
  s_add_u32 m0, s18, 7168
  s_add_u32 s24, s19, 11264
  buffer_load_dwordx4 v15, s[8:11], s24 offen lds
  v_lshrrev_b32 v103, 2, v101
  v_and_b32 v104, 1, v102
  v_lshl_add_u32 v104, v104, 2, v103
  s_lshl_b32 s24, s13, 1
  v_xor_b32 v104, s24, v104
  v_lshlrev_b32 v108, 5, v104
  v_lshl_add_u32 v103, v102, 3, v103
  v_lshl_add_u32 v108, v103, 8, v108
  v_and_b32 v103, 3, v101
  v_lshl_add_u32 v108, v103, 3, v108
  v_xor_b32 v109, 32, v108
  v_add_u32 v110, 0x10000, v108
  v_add_u32 v111, 0x10000, v109
  v_or_b32 v103, 0, v102
  v_xor_b32 v103, v103, v101
  v_lshlrev_b32 v103, 4, v103
  v_lshl_add_u32 v2, v101, 10, v103
  v_or_b32 v103, 4, v102
  v_xor_b32 v103, v103, v101
  v_lshlrev_b32 v103, 4, v103
  v_lshl_add_u32 v3, v101, 10, v103
  v_or_b32 v103, 8, v102
  v_xor_b32 v103, v103, v101
  v_lshlrev_b32 v103, 4, v103
  v_lshl_add_u32 v4, v101, 10, v103
  v_or_b32 v103, 12, v102
  v_xor_b32 v103, v103, v101
  v_lshlrev_b32 v103, 4, v103
  v_lshl_add_u32 v5, v101, 10, v103
  v_bfe_u32 v103, v101, 1, 1
  v_lshlrev_b32 v9, 11, v103
  v_lshl_add_u32 v9, v102, 8, v9
  v_lshrrev_b32 v103, 2, v101
  v_lshl_add_u32 v9, v103, 6, v9
  v_and_b32 v103, 1, v101
  v_lshl_add_u32 v9, v103, 5, v9
  s_lshr_b32 s24, s13, 1
  s_lshl_b32 s24, s24, 10
  s_and_b32 s25, s13, 1
  s_lshl_b32 s26, s25, 3
  s_add_u32 s24, s24, s26
  v_add_u32 v6, s24, v9
  v_and_b32 v103, 7, v101
  v_lshlrev_b32 v103, 5, v103
  v_lshl_add_u32 v103, v102, 8, v103
  v_lshrrev_b32 v104, 3, v101
  v_lshl_add_u32 v8, v104, 11, v103
  s_lshl_b32 s26, s25, 12
  v_add_u32 v8, s26, v8
  s_lshl_b32 s26, s25, 4
  v_lshlrev_b32 v103, 1, v102
  v_sub_u32 v10, v101, v103
  v_add_u32 v10, s26, v10
  v_cmp_le_i32 s[64:65], 0, v10
  v_cmp_le_i32 s[66:67], 1, v10
  v_cmp_le_i32 s[68:69], 8, v10
  v_cmp_le_i32 s[70:71], 9, v10
  v_cmp_le_i32 s[72:73], 16, v10
  v_cmp_le_i32 s[74:75], 17, v10
  v_cmp_le_i32 s[76:77], 24, v10
  v_cmp_le_i32 s[78:79], 25, v10
  v_and_b32 v103, 1, v102
  v_lshlrev_b32 v103, 10, v103
  v_and_b32 v104, 1, v101
  v_lshl_add_u32 v103, v104, 9, v103
  v_mul_u32_u24 v17, 0xaaaa, v104
  v_add_u32 v17, 0x4444, v17
  v_and_b32 v104, 14, v101
  v_lshl_add_u32 v103, v104, 4, v103
  v_lshrrev_b32 v104, 1, v102
  v_lshl_add_u32 v103, v104, 4, v103
  s_xor_b32 s26, s13, s14
  s_lshl_b32 s26, s26, 11
  s_add_u32 s26, s26, 73728
  v_add_u32 v11, s26, v103
  v_add_u32 v12, 73728, v1
  v_and_b32 v103, 3, v100
  v_lshlrev_b32 v103, 7, v103
  v_lshrrev_b32 v104, 2, v100
  v_lshl_add_u32 v103, v104, 3, v103
  v_add_u32 v13, 81920, v103
  s_mov_b32 s17, 0x3e0293ee
  s_mov_b32 s28, 0xff800000
  s_waitcnt vmcnt(32)
  s_waitcnt lgkmcnt(0)
  s_barrier
  s_add_u32 m0, s27, 114688
  s_xor_b32 s25, s31, 3670016
  buffer_load_dwordx4 v106, s[52:55], s25 offen lds
  ds_read_b64_tr_b16 a[128:129], v108 offset:0
  ds_read_b64_tr_b16 a[130:131], v108 offset:1024
  s_add_u32 m0, s27, 115712
  s_xor_b32 s25, s31, 3702784
  buffer_load_dwordx4 v106, s[52:55], s25 offen lds
  ds_read_b64_tr_b16 a[132:133], v108 offset:8192
  ds_read_b64_tr_b16 a[134:135], v108 offset:9216
  s_add_u32 m0, s27, 116736
  s_xor_b32 s25, s31, 3735552
  buffer_load_dwordx4 v107, s[52:55], s25 offen lds
  ds_read_b64_tr_b16 a[192:193], v109 offset:0
  ds_read_b64_tr_b16 a[194:195], v109 offset:1024
  s_add_u32 m0, s27, 117760
  s_xor_b32 s25, s31, 3768320
  buffer_load_dwordx4 v107, s[52:55], s25 offen lds
  ds_read_b64_tr_b16 a[196:197], v109 offset:8192
  ds_read_b64_tr_b16 a[198:199], v109 offset:9216
  s_waitcnt vmcnt(32)
  s_waitcnt lgkmcnt(0)
  s_barrier
  s_add_u32 m0, s27, 0
  s_xor_b32 s25, s31, 0
  buffer_load_dwordx4 v106, s[56:59], s25 offen lds
  ds_read_b64_tr_b16 a[136:137], v108 offset:16384
  ds_read_b64_tr_b16 a[138:139], v108 offset:17408
  s_add_u32 m0, s27, 1024
  s_xor_b32 s25, s31, 32768
  buffer_load_dwordx4 v106, s[56:59], s25 offen lds
  ds_read_b64_tr_b16 a[140:141], v108 offset:24576
  ds_read_b64_tr_b16 a[142:143], v108 offset:25600
  s_add_u32 m0, s27, 2048
  s_xor_b32 s25, s31, 65536
  buffer_load_dwordx4 v107, s[56:59], s25 offen lds
  ds_read_b64_tr_b16 a[200:201], v109 offset:16384
  ds_read_b64_tr_b16 a[202:203], v109 offset:17408
  s_add_u32 m0, s27, 3072
  s_xor_b32 s25, s31, 98304
  buffer_load_dwordx4 v107, s[56:59], s25 offen lds
  ds_read_b64_tr_b16 a[204:205], v109 offset:24576
  ds_read_b64_tr_b16 a[206:207], v109 offset:25600
  s_waitcnt vmcnt(32)
  s_waitcnt lgkmcnt(0)
  s_barrier
  s_add_u32 m0, s27, 16384
  s_xor_b32 s25, s31, 524288
  buffer_load_dwordx4 v106, s[56:59], s25 offen lds
  ds_read_b64_tr_b16 a[144:145], v108 offset:32768
  ds_read_b64_tr_b16 a[146:147], v108 offset:33792
  s_add_u32 m0, s27, 17408
  s_xor_b32 s25, s31, 557056
  buffer_load_dwordx4 v106, s[56:59], s25 offen lds
  ds_read_b64_tr_b16 a[148:149], v108 offset:40960
  ds_read_b64_tr_b16 a[150:151], v108 offset:41984
  s_add_u32 m0, s27, 18432
  s_xor_b32 s25, s31, 589824
  buffer_load_dwordx4 v107, s[56:59], s25 offen lds
  ds_read_b64_tr_b16 a[208:209], v109 offset:32768
  ds_read_b64_tr_b16 a[210:211], v109 offset:33792
  s_add_u32 m0, s27, 19456
  s_xor_b32 s25, s31, 622592
  buffer_load_dwordx4 v107, s[56:59], s25 offen lds
  ds_read_b64_tr_b16 a[212:213], v109 offset:40960
  ds_read_b64_tr_b16 a[214:215], v109 offset:41984
  s_waitcnt vmcnt(32)
  s_waitcnt lgkmcnt(0)
  s_barrier
  s_add_u32 m0, s27, 32768
  s_xor_b32 s25, s31, 1048576
  buffer_load_dwordx4 v106, s[56:59], s25 offen lds
  ds_read_b64_tr_b16 a[152:153], v108 offset:49152
  ds_read_b64_tr_b16 a[154:155], v108 offset:50176
  s_add_u32 m0, s27, 33792
  s_xor_b32 s25, s31, 1081344
  buffer_load_dwordx4 v106, s[56:59], s25 offen lds
  ds_read_b64_tr_b16 a[156:157], v108 offset:57344
  ds_read_b64_tr_b16 a[158:159], v108 offset:58368
  s_add_u32 m0, s27, 34816
  s_xor_b32 s25, s31, 1114112
  buffer_load_dwordx4 v107, s[56:59], s25 offen lds
  ds_read_b64_tr_b16 a[216:217], v109 offset:49152
  ds_read_b64_tr_b16 a[218:219], v109 offset:50176
  s_add_u32 m0, s27, 35840
  s_xor_b32 s25, s31, 1146880
  buffer_load_dwordx4 v107, s[56:59], s25 offen lds
  ds_read_b64_tr_b16 a[220:221], v109 offset:57344
  ds_read_b64_tr_b16 a[222:223], v109 offset:58368
  s_waitcnt vmcnt(32)
  s_waitcnt lgkmcnt(0)
  s_barrier
  s_add_u32 m0, s27, 49152
  s_xor_b32 s25, s31, 1572864
  buffer_load_dwordx4 v106, s[56:59], s25 offen lds
  ds_read_b64_tr_b16 a[160:161], v110 offset:0
  ds_read_b64_tr_b16 a[162:163], v110 offset:1024
  s_add_u32 m0, s27, 50176
  s_xor_b32 s25, s31, 1605632
  buffer_load_dwordx4 v106, s[56:59], s25 offen lds
  ds_read_b64_tr_b16 a[164:165], v110 offset:8192
  ds_read_b64_tr_b16 a[166:167], v110 offset:9216
  s_add_u32 m0, s27, 51200
  s_xor_b32 s25, s31, 1638400
  buffer_load_dwordx4 v107, s[56:59], s25 offen lds
  ds_read_b64_tr_b16 a[224:225], v111 offset:0
  ds_read_b64_tr_b16 a[226:227], v111 offset:1024
  s_add_u32 m0, s27, 52224
  s_xor_b32 s25, s31, 1671168
  buffer_load_dwordx4 v107, s[56:59], s25 offen lds
  ds_read_b64_tr_b16 a[228:229], v111 offset:8192
  ds_read_b64_tr_b16 a[230:231], v111 offset:9216
  s_waitcnt vmcnt(32)
  s_waitcnt lgkmcnt(0)
  s_barrier
  s_add_u32 m0, s27, 65536
  s_xor_b32 s25, s31, 2097152
  buffer_load_dwordx4 v106, s[56:59], s25 offen lds
  ds_read_b64_tr_b16 a[168:169], v110 offset:16384
  ds_read_b64_tr_b16 a[170:171], v110 offset:17408
  s_add_u32 m0, s27, 66560
  s_xor_b32 s25, s31, 2129920
  buffer_load_dwordx4 v106, s[56:59], s25 offen lds
  ds_read_b64_tr_b16 a[172:173], v110 offset:24576
  ds_read_b64_tr_b16 a[174:175], v110 offset:25600
  s_add_u32 m0, s27, 67584
  s_xor_b32 s25, s31, 2162688
  buffer_load_dwordx4 v107, s[56:59], s25 offen lds
  ds_read_b64_tr_b16 a[232:233], v111 offset:16384
  ds_read_b64_tr_b16 a[234:235], v111 offset:17408
  s_add_u32 m0, s27, 68608
  s_xor_b32 s25, s31, 2195456
  buffer_load_dwordx4 v107, s[56:59], s25 offen lds
  ds_read_b64_tr_b16 a[236:237], v111 offset:24576
  ds_read_b64_tr_b16 a[238:239], v111 offset:25600
  s_waitcnt vmcnt(32)
  s_waitcnt lgkmcnt(0)
  s_barrier
  s_add_u32 m0, s27, 81920
  s_xor_b32 s25, s31, 2621440
  buffer_load_dwordx4 v106, s[56:59], s25 offen lds
  ds_read_b64_tr_b16 a[176:177], v110 offset:32768
  ds_read_b64_tr_b16 a[178:179], v110 offset:33792
  s_add_u32 m0, s27, 82944
  s_xor_b32 s25, s31, 2654208
  buffer_load_dwordx4 v106, s[56:59], s25 offen lds
  ds_read_b64_tr_b16 a[180:181], v110 offset:40960
  ds_read_b64_tr_b16 a[182:183], v110 offset:41984
  s_add_u32 m0, s27, 83968
  s_xor_b32 s25, s31, 2686976
  buffer_load_dwordx4 v107, s[56:59], s25 offen lds
  ds_read_b64_tr_b16 a[240:241], v111 offset:32768
  ds_read_b64_tr_b16 a[242:243], v111 offset:33792
  s_add_u32 m0, s27, 84992
  s_xor_b32 s25, s31, 2719744
  buffer_load_dwordx4 v107, s[56:59], s25 offen lds
  ds_read_b64_tr_b16 a[244:245], v111 offset:40960
  ds_read_b64_tr_b16 a[246:247], v111 offset:41984
  s_waitcnt vmcnt(24)
  s_waitcnt lgkmcnt(0)
  s_barrier
  s_add_u32 m0, s27, 98304
  s_xor_b32 s25, s31, 3145728
  buffer_load_dwordx4 v106, s[56:59], s25 offen lds
  ds_read_b64_tr_b16 a[184:185], v110 offset:49152
  ds_read_b64_tr_b16 a[186:187], v110 offset:50176
  s_add_u32 m0, s27, 99328
  s_xor_b32 s25, s31, 3178496
  buffer_load_dwordx4 v106, s[56:59], s25 offen lds
  ds_read_b64_tr_b16 a[188:189], v110 offset:57344
  ds_read_b64_tr_b16 a[190:191], v110 offset:58368
  s_add_u32 m0, s27, 100352
  s_xor_b32 s25, s31, 3211264
  buffer_load_dwordx4 v107, s[56:59], s25 offen lds
  ds_read_b64_tr_b16 a[248:249], v111 offset:49152
  ds_read_b64_tr_b16 a[250:251], v111 offset:50176
  s_add_u32 m0, s27, 101376
  s_xor_b32 s25, s31, 3244032
  buffer_load_dwordx4 v107, s[56:59], s25 offen lds
  ds_read_b64_tr_b16 a[252:253], v111 offset:57344
  ds_read_b64_tr_b16 a[254:255], v111 offset:58368
  s_waitcnt vmcnt(24)
  s_waitcnt lgkmcnt(0)
  s_barrier
  s_add_u32 m0, s27, 114688
  s_xor_b32 s25, s31, 3670016
  buffer_load_dwordx4 v106, s[56:59], s25 offen lds
  ds_read_b64_tr_b16 v[128:129], v108 offset:0
  ds_read_b64_tr_b16 v[130:131], v108 offset:1024
  s_add_u32 m0, s27, 115712
  s_xor_b32 s25, s31, 3702784
  buffer_load_dwordx4 v106, s[56:59], s25 offen lds
  ds_read_b64_tr_b16 v[132:133], v108 offset:8192
  ds_read_b64_tr_b16 v[134:135], v108 offset:9216
  s_add_u32 m0, s27, 116736
  s_xor_b32 s25, s31, 3735552
  buffer_load_dwordx4 v107, s[56:59], s25 offen lds
  ds_read_b64_tr_b16 v[192:193], v109 offset:0
  ds_read_b64_tr_b16 v[194:195], v109 offset:1024
  s_add_u32 m0, s27, 117760
  s_xor_b32 s25, s31, 3768320
  buffer_load_dwordx4 v107, s[56:59], s25 offen lds
  ds_read_b64_tr_b16 v[196:197], v109 offset:8192
  ds_read_b64_tr_b16 v[198:199], v109 offset:9216
  s_waitcnt vmcnt(24)
  s_waitcnt lgkmcnt(0)
  s_barrier
  s_add_u32 m0, s27, 0
  s_xor_b32 s25, s31, 0
  buffer_load_dwordx4 v106, s[48:51], s25 offen lds
  ds_read_b64_tr_b16 v[136:137], v108 offset:16384
  ds_read_b64_tr_b16 v[138:139], v108 offset:17408
  s_add_u32 m0, s27, 1024
  s_xor_b32 s25, s31, 32768
  buffer_load_dwordx4 v106, s[48:51], s25 offen lds
  ds_read_b64_tr_b16 v[140:141], v108 offset:24576
  ds_read_b64_tr_b16 v[142:143], v108 offset:25600
  s_add_u32 m0, s27, 2048
  s_xor_b32 s25, s31, 65536
  buffer_load_dwordx4 v107, s[48:51], s25 offen lds
  ds_read_b64_tr_b16 v[200:201], v109 offset:16384
  ds_read_b64_tr_b16 v[202:203], v109 offset:17408
  s_add_u32 m0, s27, 3072
  s_xor_b32 s25, s31, 98304
  buffer_load_dwordx4 v107, s[48:51], s25 offen lds
  ds_read_b64_tr_b16 v[204:205], v109 offset:24576
  ds_read_b64_tr_b16 v[206:207], v109 offset:25600
  s_waitcnt vmcnt(24)
  s_waitcnt lgkmcnt(0)
  s_barrier
  s_add_u32 m0, s27, 16384
  s_xor_b32 s25, s31, 524288
  buffer_load_dwordx4 v106, s[48:51], s25 offen lds
  ds_read_b64_tr_b16 v[144:145], v108 offset:32768
  ds_read_b64_tr_b16 v[146:147], v108 offset:33792
  s_add_u32 m0, s27, 17408
  s_xor_b32 s25, s31, 557056
  buffer_load_dwordx4 v106, s[48:51], s25 offen lds
  ds_read_b64_tr_b16 v[148:149], v108 offset:40960
  ds_read_b64_tr_b16 v[150:151], v108 offset:41984
  s_add_u32 m0, s27, 18432
  s_xor_b32 s25, s31, 589824
  buffer_load_dwordx4 v107, s[48:51], s25 offen lds
  ds_read_b64_tr_b16 v[208:209], v109 offset:32768
  ds_read_b64_tr_b16 v[210:211], v109 offset:33792
  s_add_u32 m0, s27, 19456
  s_xor_b32 s25, s31, 622592
  buffer_load_dwordx4 v107, s[48:51], s25 offen lds
  ds_read_b64_tr_b16 v[212:213], v109 offset:40960
  ds_read_b64_tr_b16 v[214:215], v109 offset:41984
  s_waitcnt vmcnt(24)
  s_waitcnt lgkmcnt(0)
  s_barrier
  s_add_u32 m0, s27, 32768
  s_xor_b32 s25, s31, 1048576
  buffer_load_dwordx4 v106, s[48:51], s25 offen lds
  ds_read_b64_tr_b16 v[152:153], v108 offset:49152
  ds_read_b64_tr_b16 v[154:155], v108 offset:50176
  s_add_u32 m0, s27, 33792
  s_xor_b32 s25, s31, 1081344
  buffer_load_dwordx4 v106, s[48:51], s25 offen lds
  ds_read_b64_tr_b16 v[156:157], v108 offset:57344
  ds_read_b64_tr_b16 v[158:159], v108 offset:58368
  s_add_u32 m0, s27, 34816
  s_xor_b32 s25, s31, 1114112
  buffer_load_dwordx4 v107, s[48:51], s25 offen lds
  ds_read_b64_tr_b16 v[216:217], v109 offset:49152
  ds_read_b64_tr_b16 v[218:219], v109 offset:50176
  s_add_u32 m0, s27, 35840
  s_xor_b32 s25, s31, 1146880
  buffer_load_dwordx4 v107, s[48:51], s25 offen lds
  ds_read_b64_tr_b16 v[220:221], v109 offset:57344
  ds_read_b64_tr_b16 v[222:223], v109 offset:58368
  s_waitcnt vmcnt(24)
  s_waitcnt lgkmcnt(0)
  s_barrier
  s_add_u32 m0, s27, 49152
  s_xor_b32 s25, s31, 1572864
  buffer_load_dwordx4 v106, s[48:51], s25 offen lds
  ds_read_b64_tr_b16 v[160:161], v110 offset:0
  ds_read_b64_tr_b16 v[162:163], v110 offset:1024
  s_add_u32 m0, s27, 50176
  s_xor_b32 s25, s31, 1605632
  buffer_load_dwordx4 v106, s[48:51], s25 offen lds
  ds_read_b64_tr_b16 v[164:165], v110 offset:8192
  ds_read_b64_tr_b16 v[166:167], v110 offset:9216
  s_add_u32 m0, s27, 51200
  s_xor_b32 s25, s31, 1638400
  buffer_load_dwordx4 v107, s[48:51], s25 offen lds
  ds_read_b64_tr_b16 v[224:225], v111 offset:0
  ds_read_b64_tr_b16 v[226:227], v111 offset:1024
  s_add_u32 m0, s27, 52224
  s_xor_b32 s25, s31, 1671168
  buffer_load_dwordx4 v107, s[48:51], s25 offen lds
  ds_read_b64_tr_b16 v[228:229], v111 offset:8192
  ds_read_b64_tr_b16 v[230:231], v111 offset:9216
  s_waitcnt vmcnt(24)
  s_waitcnt lgkmcnt(0)
  s_barrier
  s_add_u32 m0, s27, 65536
  s_xor_b32 s25, s31, 2097152
  buffer_load_dwordx4 v106, s[48:51], s25 offen lds
  ds_read_b64_tr_b16 v[168:169], v110 offset:16384
  ds_read_b64_tr_b16 v[170:171], v110 offset:17408
  s_add_u32 m0, s27, 66560
  s_xor_b32 s25, s31, 2129920
  buffer_load_dwordx4 v106, s[48:51], s25 offen lds
  ds_read_b64_tr_b16 v[172:173], v110 offset:24576
  ds_read_b64_tr_b16 v[174:175], v110 offset:25600
  s_add_u32 m0, s27, 67584
  s_xor_b32 s25, s31, 2162688
  buffer_load_dwordx4 v107, s[48:51], s25 offen lds
  ds_read_b64_tr_b16 v[232:233], v111 offset:16384
  ds_read_b64_tr_b16 v[234:235], v111 offset:17408
  s_add_u32 m0, s27, 68608
  s_xor_b32 s25, s31, 2195456
  buffer_load_dwordx4 v107, s[48:51], s25 offen lds
  ds_read_b64_tr_b16 v[236:237], v111 offset:24576
  ds_read_b64_tr_b16 v[238:239], v111 offset:25600
  s_waitcnt vmcnt(24)
  s_waitcnt lgkmcnt(0)
  s_barrier
  s_add_u32 m0, s27, 81920
  s_xor_b32 s25, s31, 2621440
  buffer_load_dwordx4 v106, s[48:51], s25 offen lds
  ds_read_b64_tr_b16 v[176:177], v110 offset:32768
  ds_read_b64_tr_b16 v[178:179], v110 offset:33792
  s_add_u32 m0, s27, 82944
  s_xor_b32 s25, s31, 2654208
  buffer_load_dwordx4 v106, s[48:51], s25 offen lds
  ds_read_b64_tr_b16 v[180:181], v110 offset:40960
  ds_read_b64_tr_b16 v[182:183], v110 offset:41984
  s_add_u32 m0, s27, 83968
  s_xor_b32 s25, s31, 2686976
  buffer_load_dwordx4 v107, s[48:51], s25 offen lds
  ds_read_b64_tr_b16 v[240:241], v111 offset:32768
  ds_read_b64_tr_b16 v[242:243], v111 offset:33792
  s_add_u32 m0, s27, 84992
  s_xor_b32 s25, s31, 2719744
  buffer_load_dwordx4 v107, s[48:51], s25 offen lds
  ds_read_b64_tr_b16 v[244:245], v111 offset:40960
  ds_read_b64_tr_b16 v[246:247], v111 offset:41984
  s_waitcnt vmcnt(24)
  s_waitcnt lgkmcnt(0)
  s_barrier
  s_add_u32 m0, s27, 98304
  s_xor_b32 s25, s31, 3145728
  buffer_load_dwordx4 v106, s[48:51], s25 offen lds
  ds_read_b64_tr_b16 v[184:185], v110 offset:49152
  ds_read_b64_tr_b16 v[186:187], v110 offset:50176
  s_add_u32 m0, s27, 99328
  s_xor_b32 s25, s31, 3178496
  buffer_load_dwordx4 v106, s[48:51], s25 offen lds
  ds_read_b64_tr_b16 v[188:189], v110 offset:57344
  ds_read_b64_tr_b16 v[190:191], v110 offset:58368
  s_add_u32 m0, s27, 100352
  s_xor_b32 s25, s31, 3211264
  buffer_load_dwordx4 v107, s[48:51], s25 offen lds
  ds_read_b64_tr_b16 v[248:249], v111 offset:49152
  ds_read_b64_tr_b16 v[250:251], v111 offset:50176
  s_add_u32 m0, s27, 101376
  s_xor_b32 s25, s31, 3244032
  buffer_load_dwordx4 v107, s[48:51], s25 offen lds
  ds_read_b64_tr_b16 v[252:253], v111 offset:57344
  ds_read_b64_tr_b16 v[254:255], v111 offset:58368
  s_waitcnt vmcnt(24)
  s_waitcnt lgkmcnt(0)
  s_barrier
  s_add_u32 m0, s27, 114688
  s_xor_b32 s25, s31, 3670016
  buffer_load_dwordx4 v106, s[48:51], s25 offen lds
  ds_read_b64_tr_b16 a[0:1], v108 offset:0
  ds_read_b64_tr_b16 a[2:3], v108 offset:1024
  s_add_u32 m0, s27, 115712
  s_xor_b32 s25, s31, 3702784
  buffer_load_dwordx4 v106, s[48:51], s25 offen lds
  ds_read_b64_tr_b16 a[4:5], v108 offset:8192
  ds_read_b64_tr_b16 a[6:7], v108 offset:9216
  s_add_u32 m0, s27, 116736
  s_xor_b32 s25, s31, 3735552
  buffer_load_dwordx4 v107, s[48:51], s25 offen lds
  ds_read_b64_tr_b16 a[64:65], v109 offset:0
  ds_read_b64_tr_b16 a[66:67], v109 offset:1024
  s_add_u32 m0, s27, 117760
  s_xor_b32 s25, s31, 3768320
  buffer_load_dwordx4 v107, s[48:51], s25 offen lds
  ds_read_b64_tr_b16 a[68:69], v109 offset:8192
  ds_read_b64_tr_b16 a[70:71], v109 offset:9216
  v_and_b32 v113, 15, v0
  v_lshl_add_u32 v112, v113, 2, 64
  v_cmp_eq_u32 vcc, 0, v113
  s_nop 1
  v_cndmask_b32 v112, v112, 0, vcc
  buffer_load_dword v114, v112, s[36:39], 0 offen sc1
  buffer_load_dword v16, off, s[36:39], 0 offset:32 sc1
  s_waitcnt vmcnt(26)
  s_waitcnt lgkmcnt(0)
  s_barrier
  ds_read_b64_tr_b16 a[8:9], v108 offset:16384
  ds_read_b64_tr_b16 a[10:11], v108 offset:17408
  ds_read_b64_tr_b16 a[12:13], v108 offset:24576
  ds_read_b64_tr_b16 a[14:15], v108 offset:25600
  ds_read_b64_tr_b16 a[72:73], v109 offset:16384
  ds_read_b64_tr_b16 a[74:75], v109 offset:17408
  ds_read_b64_tr_b16 a[76:77], v109 offset:24576
  ds_read_b64_tr_b16 a[78:79], v109 offset:25600
  s_waitcnt vmcnt(22)
  s_waitcnt lgkmcnt(0)
  s_barrier
  ds_read_b64_tr_b16 a[16:17], v108 offset:32768
  ds_read_b64_tr_b16 a[18:19], v108 offset:33792
  ds_read_b64_tr_b16 a[20:21], v108 offset:40960
  ds_read_b64_tr_b16 a[22:23], v108 offset:41984
  ds_read_b64_tr_b16 a[80:81], v109 offset:32768
  ds_read_b64_tr_b16 a[82:83], v109 offset:33792
  ds_read_b64_tr_b16 a[84:85], v109 offset:40960
  ds_read_b64_tr_b16 a[86:87], v109 offset:41984
  s_waitcnt vmcnt(18)
  s_waitcnt lgkmcnt(0)
  s_barrier
  ds_read_b64_tr_b16 a[24:25], v108 offset:49152
  ds_read_b64_tr_b16 a[26:27], v108 offset:50176
  ds_read_b64_tr_b16 a[28:29], v108 offset:57344
  ds_read_b64_tr_b16 a[30:31], v108 offset:58368
  ds_read_b64_tr_b16 a[88:89], v109 offset:49152
  ds_read_b64_tr_b16 a[90:91], v109 offset:50176
  ds_read_b64_tr_b16 a[92:93], v109 offset:57344
  ds_read_b64_tr_b16 a[94:95], v109 offset:58368
  s_waitcnt vmcnt(14)
  s_waitcnt lgkmcnt(0)
  s_barrier
  ds_read_b64_tr_b16 a[32:33], v110 offset:0
  ds_read_b64_tr_b16 a[34:35], v110 offset:1024
  ds_read_b64_tr_b16 a[36:37], v110 offset:8192
  ds_read_b64_tr_b16 a[38:39], v110 offset:9216
  ds_read_b64_tr_b16 a[96:97], v111 offset:0
  ds_read_b64_tr_b16 a[98:99], v111 offset:1024
  ds_read_b64_tr_b16 a[100:101], v111 offset:8192
  ds_read_b64_tr_b16 a[102:103], v111 offset:9216
  s_waitcnt vmcnt(10)
  s_waitcnt lgkmcnt(0)
  s_barrier
  ds_read_b64_tr_b16 a[40:41], v110 offset:16384
  ds_read_b64_tr_b16 a[42:43], v110 offset:17408
  ds_read_b64_tr_b16 a[44:45], v110 offset:24576
  ds_read_b64_tr_b16 a[46:47], v110 offset:25600
  ds_read_b64_tr_b16 a[104:105], v111 offset:16384
  ds_read_b64_tr_b16 a[106:107], v111 offset:17408
  ds_read_b64_tr_b16 a[108:109], v111 offset:24576
  ds_read_b64_tr_b16 a[110:111], v111 offset:25600
  s_waitcnt vmcnt(6)
  s_waitcnt lgkmcnt(0)
  s_barrier
  ds_read_b64_tr_b16 a[48:49], v110 offset:32768
  ds_read_b64_tr_b16 a[50:51], v110 offset:33792
  ds_read_b64_tr_b16 a[52:53], v110 offset:40960
  ds_read_b64_tr_b16 a[54:55], v110 offset:41984
  ds_read_b64_tr_b16 a[112:113], v111 offset:32768
  ds_read_b64_tr_b16 a[114:115], v111 offset:33792
  ds_read_b64_tr_b16 a[116:117], v111 offset:40960
  ds_read_b64_tr_b16 a[118:119], v111 offset:41984
  s_waitcnt vmcnt(2)
  s_waitcnt lgkmcnt(0)
  s_barrier
  ds_read_b64_tr_b16 a[56:57], v110 offset:49152
  ds_read_b64_tr_b16 a[58:59], v110 offset:50176
  ds_read_b64_tr_b16 a[60:61], v110 offset:57344
  ds_read_b64_tr_b16 a[62:63], v110 offset:58368
  ds_read_b64_tr_b16 a[120:121], v111 offset:49152
  ds_read_b64_tr_b16 a[122:123], v111 offset:50176
  ds_read_b64_tr_b16 a[124:125], v111 offset:57344
  ds_read_b64_tr_b16 a[126:127], v111 offset:58368
  s_waitcnt lgkmcnt(0)
  s_mov_b32 s15, 0
  s_cmp_eq_u32 s14, 0
  s_cselect_b32 s16, 22, 21
  s_mov_b32 s20, 0
  s_mov_b32 s21, 0
  s_mov_b32 s22, s14
  s_mov_b32 s23, s14
  v_mov_b32 v22, 1
  v_min_u32 v23, 1, v0
  v_lshlrev_b32 v23, 28, v23
  s_mov_b32 s29, s6
  s_mov_b32 s30, s6
L_cen_48:
  v_cmp_gt_u32 vcc, s82, v113
  s_waitcnt vmcnt(0)
  s_nop 0
  v_cndmask_b32 v115, 0, v114, vcc
  v_add_u32_dpp v114, v114, v114 row_ror:8 row_mask:0xf bank_mask:0xf
  s_nop 0
  v_add_u32_dpp v115, v115, v115 row_ror:8 row_mask:0xf bank_mask:0xf
  v_add_u32_dpp v114, v114, v114 row_ror:4 row_mask:0xf bank_mask:0xf
  s_nop 0
  v_add_u32_dpp v115, v115, v115 row_ror:4 row_mask:0xf bank_mask:0xf
  v_add_u32_dpp v114, v114, v114 row_ror:2 row_mask:0xf bank_mask:0xf
  s_nop 0
  v_add_u32_dpp v115, v115, v115 row_ror:2 row_mask:0xf bank_mask:0xf
  v_add_u32_dpp v114, v114, v114 row_ror:1 row_mask:0xf bank_mask:0xf
  s_nop 0
  v_add_u32_dpp v115, v115, v115 row_ror:1 row_mask:0xf bank_mask:0xf
  v_readfirstlane_b32 s24, v114
  v_readfirstlane_b32 s25, v115
  s_cmp_ge_u32 s24, 256
  s_cbranch_scc1 L_cen_48_x
  s_sub_u32 s33, s33, 1
  s_cbranch_scc1 L_done
  s_sleep 8
  buffer_load_dword v114, v112, s[36:39], 0 offen sc1
  s_branch L_cen_48
L_cen_48_x:
  s_add_u32 s25, s25, s83
  s_cmp_eq_u32 s3, s25
  s_mov_b32 s3, s25
  s_cbranch_scc1 L_qok_49
  s_barrier
  s_branch L_role
L_qok_49:
L_qin_50:
  s_waitcnt vmcnt(0)
  v_cmp_gt_u32 vcc, 1, v16
  s_cbranch_vccz L_qin_50_x
  s_sub_u32 s33, s33, 1
  s_cbranch_scc1 L_done
  s_sleep 8
  buffer_load_dword v16, off, s[36:39], 0 offset:32 sc1
  s_branch L_qin_50
L_qin_50_x:
  s_barrier
L_qloop_51:
  s_lshl_b32 s34, s23, 13
  s_lshl_b32 s25, s13, 10
  s_add_u32 s34, s34, s25
  s_add_u32 s34, s34, 1310720
  s_add_u32 s35, s34, 4096
  s_cmp_lt_u32 s15, s16
  s_cbranch_scc0 L_qnp_55
  s_and_b32 s25, s18, 0xffff8000
  v_add_u32 v18, s25, v2
  v_add_u32 v19, s25, v3
  v_add_u32 v20, s25, v4
  v_add_u32 v21, s25, v5
  ds_read_b128 v[24:27], v18 offset:0
  ds_read_b128 v[28:31], v18 offset:16384
  ds_read_b128 v[32:35], v19 offset:0
  ds_read_b128 v[36:39], v19 offset:16384
  s_xor_b32 s18, s18, 229376
  s_add_u32 s19, s19, 98304
  s_waitcnt lgkmcnt(2)
  v_mfma_f32_16x16x32_bf16 v[56:59], a[128:131], v[24:27], 0
  ds_read_b128 v[112:115], v20 offset:0
  v_mfma_f32_16x16x32_bf16 v[60:63], a[128:131], v[28:31], 0
  v_mfma_f32_16x16x32_bf16 v[64:67], a[192:195], v[24:27], 0
  ds_read_b128 v[116:119], v20 offset:16384
  v_mfma_f32_16x16x32_bf16 v[68:71], a[192:195], v[28:31], 0
  v_mfma_f32_16x16x32_bf16 v[72:75], v[24:27], v[128:131], 0
  v_mfma_f32_16x16x32_bf16 v[76:79], v[28:31], v[128:131], 0
  v_mfma_f32_16x16x32_bf16 v[80:83], v[24:27], v[192:195], 0
  v_mfma_f32_16x16x32_bf16 v[84:87], v[28:31], v[192:195], 0
  s_waitcnt lgkmcnt(2)
  v_mfma_f32_16x16x32_bf16 v[56:59], a[132:135], v[32:35], v[56:59]
  ds_read_b128 v[120:123], v21 offset:0
  v_mfma_f32_16x16x32_bf16 v[60:63], a[132:135], v[36:39], v[60:63]
  v_mfma_f32_16x16x32_bf16 v[64:67], a[196:199], v[32:35], v[64:67]
  ds_read_b128 v[124:127], v21 offset:16384
  v_mfma_f32_16x16x32_bf16 v[68:71], a[196:199], v[36:39], v[68:71]
  v_mfma_f32_16x16x32_bf16 v[72:75], v[32:35], v[132:135], v[72:75]
  v_mfma_f32_16x16x32_bf16 v[76:79], v[36:39], v[132:135], v[76:79]
  v_mfma_f32_16x16x32_bf16 v[80:83], v[32:35], v[196:199], v[80:83]
  v_mfma_f32_16x16x32_bf16 v[84:87], v[36:39], v[196:199], v[84:87]
  s_waitcnt lgkmcnt(2)
  v_mfma_f32_16x16x32_bf16 v[56:59], a[136:139], v[112:115], v[56:59]
  ds_read_b128 v[24:27], v18 offset:256
  v_mfma_f32_16x16x32_bf16 v[60:63], a[136:139], v[116:119], v[60:63]
  v_mfma_f32_16x16x32_bf16 v[64:67], a[200:203], v[112:115], v[64:67]
  ds_read_b128 v[28:31], v18 offset:16640
  v_mfma_f32_16x16x32_bf16 v[68:71], a[200:203], v[116:119], v[68:71]
  v_mfma_f32_16x16x32_bf16 v[72:75], v[112:115], v[136:139], v[72:75]
  v_mfma_f32_16x16x32_bf16 v[76:79], v[116:119], v[136:139], v[76:79]
  v_mfma_f32_16x16x32_bf16 v[80:83], v[112:115], v[200:203], v[80:83]
  v_mfma_f32_16x16x32_bf16 v[84:87], v[116:119], v[200:203], v[84:87]
  s_waitcnt lgkmcnt(2)
  v_mfma_f32_16x16x32_bf16 v[56:59], a[140:143], v[120:123], v[56:59]
  ds_read_b128 v[32:35], v19 offset:256
  v_mfma_f32_16x16x32_bf16 v[60:63], a[140:143], v[124:127], v[60:63]
  v_mfma_f32_16x16x32_bf16 v[64:67], a[204:207], v[120:123], v[64:67]
  ds_read_b128 v[36:39], v19 offset:16640
  v_mfma_f32_16x16x32_bf16 v[68:71], a[204:207], v[124:127], v[68:71]
  v_mfma_f32_16x16x32_bf16 v[72:75], v[120:123], v[140:143], v[72:75]
  v_mfma_f32_16x16x32_bf16 v[76:79], v[124:127], v[140:143], v[76:79]
  v_mfma_f32_16x16x32_bf16 v[80:83], v[120:123], v[204:207], v[80:83]
  v_mfma_f32_16x16x32_bf16 v[84:87], v[124:127], v[204:207], v[84:87]
  s_waitcnt lgkmcnt(2)
  v_mfma_f32_16x16x32_bf16 v[56:59], a[144:147], v[24:27], v[56:59]
  ds_read_b128 v[112:115], v20 offset:256
  v_mfma_f32_16x16x32_bf16 v[60:63], a[144:147], v[28:31], v[60:63]
  v_mfma_f32_16x16x32_bf16 v[64:67], a[208:211], v[24:27], v[64:67]
  ds_read_b128 v[116:119], v20 offset:16640
  v_mfma_f32_16x16x32_bf16 v[68:71], a[208:211], v[28:31], v[68:71]
  v_mfma_f32_16x16x32_bf16 v[72:75], v[24:27], v[144:147], v[72:75]
  v_mfma_f32_16x16x32_bf16 v[76:79], v[28:31], v[144:147], v[76:79]
  v_mfma_f32_16x16x32_bf16 v[80:83], v[24:27], v[208:211], v[80:83]
  v_mfma_f32_16x16x32_bf16 v[84:87], v[28:31], v[208:211], v[84:87]
  s_waitcnt lgkmcnt(2)
  v_mfma_f32_16x16x32_bf16 v[56:59], a[148:151], v[32:35], v[56:59]
  ds_read_b128 v[120:123], v21 offset:256
  v_mfma_f32_16x16x32_bf16 v[60:63], a[148:151], v[36:39], v[60:63]
  v_mfma_f32_16x16x32_bf16 v[64:67], a[212:215], v[32:35], v[64:67]
  ds_read_b128 v[124:127], v21 offset:16640
  v_mfma_f32_16x16x32_bf16 v[68:71], a[212:215], v[36:39], v[68:71]
  v_mfma_f32_16x16x32_bf16 v[72:75], v[32:35], v[148:151], v[72:75]
  v_mfma_f32_16x16x32_bf16 v[76:79], v[36:39], v[148:151], v[76:79]
  v_mfma_f32_16x16x32_bf16 v[80:83], v[32:35], v[212:215], v[80:83]
  v_mfma_f32_16x16x32_bf16 v[84:87], v[36:39], v[212:215], v[84:87]
  s_waitcnt lgkmcnt(2)
  v_mfma_f32_16x16x32_bf16 v[56:59], a[152:155], v[112:115], v[56:59]
  ds_read_b128 v[24:27], v18 offset:512
  v_mfma_f32_16x16x32_bf16 v[60:63], a[152:155], v[116:119], v[60:63]
  v_mfma_f32_16x16x32_bf16 v[64:67], a[216:219], v[112:115], v[64:67]
  ds_read_b128 v[28:31], v18 offset:16896
  v_mfma_f32_16x16x32_bf16 v[68:71], a[216:219], v[116:119], v[68:71]
  v_mfma_f32_16x16x32_bf16 v[72:75], v[112:115], v[152:155], v[72:75]
  s_waitcnt vmcnt(0)
  s_barrier
  v_mfma_f32_16x16x32_bf16 v[76:79], v[116:119], v[152:155], v[76:79]
  v_mfma_f32_16x16x32_bf16 v[80:83], v[112:115], v[216:219], v[80:83]
  buffer_store_dword v22, v23, s[4:7], s29 offen sc1
  s_mov_b32 s29, s6
  v_mfma_f32_16x16x32_bf16 v[84:87], v[116:119], v[216:219], v[84:87]
  s_waitcnt lgkmcnt(2)
  v_mfma_f32_16x16x32_bf16 v[56:59], a[156:159], v[120:123], v[56:59]
  ds_read_b128 v[32:35], v19 offset:512
  v_mfma_f32_16x16x32_bf16 v[60:63], a[156:159], v[124:127], v[60:63]
  v_mfma_f32_16x16x32_bf16 v[64:67], a[220:223], v[120:123], v[64:67]
  ds_read_b128 v[36:39], v19 offset:16896
  v_mfma_f32_16x16x32_bf16 v[68:71], a[220:223], v[124:127], v[68:71]
  v_mfma_f32_16x16x32_bf16 v[72:75], v[120:123], v[156:159], v[72:75]
  v_xor_b32 v14, 0, v7
  s_add_u32 m0, s18, 0
  v_mfma_f32_16x16x32_bf16 v[76:79], v[124:127], v[156:159], v[76:79]
  s_add_u32 s24, s19, 0
  v_mfma_f32_16x16x32_bf16 v[80:83], v[120:123], v[220:223], v[80:83]
  buffer_load_dwordx4 v14, s[8:11], s24 offen lds
  v_mfma_f32_16x16x32_bf16 v[84:87], v[124:127], v[220:223], v[84:87]
  s_waitcnt lgkmcnt(2)
  v_mfma_f32_16x16x32_bf16 v[56:59], a[160:163], v[24:27], v[56:59]
  ds_read_b128 v[112:115], v20 offset:512
  v_mfma_f32_16x16x32_bf16 v[60:63], a[160:163], v[28:31], v[60:63]
  v_mfma_f32_16x16x32_bf16 v[64:67], a[224:227], v[24:27], v[64:67]
  ds_read_b128 v[116:119], v20 offset:16896
  v_mfma_f32_16x16x32_bf16 v[68:71], a[224:227], v[28:31], v[68:71]
  v_mfma_f32_16x16x32_bf16 v[72:75], v[24:27], v[160:163], v[72:75]
  v_xor_b32 v15, 16, v7
  s_add_u32 m0, s18, 1024
  v_mfma_f32_16x16x32_bf16 v[76:79], v[28:31], v[160:163], v[76:79]
  s_add_u32 s24, s19, 1024
  v_mfma_f32_16x16x32_bf16 v[80:83], v[24:27], v[224:227], v[80:83]
  buffer_load_dwordx4 v15, s[8:11], s24 offen lds
  v_mfma_f32_16x16x32_bf16 v[84:87], v[28:31], v[224:227], v[84:87]
  s_waitcnt lgkmcnt(2)
  v_mfma_f32_16x16x32_bf16 v[56:59], a[164:167], v[32:35], v[56:59]
  ds_read_b128 v[120:123], v21 offset:512
  v_mfma_f32_16x16x32_bf16 v[60:63], a[164:167], v[36:39], v[60:63]
  v_mfma_f32_16x16x32_bf16 v[64:67], a[228:231], v[32:35], v[64:67]
  ds_read_b128 v[124:127], v21 offset:16896
  v_mfma_f32_16x16x32_bf16 v[68:71], a[228:231], v[36:39], v[68:71]
  v_mfma_f32_16x16x32_bf16 v[72:75], v[32:35], v[164:167], v[72:75]
  v_xor_b32 v14, 32, v7
  s_add_u32 m0, s18, 2048
  v_mfma_f32_16x16x32_bf16 v[76:79], v[36:39], v[164:167], v[76:79]
  s_add_u32 s24, s19, 8192
  v_mfma_f32_16x16x32_bf16 v[80:83], v[32:35], v[228:231], v[80:83]
  buffer_load_dwordx4 v14, s[8:11], s24 offen lds
  v_mfma_f32_16x16x32_bf16 v[84:87], v[36:39], v[228:231], v[84:87]
  s_waitcnt lgkmcnt(2)
  v_mfma_f32_16x16x32_bf16 v[56:59], a[168:171], v[112:115], v[56:59]
  ds_read_b128 v[24:27], v18 offset:768
  v_mfma_f32_16x16x32_bf16 v[60:63], a[168:171], v[116:119], v[60:63]
  v_mfma_f32_16x16x32_bf16 v[64:67], a[232:235], v[112:115], v[64:67]
  ds_read_b128 v[28:31], v18 offset:17152
  v_mfma_f32_16x16x32_bf16 v[68:71], a[232:235], v[116:119], v[68:71]
  v_mfma_f32_16x16x32_bf16 v[72:75], v[112:115], v[168:171], v[72:75]
  v_xor_b32 v15, 48, v7
  s_add_u32 m0, s18, 3072
  v_mfma_f32_16x16x32_bf16 v[76:79], v[116:119], v[168:171], v[76:79]
  s_add_u32 s24, s19, 9216
  v_mfma_f32_16x16x32_bf16 v[80:83], v[112:115], v[232:235], v[80:83]
  buffer_load_dwordx4 v15, s[8:11], s24 offen lds
  v_mfma_f32_16x16x32_bf16 v[84:87], v[116:119], v[232:235], v[84:87]
  s_waitcnt lgkmcnt(2)
  v_mfma_f32_16x16x32_bf16 v[56:59], a[172:175], v[120:123], v[56:59]
  ds_read_b128 v[32:35], v19 offset:768
  v_mfma_f32_16x16x32_bf16 v[60:63], a[172:175], v[124:127], v[60:63]
  v_mfma_f32_16x16x32_bf16 v[64:67], a[236:239], v[120:123], v[64:67]
  ds_read_b128 v[36:39], v19 offset:17152
  v_mfma_f32_16x16x32_bf16 v[68:71], a[236:239], v[124:127], v[68:71]
  v_mfma_f32_16x16x32_bf16 v[72:75], v[120:123], v[172:175], v[72:75]
  v_xor_b32 v14, 64, v7
  s_add_u32 m0, s18, 4096
  v_mfma_f32_16x16x32_bf16 v[76:79], v[124:127], v[172:175], v[76:79]
  s_add_u32 s24, s19, 2048
  v_mfma_f32_16x16x32_bf16 v[80:83], v[120:123], v[236:239], v[80:83]
  buffer_load_dwordx4 v14, s[8:11], s24 offen lds
  v_mfma_f32_16x16x32_bf16 v[84:87], v[124:127], v[236:239], v[84:87]
  s_waitcnt lgkmcnt(2)
  v_mfma_f32_16x16x32_bf16 v[56:59], a[176:179], v[24:27], v[56:59]
  ds_read_b128 v[112:115], v20 offset:768
  v_mfma_f32_16x16x32_bf16 v[60:63], a[176:179], v[28:31], v[60:63]
  v_mfma_f32_16x16x32_bf16 v[64:67], a[240:243], v[24:27], v[64:67]
  ds_read_b128 v[116:119], v20 offset:17152
  v_mfma_f32_16x16x32_bf16 v[68:71], a[240:243], v[28:31], v[68:71]
  v_mfma_f32_16x16x32_bf16 v[72:75], v[24:27], v[176:179], v[72:75]
  v_xor_b32 v15, 80, v7
  s_add_u32 m0, s18, 5120
  v_mfma_f32_16x16x32_bf16 v[76:79], v[28:31], v[176:179], v[76:79]
  s_add_u32 s24, s19, 3072
  v_mfma_f32_16x16x32_bf16 v[80:83], v[24:27], v[240:243], v[80:83]
  buffer_load_dwordx4 v15, s[8:11], s24 offen lds
  v_mfma_f32_16x16x32_bf16 v[84:87], v[28:31], v[240:243], v[84:87]
  s_waitcnt lgkmcnt(2)
  v_mfma_f32_16x16x32_bf16 v[56:59], a[180:183], v[32:35], v[56:59]
  ds_read_b128 v[120:123], v21 offset:768
  v_mfma_f32_16x16x32_bf16 v[60:63], a[180:183], v[36:39], v[60:63]
  v_mfma_f32_16x16x32_bf16 v[64:67], a[244:247], v[32:35], v[64:67]
  ds_read_b128 v[124:127], v21 offset:17152
  v_mfma_f32_16x16x32_bf16 v[68:71], a[244:247], v[36:39], v[68:71]
  v_mfma_f32_16x16x32_bf16 v[72:75], v[32:35], v[180:183], v[72:75]
  v_xor_b32 v14, 96, v7
  s_add_u32 m0, s18, 6144
  v_mfma_f32_16x16x32_bf16 v[76:79], v[36:39], v[180:183], v[76:79]
  s_add_u32 s24, s19, 10240
  v_mfma_f32_16x16x32_bf16 v[80:83], v[32:35], v[244:247], v[80:83]
  buffer_load_dwordx4 v14, s[8:11], s24 offen lds
  v_mfma_f32_16x16x32_bf16 v[84:87], v[36:39], v[244:247], v[84:87]
  s_waitcnt lgkmcnt(2)
  v_mfma_f32_16x16x32_bf16 v[56:59], a[184:187], v[112:115], v[56:59]
  ds_read_b128 v[24:27], v18 offset:0
  v_mfma_f32_16x16x32_bf16 v[60:63], a[184:187], v[116:119], v[60:63]
  v_mfma_f32_16x16x32_bf16 v[64:67], a[248:251], v[112:115], v[64:67]
  ds_read_b128 v[28:31], v18 offset:16384
  v_mfma_f32_16x16x32_bf16 v[68:71], a[248:251], v[116:119], v[68:71]
  v_mfma_f32_16x16x32_bf16 v[72:75], v[112:115], v[184:187], v[72:75]
  v_xor_b32 v15, 112, v7
  s_add_u32 m0, s18, 7168
  v_mfma_f32_16x16x32_bf16 v[76:79], v[116:119], v[184:187], v[76:79]
  s_add_u32 s24, s19, 11264
  v_mfma_f32_16x16x32_bf16 v[80:83], v[112:115], v[248:251], v[80:83]
  buffer_load_dwordx4 v15, s[8:11], s24 offen lds
  v_mfma_f32_16x16x32_bf16 v[84:87], v[116:119], v[248:251], v[84:87]
  s_waitcnt lgkmcnt(2)
  v_mfma_f32_16x16x32_bf16 v[56:59], a[188:191], v[120:123], v[56:59]
  ds_read_b128 v[32:35], v19 offset:0
  v_mfma_f32_16x16x32_bf16 v[60:63], a[188:191], v[124:127], v[60:63]
  v_mfma_f32_16x16x32_bf16 v[64:67], a[252:255], v[120:123], v[64:67]
  ds_read_b128 v[36:39], v19 offset:16384
  v_mfma_f32_16x16x32_bf16 v[68:71], a[252:255], v[124:127], v[68:71]
  s_lshl_b32 s24, s13, 11
  s_add_u32 s25, s24, s20
  v_add_u32 v15, s25, v1
  v_mfma_f32_16x16x32_bf16 v[72:75], v[120:123], v[188:191], v[72:75]
  s_lshl_b32 s25, s22, 19
  s_lshl_b32 s26, s12, 14
  v_add_u32 v14, s20, v6
  v_mfma_f32_16x16x32_bf16 v[76:79], v[124:127], v[188:191], v[76:79]
  s_add_u32 s25, s25, s26
  s_add_u32 s25, s25, s24
  s_add_u32 s40, s25, 33554432
  v_mfma_f32_16x16x32_bf16 v[80:83], v[120:123], v[252:255], v[80:83]
  s_add_u32 s43, s40, 8192
  v_mfma_f32_16x16x32_bf16 v[84:87], v[124:127], v[252:255], v[84:87]
  s_waitcnt lgkmcnt(2)
  v_mfma_f32_16x16x32_bf16 v[40:43], a[0:3], v[24:27], 0
  ds_read_b128 v[112:115], v20 offset:0
  v_mul_f32 v56, s17, v56
  v_mfma_f32_16x16x32_bf16 v[44:47], a[0:3], v[28:31], 0
  v_mul_f32 v57, s17, v57
  v_mul_f32 v58, s17, v58
  v_mfma_f32_16x16x32_bf16 v[48:51], a[64:67], v[24:27], 0
  ds_read_b128 v[116:119], v20 offset:16384
  v_mul_f32 v59, s17, v59
  v_mfma_f32_16x16x32_bf16 v[52:55], a[64:67], v[28:31], 0
  v_cvt_pk_bf16_f32 v88, v56, v57
  v_cvt_pk_bf16_f32 v89, v58, v59
  s_waitcnt lgkmcnt(2)
  v_mfma_f32_16x16x32_bf16 v[40:43], a[4:7], v[32:35], v[40:43]
  ds_read_b128 v[120:123], v21 offset:0
  v_mul_f32 v60, s17, v60
  v_mfma_f32_16x16x32_bf16 v[44:47], a[4:7], v[36:39], v[44:47]
  ds_write_b64 v14, v[88:89] offset:8192
  v_mfma_f32_16x16x32_bf16 v[48:51], a[68:71], v[32:35], v[48:51]
  ds_read_b128 v[124:127], v21 offset:16384
  v_mul_f32 v61, s17, v61
  v_mfma_f32_16x16x32_bf16 v[52:55], a[68:71], v[36:39], v[52:55]
  v_mul_f32 v62, s17, v62
  v_mul_f32 v63, s17, v63
  s_waitcnt lgkmcnt(3)
  v_mfma_f32_16x16x32_bf16 v[40:43], a[8:11], v[112:115], v[40:43]
  ds_read_b128 v[24:27], v18 offset:256
  v_cvt_pk_bf16_f32 v90, v60, v61
  v_mfma_f32_16x16x32_bf16 v[44:47], a[8:11], v[116:119], v[44:47]
  v_cvt_pk_bf16_f32 v91, v62, v63
  v_mul_f32 v64, s17, v64
  v_mfma_f32_16x16x32_bf16 v[48:51], a[72:75], v[112:115], v[48:51]
  ds_read_b128 v[28:31], v18 offset:16640
  v_mul_f32 v65, s17, v65
  v_mfma_f32_16x16x32_bf16 v[52:55], a[72:75], v[116:119], v[52:55]
  ds_write_b64 v14, v[90:91] offset:12288
  s_waitcnt lgkmcnt(3)
  v_mfma_f32_16x16x32_bf16 v[40:43], a[12:15], v[120:123], v[40:43]
  ds_read_b128 v[32:35], v19 offset:256
  v_mul_f32 v66, s17, v66
  v_mfma_f32_16x16x32_bf16 v[44:47], a[12:15], v[124:127], v[44:47]
  v_mul_f32 v67, s17, v67
  v_cvt_pk_bf16_f32 v92, v64, v65
  v_mfma_f32_16x16x32_bf16 v[48:51], a[76:79], v[120:123], v[48:51]
  ds_read_b128 v[36:39], v19 offset:16640
  v_cvt_pk_bf16_f32 v93, v66, v67
  v_mfma_f32_16x16x32_bf16 v[52:55], a[76:79], v[124:127], v[52:55]
  ds_write_b64 v14, v[92:93] offset:8208
  s_waitcnt lgkmcnt(4)
  v_mfma_f32_16x16x32_bf16 v[40:43], a[16:19], v[24:27], v[40:43]
  ds_read_b128 v[112:115], v20 offset:256
  v_mul_f32 v68, s17, v68
  v_mfma_f32_16x16x32_bf16 v[44:47], a[16:19], v[28:31], v[44:47]
  v_mul_f32 v69, s17, v69
  v_mul_f32 v70, s17, v70
  v_mfma_f32_16x16x32_bf16 v[48:51], a[80:83], v[24:27], v[48:51]
  ds_read_b128 v[116:119], v20 offset:16640
  v_mul_f32 v71, s17, v71
  v_mfma_f32_16x16x32_bf16 v[52:55], a[80:83], v[28:31], v[52:55]
  v_cvt_pk_bf16_f32 v94, v68, v69
  v_cvt_pk_bf16_f32 v95, v70, v71
  s_waitcnt lgkmcnt(3)
  v_mfma_f32_16x16x32_bf16 v[40:43], a[20:23], v[32:35], v[40:43]
  ds_read_b128 v[120:123], v21 offset:256
  v_cvt_pk_bf16_f32 v96, v72, v73
  v_mfma_f32_16x16x32_bf16 v[44:47], a[20:23], v[36:39], v[44:47]
  ds_write_b64 v14, v[94:95] offset:12304
  v_mfma_f32_16x16x32_bf16 v[48:51], a[84:87], v[32:35], v[48:51]
  ds_read_b128 v[124:127], v21 offset:16640
  v_cvt_pk_bf16_f32 v97, v74, v75
  v_mfma_f32_16x16x32_bf16 v[52:55], a[84:87], v[36:39], v[52:55]
  v_cvt_pk_bf16_f32 v98, v76, v77
  v_cvt_pk_bf16_f32 v99, v78, v79
  s_waitcnt lgkmcnt(3)
  v_mfma_f32_16x16x32_bf16 v[40:43], a[24:27], v[112:115], v[40:43]
  ds_read_b128 v[24:27], v18 offset:512
  v_cvt_pk_bf16_f32 v100, v80, v81
  v_mfma_f32_16x16x32_bf16 v[44:47], a[24:27], v[116:119], v[44:47]
  buffer_store_dwordx4 v[96:99], v1, s[4:7], s43 offen offset:0 sc1
  v_mfma_f32_16x16x32_bf16 v[48:51], a[88:91], v[112:115], v[48:51]
  ds_read_b128 v[28:31], v18 offset:16896
  v_cvt_pk_bf16_f32 v101, v82, v83
  v_mfma_f32_16x16x32_bf16 v[52:55], a[88:91], v[116:119], v[52:55]
  ds_write_b128 v15, v[96:99] offset:16384
  s_waitcnt lgkmcnt(3)
  v_mfma_f32_16x16x32_bf16 v[40:43], a[28:31], v[120:123], v[40:43]
  ds_read_b128 v[32:35], v19 offset:512
  v_cvt_pk_bf16_f32 v102, v84, v85
  v_mfma_f32_16x16x32_bf16 v[44:47], a[28:31], v[124:127], v[44:47]
  v_cvt_pk_bf16_f32 v103, v86, v87
  v_mfma_f32_16x16x32_bf16 v[48:51], a[92:95], v[120:123], v[48:51]
  ds_read_b128 v[36:39], v19 offset:16896
  v_mfma_f32_16x16x32_bf16 v[52:55], a[92:95], v[124:127], v[52:55]
  buffer_store_dwordx4 v[100:103], v1, s[4:7], s43 offen offset:1024 sc1
  s_waitcnt lgkmcnt(3)
  v_mfma_f32_16x16x32_bf16 v[40:43], a[32:35], v[24:27], v[40:43]
  ds_read_b128 v[112:115], v20 offset:512
  v_mfma_f32_16x16x32_bf16 v[44:47], a[32:35], v[28:31], v[44:47]
  ds_write_b128 v15, v[100:103] offset:17408
  v_mfma_f32_16x16x32_bf16 v[48:51], a[96:99], v[24:27], v[48:51]
  ds_read_b128 v[116:119], v20 offset:16896
  v_mfma_f32_16x16x32_bf16 v[52:55], a[96:99], v[28:31], v[52:55]
  s_waitcnt lgkmcnt(9)
  s_barrier
  s_waitcnt lgkmcnt(3)
  v_mfma_f32_16x16x32_bf16 v[40:43], a[36:39], v[32:35], v[40:43]
  ds_read_b128 v[120:123], v21 offset:512
  v_mfma_f32_16x16x32_bf16 v[44:47], a[36:39], v[36:39], v[44:47]
  ds_read_b128 v[88:91], v15 offset:8192
  v_mfma_f32_16x16x32_bf16 v[48:51], a[100:103], v[32:35], v[48:51]
  ds_read_b128 v[124:127], v21 offset:16896
  v_mfma_f32_16x16x32_bf16 v[52:55], a[100:103], v[36:39], v[52:55]
  ds_read_b128 v[92:95], v15 offset:9216
  s_waitcnt lgkmcnt(4)
  v_mfma_f32_16x16x32_bf16 v[40:43], a[40:43], v[112:115], v[40:43]
  ds_read_b128 v[24:27], v18 offset:768
  v_mfma_f32_16x16x32_bf16 v[44:47], a[40:43], v[116:119], v[44:47]
  v_mfma_f32_16x16x32_bf16 v[48:51], a[104:107], v[112:115], v[48:51]
  ds_read_b128 v[28:31], v18 offset:17152
  v_mfma_f32_16x16x32_bf16 v[52:55], a[104:107], v[116:119], v[52:55]
  s_waitcnt lgkmcnt(3)
  v_mfma_f32_16x16x32_bf16 v[40:43], a[44:47], v[120:123], v[40:43]
  ds_read_b128 v[32:35], v19 offset:768
  v_mfma_f32_16x16x32_bf16 v[44:47], a[44:47], v[124:127], v[44:47]
  s_waitcnt lgkmcnt(5)
  buffer_store_dwordx4 v[88:91], v1, s[4:7], s40 offen offset:0 sc1
  v_mfma_f32_16x16x32_bf16 v[48:51], a[108:111], v[120:123], v[48:51]
  ds_read_b128 v[36:39], v19 offset:17152
  v_mfma_f32_16x16x32_bf16 v[52:55], a[108:111], v[124:127], v[52:55]
  s_waitcnt lgkmcnt(4)
  buffer_store_dwordx4 v[92:95], v1, s[4:7], s40 offen offset:1024 sc1
  s_waitcnt lgkmcnt(2)
  v_mfma_f32_16x16x32_bf16 v[40:43], a[48:51], v[24:27], v[40:43]
  ds_read_b128 v[112:115], v20 offset:768
  v_mfma_f32_16x16x32_bf16 v[44:47], a[48:51], v[28:31], v[44:47]
  buffer_load_dwordx4 v[104:107], v1, s[4:7], s34 offen sc1
  v_mfma_f32_16x16x32_bf16 v[48:51], a[112:115], v[24:27], v[48:51]
  ds_read_b128 v[116:119], v20 offset:17152
  v_mfma_f32_16x16x32_bf16 v[52:55], a[112:115], v[28:31], v[52:55]
  buffer_load_dwordx4 v[108:111], v1, s[4:7], s35 offen sc1
  s_waitcnt lgkmcnt(2)
  v_mfma_f32_16x16x32_bf16 v[40:43], a[52:55], v[32:35], v[40:43]
  ds_read_b128 v[120:123], v21 offset:768
  v_mfma_f32_16x16x32_bf16 v[44:47], a[52:55], v[36:39], v[44:47]
  v_mfma_f32_16x16x32_bf16 v[48:51], a[116:119], v[32:35], v[48:51]
  ds_read_b128 v[124:127], v21 offset:17152
  v_mfma_f32_16x16x32_bf16 v[52:55], a[116:119], v[36:39], v[52:55]
  s_waitcnt lgkmcnt(2)
  v_mfma_f32_16x16x32_bf16 v[40:43], a[56:59], v[112:115], v[40:43]
  v_mfma_f32_16x16x32_bf16 v[44:47], a[56:59], v[116:119], v[44:47]
  v_mfma_f32_16x16x32_bf16 v[48:51], a[120:123], v[112:115], v[48:51]
  v_mfma_f32_16x16x32_bf16 v[52:55], a[120:123], v[116:119], v[52:55]
  s_waitcnt lgkmcnt(0)
  v_mfma_f32_16x16x32_bf16 v[40:43], a[60:63], v[120:123], v[40:43]
  v_mfma_f32_16x16x32_bf16 v[44:47], a[60:63], v[124:127], v[44:47]
  v_mfma_f32_16x16x32_bf16 v[48:51], a[124:127], v[120:123], v[48:51]
  v_mfma_f32_16x16x32_bf16 v[52:55], a[124:127], v[124:127], v[52:55]
  s_lshl_b32 s24, s12, 8
  s_lshl_b32 s25, s22, 2
  s_add_u32 s24, s24, s25
  s_add_u32 s30, s24, 1114112
  s_add_u32 s22, s22, 3
  s_add_u32 s20, s20, 24576
  s_cmp_eq_u32 s20, 73728
  s_cselect_b32 s20, 0, s20
  v_cvt_pk_bf16_f32 v72, v40, v41
  v_cvt_pk_bf16_f32 v73, v42, v43
  ds_write_b64 v14, v[72:73] offset:0
  v_cvt_pk_bf16_f32 v74, v44, v45
  v_cvt_pk_bf16_f32 v75, v46, v47
  ds_write_b64 v14, v[74:75] offset:4096
  v_cvt_pk_bf16_f32 v76, v48, v49
  v_cvt_pk_bf16_f32 v77, v50, v51
  ds_write_b64 v14, v[76:77] offset:16
  v_cvt_pk_bf16_f32 v78, v52, v53
  v_cvt_pk_bf16_f32 v79, v54, v55
  ds_write_b64 v14, v[78:79] offset:4112
  s_branch L_qatt_52
L_qnp_55:
  buffer_load_dwordx4 v[104:107], v1, s[4:7], s34 offen sc1
  buffer_load_dwordx4 v[108:111], v1, s[4:7], s35 offen sc1
L_qatt_52:
  s_cmp_ge_u32 s15, 2
  s_cbranch_scc1 L_qnx_54
  s_waitcnt vmcnt(0) lgkmcnt(0)
  s_barrier
  buffer_store_dword v22, v23, s[4:7], s30 offen sc1
  s_mov_b32 s30, s6
  s_branch L_qnext_53
L_qnx_54:
  v_add_u32 v18, s21, v8
  v_add_u32 v19, s21, v9
  s_lshr_b32 s24, s13, 1
  s_lshl_b32 s25, s24, 12
  s_add_u32 s25, s25, s21
  v_add_u32 v20, s25, v1
  ds_read_b128 v[24:27], v18 offset:0
  ds_read_b128 v[28:31], v18 offset:16
  ds_read_b128 v[32:35], v18 offset:1024
  ds_read_b128 v[36:39], v18 offset:1040
  ds_read_b128 v[40:43], v19 offset:8192
  ds_read_b128 v[44:47], v19 offset:8208
  ds_read_b128 v[48:51], v19 offset:9216
  ds_read_b128 v[52:55], v19 offset:9232
  ds_read_b128 v[56:59], v19 offset:12288
  ds_read_b128 v[60:63], v19 offset:12304
  ds_read_b128 v[64:67], v19 offset:13312
  ds_read_b128 v[68:71], v19 offset:13328
  s_waitcnt lgkmcnt(0)
  ds_read_b128 v[112:115], v20 offset:16384
  ds_read_b128 v[116:119], v20 offset:17408
  ds_read_b128 v[120:123], v20 offset:18432
  ds_read_b128 v[124:127], v20 offset:19456
  v_mfma_f32_16x16x32_bf16 v[72:75], v[40:43], v[24:27], 0
  v_mfma_f32_16x16x32_bf16 v[72:75], v[44:47], v[28:31], v[72:75]
  v_mfma_f32_16x16x32_bf16 v[72:75], v[48:51], v[32:35], v[72:75]
  v_mfma_f32_16x16x32_bf16 v[72:75], v[52:55], v[36:39], v[72:75]
  v_mfma_f32_16x16x32_bf16 v[76:79], v[56:59], v[24:27], 0
  v_mfma_f32_16x16x32_bf16 v[76:79], v[60:63], v[28:31], v[76:79]
  v_mfma_f32_16x16x32_bf16 v[76:79], v[64:67], v[32:35], v[76:79]
  v_mfma_f32_16x16x32_bf16 v[76:79], v[68:71], v[36:39], v[76:79]
  v_mov_b32 v16, s28
  s_lshl_b32 s25, s13, 10
  s_add_u32 s25, s25, 81920
  v_lshrrev_b32 v14, 1, v1
  v_add_u32 v18, s25, v14
  s_lshl_b32 s25, s13, 9
  s_add_u32 s25, s25, 86016
  v_lshrrev_b32 v14, 2, v1
  v_add_u32 v19, s25, v14
  s_lshl_b32 s25, s24, 10
  s_add_u32 s25, s25, 86016
  v_add_u32 v20, s25, v14
  s_and_b32 s26, s13, 1
  s_lshl_b32 s25, s23, 1
  s_add_u32 s25, s25, s26
  s_lshl_b32 s25, s25, 5
  s_add_u32 s25, s25, s12
  s_lshl_b32 s25, s25, 1
  s_add_u32 s25, s25, s24
  s_lshl_b32 s25, s25, 11
  s_add_u32 s40, s25, 16777216
  v_cndmask_b32 v72, v16, v72, s[64:65]
  v_cndmask_b32 v73, v16, v73, s[66:67]
  v_cndmask_b32 v74, v16, v74, s[68:69]
  v_cndmask_b32 v75, v16, v75, s[70:71]
  v_cndmask_b32 v76, v16, v76, s[72:73]
  v_cndmask_b32 v77, v16, v77, s[74:75]
  v_cndmask_b32 v78, v16, v78, s[76:77]
  v_cndmask_b32 v79, v16, v79, s[78:79]
  v_max3_f32 v84, v72, v73, v74
  v_max3_f32 v84, v84, v75, v76
  v_max3_f32 v84, v84, v77, v78
  v_max_f32 v84, v84, v79
  s_waitcnt vmcnt(0)
  s_barrier
  buffer_store_dword v22, v23, s[4:7], s30 offen sc1
  s_mov_b32 s30, s6
  v_mov_b64 v[88:89], 0
  v_mov_b64 v[90:91], 0
  v_mov_b64 v[92:93], 0
  v_mov_b64 v[94:95], 0
  v_mov_b64 v[96:97], 0
  v_mov_b64 v[98:99], 0
  v_mov_b64 v[100:101], 0
  v_mov_b64 v[102:103], 0
L_mpoll_56:
  v_max3_u32 v14, v104, v105, v106
  v_max3_u32 v14, v14, v107, v108
  v_max3_u32 v14, v14, v109, v110
  v_max_u32 v14, v14, v111
  v_cmp_eq_u32 vcc, -1, v14
  s_cbranch_vccz L_mgot_57
  s_cmp_eq_u32 s23, 63
  s_cbranch_scc1 L_mpoll_56_n
  s_sleep 8
L_mpoll_56_n:
  buffer_load_dwordx4 v[104:107], v1, s[4:7], s34 offen sc1
  buffer_load_dwordx4 v[108:111], v1, s[4:7], s35 offen sc1
  s_sub_u32 s33, s33, 1
  s_cbranch_scc1 L_done
  s_waitcnt vmcnt(0)
  s_branch L_mpoll_56
L_mgot_57:
  ds_write2_b32 v11, v104, v108 offset0:0 offset1:1
  ds_write2_b32 v11, v105, v109 offset0:2 offset1:3
  ds_write2_b32 v11, v106, v110 offset0:64 offset1:65
  ds_write2_b32 v11, v107, v111 offset0:66 offset1:67
  s_waitcnt lgkmcnt(0)
  s_barrier
  ds_read_b128 v[40:43], v12 offset:0
  ds_read_b128 v[44:47], v12 offset:1024
  ds_read_b128 v[48:51], v12 offset:2048
  s_waitcnt lgkmcnt(2)
  v_smfmac_f32_16x16x64_bf16 v[88:91], v[40:43], a[128:135], v17
  ds_read_b128 v[52:55], v12 offset:3072
  v_smfmac_f32_16x16x64_bf16 v[92:95], v[40:43], a[192:199], v17
  s_waitcnt lgkmcnt(2)
  v_smfmac_f32_16x16x64_bf16 v[88:91], v[44:47], a[136:143], v17
  ds_read_b128 v[56:59], v12 offset:4096
  v_smfmac_f32_16x16x64_bf16 v[92:95], v[44:47], a[200:207], v17
  s_waitcnt lgkmcnt(2)
  v_smfmac_f32_16x16x64_bf16 v[88:91], v[48:51], a[144:151], v17
  ds_read_b128 v[60:63], v12 offset:5120
  v_smfmac_f32_16x16x64_bf16 v[92:95], v[48:51], a[208:215], v17
  s_waitcnt lgkmcnt(2)
  v_smfmac_f32_16x16x64_bf16 v[88:91], v[52:55], a[152:159], v17
  ds_read_b128 v[64:67], v12 offset:6144
  v_smfmac_f32_16x16x64_bf16 v[92:95], v[52:55], a[216:223], v17
  s_waitcnt lgkmcnt(2)
  v_smfmac_f32_16x16x64_bf16 v[88:91], v[56:59], a[160:167], v17
  ds_read_b128 v[68:71], v12 offset:7168
  v_smfmac_f32_16x16x64_bf16 v[92:95], v[56:59], a[224:231], v17
  s_waitcnt lgkmcnt(2)
  v_smfmac_f32_16x16x64_bf16 v[88:91], v[60:63], a[168:175], v17
  v_smfmac_f32_16x16x64_bf16 v[92:95], v[60:63], a[232:239], v17
  s_waitcnt lgkmcnt(1)
  v_smfmac_f32_16x16x64_bf16 v[88:91], v[64:67], a[176:183], v17
  v_smfmac_f32_16x16x64_bf16 v[92:95], v[64:67], a[240:247], v17
  s_waitcnt lgkmcnt(0)
  v_smfmac_f32_16x16x64_bf16 v[88:91], v[68:71], a[184:191], v17
  s_nop 2
  v_smfmac_f32_16x16x64_bf16 v[92:95], v[68:71], a[248:255], v17
  s_nop 2
  v_smfmac_f32_16x16x64_bf16 v[96:99], v[40:43], v[128:135], v17
  v_smfmac_f32_16x16x64_bf16 v[96:99], v[44:47], v[136:143], v17
  v_add_f32 v88, v88, v89
  v_add_f32 v90, v90, v91
  v_smfmac_f32_16x16x64_bf16 v[96:99], v[48:51], v[144:151], v17
  v_add_f32 v92, v92, v93
  v_add_f32 v94, v94, v95
  v_smfmac_f32_16x16x64_bf16 v[96:99], v[52:55], v[152:159], v17
  v_cvt_pk_bf16_f32 v89, v88, v90
  v_cvt_pk_bf16_f32 v93, v92, v94
  v_smfmac_f32_16x16x64_bf16 v[96:99], v[56:59], v[160:167], v17
  ds_write2st64_b32 v18, v89, v93 offset0:0 offset1:2
  v_smfmac_f32_16x16x64_bf16 v[96:99], v[60:63], v[168:175], v17
  v_smfmac_f32_16x16x64_bf16 v[96:99], v[64:67], v[176:183], v17
  v_smfmac_f32_16x16x64_bf16 v[96:99], v[68:71], v[184:191], v17
  s_nop 0
  v_smfmac_f32_16x16x64_bf16 v[100:103], v[40:43], v[192:199], v17
  s_waitcnt lgkmcnt(0)
  s_barrier
  v_smfmac_f32_16x16x64_bf16 v[100:103], v[44:47], v[200:207], v17
  ds_read_b64_tr_b16 v[104:105], v13 offset:0
  v_smfmac_f32_16x16x64_bf16 v[100:103], v[48:51], v[208:215], v17
  ds_read_b64_tr_b16 v[106:107], v13 offset:1024
  v_add_f32 v96, v96, v97
  v_smfmac_f32_16x16x64_bf16 v[100:103], v[52:55], v[216:223], v17
  ds_read_b64_tr_b16 v[108:109], v13 offset:512
  v_add_f32 v98, v98, v99
  v_smfmac_f32_16x16x64_bf16 v[100:103], v[56:59], v[224:231], v17
  ds_read_b64_tr_b16 v[110:111], v13 offset:1536
  v_cvt_pk_bf16_f32 v97, v96, v98
  v_smfmac_f32_16x16x64_bf16 v[100:103], v[60:63], v[232:239], v17
  ds_read_b64_tr_b16 v[88:89], v13 offset:2048
  ds_read_b64_tr_b16 v[90:91], v13 offset:3072
  v_smfmac_f32_16x16x64_bf16 v[100:103], v[64:67], v[240:247], v17
  ds_read_b64_tr_b16 v[92:93], v13 offset:2560
  ds_read_b64_tr_b16 v[94:95], v13 offset:3584
  v_smfmac_f32_16x16x64_bf16 v[100:103], v[68:71], v[248:255], v17
  s_nop 1
  s_waitcnt lgkmcnt(4)
  v_mfma_f32_16x16x32_bf16 v[80:83], v[104:107], v[24:27], 0
  s_nop 0
  v_mfma_f32_16x16x32_bf16 v[80:83], v[108:111], v[28:31], v[80:83]
  s_waitcnt lgkmcnt(0)
  v_mfma_f32_16x16x32_bf16 v[80:83], v[88:91], v[32:35], v[80:83]
  v_add_f32 v100, v100, v101
  v_add_f32 v102, v102, v103
  v_mfma_f32_16x16x32_bf16 v[80:83], v[92:95], v[36:39], v[80:83]
  v_cvt_pk_bf16_f32 v101, v100, v102
  ds_write2st64_b32 v19, v97, v101 offset0:0 offset1:1
  v_mov_b32 v69, 0
  v_mov_b32 v70, 0
  s_nop 3
  v_mul_f32 v80, s17, v80
  v_mul_f32 v81, s17, v81
  v_max3_f32 v84, v84, v80, v81
  v_mov_b32 v85, v84
  s_nop 1
  v_permlane32_swap_b32 v84, v85
  v_max_f32 v84, v84, v85
  v_mov_b32 v85, v84
  s_nop 1
  v_permlane16_swap_b32 v84, v85
  v_max_f32 v84, v84, v85
  s_waitcnt lgkmcnt(0)
  s_barrier
  ds_read2st64_b32 v[56:57], v20 offset0:0 offset1:1
  ds_read2st64_b32 v[58:59], v20 offset0:2 offset1:3
  v_sub_f32 v72, v72, v84
  v_sub_f32 v73, v73, v84
  v_sub_f32 v74, v74, v84
  v_sub_f32 v75, v75, v84
  v_sub_f32 v76, v76, v84
  v_sub_f32 v77, v77, v84
  v_sub_f32 v78, v78, v84
  v_sub_f32 v79, v79, v84
  v_sub_f32 v80, v80, v84
  v_sub_f32 v81, v81, v84
  v_exp_f32 v72, v72
  v_exp_f32 v73, v73
  v_exp_f32 v74, v74
  v_exp_f32 v75, v75
  v_exp_f32 v76, v76
  v_exp_f32 v77, v77
  v_exp_f32 v78, v78
  v_exp_f32 v79, v79
  v_exp_f32 v80, v80
  v_exp_f32 v81, v81
  v_cvt_pk_bf16_f32 v64, v72, v73
  v_cvt_pk_bf16_f32 v65, v74, v75
  v_cvt_pk_bf16_f32 v66, v76, v77
  v_cvt_pk_bf16_f32 v67, v78, v79
  v_cvt_pk_bf16_f32 v68, v80, v81
  v_cvt_pk_bf16_f32 v71, v80, v81
  s_waitcnt lgkmcnt(0)
  v_mfma_f32_16x16x32_bf16 v[24:27], v[112:115], v[64:67], 0
  v_add_f32 v86, v72, v73
  v_add_f32 v86, v86, v74
  v_mfma_f32_16x16x32_bf16 v[28:31], v[116:119], v[64:67], 0
  v_add_f32 v86, v86, v75
  v_add_f32 v86, v86, v76
  v_mfma_f32_16x16x32_bf16 v[32:35], v[120:123], v[64:67], 0
  v_add_f32 v86, v86, v77
  v_add_f32 v86, v86, v78
  v_mfma_f32_16x16x32_bf16 v[36:39], v[124:127], v[64:67], 0
  v_add_f32 v86, v86, v79
  v_add_f32 v86, v86, v80
  v_mfma_f32_16x16x16_bf16 v[24:27], v[56:57], v[68:69], v[24:27]
  v_add_f32 v86, v86, v81
  v_mfma_f32_16x16x16_bf16 v[28:31], v[56:57], v[70:71], v[28:31]
  v_mfma_f32_16x16x16_bf16 v[32:35], v[58:59], v[68:69], v[32:35]
  v_mfma_f32_16x16x16_bf16 v[36:39], v[58:59], v[70:71], v[36:39]
  v_mov_b32 v87, v86
  s_nop 1
  v_permlane32_swap_b32 v86, v87
  v_add_f32 v86, v86, v87
  v_mov_b32 v87, v86
  s_nop 1
  v_permlane16_swap_b32 v86, v87
  v_add_f32 v86, v86, v87
  v_rcp_f32 v86, v86
  s_nop 0
  v_mul_f32 v24, v24, v86
  v_mul_f32 v25, v25, v86
  v_mul_f32 v26, v26, v86
  v_mul_f32 v27, v27, v86
  v_mul_f32 v28, v28, v86
  v_mul_f32 v29, v29, v86
  v_mul_f32 v30, v30, v86
  v_mul_f32 v31, v31, v86
  v_cvt_pk_bf16_f32 v104, v24, v25
  v_cvt_pk_bf16_f32 v105, v26, v27
  v_cvt_pk_bf16_f32 v106, v28, v29
  v_cvt_pk_bf16_f32 v107, v30, v31
  buffer_store_dwordx4 v[104:107], v1, s[4:7], s40 offen offset:0 sc1
  v_mul_f32 v32, v32, v86
  v_mul_f32 v33, v33, v86
  v_mul_f32 v34, v34, v86
  v_mul_f32 v35, v35, v86
  v_mul_f32 v36, v36, v86
  v_mul_f32 v37, v37, v86
  v_mul_f32 v38, v38, v86
  v_mul_f32 v39, v39, v86
  v_cvt_pk_bf16_f32 v108, v32, v33
  v_cvt_pk_bf16_f32 v109, v34, v35
  v_cvt_pk_bf16_f32 v110, v36, v37
  v_cvt_pk_bf16_f32 v111, v38, v39
  buffer_store_dwordx4 v[108:111], v1, s[4:7], s40 offen offset:1024 sc1
  s_lshl_b32 s24, s23, 9
  s_lshr_b32 s25, s12, 3
  s_mul_i32 s25, s25, 96
  s_add_u32 s24, s24, s25
  s_lshl_b32 s25, s12, 2
  s_add_u32 s24, s24, s25
  s_add_u32 s29, s24, 1146880
  s_add_u32 s24, s15, 1
  s_cmp_lt_u32 s24, s16
  s_cbranch_scc1 L_qdf_58
  s_waitcnt vmcnt(0)
  s_barrier
  buffer_store_dword v22, v23, s[4:7], s29 offen sc1
  s_mov_b32 s29, s6
L_qdf_58:
  s_add_u32 s23, s23, 3
  s_add_u32 s21, s21, 24576
  s_cmp_eq_u32 s21, 73728
  s_cselect_b32 s21, 0, s21
L_qnext_53:
  s_add_u32 s15, s15, 1
  s_add_u32 s24, s16, 2
  s_cmp_lt_u32 s15, s24
  s_cbranch_scc1 L_qloop_51
  s_branch L_done
L_B:
  s_load_dwordx2 s[8:9], s[0:1], 0
  s_mov_b32 s10, 2097152
  s_mov_b32 s11, 0x20000
  s_load_dwordx2 s[76:77], s[0:1], 96
  s_mov_b32 s78, 1024
  s_mov_b32 s79, 0x20000
  s_sub_u32 s12, s3, 128
  v_and_b32 v5, 63, v0
  v_lshlrev_b32 v1, 4, v5
  v_and_b32 v2, 15, v5
  v_lshrrev_b32 v3, 4, v5
  s_mov_b32 s28, 0x05040100
  s_mov_b32 s29, 0x07060302
  s_cmp_ge_u32 s12, 112
  s_cbranch_scc0 L_ini_59
  s_load_dwordx2 s[68:69], s[0:1], 8
  s_mov_b32 s70, 8192
  s_mov_b32 s71, 0x20000
  v_and_b32 v33, 15, v0
  v_lshl_add_u32 v32, v33, 2, 64
  v_cmp_eq_u32 vcc, 0, v33
  s_nop 1
  v_cndmask_b32 v32, v32, 0, vcc
  s_cmp_eq_u32 s13, 0
  s_cbranch_scc0 L_cf_61
  buffer_load_dword v34, v32, s[36:39], 0 offen sc1
L_cen_62:
  v_cmp_gt_u32 vcc, s82, v33
  s_waitcnt vmcnt(0)
  s_nop 0
  v_cndmask_b32 v35, 0, v34, vcc
  v_add_u32_dpp v34, v34, v34 row_ror:8 row_mask:0xf bank_mask:0xf
  s_nop 0
  v_add_u32_dpp v35, v35, v35 row_ror:8 row_mask:0xf bank_mask:0xf
  v_add_u32_dpp v34, v34, v34 row_ror:4 row_mask:0xf bank_mask:0xf
  s_nop 0
  v_add_u32_dpp v35, v35, v35 row_ror:4 row_mask:0xf bank_mask:0xf
  v_add_u32_dpp v34, v34, v34 row_ror:2 row_mask:0xf bank_mask:0xf
  s_nop 0
  v_add_u32_dpp v35, v35, v35 row_ror:2 row_mask:0xf bank_mask:0xf
  v_add_u32_dpp v34, v34, v34 row_ror:1 row_mask:0xf bank_mask:0xf
  s_nop 0
  v_add_u32_dpp v35, v35, v35 row_ror:1 row_mask:0xf bank_mask:0xf
  v_readfirstlane_b32 s24, v34
  v_readfirstlane_b32 s25, v35
  s_cmp_ge_u32 s24, 256
  s_cbranch_scc1 L_cen_62_x
  s_sub_u32 s33, s33, 1
  s_cbranch_scc1 L_done
  s_sleep 16
  buffer_load_dword v34, v32, s[36:39], 0 offen sc1
  s_branch L_cen_62
L_cen_62_x:
  s_add_u32 s25, s25, s83
L_cf_61:
  s_barrier
  buffer_load_dword v34, v32, s[36:39], 0 offen sc1
L_cen_63:
  v_cmp_gt_u32 vcc, s82, v33
  s_waitcnt vmcnt(0)
  s_nop 0
  v_cndmask_b32 v35, 0, v34, vcc
  v_add_u32_dpp v34, v34, v34 row_ror:8 row_mask:0xf bank_mask:0xf
  s_nop 0
  v_add_u32_dpp v35, v35, v35 row_ror:8 row_mask:0xf bank_mask:0xf
  v_add_u32_dpp v34, v34, v34 row_ror:4 row_mask:0xf bank_mask:0xf
  s_nop 0
  v_add_u32_dpp v35, v35, v35 row_ror:4 row_mask:0xf bank_mask:0xf
  v_add_u32_dpp v34, v34, v34 row_ror:2 row_mask:0xf bank_mask:0xf
  s_nop 0
  v_add_u32_dpp v35, v35, v35 row_ror:2 row_mask:0xf bank_mask:0xf
  v_add_u32_dpp v34, v34, v34 row_ror:1 row_mask:0xf bank_mask:0xf
  s_nop 0
  v_add_u32_dpp v35, v35, v35 row_ror:1 row_mask:0xf bank_mask:0xf
  v_readfirstlane_b32 s24, v34
  v_readfirstlane_b32 s25, v35
  s_cmp_ge_u32 s24, 256
  s_cbranch_scc1 L_cen_63_x
  s_sub_u32 s33, s33, 1
  s_cbranch_scc1 L_done
  s_sleep 16
  buffer_load_dword v34, v32, s[36:39], 0 offen sc1
  s_branch L_cen_63
L_cen_63_x:
  s_add_u32 s25, s25, s83
  s_cmp_eq_u32 s3, s25
  s_mov_b32 s3, s25
  s_barrier
  s_cbranch_scc0 L_role
  v_lshlrev_b32 v8, 4, v0
  v_mov_b32 v16, -1
  v_mov_b32 v20, 0
  v_mov_b32 v17, -1
  v_mov_b32 v21, 0
  v_mov_b32 v18, -1
  v_mov_b32 v22, 0
  v_mov_b32 v19, -1
  v_mov_b32 v23, 0
  s_sub_u32 s26, s12, 112
  s_lshl_b32 s24, s26, 14
  s_add_u32 s24, s24, 0
  buffer_store_dwordx4 v[20:23], v8, s[4:7], s24 offen sc1
  s_add_u32 s24, s24, 4096
  buffer_store_dwordx4 v[20:23], v8, s[4:7], s24 offen sc1
  s_add_u32 s24, s24, 4096
  buffer_store_dwordx4 v[20:23], v8, s[4:7], s24 offen sc1
  s_add_u32 s24, s24, 4096
  buffer_store_dwordx4 v[20:23], v8, s[4:7], s24 offen sc1
  s_add_u32 s24, s24, 4096
  s_lshl_b32 s24, s26, 15
  s_add_u32 s24, s24, 1318912
  buffer_store_dwordx4 v[16:19], v8, s[4:7], s24 offen sc1
  s_add_u32 s24, s24, 4096
  buffer_store_dwordx4 v[16:19], v8, s[4:7], s24 offen sc1
  s_add_u32 s24, s24, 4096
  buffer_store_dwordx4 v[16:19], v8, s[4:7], s24 offen sc1
  s_add_u32 s24, s24, 4096
  buffer_store_dwordx4 v[16:19], v8, s[4:7], s24 offen sc1
  s_add_u32 s24, s24, 4096
  buffer_store_dwordx4 v[16:19], v8, s[4:7], s24 offen sc1
  s_add_u32 s24, s24, 4096
  buffer_store_dwordx4 v[16:19], v8, s[4:7], s24 offen sc1
  s_add_u32 s24, s24, 4096
  buffer_store_dwordx4 v[16:19], v8, s[4:7], s24 offen sc1
  s_add_u32 s24, s24, 4096
  buffer_store_dwordx4 v[16:19], v8, s[4:7], s24 offen sc1
  s_add_u32 s24, s24, 4096
  s_and_b32 s24, s26, 7
  s_lshl_b32 s24, s24, 12
  s_add_u32 s24, s24, 1048576
  buffer_store_dwordx4 v[16:19], v8, s[4:7], s24 offen sc1
  s_lshl_b32 s24, s26, 12
  s_add_u32 s24, s24, 1114112
  buffer_store_dwordx4 v[20:23], v8, s[4:7], s24 offen sc1
  s_cmp_eq_u32 s26, 0
  s_cbranch_scc0 L_ini0_60
  v_lshrrev_b32 v5, 1, v2
  v_lshlrev_b32 v6, 10, v5
  v_and_b32 v5, 1, v2
  v_lshl_add_u32 v6, v5, 6, v6
  v_and_b32 v5, 1, v3
  v_lshl_add_u32 v6, v5, 7, v6
  v_lshrrev_b32 v5, 1, v3
  v_lshl_add_u32 v6, v5, 2, v6
  s_lshl_b32 s24, s13, 8
  s_waitcnt lgkmcnt(0)
  buffer_load_dword v24, v6, s[68:71], s24 offen offset:0
  buffer_load_dword v25, v6, s[68:71], s24 offen offset:16
  buffer_load_dword v26, v6, s[68:71], s24 offen offset:32
  buffer_load_dword v27, v6, s[68:71], s24 offen offset:48
  buffer_load_dword v28, v6, s[68:71], s24 offen offset:8
  buffer_load_dword v29, v6, s[68:71], s24 offen offset:24
  buffer_load_dword v30, v6, s[68:71], s24 offen offset:40
  buffer_load_dword v31, v6, s[68:71], s24 offen offset:56
  s_waitcnt vmcnt(0)
  s_mov_b32 s24, 1310720
  buffer_store_dwordx4 v[24:27], v8, s[4:7], s24 offen sc1
  s_mov_b32 s24, 1314816
  buffer_store_dwordx4 v[28:31], v8, s[4:7], s24 offen sc1
L_ini0_60:
  s_waitcnt vmcnt(0)
  s_barrier
  s_cmp_eq_u32 s13, 0
  s_cbranch_scc0 L_arr_64
  v_lshlrev_b32 v5, 10, v0
  v_mov_b32 v6, 1
  buffer_atomic_add v6, v5, s[36:39], 0 offen offset:160 sc0
  s_waitcnt vmcnt(0)
  v_readfirstlane_b32 vcc_lo, v6
  v_mov_b32 v6, 1
  s_cmp_eq_u32 vcc_lo, 15
  s_cbranch_scc0 L_arr_64
  buffer_atomic_add v6, v5, s[36:39], 0 offen offset:32
L_arr_64:
L_ini_59:
  s_lshl_b32 s24, s12, 14
  s_lshl_b32 s25, s13, 12
  s_add_u32 s24, s24, s25
  s_waitcnt lgkmcnt(0)
  buffer_load_dwordx4 v[16:19], v1, s[8:11], s24 offen offset:0
  buffer_load_dwordx4 v[20:23], v1, s[8:11], s24 offen offset:1024
  buffer_load_dwordx4 v[24:27], v1, s[8:11], s24 offen offset:2048
  buffer_load_dwordx4 v[28:31], v1, s[8:11], s24 offen offset:3072
  buffer_load_dwordx4 v[32:35], v1, s[76:79], 0 offen
  s_waitcnt vmcnt(0)
  v_lshlrev_b32 v40, 16, v16
  v_and_b32 v41, 0xffff0000, v16
  v_lshlrev_b32 v42, 16, v17
  v_and_b32 v43, 0xffff0000, v17
  v_lshlrev_b32 v44, 16, v18
  v_and_b32 v45, 0xffff0000, v18
  v_lshlrev_b32 v46, 16, v19
  v_and_b32 v47, 0xffff0000, v19
  v_lshlrev_b32 v48, 16, v20
  v_and_b32 v49, 0xffff0000, v20
  v_lshlrev_b32 v50, 16, v21
  v_and_b32 v51, 0xffff0000, v21
  v_lshlrev_b32 v52, 16, v22
  v_and_b32 v53, 0xffff0000, v22
  v_lshlrev_b32 v54, 16, v23
  v_and_b32 v55, 0xffff0000, v23
  v_lshlrev_b32 v56, 16, v24
  v_and_b32 v57, 0xffff0000, v24
  v_lshlrev_b32 v58, 16, v25
  v_and_b32 v59, 0xffff0000, v25
  v_lshlrev_b32 v60, 16, v26
  v_and_b32 v61, 0xffff0000, v26
  v_lshlrev_b32 v62, 16, v27
  v_and_b32 v63, 0xffff0000, v27
  v_lshlrev_b32 v64, 16, v28
  v_and_b32 v65, 0xffff0000, v28
  v_lshlrev_b32 v66, 16, v29
  v_and_b32 v67, 0xffff0000, v29
  v_lshlrev_b32 v68, 16, v30
  v_and_b32 v69, 0xffff0000, v30
  v_lshlrev_b32 v70, 16, v31
  v_and_b32 v71, 0xffff0000, v31
  v_lshlrev_b32 v72, 16, v32
  v_and_b32 v73, 0xffff0000, v32
  v_lshlrev_b32 v74, 16, v33
  v_and_b32 v75, 0xffff0000, v33
  v_lshlrev_b32 v76, 16, v34
  v_and_b32 v77, 0xffff0000, v34
  v_lshlrev_b32 v78, 16, v35
  v_and_b32 v79, 0xffff0000, v35
  v_add_f32 v80, v40, v41
  v_mul_f32 v84, v40, v72
  v_add_f32 v80, v80, v42
  v_add_f32 v80, v80, v43
  v_add_f32 v80, v80, v44
  v_add_f32 v80, v80, v45
  v_add_f32 v80, v80, v46
  v_add_f32 v80, v80, v47
  v_fmac_f32 v84, v41, v73
  v_fmac_f32 v84, v42, v74
  v_fmac_f32 v84, v43, v75
  v_fmac_f32 v84, v44, v76
  v_fmac_f32 v84, v45, v77
  v_fmac_f32 v84, v46, v78
  v_fmac_f32 v84, v47, v79
  v_add_f32 v81, v48, v49
  v_mul_f32 v85, v48, v72
  v_add_f32 v81, v81, v50
  v_add_f32 v81, v81, v51
  v_add_f32 v81, v81, v52
  v_add_f32 v81, v81, v53
  v_add_f32 v81, v81, v54
  v_add_f32 v81, v81, v55
  v_fmac_f32 v85, v49, v73
  v_fmac_f32 v85, v50, v74
  v_fmac_f32 v85, v51, v75
  v_fmac_f32 v85, v52, v76
  v_fmac_f32 v85, v53, v77
  v_fmac_f32 v85, v54, v78
  v_fmac_f32 v85, v55, v79
  v_add_f32 v82, v56, v57
  v_mul_f32 v86, v56, v72
  v_add_f32 v82, v82, v58
  v_add_f32 v82, v82, v59
  v_add_f32 v82, v82, v60
  v_add_f32 v82, v82, v61
  v_add_f32 v82, v82, v62
  v_add_f32 v82, v82, v63
  v_fmac_f32 v86, v57, v73
  v_fmac_f32 v86, v58, v74
  v_fmac_f32 v86, v59, v75
  v_fmac_f32 v86, v60, v76
  v_fmac_f32 v86, v61, v77
  v_fmac_f32 v86, v62, v78
  v_fmac_f32 v86, v63, v79
  v_add_f32 v83, v64, v65
  v_mul_f32 v87, v64, v72
  v_add_f32 v83, v83, v66
  v_add_f32 v83, v83, v67
  v_add_f32 v83, v83, v68
  v_add_f32 v83, v83, v69
  v_add_f32 v83, v83, v70
  v_add_f32 v83, v83, v71
  v_fmac_f32 v87, v65, v73
  v_fmac_f32 v87, v66, v74
  v_fmac_f32 v87, v67, v75
  v_fmac_f32 v87, v68, v76
  v_fmac_f32 v87, v69, v77
  v_fmac_f32 v87, v70, v78
  v_fmac_f32 v87, v71, v79
  v_add_f32_dpp v80, v80, v80 row_ror:8 row_mask:0xf bank_mask:0xf
  v_add_f32_dpp v81, v81, v81 row_ror:8 row_mask:0xf bank_mask:0xf
  v_add_f32_dpp v82, v82, v82 row_ror:8 row_mask:0xf bank_mask:0xf
  v_add_f32_dpp v83, v83, v83 row_ror:8 row_mask:0xf bank_mask:0xf
  v_add_f32_dpp v84, v84, v84 row_ror:8 row_mask:0xf bank_mask:0xf
  v_add_f32_dpp v85, v85, v85 row_ror:8 row_mask:0xf bank_mask:0xf
  v_add_f32_dpp v86, v86, v86 row_ror:8 row_mask:0xf bank_mask:0xf
  v_add_f32_dpp v87, v87, v87 row_ror:8 row_mask:0xf bank_mask:0xf
  v_add_f32_dpp v80, v80, v80 row_ror:4 row_mask:0xf bank_mask:0xf
  v_add_f32_dpp v81, v81, v81 row_ror:4 row_mask:0xf bank_mask:0xf
  v_add_f32_dpp v82, v82, v82 row_ror:4 row_mask:0xf bank_mask:0xf
  v_add_f32_dpp v83, v83, v83 row_ror:4 row_mask:0xf bank_mask:0xf
  v_add_f32_dpp v84, v84, v84 row_ror:4 row_mask:0xf bank_mask:0xf
  v_add_f32_dpp v85, v85, v85 row_ror:4 row_mask:0xf bank_mask:0xf
  v_add_f32_dpp v86, v86, v86 row_ror:4 row_mask:0xf bank_mask:0xf
  v_add_f32_dpp v87, v87, v87 row_ror:4 row_mask:0xf bank_mask:0xf
  v_add_f32_dpp v80, v80, v80 row_ror:2 row_mask:0xf bank_mask:0xf
  v_add_f32_dpp v81, v81, v81 row_ror:2 row_mask:0xf bank_mask:0xf
  v_add_f32_dpp v82, v82, v82 row_ror:2 row_mask:0xf bank_mask:0xf
  v_add_f32_dpp v83, v83, v83 row_ror:2 row_mask:0xf bank_mask:0xf
  v_add_f32_dpp v84, v84, v84 row_ror:2 row_mask:0xf bank_mask:0xf
  v_add_f32_dpp v85, v85, v85 row_ror:2 row_mask:0xf bank_mask:0xf
  v_add_f32_dpp v86, v86, v86 row_ror:2 row_mask:0xf bank_mask:0xf
  v_add_f32_dpp v87, v87, v87 row_ror:2 row_mask:0xf bank_mask:0xf
  v_add_f32_dpp v80, v80, v80 row_ror:1 row_mask:0xf bank_mask:0xf
  v_add_f32_dpp v81, v81, v81 row_ror:1 row_mask:0xf bank_mask:0xf
  v_add_f32_dpp v82, v82, v82 row_ror:1 row_mask:0xf bank_mask:0xf
  v_add_f32_dpp v83, v83, v83 row_ror:1 row_mask:0xf bank_mask:0xf
  v_add_f32_dpp v84, v84, v84 row_ror:1 row_mask:0xf bank_mask:0xf
  v_add_f32_dpp v85, v85, v85 row_ror:1 row_mask:0xf bank_mask:0xf
  v_add_f32_dpp v86, v86, v86 row_ror:1 row_mask:0xf bank_mask:0xf
  v_add_f32_dpp v87, v87, v87 row_ror:1 row_mask:0xf bank_mask:0xf
  v_mov_b32 v92, v80
  v_mov_b32 v93, v81
  v_mov_b32 v94, v82
  v_mov_b32 v95, v83
  v_mov_b32 v96, v84
  v_mov_b32 v97, v85
  v_mov_b32 v98, v86
  v_mov_b32 v99, v87
  v_permlane16_swap_b32 v80, v92
  v_permlane16_swap_b32 v81, v93
  v_permlane16_swap_b32 v82, v94
  v_permlane16_swap_b32 v83, v95
  v_permlane16_swap_b32 v84, v96
  v_permlane16_swap_b32 v85, v97
  v_permlane16_swap_b32 v86, v98
  v_permlane16_swap_b32 v87, v99
  v_add_f32 v80, v80, v92
  v_add_f32 v81, v81, v93
  v_add_f32 v82, v82, v94
  v_add_f32 v83, v83, v95
  v_add_f32 v84, v84, v96
  v_add_f32 v85, v85, v97
  v_add_f32 v86, v86, v98
  v_add_f32 v87, v87, v99
  v_mov_b32 v92, v80
  v_mov_b32 v93, v81
  v_mov_b32 v94, v82
  v_mov_b32 v95, v83
  v_mov_b32 v96, v84
  v_mov_b32 v97, v85
  v_mov_b32 v98, v86
  v_mov_b32 v99, v87
  v_permlane32_swap_b32 v80, v92
  v_permlane32_swap_b32 v81, v93
  v_permlane32_swap_b32 v82, v94
  v_permlane32_swap_b32 v83, v95
  v_permlane32_swap_b32 v84, v96
  v_permlane32_swap_b32 v85, v97
  v_permlane32_swap_b32 v86, v98
  v_permlane32_swap_b32 v87, v99
  v_add_f32 v80, v80, v92
  v_add_f32 v81, v81, v93
  v_add_f32 v82, v82, v94
  v_add_f32 v83, v83, v95
  v_add_f32 v84, v84, v96
  v_add_f32 v85, v85, v97
  v_add_f32 v86, v86, v98
  v_add_f32 v87, v87, v99
  v_mul_f32 v80, 0x3b000000, v80
  v_sub_f32 v40, v40, v80
  v_sub_f32 v41, v41, v80
  v_sub_f32 v42, v42, v80
  v_sub_f32 v43, v43, v80
  v_sub_f32 v44, v44, v80
  v_sub_f32 v45, v45, v80
  v_sub_f32 v46, v46, v80
  v_sub_f32 v47, v47, v80
  v_mul_f32 v88, v40, v40
  v_fmac_f32 v88, v41, v41
  v_fmac_f32 v88, v42, v42
  v_fmac_f32 v88, v43, v43
  v_fmac_f32 v88, v44, v44
  v_fmac_f32 v88, v45, v45
  v_fmac_f32 v88, v46, v46
  v_fmac_f32 v88, v47, v47
  v_mul_f32 v81, 0x3b000000, v81
  v_sub_f32 v48, v48, v81
  v_sub_f32 v49, v49, v81
  v_sub_f32 v50, v50, v81
  v_sub_f32 v51, v51, v81
  v_sub_f32 v52, v52, v81
  v_sub_f32 v53, v53, v81
  v_sub_f32 v54, v54, v81
  v_sub_f32 v55, v55, v81
  v_mul_f32 v89, v48, v48
  v_fmac_f32 v89, v49, v49
  v_fmac_f32 v89, v50, v50
  v_fmac_f32 v89, v51, v51
  v_fmac_f32 v89, v52, v52
  v_fmac_f32 v89, v53, v53
  v_fmac_f32 v89, v54, v54
  v_fmac_f32 v89, v55, v55
  v_mul_f32 v82, 0x3b000000, v82
  v_sub_f32 v56, v56, v82
  v_sub_f32 v57, v57, v82
  v_sub_f32 v58, v58, v82
  v_sub_f32 v59, v59, v82
  v_sub_f32 v60, v60, v82
  v_sub_f32 v61, v61, v82
  v_sub_f32 v62, v62, v82
  v_sub_f32 v63, v63, v82
  v_mul_f32 v90, v56, v56
  v_fmac_f32 v90, v57, v57
  v_fmac_f32 v90, v58, v58
  v_fmac_f32 v90, v59, v59
  v_fmac_f32 v90, v60, v60
  v_fmac_f32 v90, v61, v61
  v_fmac_f32 v90, v62, v62
  v_fmac_f32 v90, v63, v63
  v_mul_f32 v83, 0x3b000000, v83
  v_sub_f32 v64, v64, v83
  v_sub_f32 v65, v65, v83
  v_sub_f32 v66, v66, v83
  v_sub_f32 v67, v67, v83
  v_sub_f32 v68, v68, v83
  v_sub_f32 v69, v69, v83
  v_sub_f32 v70, v70, v83
  v_sub_f32 v71, v71, v83
  v_mul_f32 v91, v64, v64
  v_fmac_f32 v91, v65, v65
  v_fmac_f32 v91, v66, v66
  v_fmac_f32 v91, v67, v67
  v_fmac_f32 v91, v68, v68
  v_fmac_f32 v91, v69, v69
  v_fmac_f32 v91, v70, v70
  v_fmac_f32 v91, v71, v71
  v_add_f32_dpp v88, v88, v88 row_ror:8 row_mask:0xf bank_mask:0xf
  v_add_f32_dpp v89, v89, v89 row_ror:8 row_mask:0xf bank_mask:0xf
  v_add_f32_dpp v90, v90, v90 row_ror:8 row_mask:0xf bank_mask:0xf
  v_add_f32_dpp v91, v91, v91 row_ror:8 row_mask:0xf bank_mask:0xf
  v_add_f32_dpp v88, v88, v88 row_ror:4 row_mask:0xf bank_mask:0xf
  v_add_f32_dpp v89, v89, v89 row_ror:4 row_mask:0xf bank_mask:0xf
  v_add_f32_dpp v90, v90, v90 row_ror:4 row_mask:0xf bank_mask:0xf
  v_add_f32_dpp v91, v91, v91 row_ror:4 row_mask:0xf bank_mask:0xf
  v_add_f32_dpp v88, v88, v88 row_ror:2 row_mask:0xf bank_mask:0xf
  v_add_f32_dpp v89, v89, v89 row_ror:2 row_mask:0xf bank_mask:0xf
  v_add_f32_dpp v90, v90, v90 row_ror:2 row_mask:0xf bank_mask:0xf
  v_add_f32_dpp v91, v91, v91 row_ror:2 row_mask:0xf bank_mask:0xf
  v_add_f32_dpp v88, v88, v88 row_ror:1 row_mask:0xf bank_mask:0xf
  v_add_f32_dpp v89, v89, v89 row_ror:1 row_mask:0xf bank_mask:0xf
  v_add_f32_dpp v90, v90, v90 row_ror:1 row_mask:0xf bank_mask:0xf
  v_add_f32_dpp v91, v91, v91 row_ror:1 row_mask:0xf bank_mask:0xf
  v_mov_b32 v92, v88
  v_mov_b32 v93, v89
  v_mov_b32 v94, v90
  v_mov_b32 v95, v91
  v_permlane16_swap_b32 v88, v92
  v_permlane16_swap_b32 v89, v93
  v_permlane16_swap_b32 v90, v94
  v_permlane16_swap_b32 v91, v95
  v_add_f32 v88, v88, v92
  v_add_f32 v89, v89, v93
  v_add_f32 v90, v90, v94
  v_add_f32 v91, v91, v95
  v_mov_b32 v92, v88
  v_mov_b32 v93, v89
  v_mov_b32 v94, v90
  v_mov_b32 v95, v91
  v_permlane32_swap_b32 v88, v92
  v_permlane32_swap_b32 v89, v93
  v_permlane32_swap_b32 v90, v94
  v_permlane32_swap_b32 v91, v95
  v_add_f32 v88, v88, v92
  v_add_f32 v89, v89, v93
  v_add_f32 v90, v90, v94
  v_add_f32 v91, v91, v95
  s_mul_i32 s24, s13, 4160
  v_add_u32 v8, s24, v1
  v_mov_b32 v5, 0x3727c5ac
  v_fmamk_f32 v88, v88, 0x3b000000, v5
  v_mul_f32 v84, 0xbfb8aa3b, v84
  v_fmamk_f32 v89, v89, 0x3b000000, v5
  v_mul_f32 v85, 0xbfb8aa3b, v85
  v_fmamk_f32 v90, v90, 0x3b000000, v5
  v_mul_f32 v86, 0xbfb8aa3b, v86
  v_fmamk_f32 v91, v91, 0x3b000000, v5
  v_mul_f32 v87, 0xbfb8aa3b, v87
  v_rsq_f32 v88, v88
  v_exp_f32 v84, v84
  v_rsq_f32 v89, v89
  v_exp_f32 v85, v85
  v_rsq_f32 v90, v90
  v_exp_f32 v86, v86
  v_rsq_f32 v91, v91
  v_exp_f32 v87, v87
  v_add_f32 v84, 1.0, v84
  v_add_f32 v85, 1.0, v85
  v_add_f32 v86, 1.0, v86
  v_add_f32 v87, 1.0, v87
  v_rcp_f32 v84, v84
  v_rcp_f32 v85, v85
  v_rcp_f32 v86, v86
  v_rcp_f32 v87, v87
  v_mul_f32 v40, v40, v88
  v_mul_f32 v41, v41, v88
  v_mul_f32 v42, v42, v88
  v_mul_f32 v43, v43, v88
  v_mul_f32 v44, v44, v88
  v_mul_f32 v45, v45, v88
  v_mul_f32 v46, v46, v88
  v_mul_f32 v47, v47, v88
  v_cvt_pk_bf16_f32 v16, v40, v41
  v_cvt_pk_bf16_f32 v17, v42, v43
  v_cvt_pk_bf16_f32 v18, v44, v45
  v_cvt_pk_bf16_f32 v19, v46, v47
  ds_write_b128 v8, v[16:19] offset:0
  v_mul_f32 v48, v48, v89
  v_mul_f32 v49, v49, v89
  v_mul_f32 v50, v50, v89
  v_mul_f32 v51, v51, v89
  v_mul_f32 v52, v52, v89
  v_mul_f32 v53, v53, v89
  v_mul_f32 v54, v54, v89
  v_mul_f32 v55, v55, v89
  v_cvt_pk_bf16_f32 v20, v48, v49
  v_cvt_pk_bf16_f32 v21, v50, v51
  v_cvt_pk_bf16_f32 v22, v52, v53
  v_cvt_pk_bf16_f32 v23, v54, v55
  ds_write_b128 v8, v[20:23] offset:1040
  v_mul_f32 v56, v56, v90
  v_mul_f32 v57, v57, v90
  v_mul_f32 v58, v58, v90
  v_mul_f32 v59, v59, v90
  v_mul_f32 v60, v60, v90
  v_mul_f32 v61, v61, v90
  v_mul_f32 v62, v62, v90
  v_mul_f32 v63, v63, v90
  v_cvt_pk_bf16_f32 v24, v56, v57
  v_cvt_pk_bf16_f32 v25, v58, v59
  v_cvt_pk_bf16_f32 v26, v60, v61
  v_cvt_pk_bf16_f32 v27, v62, v63
  ds_write_b128 v8, v[24:27] offset:2080
  v_mul_f32 v64, v64, v91
  v_mul_f32 v65, v65, v91
  v_mul_f32 v66, v66, v91
  v_mul_f32 v67, v67, v91
  v_mul_f32 v68, v68, v91
  v_mul_f32 v69, v69, v91
  v_mul_f32 v70, v70, v91
  v_mul_f32 v71, v71, v91
  v_cvt_pk_bf16_f32 v28, v64, v65
  v_cvt_pk_bf16_f32 v29, v66, v67
  v_cvt_pk_bf16_f32 v30, v68, v69
  v_cvt_pk_bf16_f32 v31, v70, v71
  ds_write_b128 v8, v[28:31] offset:3120
  v_min_u32 v5, 1, v1
  v_lshlrev_b32 v5, 28, v5
  s_lshl_b32 s24, s12, 6
  s_lshl_b32 s25, s13, 4
  s_add_u32 s24, s24, s25
  s_add_u32 s24, s24, 1245184
  buffer_store_dwordx4 v[84:87], v5, s[4:7], s24 offen sc1
  v_and_b32 v5, 1, v3
  v_lshrrev_b32 v6, 2, v2
  v_lshl_add_u32 v5, v5, 3, v6
  v_mul_u32_u24 v8, 1040, v5
  v_and_b32 v5, 3, v2
  v_lshl_add_u32 v8, v5, 5, v8
  v_lshrrev_b32 v5, 1, v3
  v_lshl_add_u32 v8, v5, 3, v8
  s_lshl_b32 s24, s13, 8
  v_add_u32 v8, s24, v8
  v_and_b32 v9, 0x1ff, v1
  v_lshl_add_u32 v9, v5, 16, v9
  s_lshl_b32 s24, s13, 19
  s_lshl_b32 s25, s12, 9
  s_add_u32 s24, s24, s25
  s_add_u32 s24, s24, 2097152
  s_waitcnt lgkmcnt(0)
  s_barrier
  ds_read_b64_tr_b16 v[16:17], v8 offset:0
  ds_read_b64_tr_b16 v[18:19], v8 offset:4160
  ds_read_b64_tr_b16 v[20:21], v8 offset:16
  ds_read_b64_tr_b16 v[22:23], v8 offset:4176
  ds_read_b64_tr_b16 v[24:25], v8 offset:128
  ds_read_b64_tr_b16 v[26:27], v8 offset:4288
  ds_read_b64_tr_b16 v[28:29], v8 offset:144
  ds_read_b64_tr_b16 v[30:31], v8 offset:4304
  s_waitcnt lgkmcnt(0)
  buffer_store_dwordx4 v[16:19], v9, s[4:7], s24 offen sc1
  s_add_u32 s24, s24, 131072
  buffer_store_dwordx4 v[20:23], v9, s[4:7], s24 offen sc1
  s_add_u32 s24, s24, 131072
  buffer_store_dwordx4 v[24:27], v9, s[4:7], s24 offen sc1
  s_add_u32 s24, s24, 131072
  buffer_store_dwordx4 v[28:31], v9, s[4:7], s24 offen sc1
  s_add_u32 s24, s24, 131072
  v_and_b32 v33, 15, v0
  v_lshl_add_u32 v32, v33, 2, 64
  v_cmp_eq_u32 vcc, 0, v33
  s_nop 1
  v_cndmask_b32 v32, v32, 0, vcc
  buffer_load_dword v34, v32, s[36:39], 0 offen sc1
L_cen_65:
  v_cmp_gt_u32 vcc, s82, v33
  s_waitcnt vmcnt(0)
  s_nop 0
  v_cndmask_b32 v35, 0, v34, vcc
  v_add_u32_dpp v34, v34, v34 row_ror:8 row_mask:0xf bank_mask:0xf
  s_nop 0
  v_add_u32_dpp v35, v35, v35 row_ror:8 row_mask:0xf bank_mask:0xf
  v_add_u32_dpp v34, v34, v34 row_ror:4 row_mask:0xf bank_mask:0xf
  s_nop 0
  v_add_u32_dpp v35, v35, v35 row_ror:4 row_mask:0xf bank_mask:0xf
  v_add_u32_dpp v34, v34, v34 row_ror:2 row_mask:0xf bank_mask:0xf
  s_nop 0
  v_add_u32_dpp v35, v35, v35 row_ror:2 row_mask:0xf bank_mask:0xf
  v_add_u32_dpp v34, v34, v34 row_ror:1 row_mask:0xf bank_mask:0xf
  s_nop 0
  v_add_u32_dpp v35, v35, v35 row_ror:1 row_mask:0xf bank_mask:0xf
  v_readfirstlane_b32 s24, v34
  v_readfirstlane_b32 s25, v35
  s_cmp_ge_u32 s24, 256
  s_cbranch_scc1 L_cen_65_x
  s_sub_u32 s33, s33, 1
  s_cbranch_scc1 L_done
  s_sleep 16
  buffer_load_dword v34, v32, s[36:39], 0 offen sc1
  s_branch L_cen_65
L_cen_65_x:
  s_add_u32 s25, s25, s83
  s_cmp_eq_u32 s3, s25
  s_mov_b32 s3, s25
  s_barrier
  s_cbranch_scc0 L_role
  s_load_dwordx2 s[52:53], s[0:1], 64
  s_mov_b32 s54, 7340032
  s_mov_b32 s55, 0x20000
  s_load_dwordx2 s[56:57], s[0:1], 72
  s_mov_b32 s58, 3584
  s_mov_b32 s59, 0x20000
  s_load_dwordx2 s[60:61], s[0:1], 80
  s_mov_b32 s62, 7340032
  s_mov_b32 s63, 0x20000
  s_load_dwordx2 s[64:65], s[0:1], 88
  s_mov_b32 s66, 4096
  s_mov_b32 s67, 0x20000
  s_load_dwordx2 s[68:69], s[0:1], 40
  s_mov_b32 s70, 4194304
  s_mov_b32 s71, 0x20000
  s_load_dwordx2 s[72:73], s[0:1], 104
  s_mov_b32 s74, 2097152
  s_mov_b32 s75, 0x20000
  s_cmp_eq_u32 s13, 0
  s_cbranch_scc0 L_arr_66
  v_lshlrev_b32 v5, 10, v0
  v_mov_b32 v6, 1
  buffer_atomic_add v6, v5, s[36:39], 0 offen offset:164 sc0
  s_waitcnt vmcnt(0)
  v_readfirstlane_b32 vcc_lo, v6
  v_mov_b32 v6, 1
  s_cmp_eq_u32 vcc_lo, 127
  s_cbranch_scc0 L_arr_66
  buffer_atomic_add v6, v5, s[36:39], 0 offen offset:36
L_arr_66:
  s_waitcnt lgkmcnt(0)
  s_cmp_ge_u32 s12, 96
  s_cbranch_scc0 L_g0_69
  s_barrier
  s_sub_u32 s24, s12, 96
  s_lshl_b32 s24, s24, 15
  v_lshlrev_b32 v5, 7, v0
  buffer_load_dword v16, v5, s[52:55], s24 offen
  s_add_u32 s24, s24, 1048576
  buffer_load_dword v17, v5, s[52:55], s24 offen
  s_add_u32 s24, s24, 1048576
  buffer_load_dword v18, v5, s[52:55], s24 offen
  s_add_u32 s24, s24, 1048576
  buffer_load_dword v19, v5, s[52:55], s24 offen
  s_add_u32 s24, s24, 1048576
  buffer_load_dword v20, v5, s[52:55], s24 offen
  s_add_u32 s24, s24, 1048576
  buffer_load_dword v21, v5, s[52:55], s24 offen
  s_add_u32 s24, s24, 1048576
  buffer_load_dword v22, v5, s[52:55], s24 offen
  s_add_u32 s24, s24, 1048576
  s_waitcnt vmcnt(0)
  s_branch L_done
L_g0_69:
  s_cmp_eq_u32 s13, 0
  s_cbranch_scc0 L_cntx_71
L_cnt_70:
  s_sub_u32 s33, s33, 1
  s_cbranch_scc1 L_done
  buffer_load_dword v5, off, s[36:39], 0 offset:36 sc1
  s_waitcnt vmcnt(0)
  v_cmp_gt_u32 vcc, 1, v5
  s_cbranch_vccz L_cntx_71
  s_sleep 8
  s_branch L_cnt_70
L_cntx_71:
  s_barrier
  s_cmp_eq_u32 s13, 0
  s_cbranch_scc0 L_cntx_73
L_cnt_72:
  s_sub_u32 s33, s33, 1
  s_cbranch_scc1 L_done
  buffer_load_dword v5, off, s[36:39], 0 offset:32 sc1
  s_waitcnt vmcnt(0)
  v_cmp_gt_u32 vcc, 1, v5
  s_cbranch_vccz L_cntx_73
  s_sleep 8
  s_branch L_cnt_72
L_cntx_73:
  s_barrier
L_g1_67:
  v_mul_u32_u24 v4, 28672, v3
  v_lshl_add_u32 v4, v2, 4, v4
  s_lshr_b32 s24, s12, 3
  s_lshl_b32 s24, s24, 8
  s_mul_i32 s14, s13, 1835008
  s_add_u32 s14, s14, s24
  v_lshlrev_b32 v5, 6, v3
  buffer_load_dwordx4 v[240:243], v5, s[56:59], s24 offen offset:0
  buffer_load_dwordx4 v[244:247], v5, s[56:59], s24 offen offset:16
  buffer_load_dwordx4 v[248:251], v5, s[56:59], s24 offen offset:32
  buffer_load_dwordx4 v[252:255], v5, s[56:59], s24 offen offset:48
  s_and_b32 s24, s12, 7
  s_lshl_b32 s15, s24, 18
  s_lshl_b32 s24, s13, 14
  s_add_u32 s15, s15, s24
  s_add_u32 s15, s15, 2097152
  s_mov_b32 s26, 65536
  s_mov_b32 s19, 0
  s_add_u32 s19, s19, 1
  s_and_b32 s19, s19, 15
  s_mul_i32 s24, s19, 114688
  s_add_u32 s24, s24, s14
  s_lshl_b32 s25, s19, 10
  s_add_u32 s25, s25, s15
  buffer_load_dwordx4 v[16:19], v4, s[52:55], s24 offen
  s_add_u32 s24, s24, 3584
  buffer_load_dwordx4 v[20:23], v4, s[52:55], s24 offen
  s_add_u32 s24, s24, 3584
  buffer_load_dwordx4 v[24:27], v4, s[52:55], s24 offen
  s_add_u32 s24, s24, 3584
  buffer_load_dwordx4 v[28:31], v4, s[52:55], s24 offen
  s_add_u32 s24, s24, 3584
  buffer_load_dwordx4 v[32:35], v4, s[52:55], s24 offen
  s_add_u32 s24, s24, 3584
  buffer_load_dwordx4 v[36:39], v4, s[52:55], s24 offen
  s_add_u32 s24, s24, 3584
  buffer_load_dwordx4 v[40:43], v4, s[52:55], s24 offen
  s_add_u32 s24, s24, 3584
  buffer_load_dwordx4 v[44:47], v4, s[52:55], s24 offen
  buffer_load_dwordx4 v[112:115], v1, s[4:7], s25 offen sc1
  s_add_u32 s25, s25, s26
  buffer_load_dwordx4 v[116:119], v1, s[4:7], s25 offen sc1
  s_add_u32 s25, s25, s26
  buffer_load_dwordx4 v[120:123], v1, s[4:7], s25 offen sc1
  s_add_u32 s25, s25, s26
  buffer_load_dwordx4 v[124:127], v1, s[4:7], s25 offen sc1
  s_add_u32 s19, s19, 1
  s_and_b32 s19, s19, 15
  s_mul_i32 s24, s19, 114688
  s_add_u32 s24, s24, s14
  s_lshl_b32 s25, s19, 10
  s_add_u32 s25, s25, s15
  buffer_load_dwordx4 v[48:51], v4, s[52:55], s24 offen
  s_add_u32 s24, s24, 3584
  buffer_load_dwordx4 v[52:55], v4, s[52:55], s24 offen
  s_add_u32 s24, s24, 3584
  buffer_load_dwordx4 v[56:59], v4, s[52:55], s24 offen
  s_add_u32 s24, s24, 3584
  buffer_load_dwordx4 v[60:63], v4, s[52:55], s24 offen
  s_add_u32 s24, s24, 3584
  buffer_load_dwordx4 v[64:67], v4, s[52:55], s24 offen
  s_add_u32 s24, s24, 3584
  buffer_load_dwordx4 v[68:71], v4, s[52:55], s24 offen
  s_add_u32 s24, s24, 3584
  buffer_load_dwordx4 v[72:75], v4, s[52:55], s24 offen
  s_add_u32 s24, s24, 3584
  buffer_load_dwordx4 v[76:79], v4, s[52:55], s24 offen
  buffer_load_dwordx4 v[128:131], v1, s[4:7], s25 offen sc1
  s_add_u32 s25, s25, s26
  buffer_load_dwordx4 v[132:135], v1, s[4:7], s25 offen sc1
  s_add_u32 s25, s25, s26
  buffer_load_dwordx4 v[136:139], v1, s[4:7], s25 offen sc1
  s_add_u32 s25, s25, s26
  buffer_load_dwordx4 v[140:143], v1, s[4:7], s25 offen sc1
  s_add_u32 s19, s19, 1
  s_and_b32 s19, s19, 15
  s_mul_i32 s24, s19, 114688
  s_add_u32 s24, s24, s14
  s_lshl_b32 s25, s19, 10
  s_add_u32 s25, s25, s15
  buffer_load_dwordx4 v[80:83], v4, s[52:55], s24 offen
  s_add_u32 s24, s24, 3584
  buffer_load_dwordx4 v[84:87], v4, s[52:55], s24 offen
  s_add_u32 s24, s24, 3584
  buffer_load_dwordx4 v[88:91], v4, s[52:55], s24 offen
  s_add_u32 s24, s24, 3584
  buffer_load_dwordx4 v[92:95], v4, s[52:55], s24 offen
  s_add_u32 s24, s24, 3584
  buffer_load_dwordx4 v[96:99], v4, s[52:55], s24 offen
  s_add_u32 s24, s24, 3584
  buffer_load_dwordx4 v[100:103], v4, s[52:55], s24 offen
  s_add_u32 s24, s24, 3584
  buffer_load_dwordx4 v[104:107], v4, s[52:55], s24 offen
  s_add_u32 s24, s24, 3584
  buffer_load_dwordx4 v[108:111], v4, s[52:55], s24 offen
  buffer_load_dwordx4 v[144:147], v1, s[4:7], s25 offen sc1
  s_add_u32 s25, s25, s26
  buffer_load_dwordx4 v[148:151], v1, s[4:7], s25 offen sc1
  s_add_u32 s25, s25, s26
  buffer_load_dwordx4 v[152:155], v1, s[4:7], s25 offen sc1
  s_add_u32 s25, s25, s26
  buffer_load_dwordx4 v[156:159], v1, s[4:7], s25 offen sc1
  s_waitcnt vmcnt(28)
  v_perm_b32 v176, v20, v16, s28
  v_perm_b32 v177, v28, v24, s28
  v_perm_b32 v178, v36, v32, s28
  v_perm_b32 v179, v44, v40, s28
  v_perm_b32 v180, v20, v16, s29
  v_perm_b32 v181, v28, v24, s29
  v_perm_b32 v182, v36, v32, s29
  v_perm_b32 v183, v44, v40, s29
  v_perm_b32 v184, v21, v17, s28
  v_perm_b32 v185, v29, v25, s28
  v_perm_b32 v186, v37, v33, s28
  v_perm_b32 v187, v45, v41, s28
  v_perm_b32 v188, v21, v17, s29
  v_perm_b32 v189, v29, v25, s29
  v_perm_b32 v190, v37, v33, s29
  v_perm_b32 v191, v45, v41, s29
  v_perm_b32 v192, v22, v18, s28
  v_perm_b32 v193, v30, v26, s28
  v_perm_b32 v194, v38, v34, s28
  v_perm_b32 v195, v46, v42, s28
  v_perm_b32 v196, v22, v18, s29
  v_perm_b32 v197, v30, v26, s29
  v_perm_b32 v198, v38, v34, s29
  v_perm_b32 v199, v46, v42, s29
  v_perm_b32 v200, v23, v19, s28
  v_perm_b32 v201, v31, v27, s28
  v_perm_b32 v202, v39, v35, s28
  v_perm_b32 v203, v47, v43, s28
  v_perm_b32 v204, v23, v19, s29
  v_perm_b32 v205, v31, v27, s29
  v_perm_b32 v206, v39, v35, s29
  v_perm_b32 v207, v47, v43, s29
  s_waitcnt vmcnt(16)
  v_mfma_f32_16x16x32_bf16 a[0:3], v[176:179], v[112:115], 0
  s_add_u32 s19, s19, 1
  v_perm_b32 v208, v52, v48, s28
  v_mfma_f32_16x16x32_bf16 a[4:7], v[176:179], v[116:119], 0
  s_and_b32 s19, s19, 15
  v_perm_b32 v209, v60, v56, s28
  v_mfma_f32_16x16x32_bf16 a[8:11], v[176:179], v[120:123], 0
  s_mul_i32 s24, s19, 114688
  v_perm_b32 v210, v68, v64, s28
  v_mfma_f32_16x16x32_bf16 a[12:15], v[176:179], v[124:127], 0
  s_add_u32 s24, s24, s14
  v_perm_b32 v211, v76, v72, s28
  v_mfma_f32_16x16x32_bf16 a[16:19], v[180:183], v[112:115], 0
  s_lshl_b32 s25, s19, 10
  v_perm_b32 v212, v52, v48, s29
  v_mfma_f32_16x16x32_bf16 a[20:23], v[180:183], v[116:119], 0
  s_add_u32 s25, s25, s15
  v_perm_b32 v213, v60, v56, s29
  v_mfma_f32_16x16x32_bf16 a[24:27], v[180:183], v[120:123], 0
  buffer_load_dwordx4 v[16:19], v4, s[52:55], s24 offen
  v_perm_b32 v214, v68, v64, s29
  v_mfma_f32_16x16x32_bf16 a[28:31], v[180:183], v[124:127], 0
  s_add_u32 s24, s24, 3584
  v_perm_b32 v215, v76, v72, s29
  v_mfma_f32_16x16x32_bf16 a[32:35], v[184:187], v[112:115], 0
  buffer_load_dwordx4 v[20:23], v4, s[52:55], s24 offen
  v_perm_b32 v216, v53, v49, s28
  v_mfma_f32_16x16x32_bf16 a[36:39], v[184:187], v[116:119], 0
  s_add_u32 s24, s24, 3584
  v_perm_b32 v217, v61, v57, s28
  v_mfma_f32_16x16x32_bf16 a[40:43], v[184:187], v[120:123], 0
  buffer_load_dwordx4 v[24:27], v4, s[52:55], s24 offen
  v_perm_b32 v218, v69, v65, s28
  v_mfma_f32_16x16x32_bf16 a[44:47], v[184:187], v[124:127], 0
  s_add_u32 s24, s24, 3584
  v_perm_b32 v219, v77, v73, s28
  v_mfma_f32_16x16x32_bf16 a[48:51], v[188:191], v[112:115], 0
  buffer_load_dwordx4 v[28:31], v4, s[52:55], s24 offen
  v_perm_b32 v220, v53, v49, s29
  v_mfma_f32_16x16x32_bf16 a[52:55], v[188:191], v[116:119], 0
  s_add_u32 s24, s24, 3584
  v_perm_b32 v221, v61, v57, s29
  v_mfma_f32_16x16x32_bf16 a[56:59], v[188:191], v[120:123], 0
  buffer_load_dwordx4 v[32:35], v4, s[52:55], s24 offen
  v_perm_b32 v222, v69, v65, s29
  v_mfma_f32_16x16x32_bf16 a[60:63], v[188:191], v[124:127], 0
  s_add_u32 s24, s24, 3584
  v_perm_b32 v223, v77, v73, s29
  v_mfma_f32_16x16x32_bf16 a[64:67], v[192:195], v[112:115], 0
  buffer_load_dwordx4 v[36:39], v4, s[52:55], s24 offen
  v_perm_b32 v224, v54, v50, s28
  v_mfma_f32_16x16x32_bf16 a[68:71], v[192:195], v[116:119], 0
  s_add_u32 s24, s24, 3584
  v_perm_b32 v225, v62, v58, s28
  v_mfma_f32_16x16x32_bf16 a[72:75], v[192:195], v[120:123], 0
  buffer_load_dwordx4 v[40:43], v4, s[52:55], s24 offen
  v_perm_b32 v226, v70, v66, s28
  v_mfma_f32_16x16x32_bf16 a[76:79], v[192:195], v[124:127], 0
  s_add_u32 s24, s24, 3584
  v_perm_b32 v227, v78, v74, s28
  v_mfma_f32_16x16x32_bf16 a[80:83], v[196:199], v[112:115], 0
  buffer_load_dwordx4 v[44:47], v4, s[52:55], s24 offen
  v_perm_b32 v228, v54, v50, s29
  v_mfma_f32_16x16x32_bf16 a[84:87], v[196:199], v[116:119], 0
  buffer_load_dwordx4 v[160:163], v1, s[4:7], s25 offen sc1
  v_perm_b32 v229, v62, v58, s29
  v_mfma_f32_16x16x32_bf16 a[88:91], v[196:199], v[120:123], 0
  s_add_u32 s25, s25, s26
  v_perm_b32 v230, v70, v66, s29
  v_mfma_f32_16x16x32_bf16 a[92:95], v[196:199], v[124:127], 0
  buffer_load_dwordx4 v[164:167], v1, s[4:7], s25 offen sc1
  v_perm_b32 v231, v78, v74, s29
  v_mfma_f32_16x16x32_bf16 a[96:99], v[200:203], v[112:115], 0
  s_add_u32 s25, s25, s26
  v_perm_b32 v232, v55, v51, s28
  v_mfma_f32_16x16x32_bf16 a[100:103], v[200:203], v[116:119], 0
  buffer_load_dwordx4 v[168:171], v1, s[4:7], s25 offen sc1
  v_perm_b32 v233, v63, v59, s28
  v_mfma_f32_16x16x32_bf16 a[104:107], v[200:203], v[120:123], 0
  s_add_u32 s25, s25, s26
  v_perm_b32 v234, v71, v67, s28
  v_mfma_f32_16x16x32_bf16 a[108:111], v[200:203], v[124:127], 0
  buffer_load_dwordx4 v[172:175], v1, s[4:7], s25 offen sc1
  v_perm_b32 v235, v79, v75, s28
  v_mfma_f32_16x16x32_bf16 a[112:115], v[204:207], v[112:115], 0
  v_perm_b32 v236, v55, v51, s29
  v_mfma_f32_16x16x32_bf16 a[116:119], v[204:207], v[116:119], 0
  v_perm_b32 v237, v63, v59, s29
  v_mfma_f32_16x16x32_bf16 a[120:123], v[204:207], v[120:123], 0
  v_perm_b32 v238, v71, v67, s29
  v_mfma_f32_16x16x32_bf16 a[124:127], v[204:207], v[124:127], 0
  v_perm_b32 v239, v79, v75, s29
  s_waitcnt vmcnt(16)
  v_mfma_f32_16x16x32_bf16 a[0:3], v[208:211], v[128:131], a[0:3]
  s_add_u32 s19, s19, 1
  v_perm_b32 v176, v84, v80, s28
  v_mfma_f32_16x16x32_bf16 a[4:7], v[208:211], v[132:135], a[4:7]
  s_and_b32 s19, s19, 15
  v_perm_b32 v177, v92, v88, s28
  v_mfma_f32_16x16x32_bf16 a[8:11], v[208:211], v[136:139], a[8:11]
  s_mul_i32 s24, s19, 114688
  v_perm_b32 v178, v100, v96, s28
  v_mfma_f32_16x16x32_bf16 a[12:15], v[208:211], v[140:143], a[12:15]
  s_add_u32 s24, s24, s14
  v_perm_b32 v179, v108, v104, s28
  v_mfma_f32_16x16x32_bf16 a[16:19], v[212:215], v[128:131], a[16:19]
  s_lshl_b32 s25, s19, 10
  v_perm_b32 v180, v84, v80, s29
  v_mfma_f32_16x16x32_bf16 a[20:23], v[212:215], v[132:135], a[20:23]
  s_add_u32 s25, s25, s15
  v_perm_b32 v181, v92, v88, s29
  v_mfma_f32_16x16x32_bf16 a[24:27], v[212:215], v[136:139], a[24:27]
  buffer_load_dwordx4 v[48:51], v4, s[52:55], s24 offen
  v_perm_b32 v182, v100, v96, s29
  v_mfma_f32_16x16x32_bf16 a[28:31], v[212:215], v[140:143], a[28:31]
  s_add_u32 s24, s24, 3584
  v_perm_b32 v183, v108, v104, s29
  v_mfma_f32_16x16x32_bf16 a[32:35], v[216:219], v[128:131], a[32:35]
  buffer_load_dwordx4 v[52:55], v4, s[52:55], s24 offen
  v_perm_b32 v184, v85, v81, s28
  v_mfma_f32_16x16x32_bf16 a[36:39], v[216:219], v[132:135], a[36:39]
  s_add_u32 s24, s24, 3584
  v_perm_b32 v185, v93, v89, s28
  v_mfma_f32_16x16x32_bf16 a[40:43], v[216:219], v[136:139], a[40:43]
  buffer_load_dwordx4 v[56:59], v4, s[52:55], s24 offen
  v_perm_b32 v186, v101, v97, s28
  v_mfma_f32_16x16x32_bf16 a[44:47], v[216:219], v[140:143], a[44:47]
  s_add_u32 s24, s24, 3584
  v_perm_b32 v187, v109, v105, s28
  v_mfma_f32_16x16x32_bf16 a[48:51], v[220:223], v[128:131], a[48:51]
  buffer_load_dwordx4 v[60:63], v4, s[52:55], s24 offen
  v_perm_b32 v188, v85, v81, s29
  v_mfma_f32_16x16x32_bf16 a[52:55], v[220:223], v[132:135], a[52:55]
  s_add_u32 s24, s24, 3584
  v_perm_b32 v189, v93, v89, s29
  v_mfma_f32_16x16x32_bf16 a[56:59], v[220:223], v[136:139], a[56:59]
  buffer_load_dwordx4 v[64:67], v4, s[52:55], s24 offen
  v_perm_b32 v190, v101, v97, s29
  v_mfma_f32_16x16x32_bf16 a[60:63], v[220:223], v[140:143], a[60:63]
  s_add_u32 s24, s24, 3584
  v_perm_b32 v191, v109, v105, s29
  v_mfma_f32_16x16x32_bf16 a[64:67], v[224:227], v[128:131], a[64:67]
  buffer_load_dwordx4 v[68:71], v4, s[52:55], s24 offen
  v_perm_b32 v192, v86, v82, s28
  v_mfma_f32_16x16x32_bf16 a[68:71], v[224:227], v[132:135], a[68:71]
  s_add_u32 s24, s24, 3584
  v_perm_b32 v193, v94, v90, s28
  v_mfma_f32_16x16x32_bf16 a[72:75], v[224:227], v[136:139], a[72:75]
  buffer_load_dwordx4 v[72:75], v4, s[52:55], s24 offen
  v_perm_b32 v194, v102, v98, s28
  v_mfma_f32_16x16x32_bf16 a[76:79], v[224:227], v[140:143], a[76:79]
  s_add_u32 s24, s24, 3584
  v_perm_b32 v195, v110, v106, s28
  v_mfma_f32_16x16x32_bf16 a[80:83], v[228:231], v[128:131], a[80:83]
  buffer_load_dwordx4 v[76:79], v4, s[52:55], s24 offen
  v_perm_b32 v196, v86, v82, s29
  v_mfma_f32_16x16x32_bf16 a[84:87], v[228:231], v[132:135], a[84:87]
  buffer_load_dwordx4 v[112:115], v1, s[4:7], s25 offen sc1
  v_perm_b32 v197, v94, v90, s29
  v_mfma_f32_16x16x32_bf16 a[88:91], v[228:231], v[136:139], a[88:91]
  s_add_u32 s25, s25, s26
  v_perm_b32 v198, v102, v98, s29
  v_mfma_f32_16x16x32_bf16 a[92:95], v[228:231], v[140:143], a[92:95]
  buffer_load_dwordx4 v[116:119], v1, s[4:7], s25 offen sc1
  v_perm_b32 v199, v110, v106, s29
  v_mfma_f32_16x16x32_bf16 a[96:99], v[232:235], v[128:131], a[96:99]
  s_add_u32 s25, s25, s26
  v_perm_b32 v200, v87, v83, s28
  v_mfma_f32_16x16x32_bf16 a[100:103], v[232:235], v[132:135], a[100:103]
  buffer_load_dwordx4 v[120:123], v1, s[4:7], s25 offen sc1
  v_perm_b32 v201, v95, v91, s28
  v_mfma_f32_16x16x32_bf16 a[104:107], v[232:235], v[136:139], a[104:107]
  s_add_u32 s25, s25, s26
  v_perm_b32 v202, v103, v99, s28
  v_mfma_f32_16x16x32_bf16 a[108:111], v[232:235], v[140:143], a[108:111]
  buffer_load_dwordx4 v[124:127], v1, s[4:7], s25 offen sc1
  v_perm_b32 v203, v111, v107, s28
  v_mfma_f32_16x16x32_bf16 a[112:115], v[236:239], v[128:131], a[112:115]
  v_perm_b32 v204, v87, v83, s29
  v_mfma_f32_16x16x32_bf16 a[116:119], v[236:239], v[132:135], a[116:119]
  v_perm_b32 v205, v95, v91, s29
  v_mfma_f32_16x16x32_bf16 a[120:123], v[236:239], v[136:139], a[120:123]
  v_perm_b32 v206, v103, v99, s29
  v_mfma_f32_16x16x32_bf16 a[124:127], v[236:239], v[140:143], a[124:127]
  v_perm_b32 v207, v111, v107, s29
  s_waitcnt vmcnt(16)
  v_mfma_f32_16x16x32_bf16 a[0:3], v[176:179], v[144:147], a[0:3]
  s_add_u32 s19, s19, 1
  v_perm_b32 v208, v20, v16, s28
  v_mfma_f32_16x16x32_bf16 a[4:7], v[176:179], v[148:151], a[4:7]
  s_and_b32 s19, s19, 15
  v_perm_b32 v209, v28, v24, s28
  v_mfma_f32_16x16x32_bf16 a[8:11], v[176:179], v[152:155], a[8:11]
  s_mul_i32 s24, s19, 114688
  v_perm_b32 v210, v36, v32, s28
  v_mfma_f32_16x16x32_bf16 a[12:15], v[176:179], v[156:159], a[12:15]
  s_add_u32 s24, s24, s14
  v_perm_b32 v211, v44, v40, s28
  v_mfma_f32_16x16x32_bf16 a[16:19], v[180:183], v[144:147], a[16:19]
  s_lshl_b32 s25, s19, 10
  v_perm_b32 v212, v20, v16, s29
  v_mfma_f32_16x16x32_bf16 a[20:23], v[180:183], v[148:151], a[20:23]
  s_add_u32 s25, s25, s15
  v_perm_b32 v213, v28, v24, s29
  v_mfma_f32_16x16x32_bf16 a[24:27], v[180:183], v[152:155], a[24:27]
  buffer_load_dwordx4 v[80:83], v4, s[52:55], s24 offen
  v_perm_b32 v214, v36, v32, s29
  v_mfma_f32_16x16x32_bf16 a[28:31], v[180:183], v[156:159], a[28:31]
  s_add_u32 s24, s24, 3584
  v_perm_b32 v215, v44, v40, s29
  v_mfma_f32_16x16x32_bf16 a[32:35], v[184:187], v[144:147], a[32:35]
  buffer_load_dwordx4 v[84:87], v4, s[52:55], s24 offen
  v_perm_b32 v216, v21, v17, s28
  v_mfma_f32_16x16x32_bf16 a[36:39], v[184:187], v[148:151], a[36:39]
  s_add_u32 s24, s24, 3584
  v_perm_b32 v217, v29, v25, s28
  v_mfma_f32_16x16x32_bf16 a[40:43], v[184:187], v[152:155], a[40:43]
  buffer_load_dwordx4 v[88:91], v4, s[52:55], s24 offen
  v_perm_b32 v218, v37, v33, s28
  v_mfma_f32_16x16x32_bf16 a[44:47], v[184:187], v[156:159], a[44:47]
  s_add_u32 s24, s24, 3584
  v_perm_b32 v219, v45, v41, s28
  v_mfma_f32_16x16x32_bf16 a[48:51], v[188:191], v[144:147], a[48:51]
  buffer_load_dwordx4 v[92:95], v4, s[52:55], s24 offen
  v_perm_b32 v220, v21, v17, s29
  v_mfma_f32_16x16x32_bf16 a[52:55], v[188:191], v[148:151], a[52:55]
  s_add_u32 s24, s24, 3584
  v_perm_b32 v221, v29, v25, s29
  v_mfma_f32_16x16x32_bf16 a[56:59], v[188:191], v[152:155], a[56:59]
  buffer_load_dwordx4 v[96:99], v4, s[52:55], s24 offen
  v_perm_b32 v222, v37, v33, s29
  v_mfma_f32_16x16x32_bf16 a[60:63], v[188:191], v[156:159], a[60:63]
  s_add_u32 s24, s24, 3584
  v_perm_b32 v223, v45, v41, s29
  v_mfma_f32_16x16x32_bf16 a[64:67], v[192:195], v[144:147], a[64:67]
  buffer_load_dwordx4 v[100:103], v4, s[52:55], s24 offen
  v_perm_b32 v224, v22, v18, s28
  v_mfma_f32_16x16x32_bf16 a[68:71], v[192:195], v[148:151], a[68:71]
  s_add_u32 s24, s24, 3584
  v_perm_b32 v225, v30, v26, s28
  v_mfma_f32_16x16x32_bf16 a[72:75], v[192:195], v[152:155], a[72:75]
  buffer_load_dwordx4 v[104:107], v4, s[52:55], s24 offen
  v_perm_b32 v226, v38, v34, s28
  v_mfma_f32_16x16x32_bf16 a[76:79], v[192:195], v[156:159], a[76:79]
  s_add_u32 s24, s24, 3584
  v_perm_b32 v227, v46, v42, s28
  v_mfma_f32_16x16x32_bf16 a[80:83], v[196:199], v[144:147], a[80:83]
  buffer_load_dwordx4 v[108:111], v4, s[52:55], s24 offen
  v_perm_b32 v228, v22, v18, s29
  v_mfma_f32_16x16x32_bf16 a[84:87], v[196:199], v[148:151], a[84:87]
  buffer_load_dwordx4 v[128:131], v1, s[4:7], s25 offen sc1
  v_perm_b32 v229, v30, v26, s29
  v_mfma_f32_16x16x32_bf16 a[88:91], v[196:199], v[152:155], a[88:91]
  s_add_u32 s25, s25, s26
  v_perm_b32 v230, v38, v34, s29
  v_mfma_f32_16x16x32_bf16 a[92:95], v[196:199], v[156:159], a[92:95]
  buffer_load_dwordx4 v[132:135], v1, s[4:7], s25 offen sc1
  v_perm_b32 v231, v46, v42, s29
  v_mfma_f32_16x16x32_bf16 a[96:99], v[200:203], v[144:147], a[96:99]
  s_add_u32 s25, s25, s26
  v_perm_b32 v232, v23, v19, s28
  v_mfma_f32_16x16x32_bf16 a[100:103], v[200:203], v[148:151], a[100:103]
  buffer_load_dwordx4 v[136:139], v1, s[4:7], s25 offen sc1
  v_perm_b32 v233, v31, v27, s28
  v_mfma_f32_16x16x32_bf16 a[104:107], v[200:203], v[152:155], a[104:107]
  s_add_u32 s25, s25, s26
  v_perm_b32 v234, v39, v35, s28
  v_mfma_f32_16x16x32_bf16 a[108:111], v[200:203], v[156:159], a[108:111]
  buffer_load_dwordx4 v[140:143], v1, s[4:7], s25 offen sc1
  v_perm_b32 v235, v47, v43, s28
  v_mfma_f32_16x16x32_bf16 a[112:115], v[204:207], v[144:147], a[112:115]
  v_perm_b32 v236, v23, v19, s29
  v_mfma_f32_16x16x32_bf16 a[116:119], v[204:207], v[148:151], a[116:119]
  v_perm_b32 v237, v31, v27, s29
  v_mfma_f32_16x16x32_bf16 a[120:123], v[204:207], v[152:155], a[120:123]
  v_perm_b32 v238, v39, v35, s29
  v_mfma_f32_16x16x32_bf16 a[124:127], v[204:207], v[156:159], a[124:127]
  v_perm_b32 v239, v47, v43, s29
  s_waitcnt vmcnt(16)
  v_mfma_f32_16x16x32_bf16 a[0:3], v[208:211], v[160:163], a[0:3]
  s_add_u32 s19, s19, 1
  v_perm_b32 v176, v52, v48, s28
  v_mfma_f32_16x16x32_bf16 a[4:7], v[208:211], v[164:167], a[4:7]
  s_and_b32 s19, s19, 15
  v_perm_b32 v177, v60, v56, s28
  v_mfma_f32_16x16x32_bf16 a[8:11], v[208:211], v[168:171], a[8:11]
  s_mul_i32 s24, s19, 114688
  v_perm_b32 v178, v68, v64, s28
  v_mfma_f32_16x16x32_bf16 a[12:15], v[208:211], v[172:175], a[12:15]
  s_add_u32 s24, s24, s14
  v_perm_b32 v179, v76, v72, s28
  v_mfma_f32_16x16x32_bf16 a[16:19], v[212:215], v[160:163], a[16:19]
  s_lshl_b32 s25, s19, 10
  v_perm_b32 v180, v52, v48, s29
  v_mfma_f32_16x16x32_bf16 a[20:23], v[212:215], v[164:167], a[20:23]
  s_add_u32 s25, s25, s15
  v_perm_b32 v181, v60, v56, s29
  v_mfma_f32_16x16x32_bf16 a[24:27], v[212:215], v[168:171], a[24:27]
  buffer_load_dwordx4 v[16:19], v4, s[52:55], s24 offen
  v_perm_b32 v182, v68, v64, s29
  v_mfma_f32_16x16x32_bf16 a[28:31], v[212:215], v[172:175], a[28:31]
  s_add_u32 s24, s24, 3584
  v_perm_b32 v183, v76, v72, s29
  v_mfma_f32_16x16x32_bf16 a[32:35], v[216:219], v[160:163], a[32:35]
  buffer_load_dwordx4 v[20:23], v4, s[52:55], s24 offen
  v_perm_b32 v184, v53, v49, s28
  v_mfma_f32_16x16x32_bf16 a[36:39], v[216:219], v[164:167], a[36:39]
  s_add_u32 s24, s24, 3584
  v_perm_b32 v185, v61, v57, s28
  v_mfma_f32_16x16x32_bf16 a[40:43], v[216:219], v[168:171], a[40:43]
  buffer_load_dwordx4 v[24:27], v4, s[52:55], s24 offen
  v_perm_b32 v186, v69, v65, s28
  v_mfma_f32_16x16x32_bf16 a[44:47], v[216:219], v[172:175], a[44:47]
  s_add_u32 s24, s24, 3584
  v_perm_b32 v187, v77, v73, s28
  v_mfma_f32_16x16x32_bf16 a[48:51], v[220:223], v[160:163], a[48:51]
  buffer_load_dwordx4 v[28:31], v4, s[52:55], s24 offen
  v_perm_b32 v188, v53, v49, s29
  v_mfma_f32_16x16x32_bf16 a[52:55], v[220:223], v[164:167], a[52:55]
  s_add_u32 s24, s24, 3584
  v_perm_b32 v189, v61, v57, s29
  v_mfma_f32_16x16x32_bf16 a[56:59], v[220:223], v[168:171], a[56:59]
  buffer_load_dwordx4 v[32:35], v4, s[52:55], s24 offen
  v_perm_b32 v190, v69, v65, s29
  v_mfma_f32_16x16x32_bf16 a[60:63], v[220:223], v[172:175], a[60:63]
  s_add_u32 s24, s24, 3584
  v_perm_b32 v191, v77, v73, s29
  v_mfma_f32_16x16x32_bf16 a[64:67], v[224:227], v[160:163], a[64:67]
  buffer_load_dwordx4 v[36:39], v4, s[52:55], s24 offen
  v_perm_b32 v192, v54, v50, s28
  v_mfma_f32_16x16x32_bf16 a[68:71], v[224:227], v[164:167], a[68:71]
  s_add_u32 s24, s24, 3584
  v_perm_b32 v193, v62, v58, s28
  v_mfma_f32_16x16x32_bf16 a[72:75], v[224:227], v[168:171], a[72:75]
  buffer_load_dwordx4 v[40:43], v4, s[52:55], s24 offen
  v_perm_b32 v194, v70, v66, s28
  v_mfma_f32_16x16x32_bf16 a[76:79], v[224:227], v[172:175], a[76:79]
  s_add_u32 s24, s24, 3584
  v_perm_b32 v195, v78, v74, s28
  v_mfma_f32_16x16x32_bf16 a[80:83], v[228:231], v[160:163], a[80:83]
  buffer_load_dwordx4 v[44:47], v4, s[52:55], s24 offen
  v_perm_b32 v196, v54, v50, s29
  v_mfma_f32_16x16x32_bf16 a[84:87], v[228:231], v[164:167], a[84:87]
  buffer_load_dwordx4 v[144:147], v1, s[4:7], s25 offen sc1
  v_perm_b32 v197, v62, v58, s29
  v_mfma_f32_16x16x32_bf16 a[88:91], v[228:231], v[168:171], a[88:91]
  s_add_u32 s25, s25, s26
  v_perm_b32 v198, v70, v66, s29
  v_mfma_f32_16x16x32_bf16 a[92:95], v[228:231], v[172:175], a[92:95]
  buffer_load_dwordx4 v[148:151], v1, s[4:7], s25 offen sc1
  v_perm_b32 v199, v78, v74, s29
  v_mfma_f32_16x16x32_bf16 a[96:99], v[232:235], v[160:163], a[96:99]
  s_add_u32 s25, s25, s26
  v_perm_b32 v200, v55, v51, s28
  v_mfma_f32_16x16x32_bf16 a[100:103], v[232:235], v[164:167], a[100:103]
  buffer_load_dwordx4 v[152:155], v1, s[4:7], s25 offen sc1
  v_perm_b32 v201, v63, v59, s28
  v_mfma_f32_16x16x32_bf16 a[104:107], v[232:235], v[168:171], a[104:107]
  s_add_u32 s25, s25, s26
  v_perm_b32 v202, v71, v67, s28
  v_mfma_f32_16x16x32_bf16 a[108:111], v[232:235], v[172:175], a[108:111]
  buffer_load_dwordx4 v[156:159], v1, s[4:7], s25 offen sc1
  v_perm_b32 v203, v79, v75, s28
  v_mfma_f32_16x16x32_bf16 a[112:115], v[236:239], v[160:163], a[112:115]
  v_perm_b32 v204, v55, v51, s29
  v_mfma_f32_16x16x32_bf16 a[116:119], v[236:239], v[164:167], a[116:119]
  v_perm_b32 v205, v63, v59, s29
  v_mfma_f32_16x16x32_bf16 a[120:123], v[236:239], v[168:171], a[120:123]
  v_perm_b32 v206, v71, v67, s29
  v_mfma_f32_16x16x32_bf16 a[124:127], v[236:239], v[172:175], a[124:127]
  v_perm_b32 v207, v79, v75, s29
  s_waitcnt vmcnt(16)
  v_mfma_f32_16x16x32_bf16 a[0:3], v[176:179], v[112:115], a[0:3]
  s_add_u32 s19, s19, 1
  v_perm_b32 v208, v84, v80, s28
  v_mfma_f32_16x16x32_bf16 a[4:7], v[176:179], v[116:119], a[4:7]
  s_and_b32 s19, s19, 15
  v_perm_b32 v209, v92, v88, s28
  v_mfma_f32_16x16x32_bf16 a[8:11], v[176:179], v[120:123], a[8:11]
  s_mul_i32 s24, s19, 114688
  v_perm_b32 v210, v100, v96, s28
  v_mfma_f32_16x16x32_bf16 a[12:15], v[176:179], v[124:127], a[12:15]
  s_add_u32 s24, s24, s14
  v_perm_b32 v211, v108, v104, s28
  v_mfma_f32_16x16x32_bf16 a[16:19], v[180:183], v[112:115], a[16:19]
  s_lshl_b32 s25, s19, 10
  v_perm_b32 v212, v84, v80, s29
  v_mfma_f32_16x16x32_bf16 a[20:23], v[180:183], v[116:119], a[20:23]
  s_add_u32 s25, s25, s15
  v_perm_b32 v213, v92, v88, s29
  v_mfma_f32_16x16x32_bf16 a[24:27], v[180:183], v[120:123], a[24:27]
  buffer_load_dwordx4 v[48:51], v4, s[52:55], s24 offen
  v_perm_b32 v214, v100, v96, s29
  v_mfma_f32_16x16x32_bf16 a[28:31], v[180:183], v[124:127], a[28:31]
  s_add_u32 s24, s24, 3584
  v_perm_b32 v215, v108, v104, s29
  v_mfma_f32_16x16x32_bf16 a[32:35], v[184:187], v[112:115], a[32:35]
  buffer_load_dwordx4 v[52:55], v4, s[52:55], s24 offen
  v_perm_b32 v216, v85, v81, s28
  v_mfma_f32_16x16x32_bf16 a[36:39], v[184:187], v[116:119], a[36:39]
  s_add_u32 s24, s24, 3584
  v_perm_b32 v217, v93, v89, s28
  v_mfma_f32_16x16x32_bf16 a[40:43], v[184:187], v[120:123], a[40:43]
  buffer_load_dwordx4 v[56:59], v4, s[52:55], s24 offen
  v_perm_b32 v218, v101, v97, s28
  v_mfma_f32_16x16x32_bf16 a[44:47], v[184:187], v[124:127], a[44:47]
  s_add_u32 s24, s24, 3584
  v_perm_b32 v219, v109, v105, s28
  v_mfma_f32_16x16x32_bf16 a[48:51], v[188:191], v[112:115], a[48:51]
  buffer_load_dwordx4 v[60:63], v4, s[52:55], s24 offen
  v_perm_b32 v220, v85, v81, s29
  v_mfma_f32_16x16x32_bf16 a[52:55], v[188:191], v[116:119], a[52:55]
  s_add_u32 s24, s24, 3584
  v_perm_b32 v221, v93, v89, s29
  v_mfma_f32_16x16x32_bf16 a[56:59], v[188:191], v[120:123], a[56:59]
  buffer_load_dwordx4 v[64:67], v4, s[52:55], s24 offen
  v_perm_b32 v222, v101, v97, s29
  v_mfma_f32_16x16x32_bf16 a[60:63], v[188:191], v[124:127], a[60:63]
  s_add_u32 s24, s24, 3584
  v_perm_b32 v223, v109, v105, s29
  v_mfma_f32_16x16x32_bf16 a[64:67], v[192:195], v[112:115], a[64:67]
  buffer_load_dwordx4 v[68:71], v4, s[52:55], s24 offen
  v_perm_b32 v224, v86, v82, s28
  v_mfma_f32_16x16x32_bf16 a[68:71], v[192:195], v[116:119], a[68:71]
  s_add_u32 s24, s24, 3584
  v_perm_b32 v225, v94, v90, s28
  v_mfma_f32_16x16x32_bf16 a[72:75], v[192:195], v[120:123], a[72:75]
  buffer_load_dwordx4 v[72:75], v4, s[52:55], s24 offen
  v_perm_b32 v226, v102, v98, s28
  v_mfma_f32_16x16x32_bf16 a[76:79], v[192:195], v[124:127], a[76:79]
  s_add_u32 s24, s24, 3584
  v_perm_b32 v227, v110, v106, s28
  v_mfma_f32_16x16x32_bf16 a[80:83], v[196:199], v[112:115], a[80:83]
  buffer_load_dwordx4 v[76:79], v4, s[52:55], s24 offen
  v_perm_b32 v228, v86, v82, s29
  v_mfma_f32_16x16x32_bf16 a[84:87], v[196:199], v[116:119], a[84:87]
  buffer_load_dwordx4 v[160:163], v1, s[4:7], s25 offen sc1
  v_perm_b32 v229, v94, v90, s29
  v_mfma_f32_16x16x32_bf16 a[88:91], v[196:199], v[120:123], a[88:91]
  s_add_u32 s25, s25, s26
  v_perm_b32 v230, v102, v98, s29
  v_mfma_f32_16x16x32_bf16 a[92:95], v[196:199], v[124:127], a[92:95]
  buffer_load_dwordx4 v[164:167], v1, s[4:7], s25 offen sc1
  v_perm_b32 v231, v110, v106, s29
  v_mfma_f32_16x16x32_bf16 a[96:99], v[200:203], v[112:115], a[96:99]
  s_add_u32 s25, s25, s26
  v_perm_b32 v232, v87, v83, s28
  v_mfma_f32_16x16x32_bf16 a[100:103], v[200:203], v[116:119], a[100:103]
  buffer_load_dwordx4 v[168:171], v1, s[4:7], s25 offen sc1
  v_perm_b32 v233, v95, v91, s28
  v_mfma_f32_16x16x32_bf16 a[104:107], v[200:203], v[120:123], a[104:107]
  s_add_u32 s25, s25, s26
  v_perm_b32 v234, v103, v99, s28
  v_mfma_f32_16x16x32_bf16 a[108:111], v[200:203], v[124:127], a[108:111]
  buffer_load_dwordx4 v[172:175], v1, s[4:7], s25 offen sc1
  v_perm_b32 v235, v111, v107, s28
  v_mfma_f32_16x16x32_bf16 a[112:115], v[204:207], v[112:115], a[112:115]
  v_perm_b32 v236, v87, v83, s29
  v_mfma_f32_16x16x32_bf16 a[116:119], v[204:207], v[116:119], a[116:119]
  v_perm_b32 v237, v95, v91, s29
  v_mfma_f32_16x16x32_bf16 a[120:123], v[204:207], v[120:123], a[120:123]
  v_perm_b32 v238, v103, v99, s29
  v_mfma_f32_16x16x32_bf16 a[124:127], v[204:207], v[124:127], a[124:127]
  v_perm_b32 v239, v111, v107, s29
  s_waitcnt vmcnt(16)
  v_mfma_f32_16x16x32_bf16 a[0:3], v[208:211], v[128:131], a[0:3]
  s_add_u32 s19, s19, 1
  v_perm_b32 v176, v20, v16, s28
  v_mfma_f32_16x16x32_bf16 a[4:7], v[208:211], v[132:135], a[4:7]
  s_and_b32 s19, s19, 15
  v_perm_b32 v177, v28, v24, s28
  v_mfma_f32_16x16x32_bf16 a[8:11], v[208:211], v[136:139], a[8:11]
  s_mul_i32 s24, s19, 114688
  v_perm_b32 v178, v36, v32, s28
  v_mfma_f32_16x16x32_bf16 a[12:15], v[208:211], v[140:143], a[12:15]
  s_add_u32 s24, s24, s14
  v_perm_b32 v179, v44, v40, s28
  v_mfma_f32_16x16x32_bf16 a[16:19], v[212:215], v[128:131], a[16:19]
  s_lshl_b32 s25, s19, 10
  v_perm_b32 v180, v20, v16, s29
  v_mfma_f32_16x16x32_bf16 a[20:23], v[212:215], v[132:135], a[20:23]
  s_add_u32 s25, s25, s15
  v_perm_b32 v181, v28, v24, s29
  v_mfma_f32_16x16x32_bf16 a[24:27], v[212:215], v[136:139], a[24:27]
  buffer_load_dwordx4 v[80:83], v4, s[52:55], s24 offen
  v_perm_b32 v182, v36, v32, s29
  v_mfma_f32_16x16x32_bf16 a[28:31], v[212:215], v[140:143], a[28:31]
  s_add_u32 s24, s24, 3584
  v_perm_b32 v183, v44, v40, s29
  v_mfma_f32_16x16x32_bf16 a[32:35], v[216:219], v[128:131], a[32:35]
  buffer_load_dwordx4 v[84:87], v4, s[52:55], s24 offen
  v_perm_b32 v184, v21, v17, s28
  v_mfma_f32_16x16x32_bf16 a[36:39], v[216:219], v[132:135], a[36:39]
  s_add_u32 s24, s24, 3584
  v_perm_b32 v185, v29, v25, s28
  v_mfma_f32_16x16x32_bf16 a[40:43], v[216:219], v[136:139], a[40:43]
  buffer_load_dwordx4 v[88:91], v4, s[52:55], s24 offen
  v_perm_b32 v186, v37, v33, s28
  v_mfma_f32_16x16x32_bf16 a[44:47], v[216:219], v[140:143], a[44:47]
  s_add_u32 s24, s24, 3584
  v_perm_b32 v187, v45, v41, s28
  v_mfma_f32_16x16x32_bf16 a[48:51], v[220:223], v[128:131], a[48:51]
  buffer_load_dwordx4 v[92:95], v4, s[52:55], s24 offen
  v_perm_b32 v188, v21, v17, s29
  v_mfma_f32_16x16x32_bf16 a[52:55], v[220:223], v[132:135], a[52:55]
  s_add_u32 s24, s24, 3584
  v_perm_b32 v189, v29, v25, s29
  v_mfma_f32_16x16x32_bf16 a[56:59], v[220:223], v[136:139], a[56:59]
  buffer_load_dwordx4 v[96:99], v4, s[52:55], s24 offen
  v_perm_b32 v190, v37, v33, s29
  v_mfma_f32_16x16x32_bf16 a[60:63], v[220:223], v[140:143], a[60:63]
  s_add_u32 s24, s24, 3584
  v_perm_b32 v191, v45, v41, s29
  v_mfma_f32_16x16x32_bf16 a[64:67], v[224:227], v[128:131], a[64:67]
  buffer_load_dwordx4 v[100:103], v4, s[52:55], s24 offen
  v_perm_b32 v192, v22, v18, s28
  v_mfma_f32_16x16x32_bf16 a[68:71], v[224:227], v[132:135], a[68:71]
  s_add_u32 s24, s24, 3584
  v_perm_b32 v193, v30, v26, s28
  v_mfma_f32_16x16x32_bf16 a[72:75], v[224:227], v[136:139], a[72:75]
  buffer_load_dwordx4 v[104:107], v4, s[52:55], s24 offen
  v_perm_b32 v194, v38, v34, s28
  v_mfma_f32_16x16x32_bf16 a[76:79], v[224:227], v[140:143], a[76:79]
  s_add_u32 s24, s24, 3584
  v_perm_b32 v195, v46, v42, s28
  v_mfma_f32_16x16x32_bf16 a[80:83], v[228:231], v[128:131], a[80:83]
  buffer_load_dwordx4 v[108:111], v4, s[52:55], s24 offen
  v_perm_b32 v196, v22, v18, s29
  v_mfma_f32_16x16x32_bf16 a[84:87], v[228:231], v[132:135], a[84:87]
  buffer_load_dwordx4 v[112:115], v1, s[4:7], s25 offen sc1
  v_perm_b32 v197, v30, v26, s29
  v_mfma_f32_16x16x32_bf16 a[88:91], v[228:231], v[136:139], a[88:91]
  s_add_u32 s25, s25, s26
  v_perm_b32 v198, v38, v34, s29
  v_mfma_f32_16x16x32_bf16 a[92:95], v[228:231], v[140:143], a[92:95]
  buffer_load_dwordx4 v[116:119], v1, s[4:7], s25 offen sc1
  v_perm_b32 v199, v46, v42, s29
  v_mfma_f32_16x16x32_bf16 a[96:99], v[232:235], v[128:131], a[96:99]
  s_add_u32 s25, s25, s26
  v_perm_b32 v200, v23, v19, s28
  v_mfma_f32_16x16x32_bf16 a[100:103], v[232:235], v[132:135], a[100:103]
  buffer_load_dwordx4 v[120:123], v1, s[4:7], s25 offen sc1
  v_perm_b32 v201, v31, v27, s28
  v_mfma_f32_16x16x32_bf16 a[104:107], v[232:235], v[136:139], a[104:107]
  s_add_u32 s25, s25, s26
  v_perm_b32 v202, v39, v35, s28
  v_mfma_f32_16x16x32_bf16 a[108:111], v[232:235], v[140:143], a[108:111]
  buffer_load_dwordx4 v[124:127], v1, s[4:7], s25 offen sc1
  v_perm_b32 v203, v47, v43, s28
  v_mfma_f32_16x16x32_bf16 a[112:115], v[236:239], v[128:131], a[112:115]
  v_perm_b32 v204, v23, v19, s29
  v_mfma_f32_16x16x32_bf16 a[116:119], v[236:239], v[132:135], a[116:119]
  v_perm_b32 v205, v31, v27, s29
  v_mfma_f32_16x16x32_bf16 a[120:123], v[236:239], v[136:139], a[120:123]
  v_perm_b32 v206, v39, v35, s29
  v_mfma_f32_16x16x32_bf16 a[124:127], v[236:239], v[140:143], a[124:127]
  v_perm_b32 v207, v47, v43, s29
  s_waitcnt vmcnt(16)
  v_mfma_f32_16x16x32_bf16 a[0:3], v[176:179], v[144:147], a[0:3]
  s_add_u32 s19, s19, 1
  v_perm_b32 v208, v52, v48, s28
  v_mfma_f32_16x16x32_bf16 a[4:7], v[176:179], v[148:151], a[4:7]
  s_and_b32 s19, s19, 15
  v_perm_b32 v209, v60, v56, s28
  v_mfma_f32_16x16x32_bf16 a[8:11], v[176:179], v[152:155], a[8:11]
  s_mul_i32 s24, s19, 114688
  v_perm_b32 v210, v68, v64, s28
  v_mfma_f32_16x16x32_bf16 a[12:15], v[176:179], v[156:159], a[12:15]
  s_add_u32 s24, s24, s14
  v_perm_b32 v211, v76, v72, s28
  v_mfma_f32_16x16x32_bf16 a[16:19], v[180:183], v[144:147], a[16:19]
  s_lshl_b32 s25, s19, 10
  v_perm_b32 v212, v52, v48, s29
  v_mfma_f32_16x16x32_bf16 a[20:23], v[180:183], v[148:151], a[20:23]
  s_add_u32 s25, s25, s15
  v_perm_b32 v213, v60, v56, s29
  v_mfma_f32_16x16x32_bf16 a[24:27], v[180:183], v[152:155], a[24:27]
  buffer_load_dwordx4 v[16:19], v4, s[52:55], s24 offen
  v_perm_b32 v214, v68, v64, s29
  v_mfma_f32_16x16x32_bf16 a[28:31], v[180:183], v[156:159], a[28:31]
  s_add_u32 s24, s24, 3584
  v_perm_b32 v215, v76, v72, s29
  v_mfma_f32_16x16x32_bf16 a[32:35], v[184:187], v[144:147], a[32:35]
  buffer_load_dwordx4 v[20:23], v4, s[52:55], s24 offen
  v_perm_b32 v216, v53, v49, s28
  v_mfma_f32_16x16x32_bf16 a[36:39], v[184:187], v[148:151], a[36:39]
  s_add_u32 s24, s24, 3584
  v_perm_b32 v217, v61, v57, s28
  v_mfma_f32_16x16x32_bf16 a[40:43], v[184:187], v[152:155], a[40:43]
  buffer_load_dwordx4 v[24:27], v4, s[52:55], s24 offen
  v_perm_b32 v218, v69, v65, s28
  v_mfma_f32_16x16x32_bf16 a[44:47], v[184:187], v[156:159], a[44:47]
  s_add_u32 s24, s24, 3584
  v_perm_b32 v219, v77, v73, s28
  v_mfma_f32_16x16x32_bf16 a[48:51], v[188:191], v[144:147], a[48:51]
  buffer_load_dwordx4 v[28:31], v4, s[52:55], s24 offen
  v_perm_b32 v220, v53, v49, s29
  v_mfma_f32_16x16x32_bf16 a[52:55], v[188:191], v[148:151], a[52:55]
  s_add_u32 s24, s24, 3584
  v_perm_b32 v221, v61, v57, s29
  v_mfma_f32_16x16x32_bf16 a[56:59], v[188:191], v[152:155], a[56:59]
  buffer_load_dwordx4 v[32:35], v4, s[52:55], s24 offen
  v_perm_b32 v222, v69, v65, s29
  v_mfma_f32_16x16x32_bf16 a[60:63], v[188:191], v[156:159], a[60:63]
  s_add_u32 s24, s24, 3584
  v_perm_b32 v223, v77, v73, s29
  v_mfma_f32_16x16x32_bf16 a[64:67], v[192:195], v[144:147], a[64:67]
  buffer_load_dwordx4 v[36:39], v4, s[52:55], s24 offen
  v_perm_b32 v224, v54, v50, s28
  v_mfma_f32_16x16x32_bf16 a[68:71], v[192:195], v[148:151], a[68:71]
  s_add_u32 s24, s24, 3584
  v_perm_b32 v225, v62, v58, s28
  v_mfma_f32_16x16x32_bf16 a[72:75], v[192:195], v[152:155], a[72:75]
  buffer_load_dwordx4 v[40:43], v4, s[52:55], s24 offen
  v_perm_b32 v226, v70, v66, s28
  v_mfma_f32_16x16x32_bf16 a[76:79], v[192:195], v[156:159], a[76:79]
  s_add_u32 s24, s24, 3584
  v_perm_b32 v227, v78, v74, s28
  v_mfma_f32_16x16x32_bf16 a[80:83], v[196:199], v[144:147], a[80:83]
  buffer_load_dwordx4 v[44:47], v4, s[52:55], s24 offen
  v_perm_b32 v228, v54, v50, s29
  v_mfma_f32_16x16x32_bf16 a[84:87], v[196:199], v[148:151], a[84:87]
  buffer_load_dwordx4 v[128:131], v1, s[4:7], s25 offen sc1
  v_perm_b32 v229, v62, v58, s29
  v_mfma_f32_16x16x32_bf16 a[88:91], v[196:199], v[152:155], a[88:91]
  s_add_u32 s25, s25, s26
  v_perm_b32 v230, v70, v66, s29
  v_mfma_f32_16x16x32_bf16 a[92:95], v[196:199], v[156:159], a[92:95]
  buffer_load_dwordx4 v[132:135], v1, s[4:7], s25 offen sc1
  v_perm_b32 v231, v78, v74, s29
  v_mfma_f32_16x16x32_bf16 a[96:99], v[200:203], v[144:147], a[96:99]
  s_add_u32 s25, s25, s26
  v_perm_b32 v232, v55, v51, s28
  v_mfma_f32_16x16x32_bf16 a[100:103], v[200:203], v[148:151], a[100:103]
  buffer_load_dwordx4 v[136:139], v1, s[4:7], s25 offen sc1
  v_perm_b32 v233, v63, v59, s28
  v_mfma_f32_16x16x32_bf16 a[104:107], v[200:203], v[152:155], a[104:107]
  s_add_u32 s25, s25, s26
  v_perm_b32 v234, v71, v67, s28
  v_mfma_f32_16x16x32_bf16 a[108:111], v[200:203], v[156:159], a[108:111]
  buffer_load_dwordx4 v[140:143], v1, s[4:7], s25 offen sc1
  v_perm_b32 v235, v79, v75, s28
  v_mfma_f32_16x16x32_bf16 a[112:115], v[204:207], v[144:147], a[112:115]
  v_perm_b32 v236, v55, v51, s29
  v_mfma_f32_16x16x32_bf16 a[116:119], v[204:207], v[148:151], a[116:119]
  v_perm_b32 v237, v63, v59, s29
  v_mfma_f32_16x16x32_bf16 a[120:123], v[204:207], v[152:155], a[120:123]
  v_perm_b32 v238, v71, v67, s29
  v_mfma_f32_16x16x32_bf16 a[124:127], v[204:207], v[156:159], a[124:127]
  v_perm_b32 v239, v79, v75, s29
  s_waitcnt vmcnt(16)
  v_mfma_f32_16x16x32_bf16 a[0:3], v[208:211], v[160:163], a[0:3]
  s_add_u32 s19, s19, 1
  v_perm_b32 v176, v84, v80, s28
  v_mfma_f32_16x16x32_bf16 a[4:7], v[208:211], v[164:167], a[4:7]
  s_and_b32 s19, s19, 15
  v_perm_b32 v177, v92, v88, s28
  v_mfma_f32_16x16x32_bf16 a[8:11], v[208:211], v[168:171], a[8:11]
  s_mul_i32 s24, s19, 114688
  v_perm_b32 v178, v100, v96, s28
  v_mfma_f32_16x16x32_bf16 a[12:15], v[208:211], v[172:175], a[12:15]
  s_add_u32 s24, s24, s14
  v_perm_b32 v179, v108, v104, s28
  v_mfma_f32_16x16x32_bf16 a[16:19], v[212:215], v[160:163], a[16:19]
  s_lshl_b32 s25, s19, 10
  v_perm_b32 v180, v84, v80, s29
  v_mfma_f32_16x16x32_bf16 a[20:23], v[212:215], v[164:167], a[20:23]
  s_add_u32 s25, s25, s15
  v_perm_b32 v181, v92, v88, s29
  v_mfma_f32_16x16x32_bf16 a[24:27], v[212:215], v[168:171], a[24:27]
  buffer_load_dwordx4 v[48:51], v4, s[52:55], s24 offen
  v_perm_b32 v182, v100, v96, s29
  v_mfma_f32_16x16x32_bf16 a[28:31], v[212:215], v[172:175], a[28:31]
  s_add_u32 s24, s24, 3584
  v_perm_b32 v183, v108, v104, s29
  v_mfma_f32_16x16x32_bf16 a[32:35], v[216:219], v[160:163], a[32:35]
  buffer_load_dwordx4 v[52:55], v4, s[52:55], s24 offen
  v_perm_b32 v184, v85, v81, s28
  v_mfma_f32_16x16x32_bf16 a[36:39], v[216:219], v[164:167], a[36:39]
  s_add_u32 s24, s24, 3584
  v_perm_b32 v185, v93, v89, s28
  v_mfma_f32_16x16x32_bf16 a[40:43], v[216:219], v[168:171], a[40:43]
  buffer_load_dwordx4 v[56:59], v4, s[52:55], s24 offen
  v_perm_b32 v186, v101, v97, s28
  v_mfma_f32_16x16x32_bf16 a[44:47], v[216:219], v[172:175], a[44:47]
  s_add_u32 s24, s24, 3584
  v_perm_b32 v187, v109, v105, s28
  v_mfma_f32_16x16x32_bf16 a[48:51], v[220:223], v[160:163], a[48:51]
  buffer_load_dwordx4 v[60:63], v4, s[52:55], s24 offen
  v_perm_b32 v188, v85, v81, s29
  v_mfma_f32_16x16x32_bf16 a[52:55], v[220:223], v[164:167], a[52:55]
  s_add_u32 s24, s24, 3584
  v_perm_b32 v189, v93, v89, s29
  v_mfma_f32_16x16x32_bf16 a[56:59], v[220:223], v[168:171], a[56:59]
  buffer_load_dwordx4 v[64:67], v4, s[52:55], s24 offen
  v_perm_b32 v190, v101, v97, s29
  v_mfma_f32_16x16x32_bf16 a[60:63], v[220:223], v[172:175], a[60:63]
  s_add_u32 s24, s24, 3584
  v_perm_b32 v191, v109, v105, s29
  v_mfma_f32_16x16x32_bf16 a[64:67], v[224:227], v[160:163], a[64:67]
  buffer_load_dwordx4 v[68:71], v4, s[52:55], s24 offen
  v_perm_b32 v192, v86, v82, s28
  v_mfma_f32_16x16x32_bf16 a[68:71], v[224:227], v[164:167], a[68:71]
  s_add_u32 s24, s24, 3584
  v_perm_b32 v193, v94, v90, s28
  v_mfma_f32_16x16x32_bf16 a[72:75], v[224:227], v[168:171], a[72:75]
  buffer_load_dwordx4 v[72:75], v4, s[52:55], s24 offen
  v_perm_b32 v194, v102, v98, s28
  v_mfma_f32_16x16x32_bf16 a[76:79], v[224:227], v[172:175], a[76:79]
  s_add_u32 s24, s24, 3584
  v_perm_b32 v195, v110, v106, s28
  v_mfma_f32_16x16x32_bf16 a[80:83], v[228:231], v[160:163], a[80:83]
  buffer_load_dwordx4 v[76:79], v4, s[52:55], s24 offen
  v_perm_b32 v196, v86, v82, s29
  v_mfma_f32_16x16x32_bf16 a[84:87], v[228:231], v[164:167], a[84:87]
  buffer_load_dwordx4 v[144:147], v1, s[4:7], s25 offen sc1
  v_perm_b32 v197, v94, v90, s29
  v_mfma_f32_16x16x32_bf16 a[88:91], v[228:231], v[168:171], a[88:91]
  s_add_u32 s25, s25, s26
  v_perm_b32 v198, v102, v98, s29
  v_mfma_f32_16x16x32_bf16 a[92:95], v[228:231], v[172:175], a[92:95]
  buffer_load_dwordx4 v[148:151], v1, s[4:7], s25 offen sc1
  v_perm_b32 v199, v110, v106, s29
  v_mfma_f32_16x16x32_bf16 a[96:99], v[232:235], v[160:163], a[96:99]
  s_add_u32 s25, s25, s26
  v_perm_b32 v200, v87, v83, s28
  v_mfma_f32_16x16x32_bf16 a[100:103], v[232:235], v[164:167], a[100:103]
  buffer_load_dwordx4 v[152:155], v1, s[4:7], s25 offen sc1
  v_perm_b32 v201, v95, v91, s28
  v_mfma_f32_16x16x32_bf16 a[104:107], v[232:235], v[168:171], a[104:107]
  s_add_u32 s25, s25, s26
  v_perm_b32 v202, v103, v99, s28
  v_mfma_f32_16x16x32_bf16 a[108:111], v[232:235], v[172:175], a[108:111]
  buffer_load_dwordx4 v[156:159], v1, s[4:7], s25 offen sc1
  v_perm_b32 v203, v111, v107, s28
  v_mfma_f32_16x16x32_bf16 a[112:115], v[236:239], v[160:163], a[112:115]
  v_perm_b32 v204, v87, v83, s29
  v_mfma_f32_16x16x32_bf16 a[116:119], v[236:239], v[164:167], a[116:119]
  v_perm_b32 v205, v95, v91, s29
  v_mfma_f32_16x16x32_bf16 a[120:123], v[236:239], v[168:171], a[120:123]
  v_perm_b32 v206, v103, v99, s29
  v_mfma_f32_16x16x32_bf16 a[124:127], v[236:239], v[172:175], a[124:127]
  v_perm_b32 v207, v111, v107, s29
  s_waitcnt vmcnt(16)
  v_mfma_f32_16x16x32_bf16 a[0:3], v[176:179], v[112:115], a[0:3]
  s_add_u32 s19, s19, 1
  v_perm_b32 v208, v20, v16, s28
  v_mfma_f32_16x16x32_bf16 a[4:7], v[176:179], v[116:119], a[4:7]
  s_and_b32 s19, s19, 15
  v_perm_b32 v209, v28, v24, s28
  v_mfma_f32_16x16x32_bf16 a[8:11], v[176:179], v[120:123], a[8:11]
  s_mul_i32 s24, s19, 114688
  v_perm_b32 v210, v36, v32, s28
  v_mfma_f32_16x16x32_bf16 a[12:15], v[176:179], v[124:127], a[12:15]
  s_add_u32 s24, s24, s14
  v_perm_b32 v211, v44, v40, s28
  v_mfma_f32_16x16x32_bf16 a[16:19], v[180:183], v[112:115], a[16:19]
  s_lshl_b32 s25, s19, 10
  v_perm_b32 v212, v20, v16, s29
  v_mfma_f32_16x16x32_bf16 a[20:23], v[180:183], v[116:119], a[20:23]
  s_add_u32 s25, s25, s15
  v_perm_b32 v213, v28, v24, s29
  v_mfma_f32_16x16x32_bf16 a[24:27], v[180:183], v[120:123], a[24:27]
  buffer_load_dwordx4 v[80:83], v4, s[52:55], s24 offen
  v_perm_b32 v214, v36, v32, s29
  v_mfma_f32_16x16x32_bf16 a[28:31], v[180:183], v[124:127], a[28:31]
  s_add_u32 s24, s24, 3584
  v_perm_b32 v215, v44, v40, s29
  v_mfma_f32_16x16x32_bf16 a[32:35], v[184:187], v[112:115], a[32:35]
  buffer_load_dwordx4 v[84:87], v4, s[52:55], s24 offen
  v_perm_b32 v216, v21, v17, s28
  v_mfma_f32_16x16x32_bf16 a[36:39], v[184:187], v[116:119], a[36:39]
  s_add_u32 s24, s24, 3584
  v_perm_b32 v217, v29, v25, s28
  v_mfma_f32_16x16x32_bf16 a[40:43], v[184:187], v[120:123], a[40:43]
  buffer_load_dwordx4 v[88:91], v4, s[52:55], s24 offen
  v_perm_b32 v218, v37, v33, s28
  v_mfma_f32_16x16x32_bf16 a[44:47], v[184:187], v[124:127], a[44:47]
  s_add_u32 s24, s24, 3584
  v_perm_b32 v219, v45, v41, s28
  v_mfma_f32_16x16x32_bf16 a[48:51], v[188:191], v[112:115], a[48:51]
  buffer_load_dwordx4 v[92:95], v4, s[52:55], s24 offen
  v_perm_b32 v220, v21, v17, s29
  v_mfma_f32_16x16x32_bf16 a[52:55], v[188:191], v[116:119], a[52:55]
  s_add_u32 s24, s24, 3584
  v_perm_b32 v221, v29, v25, s29
  v_mfma_f32_16x16x32_bf16 a[56:59], v[188:191], v[120:123], a[56:59]
  buffer_load_dwordx4 v[96:99], v4, s[52:55], s24 offen
  v_perm_b32 v222, v37, v33, s29
  v_mfma_f32_16x16x32_bf16 a[60:63], v[188:191], v[124:127], a[60:63]
  s_add_u32 s24, s24, 3584
  v_perm_b32 v223, v45, v41, s29
  v_mfma_f32_16x16x32_bf16 a[64:67], v[192:195], v[112:115], a[64:67]
  buffer_load_dwordx4 v[100:103], v4, s[52:55], s24 offen
  v_perm_b32 v224, v22, v18, s28
  v_mfma_f32_16x16x32_bf16 a[68:71], v[192:195], v[116:119], a[68:71]
  s_add_u32 s24, s24, 3584
  v_perm_b32 v225, v30, v26, s28
  v_mfma_f32_16x16x32_bf16 a[72:75], v[192:195], v[120:123], a[72:75]
  buffer_load_dwordx4 v[104:107], v4, s[52:55], s24 offen
  v_perm_b32 v226, v38, v34, s28
  v_mfma_f32_16x16x32_bf16 a[76:79], v[192:195], v[124:127], a[76:79]
  s_add_u32 s24, s24, 3584
  v_perm_b32 v227, v46, v42, s28
  v_mfma_f32_16x16x32_bf16 a[80:83], v[196:199], v[112:115], a[80:83]
  buffer_load_dwordx4 v[108:111], v4, s[52:55], s24 offen
  v_perm_b32 v228, v22, v18, s29
  v_mfma_f32_16x16x32_bf16 a[84:87], v[196:199], v[116:119], a[84:87]
  buffer_load_dwordx4 v[160:163], v1, s[4:7], s25 offen sc1
  v_perm_b32 v229, v30, v26, s29
  v_mfma_f32_16x16x32_bf16 a[88:91], v[196:199], v[120:123], a[88:91]
  s_add_u32 s25, s25, s26
  v_perm_b32 v230, v38, v34, s29
  v_mfma_f32_16x16x32_bf16 a[92:95], v[196:199], v[124:127], a[92:95]
  buffer_load_dwordx4 v[164:167], v1, s[4:7], s25 offen sc1
  v_perm_b32 v231, v46, v42, s29
  v_mfma_f32_16x16x32_bf16 a[96:99], v[200:203], v[112:115], a[96:99]
  s_add_u32 s25, s25, s26
  v_perm_b32 v232, v23, v19, s28
  v_mfma_f32_16x16x32_bf16 a[100:103], v[200:203], v[116:119], a[100:103]
  buffer_load_dwordx4 v[168:171], v1, s[4:7], s25 offen sc1
  v_perm_b32 v233, v31, v27, s28
  v_mfma_f32_16x16x32_bf16 a[104:107], v[200:203], v[120:123], a[104:107]
  s_add_u32 s25, s25, s26
  v_perm_b32 v234, v39, v35, s28
  v_mfma_f32_16x16x32_bf16 a[108:111], v[200:203], v[124:127], a[108:111]
  buffer_load_dwordx4 v[172:175], v1, s[4:7], s25 offen sc1
  v_perm_b32 v235, v47, v43, s28
  v_mfma_f32_16x16x32_bf16 a[112:115], v[204:207], v[112:115], a[112:115]
  v_perm_b32 v236, v23, v19, s29
  v_mfma_f32_16x16x32_bf16 a[116:119], v[204:207], v[116:119], a[116:119]
  v_perm_b32 v237, v31, v27, s29
  v_mfma_f32_16x16x32_bf16 a[120:123], v[204:207], v[120:123], a[120:123]
  v_perm_b32 v238, v39, v35, s29
  v_mfma_f32_16x16x32_bf16 a[124:127], v[204:207], v[124:127], a[124:127]
  v_perm_b32 v239, v47, v43, s29
  s_waitcnt vmcnt(16)
  v_mfma_f32_16x16x32_bf16 a[0:3], v[208:211], v[128:131], a[0:3]
  s_add_u32 s19, s19, 1
  v_perm_b32 v176, v52, v48, s28
  v_mfma_f32_16x16x32_bf16 a[4:7], v[208:211], v[132:135], a[4:7]
  s_and_b32 s19, s19, 15
  v_perm_b32 v177, v60, v56, s28
  v_mfma_f32_16x16x32_bf16 a[8:11], v[208:211], v[136:139], a[8:11]
  s_mul_i32 s24, s19, 114688
  v_perm_b32 v178, v68, v64, s28
  v_mfma_f32_16x16x32_bf16 a[12:15], v[208:211], v[140:143], a[12:15]
  s_add_u32 s24, s24, s14
  v_perm_b32 v179, v76, v72, s28
  v_mfma_f32_16x16x32_bf16 a[16:19], v[212:215], v[128:131], a[16:19]
  s_lshl_b32 s25, s19, 10
  v_perm_b32 v180, v52, v48, s29
  v_mfma_f32_16x16x32_bf16 a[20:23], v[212:215], v[132:135], a[20:23]
  s_add_u32 s25, s25, s15
  v_perm_b32 v181, v60, v56, s29
  v_mfma_f32_16x16x32_bf16 a[24:27], v[212:215], v[136:139], a[24:27]
  buffer_load_dwordx4 v[16:19], v4, s[52:55], s24 offen
  v_perm_b32 v182, v68, v64, s29
  v_mfma_f32_16x16x32_bf16 a[28:31], v[212:215], v[140:143], a[28:31]
  s_add_u32 s24, s24, 3584
  v_perm_b32 v183, v76, v72, s29
  v_mfma_f32_16x16x32_bf16 a[32:35], v[216:219], v[128:131], a[32:35]
  buffer_load_dwordx4 v[20:23], v4, s[52:55], s24 offen
  v_perm_b32 v184, v53, v49, s28
  v_mfma_f32_16x16x32_bf16 a[36:39], v[216:219], v[132:135], a[36:39]
  s_add_u32 s24, s24, 3584
  v_perm_b32 v185, v61, v57, s28
  v_mfma_f32_16x16x32_bf16 a[40:43], v[216:219], v[136:139], a[40:43]
  buffer_load_dwordx4 v[24:27], v4, s[52:55], s24 offen
  v_perm_b32 v186, v69, v65, s28
  v_mfma_f32_16x16x32_bf16 a[44:47], v[216:219], v[140:143], a[44:47]
  s_add_u32 s24, s24, 3584
  v_perm_b32 v187, v77, v73, s28
  v_mfma_f32_16x16x32_bf16 a[48:51], v[220:223], v[128:131], a[48:51]
  buffer_load_dwordx4 v[28:31], v4, s[52:55], s24 offen
  v_perm_b32 v188, v53, v49, s29
  v_mfma_f32_16x16x32_bf16 a[52:55], v[220:223], v[132:135], a[52:55]
  s_add_u32 s24, s24, 3584
  v_perm_b32 v189, v61, v57, s29
  v_mfma_f32_16x16x32_bf16 a[56:59], v[220:223], v[136:139], a[56:59]
  buffer_load_dwordx4 v[32:35], v4, s[52:55], s24 offen
  v_perm_b32 v190, v69, v65, s29
  v_mfma_f32_16x16x32_bf16 a[60:63], v[220:223], v[140:143], a[60:63]
  s_add_u32 s24, s24, 3584
  v_perm_b32 v191, v77, v73, s29
  v_mfma_f32_16x16x32_bf16 a[64:67], v[224:227], v[128:131], a[64:67]
  buffer_load_dwordx4 v[36:39], v4, s[52:55], s24 offen
  v_perm_b32 v192, v54, v50, s28
  v_mfma_f32_16x16x32_bf16 a[68:71], v[224:227], v[132:135], a[68:71]
  s_add_u32 s24, s24, 3584
  v_perm_b32 v193, v62, v58, s28
  v_mfma_f32_16x16x32_bf16 a[72:75], v[224:227], v[136:139], a[72:75]
  buffer_load_dwordx4 v[40:43], v4, s[52:55], s24 offen
  v_perm_b32 v194, v70, v66, s28
  v_mfma_f32_16x16x32_bf16 a[76:79], v[224:227], v[140:143], a[76:79]
  s_add_u32 s24, s24, 3584
  v_perm_b32 v195, v78, v74, s28
  v_mfma_f32_16x16x32_bf16 a[80:83], v[228:231], v[128:131], a[80:83]
  buffer_load_dwordx4 v[44:47], v4, s[52:55], s24 offen
  v_perm_b32 v196, v54, v50, s29
  v_mfma_f32_16x16x32_bf16 a[84:87], v[228:231], v[132:135], a[84:87]
  buffer_load_dwordx4 v[112:115], v1, s[4:7], s25 offen sc1
  v_perm_b32 v197, v62, v58, s29
  v_mfma_f32_16x16x32_bf16 a[88:91], v[228:231], v[136:139], a[88:91]
  s_add_u32 s25, s25, s26
  v_perm_b32 v198, v70, v66, s29
  v_mfma_f32_16x16x32_bf16 a[92:95], v[228:231], v[140:143], a[92:95]
  buffer_load_dwordx4 v[116:119], v1, s[4:7], s25 offen sc1
  v_perm_b32 v199, v78, v74, s29
  v_mfma_f32_16x16x32_bf16 a[96:99], v[232:235], v[128:131], a[96:99]
  s_add_u32 s25, s25, s26
  v_perm_b32 v200, v55, v51, s28
  v_mfma_f32_16x16x32_bf16 a[100:103], v[232:235], v[132:135], a[100:103]
  buffer_load_dwordx4 v[120:123], v1, s[4:7], s25 offen sc1
  v_perm_b32 v201, v63, v59, s28
  v_mfma_f32_16x16x32_bf16 a[104:107], v[232:235], v[136:139], a[104:107]
  s_add_u32 s25, s25, s26
  v_perm_b32 v202, v71, v67, s28
  v_mfma_f32_16x16x32_bf16 a[108:111], v[232:235], v[140:143], a[108:111]
  buffer_load_dwordx4 v[124:127], v1, s[4:7], s25 offen sc1
  v_perm_b32 v203, v79, v75, s28
  v_mfma_f32_16x16x32_bf16 a[112:115], v[236:239], v[128:131], a[112:115]
  v_perm_b32 v204, v55, v51, s29
  v_mfma_f32_16x16x32_bf16 a[116:119], v[236:239], v[132:135], a[116:119]
  v_perm_b32 v205, v63, v59, s29
  v_mfma_f32_16x16x32_bf16 a[120:123], v[236:239], v[136:139], a[120:123]
  v_perm_b32 v206, v71, v67, s29
  v_mfma_f32_16x16x32_bf16 a[124:127], v[236:239], v[140:143], a[124:127]
  v_perm_b32 v207, v79, v75, s29
  s_waitcnt vmcnt(16)
  v_mfma_f32_16x16x32_bf16 a[0:3], v[176:179], v[144:147], a[0:3]
  s_add_u32 s19, s19, 1
  v_perm_b32 v208, v84, v80, s28
  v_mfma_f32_16x16x32_bf16 a[4:7], v[176:179], v[148:151], a[4:7]
  s_and_b32 s19, s19, 15
  v_perm_b32 v209, v92, v88, s28
  v_mfma_f32_16x16x32_bf16 a[8:11], v[176:179], v[152:155], a[8:11]
  s_mul_i32 s24, s19, 114688
  v_perm_b32 v210, v100, v96, s28
  v_mfma_f32_16x16x32_bf16 a[12:15], v[176:179], v[156:159], a[12:15]
  s_add_u32 s24, s24, s14
  v_perm_b32 v211, v108, v104, s28
  v_mfma_f32_16x16x32_bf16 a[16:19], v[180:183], v[144:147], a[16:19]
  s_lshl_b32 s25, s19, 10
  v_perm_b32 v212, v84, v80, s29
  v_mfma_f32_16x16x32_bf16 a[20:23], v[180:183], v[148:151], a[20:23]
  s_add_u32 s25, s25, s15
  v_perm_b32 v213, v92, v88, s29
  v_mfma_f32_16x16x32_bf16 a[24:27], v[180:183], v[152:155], a[24:27]
  buffer_load_dwordx4 v[48:51], v4, s[52:55], s24 offen
  v_perm_b32 v214, v100, v96, s29
  v_mfma_f32_16x16x32_bf16 a[28:31], v[180:183], v[156:159], a[28:31]
  s_add_u32 s24, s24, 3584
  v_perm_b32 v215, v108, v104, s29
  v_mfma_f32_16x16x32_bf16 a[32:35], v[184:187], v[144:147], a[32:35]
  buffer_load_dwordx4 v[52:55], v4, s[52:55], s24 offen
  v_perm_b32 v216, v85, v81, s28
  v_mfma_f32_16x16x32_bf16 a[36:39], v[184:187], v[148:151], a[36:39]
  s_add_u32 s24, s24, 3584
  v_perm_b32 v217, v93, v89, s28
  v_mfma_f32_16x16x32_bf16 a[40:43], v[184:187], v[152:155], a[40:43]
  buffer_load_dwordx4 v[56:59], v4, s[52:55], s24 offen
  v_perm_b32 v218, v101, v97, s28
  v_mfma_f32_16x16x32_bf16 a[44:47], v[184:187], v[156:159], a[44:47]
  s_add_u32 s24, s24, 3584
  v_perm_b32 v219, v109, v105, s28
  v_mfma_f32_16x16x32_bf16 a[48:51], v[188:191], v[144:147], a[48:51]
  buffer_load_dwordx4 v[60:63], v4, s[52:55], s24 offen
  v_perm_b32 v220, v85, v81, s29
  v_mfma_f32_16x16x32_bf16 a[52:55], v[188:191], v[148:151], a[52:55]
  s_add_u32 s24, s24, 3584
  v_perm_b32 v221, v93, v89, s29
  v_mfma_f32_16x16x32_bf16 a[56:59], v[188:191], v[152:155], a[56:59]
  buffer_load_dwordx4 v[64:67], v4, s[52:55], s24 offen
  v_perm_b32 v222, v101, v97, s29
  v_mfma_f32_16x16x32_bf16 a[60:63], v[188:191], v[156:159], a[60:63]
  s_add_u32 s24, s24, 3584
  v_perm_b32 v223, v109, v105, s29
  v_mfma_f32_16x16x32_bf16 a[64:67], v[192:195], v[144:147], a[64:67]
  buffer_load_dwordx4 v[68:71], v4, s[52:55], s24 offen
  v_perm_b32 v224, v86, v82, s28
  v_mfma_f32_16x16x32_bf16 a[68:71], v[192:195], v[148:151], a[68:71]
  s_add_u32 s24, s24, 3584
  v_perm_b32 v225, v94, v90, s28
  v_mfma_f32_16x16x32_bf16 a[72:75], v[192:195], v[152:155], a[72:75]
  buffer_load_dwordx4 v[72:75], v4, s[52:55], s24 offen
  v_perm_b32 v226, v102, v98, s28
  v_mfma_f32_16x16x32_bf16 a[76:79], v[192:195], v[156:159], a[76:79]
  s_add_u32 s24, s24, 3584
  v_perm_b32 v227, v110, v106, s28
  v_mfma_f32_16x16x32_bf16 a[80:83], v[196:199], v[144:147], a[80:83]
  buffer_load_dwordx4 v[76:79], v4, s[52:55], s24 offen
  v_perm_b32 v228, v86, v82, s29
  v_mfma_f32_16x16x32_bf16 a[84:87], v[196:199], v[148:151], a[84:87]
  buffer_load_dwordx4 v[128:131], v1, s[4:7], s25 offen sc1
  v_perm_b32 v229, v94, v90, s29
  v_mfma_f32_16x16x32_bf16 a[88:91], v[196:199], v[152:155], a[88:91]
  s_add_u32 s25, s25, s26
  v_perm_b32 v230, v102, v98, s29
  v_mfma_f32_16x16x32_bf16 a[92:95], v[196:199], v[156:159], a[92:95]
  buffer_load_dwordx4 v[132:135], v1, s[4:7], s25 offen sc1
  v_perm_b32 v231, v110, v106, s29
  v_mfma_f32_16x16x32_bf16 a[96:99], v[200:203], v[144:147], a[96:99]
  s_add_u32 s25, s25, s26
  v_perm_b32 v232, v87, v83, s28
  v_mfma_f32_16x16x32_bf16 a[100:103], v[200:203], v[148:151], a[100:103]
  buffer_load_dwordx4 v[136:139], v1, s[4:7], s25 offen sc1
  v_perm_b32 v233, v95, v91, s28
  v_mfma_f32_16x16x32_bf16 a[104:107], v[200:203], v[152:155], a[104:107]
  s_add_u32 s25, s25, s26
  v_perm_b32 v234, v103, v99, s28
  v_mfma_f32_16x16x32_bf16 a[108:111], v[200:203], v[156:159], a[108:111]
  buffer_load_dwordx4 v[140:143], v1, s[4:7], s25 offen sc1
  v_perm_b32 v235, v111, v107, s28
  v_mfma_f32_16x16x32_bf16 a[112:115], v[204:207], v[144:147], a[112:115]
  v_perm_b32 v236, v87, v83, s29
  v_mfma_f32_16x16x32_bf16 a[116:119], v[204:207], v[148:151], a[116:119]
  v_perm_b32 v237, v95, v91, s29
  v_mfma_f32_16x16x32_bf16 a[120:123], v[204:207], v[152:155], a[120:123]
  v_perm_b32 v238, v103, v99, s29
  v_mfma_f32_16x16x32_bf16 a[124:127], v[204:207], v[156:159], a[124:127]
  v_perm_b32 v239, v111, v107, s29
  s_waitcnt vmcnt(16)
  v_mfma_f32_16x16x32_bf16 a[0:3], v[208:211], v[160:163], a[0:3]
  s_add_u32 s19, s19, 1
  v_perm_b32 v176, v20, v16, s28
  v_mfma_f32_16x16x32_bf16 a[4:7], v[208:211], v[164:167], a[4:7]
  s_and_b32 s19, s19, 15
  v_perm_b32 v177, v28, v24, s28
  v_mfma_f32_16x16x32_bf16 a[8:11], v[208:211], v[168:171], a[8:11]
  s_mul_i32 s24, s19, 114688
  v_perm_b32 v178, v36, v32, s28
  v_mfma_f32_16x16x32_bf16 a[12:15], v[208:211], v[172:175], a[12:15]
  s_add_u32 s24, s24, s14
  v_perm_b32 v179, v44, v40, s28
  v_mfma_f32_16x16x32_bf16 a[16:19], v[212:215], v[160:163], a[16:19]
  s_lshl_b32 s25, s19, 10
  v_perm_b32 v180, v20, v16, s29
  v_mfma_f32_16x16x32_bf16 a[20:23], v[212:215], v[164:167], a[20:23]
  s_add_u32 s25, s25, s15
  v_perm_b32 v181, v28, v24, s29
  v_mfma_f32_16x16x32_bf16 a[24:27], v[212:215], v[168:171], a[24:27]
  buffer_load_dwordx4 v[80:83], v4, s[52:55], s24 offen
  v_perm_b32 v182, v36, v32, s29
  v_mfma_f32_16x16x32_bf16 a[28:31], v[212:215], v[172:175], a[28:31]
  s_add_u32 s24, s24, 3584
  v_perm_b32 v183, v44, v40, s29
  v_mfma_f32_16x16x32_bf16 a[32:35], v[216:219], v[160:163], a[32:35]
  buffer_load_dwordx4 v[84:87], v4, s[52:55], s24 offen
  v_perm_b32 v184, v21, v17, s28
  v_mfma_f32_16x16x32_bf16 a[36:39], v[216:219], v[164:167], a[36:39]
  s_add_u32 s24, s24, 3584
  v_perm_b32 v185, v29, v25, s28
  v_mfma_f32_16x16x32_bf16 a[40:43], v[216:219], v[168:171], a[40:43]
  buffer_load_dwordx4 v[88:91], v4, s[52:55], s24 offen
  v_perm_b32 v186, v37, v33, s28
  v_mfma_f32_16x16x32_bf16 a[44:47], v[216:219], v[172:175], a[44:47]
  s_add_u32 s24, s24, 3584
  v_perm_b32 v187, v45, v41, s28
  v_mfma_f32_16x16x32_bf16 a[48:51], v[220:223], v[160:163], a[48:51]
  buffer_load_dwordx4 v[92:95], v4, s[52:55], s24 offen
  v_perm_b32 v188, v21, v17, s29
  v_mfma_f32_16x16x32_bf16 a[52:55], v[220:223], v[164:167], a[52:55]
  s_add_u32 s24, s24, 3584
  v_perm_b32 v189, v29, v25, s29
  v_mfma_f32_16x16x32_bf16 a[56:59], v[220:223], v[168:171], a[56:59]
  buffer_load_dwordx4 v[96:99], v4, s[52:55], s24 offen
  v_perm_b32 v190, v37, v33, s29
  v_mfma_f32_16x16x32_bf16 a[60:63], v[220:223], v[172:175], a[60:63]
  s_add_u32 s24, s24, 3584
  v_perm_b32 v191, v45, v41, s29
  v_mfma_f32_16x16x32_bf16 a[64:67], v[224:227], v[160:163], a[64:67]
  buffer_load_dwordx4 v[100:103], v4, s[52:55], s24 offen
  v_perm_b32 v192, v22, v18, s28
  v_mfma_f32_16x16x32_bf16 a[68:71], v[224:227], v[164:167], a[68:71]
  s_add_u32 s24, s24, 3584
  v_perm_b32 v193, v30, v26, s28
  v_mfma_f32_16x16x32_bf16 a[72:75], v[224:227], v[168:171], a[72:75]
  buffer_load_dwordx4 v[104:107], v4, s[52:55], s24 offen
  v_perm_b32 v194, v38, v34, s28
  v_mfma_f32_16x16x32_bf16 a[76:79], v[224:227], v[172:175], a[76:79]
  s_add_u32 s24, s24, 3584
  v_perm_b32 v195, v46, v42, s28
  v_mfma_f32_16x16x32_bf16 a[80:83], v[228:231], v[160:163], a[80:83]
  buffer_load_dwordx4 v[108:111], v4, s[52:55], s24 offen
  v_perm_b32 v196, v22, v18, s29
  v_mfma_f32_16x16x32_bf16 a[84:87], v[228:231], v[164:167], a[84:87]
  buffer_load_dwordx4 v[144:147], v1, s[4:7], s25 offen sc1
  v_perm_b32 v197, v30, v26, s29
  v_mfma_f32_16x16x32_bf16 a[88:91], v[228:231], v[168:171], a[88:91]
  s_add_u32 s25, s25, s26
  v_perm_b32 v198, v38, v34, s29
  v_mfma_f32_16x16x32_bf16 a[92:95], v[228:231], v[172:175], a[92:95]
  buffer_load_dwordx4 v[148:151], v1, s[4:7], s25 offen sc1
  v_perm_b32 v199, v46, v42, s29
  v_mfma_f32_16x16x32_bf16 a[96:99], v[232:235], v[160:163], a[96:99]
  s_add_u32 s25, s25, s26
  v_perm_b32 v200, v23, v19, s28
  v_mfma_f32_16x16x32_bf16 a[100:103], v[232:235], v[164:167], a[100:103]
  buffer_load_dwordx4 v[152:155], v1, s[4:7], s25 offen sc1
  v_perm_b32 v201, v31, v27, s28
  v_mfma_f32_16x16x32_bf16 a[104:107], v[232:235], v[168:171], a[104:107]
  s_add_u32 s25, s25, s26
  v_perm_b32 v202, v39, v35, s28
  v_mfma_f32_16x16x32_bf16 a[108:111], v[232:235], v[172:175], a[108:111]
  buffer_load_dwordx4 v[156:159], v1, s[4:7], s25 offen sc1
  v_perm_b32 v203, v47, v43, s28
  v_mfma_f32_16x16x32_bf16 a[112:115], v[236:239], v[160:163], a[112:115]
  v_perm_b32 v204, v23, v19, s29
  v_mfma_f32_16x16x32_bf16 a[116:119], v[236:239], v[164:167], a[116:119]
  v_perm_b32 v205, v31, v27, s29
  v_mfma_f32_16x16x32_bf16 a[120:123], v[236:239], v[168:171], a[120:123]
  v_perm_b32 v206, v39, v35, s29
  v_mfma_f32_16x16x32_bf16 a[124:127], v[236:239], v[172:175], a[124:127]
  v_perm_b32 v207, v47, v43, s29
  s_waitcnt vmcnt(16)
  v_mfma_f32_16x16x32_bf16 a[0:3], v[176:179], v[112:115], a[0:3]
  s_add_u32 s19, s19, 1
  v_perm_b32 v208, v52, v48, s28
  v_mfma_f32_16x16x32_bf16 a[4:7], v[176:179], v[116:119], a[4:7]
  s_and_b32 s19, s19, 15
  v_perm_b32 v209, v60, v56, s28
  v_mfma_f32_16x16x32_bf16 a[8:11], v[176:179], v[120:123], a[8:11]
  s_mul_i32 s24, s19, 114688
  v_perm_b32 v210, v68, v64, s28
  v_mfma_f32_16x16x32_bf16 a[12:15], v[176:179], v[124:127], a[12:15]
  s_add_u32 s24, s24, s14
  v_perm_b32 v211, v76, v72, s28
  v_mfma_f32_16x16x32_bf16 a[16:19], v[180:183], v[112:115], a[16:19]
  s_lshl_b32 s25, s19, 10
  v_perm_b32 v212, v52, v48, s29
  v_mfma_f32_16x16x32_bf16 a[20:23], v[180:183], v[116:119], a[20:23]
  s_add_u32 s25, s25, s15
  v_perm_b32 v213, v60, v56, s29
  v_mfma_f32_16x16x32_bf16 a[24:27], v[180:183], v[120:123], a[24:27]
  buffer_load_dwordx4 v[16:19], v4, s[52:55], s24 offen
  v_perm_b32 v214, v68, v64, s29
  v_mfma_f32_16x16x32_bf16 a[28:31], v[180:183], v[124:127], a[28:31]
  s_add_u32 s24, s24, 3584
  v_perm_b32 v215, v76, v72, s29
  v_mfma_f32_16x16x32_bf16 a[32:35], v[184:187], v[112:115], a[32:35]
  buffer_load_dwordx4 v[20:23], v4, s[52:55], s24 offen
  v_perm_b32 v216, v53, v49, s28
  v_mfma_f32_16x16x32_bf16 a[36:39], v[184:187], v[116:119], a[36:39]
  s_add_u32 s24, s24, 3584
  v_perm_b32 v217, v61, v57, s28
  v_mfma_f32_16x16x32_bf16 a[40:43], v[184:187], v[120:123], a[40:43]
  buffer_load_dwordx4 v[24:27], v4, s[52:55], s24 offen
  v_perm_b32 v218, v69, v65, s28
  v_mfma_f32_16x16x32_bf16 a[44:47], v[184:187], v[124:127], a[44:47]
  s_add_u32 s24, s24, 3584
  v_perm_b32 v219, v77, v73, s28
  v_mfma_f32_16x16x32_bf16 a[48:51], v[188:191], v[112:115], a[48:51]
  buffer_load_dwordx4 v[28:31], v4, s[52:55], s24 offen
  v_perm_b32 v220, v53, v49, s29
  v_mfma_f32_16x16x32_bf16 a[52:55], v[188:191], v[116:119], a[52:55]
  s_add_u32 s24, s24, 3584
  v_perm_b32 v221, v61, v57, s29
  v_mfma_f32_16x16x32_bf16 a[56:59], v[188:191], v[120:123], a[56:59]
  buffer_load_dwordx4 v[32:35], v4, s[52:55], s24 offen
  v_perm_b32 v222, v69, v65, s29
  v_mfma_f32_16x16x32_bf16 a[60:63], v[188:191], v[124:127], a[60:63]
  s_add_u32 s24, s24, 3584
  v_perm_b32 v223, v77, v73, s29
  v_mfma_f32_16x16x32_bf16 a[64:67], v[192:195], v[112:115], a[64:67]
  buffer_load_dwordx4 v[36:39], v4, s[52:55], s24 offen
  v_perm_b32 v224, v54, v50, s28
  v_mfma_f32_16x16x32_bf16 a[68:71], v[192:195], v[116:119], a[68:71]
  s_add_u32 s24, s24, 3584
  v_perm_b32 v225, v62, v58, s28
  v_mfma_f32_16x16x32_bf16 a[72:75], v[192:195], v[120:123], a[72:75]
  buffer_load_dwordx4 v[40:43], v4, s[52:55], s24 offen
  v_perm_b32 v226, v70, v66, s28
  v_mfma_f32_16x16x32_bf16 a[76:79], v[192:195], v[124:127], a[76:79]
  s_add_u32 s24, s24, 3584
  v_perm_b32 v227, v78, v74, s28
  v_mfma_f32_16x16x32_bf16 a[80:83], v[196:199], v[112:115], a[80:83]
  buffer_load_dwordx4 v[44:47], v4, s[52:55], s24 offen
  v_perm_b32 v228, v54, v50, s29
  v_mfma_f32_16x16x32_bf16 a[84:87], v[196:199], v[116:119], a[84:87]
  buffer_load_dwordx4 v[160:163], v1, s[4:7], s25 offen sc1
  v_perm_b32 v229, v62, v58, s29
  v_mfma_f32_16x16x32_bf16 a[88:91], v[196:199], v[120:123], a[88:91]
  s_add_u32 s25, s25, s26
  v_perm_b32 v230, v70, v66, s29
  v_mfma_f32_16x16x32_bf16 a[92:95], v[196:199], v[124:127], a[92:95]
  buffer_load_dwordx4 v[164:167], v1, s[4:7], s25 offen sc1
  v_perm_b32 v231, v78, v74, s29
  v_mfma_f32_16x16x32_bf16 a[96:99], v[200:203], v[112:115], a[96:99]
  s_add_u32 s25, s25, s26
  v_perm_b32 v232, v55, v51, s28
  v_mfma_f32_16x16x32_bf16 a[100:103], v[200:203], v[116:119], a[100:103]
  buffer_load_dwordx4 v[168:171], v1, s[4:7], s25 offen sc1
  v_perm_b32 v233, v63, v59, s28
  v_mfma_f32_16x16x32_bf16 a[104:107], v[200:203], v[120:123], a[104:107]
  s_add_u32 s25, s25, s26
  v_perm_b32 v234, v71, v67, s28
  v_mfma_f32_16x16x32_bf16 a[108:111], v[200:203], v[124:127], a[108:111]
  buffer_load_dwordx4 v[172:175], v1, s[4:7], s25 offen sc1
  v_perm_b32 v235, v79, v75, s28
  v_mfma_f32_16x16x32_bf16 a[112:115], v[204:207], v[112:115], a[112:115]
  v_perm_b32 v236, v55, v51, s29
  v_mfma_f32_16x16x32_bf16 a[116:119], v[204:207], v[116:119], a[116:119]
  v_perm_b32 v237, v63, v59, s29
  v_mfma_f32_16x16x32_bf16 a[120:123], v[204:207], v[120:123], a[120:123]
  v_perm_b32 v238, v71, v67, s29
  v_mfma_f32_16x16x32_bf16 a[124:127], v[204:207], v[124:127], a[124:127]
  v_perm_b32 v239, v79, v75, s29
  s_waitcnt vmcnt(16)
  v_mfma_f32_16x16x32_bf16 a[0:3], v[208:211], v[128:131], a[0:3]
  v_perm_b32 v176, v84, v80, s28
  v_mfma_f32_16x16x32_bf16 a[4:7], v[208:211], v[132:135], a[4:7]
  v_perm_b32 v177, v92, v88, s28
  v_mfma_f32_16x16x32_bf16 a[8:11], v[208:211], v[136:139], a[8:11]
  v_perm_b32 v178, v100, v96, s28
  v_mfma_f32_16x16x32_bf16 a[12:15], v[208:211], v[140:143], a[12:15]
  v_perm_b32 v179, v108, v104, s28
  v_mfma_f32_16x16x32_bf16 a[16:19], v[212:215], v[128:131], a[16:19]
  v_perm_b32 v180, v84, v80, s29
  v_mfma_f32_16x16x32_bf16 a[20:23], v[212:215], v[132:135], a[20:23]
  v_perm_b32 v181, v92, v88, s29
  v_mfma_f32_16x16x32_bf16 a[24:27], v[212:215], v[136:139], a[24:27]
  v_perm_b32 v182, v100, v96, s29
  v_mfma_f32_16x16x32_bf16 a[28:31], v[212:215], v[140:143], a[28:31]
  v_perm_b32 v183, v108, v104, s29
  v_mfma_f32_16x16x32_bf16 a[32:35], v[216:219], v[128:131], a[32:35]
  v_perm_b32 v184, v85, v81, s28
  v_mfma_f32_16x16x32_bf16 a[36:39], v[216:219], v[132:135], a[36:39]
  v_perm_b32 v185, v93, v89, s28
  v_mfma_f32_16x16x32_bf16 a[40:43], v[216:219], v[136:139], a[40:43]
  v_perm_b32 v186, v101, v97, s28
  v_mfma_f32_16x16x32_bf16 a[44:47], v[216:219], v[140:143], a[44:47]
  v_perm_b32 v187, v109, v105, s28
  v_mfma_f32_16x16x32_bf16 a[48:51], v[220:223], v[128:131], a[48:51]
  v_perm_b32 v188, v85, v81, s29
  v_mfma_f32_16x16x32_bf16 a[52:55], v[220:223], v[132:135], a[52:55]
  v_perm_b32 v189, v93, v89, s29
  v_mfma_f32_16x16x32_bf16 a[56:59], v[220:223], v[136:139], a[56:59]
  v_perm_b32 v190, v101, v97, s29
  v_mfma_f32_16x16x32_bf16 a[60:63], v[220:223], v[140:143], a[60:63]
  v_perm_b32 v191, v109, v105, s29
  v_mfma_f32_16x16x32_bf16 a[64:67], v[224:227], v[128:131], a[64:67]
  v_perm_b32 v192, v86, v82, s28
  v_mfma_f32_16x16x32_bf16 a[68:71], v[224:227], v[132:135], a[68:71]
  v_perm_b32 v193, v94, v90, s28
  v_mfma_f32_16x16x32_bf16 a[72:75], v[224:227], v[136:139], a[72:75]
  v_perm_b32 v194, v102, v98, s28
  v_mfma_f32_16x16x32_bf16 a[76:79], v[224:227], v[140:143], a[76:79]
  v_perm_b32 v195, v110, v106, s28
  v_mfma_f32_16x16x32_bf16 a[80:83], v[228:231], v[128:131], a[80:83]
  v_perm_b32 v196, v86, v82, s29
  v_mfma_f32_16x16x32_bf16 a[84:87], v[228:231], v[132:135], a[84:87]
  v_perm_b32 v197, v94, v90, s29
  v_mfma_f32_16x16x32_bf16 a[88:91], v[228:231], v[136:139], a[88:91]
  v_perm_b32 v198, v102, v98, s29
  v_mfma_f32_16x16x32_bf16 a[92:95], v[228:231], v[140:143], a[92:95]
  v_perm_b32 v199, v110, v106, s29
  v_mfma_f32_16x16x32_bf16 a[96:99], v[232:235], v[128:131], a[96:99]
  v_perm_b32 v200, v87, v83, s28
  v_mfma_f32_16x16x32_bf16 a[100:103], v[232:235], v[132:135], a[100:103]
  v_perm_b32 v201, v95, v91, s28
  v_mfma_f32_16x16x32_bf16 a[104:107], v[232:235], v[136:139], a[104:107]
  v_perm_b32 v202, v103, v99, s28
  v_mfma_f32_16x16x32_bf16 a[108:111], v[232:235], v[140:143], a[108:111]
  v_perm_b32 v203, v111, v107, s28
  v_mfma_f32_16x16x32_bf16 a[112:115], v[236:239], v[128:131], a[112:115]
  v_perm_b32 v204, v87, v83, s29
  v_mfma_f32_16x16x32_bf16 a[116:119], v[236:239], v[132:135], a[116:119]
  v_perm_b32 v205, v95, v91, s29
  v_mfma_f32_16x16x32_bf16 a[120:123], v[236:239], v[136:139], a[120:123]
  v_perm_b32 v206, v103, v99, s29
  v_mfma_f32_16x16x32_bf16 a[124:127], v[236:239], v[140:143], a[124:127]
  v_perm_b32 v207, v111, v107, s29
  s_waitcnt vmcnt(4)
  v_mfma_f32_16x16x32_bf16 a[0:3], v[176:179], v[144:147], a[0:3]
  v_perm_b32 v208, v20, v16, s28
  v_mfma_f32_16x16x32_bf16 a[4:7], v[176:179], v[148:151], a[4:7]
  v_perm_b32 v209, v28, v24, s28
  v_mfma_f32_16x16x32_bf16 a[8:11], v[176:179], v[152:155], a[8:11]
  v_perm_b32 v210, v36, v32, s28
  v_mfma_f32_16x16x32_bf16 a[12:15], v[176:179], v[156:159], a[12:15]
  v_perm_b32 v211, v44, v40, s28
  v_mfma_f32_16x16x32_bf16 a[16:19], v[180:183], v[144:147], a[16:19]
  v_perm_b32 v212, v20, v16, s29
  v_mfma_f32_16x16x32_bf16 a[20:23], v[180:183], v[148:151], a[20:23]
  v_perm_b32 v213, v28, v24, s29
  v_mfma_f32_16x16x32_bf16 a[24:27], v[180:183], v[152:155], a[24:27]
  v_perm_b32 v214, v36, v32, s29
  v_mfma_f32_16x16x32_bf16 a[28:31], v[180:183], v[156:159], a[28:31]
  v_perm_b32 v215, v44, v40, s29
  v_mfma_f32_16x16x32_bf16 a[32:35], v[184:187], v[144:147], a[32:35]
  v_perm_b32 v216, v21, v17, s28
  v_mfma_f32_16x16x32_bf16 a[36:39], v[184:187], v[148:151], a[36:39]
  v_perm_b32 v217, v29, v25, s28
  v_mfma_f32_16x16x32_bf16 a[40:43], v[184:187], v[152:155], a[40:43]
  v_perm_b32 v218, v37, v33, s28
  v_mfma_f32_16x16x32_bf16 a[44:47], v[184:187], v[156:159], a[44:47]
  v_perm_b32 v219, v45, v41, s28
  v_mfma_f32_16x16x32_bf16 a[48:51], v[188:191], v[144:147], a[48:51]
  v_perm_b32 v220, v21, v17, s29
  v_mfma_f32_16x16x32_bf16 a[52:55], v[188:191], v[148:151], a[52:55]
  v_perm_b32 v221, v29, v25, s29
  v_mfma_f32_16x16x32_bf16 a[56:59], v[188:191], v[152:155], a[56:59]
  v_perm_b32 v222, v37, v33, s29
  v_mfma_f32_16x16x32_bf16 a[60:63], v[188:191], v[156:159], a[60:63]
  v_perm_b32 v223, v45, v41, s29
  v_mfma_f32_16x16x32_bf16 a[64:67], v[192:195], v[144:147], a[64:67]
  v_perm_b32 v224, v22, v18, s28
  v_mfma_f32_16x16x32_bf16 a[68:71], v[192:195], v[148:151], a[68:71]
  v_perm_b32 v225, v30, v26, s28
  v_mfma_f32_16x16x32_bf16 a[72:75], v[192:195], v[152:155], a[72:75]
  v_perm_b32 v226, v38, v34, s28
  v_mfma_f32_16x16x32_bf16 a[76:79], v[192:195], v[156:159], a[76:79]
  v_perm_b32 v227, v46, v42, s28
  v_mfma_f32_16x16x32_bf16 a[80:83], v[196:199], v[144:147], a[80:83]
  v_perm_b32 v228, v22, v18, s29
  v_mfma_f32_16x16x32_bf16 a[84:87], v[196:199], v[148:151], a[84:87]
  v_perm_b32 v229, v30, v26, s29
  v_mfma_f32_16x16x32_bf16 a[88:91], v[196:199], v[152:155], a[88:91]
  v_perm_b32 v230, v38, v34, s29
  v_mfma_f32_16x16x32_bf16 a[92:95], v[196:199], v[156:159], a[92:95]
  v_perm_b32 v231, v46, v42, s29
  v_mfma_f32_16x16x32_bf16 a[96:99], v[200:203], v[144:147], a[96:99]
  v_perm_b32 v232, v23, v19, s28
  v_mfma_f32_16x16x32_bf16 a[100:103], v[200:203], v[148:151], a[100:103]
  v_perm_b32 v233, v31, v27, s28
  v_mfma_f32_16x16x32_bf16 a[104:107], v[200:203], v[152:155], a[104:107]
  v_perm_b32 v234, v39, v35, s28
  v_mfma_f32_16x16x32_bf16 a[108:111], v[200:203], v[156:159], a[108:111]
  v_perm_b32 v235, v47, v43, s28
  v_mfma_f32_16x16x32_bf16 a[112:115], v[204:207], v[144:147], a[112:115]
  v_perm_b32 v236, v23, v19, s29
  v_mfma_f32_16x16x32_bf16 a[116:119], v[204:207], v[148:151], a[116:119]
  v_perm_b32 v237, v31, v27, s29
  v_mfma_f32_16x16x32_bf16 a[120:123], v[204:207], v[152:155], a[120:123]
  v_perm_b32 v238, v39, v35, s29
  v_mfma_f32_16x16x32_bf16 a[124:127], v[204:207], v[156:159], a[124:127]
  v_perm_b32 v239, v47, v43, s29
  s_waitcnt vmcnt(0)
  v_mfma_f32_16x16x32_bf16 a[0:3], v[208:211], v[160:163], a[0:3]
  v_mfma_f32_16x16x32_bf16 a[4:7], v[208:211], v[164:167], a[4:7]
  v_mfma_f32_16x16x32_bf16 a[8:11], v[208:211], v[168:171], a[8:11]
  v_mfma_f32_16x16x32_bf16 a[12:15], v[208:211], v[172:175], a[12:15]
  v_mfma_f32_16x16x32_bf16 a[16:19], v[212:215], v[160:163], a[16:19]
  v_mfma_f32_16x16x32_bf16 a[20:23], v[212:215], v[164:167], a[20:23]
  v_mfma_f32_16x16x32_bf16 a[24:27], v[212:215], v[168:171], a[24:27]
  v_mfma_f32_16x16x32_bf16 a[28:31], v[212:215], v[172:175], a[28:31]
  v_mfma_f32_16x16x32_bf16 a[32:35], v[216:219], v[160:163], a[32:35]
  v_mfma_f32_16x16x32_bf16 a[36:39], v[216:219], v[164:167], a[36:39]
  v_mfma_f32_16x16x32_bf16 a[40:43], v[216:219], v[168:171], a[40:43]
  v_mfma_f32_16x16x32_bf16 a[44:47], v[216:219], v[172:175], a[44:47]
  v_mfma_f32_16x16x32_bf16 a[48:51], v[220:223], v[160:163], a[48:51]
  v_mfma_f32_16x16x32_bf16 a[52:55], v[220:223], v[164:167], a[52:55]
  v_mfma_f32_16x16x32_bf16 a[56:59], v[220:223], v[168:171], a[56:59]
  v_mfma_f32_16x16x32_bf16 a[60:63], v[220:223], v[172:175], a[60:63]
  v_mfma_f32_16x16x32_bf16 a[64:67], v[224:227], v[160:163], a[64:67]
  v_mfma_f32_16x16x32_bf16 a[68:71], v[224:227], v[164:167], a[68:71]
  v_mfma_f32_16x16x32_bf16 a[72:75], v[224:227], v[168:171], a[72:75]
  v_mfma_f32_16x16x32_bf16 a[76:79], v[224:227], v[172:175], a[76:79]
  v_mfma_f32_16x16x32_bf16 a[80:83], v[228:231], v[160:163], a[80:83]
  v_mfma_f32_16x16x32_bf16 a[84:87], v[228:231], v[164:167], a[84:87]
  v_mfma_f32_16x16x32_bf16 a[88:91], v[228:231], v[168:171], a[88:91]
  v_mfma_f32_16x16x32_bf16 a[92:95], v[228:231], v[172:175], a[92:95]
  v_mfma_f32_16x16x32_bf16 a[96:99], v[232:235], v[160:163], a[96:99]
  v_mfma_f32_16x16x32_bf16 a[100:103], v[232:235], v[164:167], a[100:103]
  v_mfma_f32_16x16x32_bf16 a[104:107], v[232:235], v[168:171], a[104:107]
  v_mfma_f32_16x16x32_bf16 a[108:111], v[232:235], v[172:175], a[108:111]
  v_mfma_f32_16x16x32_bf16 a[112:115], v[236:239], v[160:163], a[112:115]
  v_mfma_f32_16x16x32_bf16 a[116:119], v[236:239], v[164:167], a[116:119]
  v_mfma_f32_16x16x32_bf16 a[120:123], v[236:239], v[168:171], a[120:123]
  v_mfma_f32_16x16x32_bf16 a[124:127], v[236:239], v[172:175], a[124:127]
  s_lshl_b32 s24, s13, 13
  v_add_u32 v8, s24, v1
  v_add_u32 v9, 0x10000, v8
  s_lshl_b32 s24, s13, 15
  v_add_u32 v10, s24, v1
  ds_write_b128 v8, a[0:3] offset:0
  ds_write_b128 v8, a[16:19] offset:1024
  ds_write_b128 v8, a[32:35] offset:2048
  ds_write_b128 v8, a[48:51] offset:3072
  ds_write_b128 v8, a[64:67] offset:4096
  ds_write_b128 v8, a[80:83] offset:5120
  ds_write_b128 v8, a[96:99] offset:6144
  ds_write_b128 v8, a[112:115] offset:7168
  s_waitcnt lgkmcnt(0)
  ds_write_b128 v8, a[4:7] offset:32768
  ds_write_b128 v8, a[20:23] offset:33792
  ds_write_b128 v8, a[36:39] offset:34816
  ds_write_b128 v8, a[52:55] offset:35840
  ds_write_b128 v8, a[68:71] offset:36864
  ds_write_b128 v8, a[84:87] offset:37888
  ds_write_b128 v8, a[100:103] offset:38912
  ds_write_b128 v8, a[116:119] offset:39936
  s_waitcnt lgkmcnt(0)
  ds_write_b128 v9, a[8:11] offset:0
  ds_write_b128 v9, a[24:27] offset:1024
  ds_write_b128 v9, a[40:43] offset:2048
  ds_write_b128 v9, a[56:59] offset:3072
  ds_write_b128 v9, a[72:75] offset:4096
  ds_write_b128 v9, a[88:91] offset:5120
  ds_write_b128 v9, a[104:107] offset:6144
  ds_write_b128 v9, a[120:123] offset:7168
  s_waitcnt lgkmcnt(0)
  ds_write_b128 v9, a[12:15] offset:32768
  ds_write_b128 v9, a[28:31] offset:33792
  ds_write_b128 v9, a[44:47] offset:34816
  ds_write_b128 v9, a[60:63] offset:35840
  ds_write_b128 v9, a[76:79] offset:36864
  ds_write_b128 v9, a[92:95] offset:37888
  ds_write_b128 v9, a[108:111] offset:38912
  ds_write_b128 v9, a[124:127] offset:39936
  s_waitcnt lgkmcnt(0)
  s_barrier
  ds_read_b128 v[16:19], v10 offset:0
  ds_read_b128 v[20:23], v10 offset:1024
  ds_read_b128 v[24:27], v10 offset:2048
  ds_read_b128 v[28:31], v10 offset:3072
  ds_read_b128 v[32:35], v10 offset:4096
  ds_read_b128 v[36:39], v10 offset:5120
  ds_read_b128 v[40:43], v10 offset:6144
  ds_read_b128 v[44:47], v10 offset:7168
  s_waitcnt lgkmcnt(0)
  ds_read_b128 v[48:51], v10 offset:8192
  ds_read_b128 v[52:55], v10 offset:9216
  ds_read_b128 v[56:59], v10 offset:10240
  ds_read_b128 v[60:63], v10 offset:11264
  ds_read_b128 v[64:67], v10 offset:12288
  ds_read_b128 v[68:71], v10 offset:13312
  ds_read_b128 v[72:75], v10 offset:14336
  ds_read_b128 v[76:79], v10 offset:15360
  s_waitcnt lgkmcnt(0)
  ds_read_b128 v[80:83], v10 offset:16384
  ds_read_b128 v[84:87], v10 offset:17408
  ds_read_b128 v[88:91], v10 offset:18432
  ds_read_b128 v[92:95], v10 offset:19456
  ds_read_b128 v[96:99], v10 offset:20480
  ds_read_b128 v[100:103], v10 offset:21504
  ds_read_b128 v[104:107], v10 offset:22528
  ds_read_b128 v[108:111], v10 offset:23552
  s_waitcnt lgkmcnt(0)
  ds_read_b128 v[112:115], v10 offset:24576
  ds_read_b128 v[116:119], v10 offset:25600
  ds_read_b128 v[120:123], v10 offset:26624
  ds_read_b128 v[124:127], v10 offset:27648
  ds_read_b128 v[128:131], v10 offset:28672
  ds_read_b128 v[132:135], v10 offset:29696
  ds_read_b128 v[136:139], v10 offset:30720
  ds_read_b128 v[140:143], v10 offset:31744
  s_waitcnt lgkmcnt(0)
  v_add_f32 v16, v16, v48
  v_add_f32 v80, v80, v112
  v_add_f32 v16, v16, v80
  v_add_f32 v17, v17, v49
  v_add_f32 v81, v81, v113
  v_add_f32 v17, v17, v81
  v_add_f32 v18, v18, v50
  v_add_f32 v82, v82, v114
  v_add_f32 v18, v18, v82
  v_add_f32 v19, v19, v51
  v_add_f32 v83, v83, v115
  v_add_f32 v19, v19, v83
  v_add_f32 v20, v20, v52
  v_add_f32 v84, v84, v116
  v_add_f32 v20, v20, v84
  v_add_f32 v21, v21, v53
  v_add_f32 v85, v85, v117
  v_add_f32 v21, v21, v85
  v_add_f32 v22, v22, v54
  v_add_f32 v86, v86, v118
  v_add_f32 v22, v22, v86
  v_add_f32 v23, v23, v55
  v_add_f32 v87, v87, v119
  v_add_f32 v23, v23, v87
  v_add_f32 v24, v24, v56
  v_add_f32 v88, v88, v120
  v_add_f32 v24, v24, v88
  v_add_f32 v25, v25, v57
  v_add_f32 v89, v89, v121
  v_add_f32 v25, v25, v89
  v_add_f32 v26, v26, v58
  v_add_f32 v90, v90, v122
  v_add_f32 v26, v26, v90
  v_add_f32 v27, v27, v59
  v_add_f32 v91, v91, v123
  v_add_f32 v27, v27, v91
  v_add_f32 v28, v28, v60
  v_add_f32 v92, v92, v124
  v_add_f32 v28, v28, v92
  v_add_f32 v29, v29, v61
  v_add_f32 v93, v93, v125
  v_add_f32 v29, v29, v93
  v_add_f32 v30, v30, v62
  v_add_f32 v94, v94, v126
  v_add_f32 v30, v30, v94
  v_add_f32 v31, v31, v63
  v_add_f32 v95, v95, v127
  v_add_f32 v31, v31, v95
  v_add_f32 v32, v32, v64
  v_add_f32 v96, v96, v128
  v_add_f32 v32, v32, v96
  v_add_f32 v33, v33, v65
  v_add_f32 v97, v97, v129
  v_add_f32 v33, v33, v97
  v_add_f32 v34, v34, v66
  v_add_f32 v98, v98, v130
  v_add_f32 v34, v34, v98
  v_add_f32 v35, v35, v67
  v_add_f32 v99, v99, v131
  v_add_f32 v35, v35, v99
  v_add_f32 v36, v36, v68
  v_add_f32 v100, v100, v132
  v_add_f32 v36, v36, v100
  v_add_f32 v37, v37, v69
  v_add_f32 v101, v101, v133
  v_add_f32 v37, v37, v101
  v_add_f32 v38, v38, v70
  v_add_f32 v102, v102, v134
  v_add_f32 v38, v38, v102
  v_add_f32 v39, v39, v71
  v_add_f32 v103, v103, v135
  v_add_f32 v39, v39, v103
  v_add_f32 v40, v40, v72
  v_add_f32 v104, v104, v136
  v_add_f32 v40, v40, v104
  v_add_f32 v41, v41, v73
  v_add_f32 v105, v105, v137
  v_add_f32 v41, v41, v105
  v_add_f32 v42, v42, v74
  v_add_f32 v106, v106, v138
  v_add_f32 v42, v42, v106
  v_add_f32 v43, v43, v75
  v_add_f32 v107, v107, v139
  v_add_f32 v43, v43, v107
  v_add_f32 v44, v44, v76
  v_add_f32 v108, v108, v140
  v_add_f32 v44, v44, v108
  v_add_f32 v45, v45, v77
  v_add_f32 v109, v109, v141
  v_add_f32 v45, v45, v109
  v_add_f32 v46, v46, v78
  v_add_f32 v110, v110, v142
  v_add_f32 v46, v46, v110
  v_add_f32 v47, v47, v79
  v_add_f32 v111, v111, v143
  v_add_f32 v47, v47, v111
  s_mov_b32 s26, 0xc0135761
  v_mov_b32 v5, 0xbdd2d3e8
  s_and_b32 s24, s12, 7
  s_lshl_b32 s24, s24, 2
  s_add_u32 s24, s24, s13
  s_mul_i32 s24, s24, 57344
  s_lshr_b32 s25, s12, 3
  s_lshl_b32 s25, s25, 12
  s_add_u32 s24, s24, s25
  s_add_u32 s24, s24, 4194304
  v_lshlrev_b32 v48, 16, v240
  v_and_b32 v49, 0xffff0000, v240
  v_lshlrev_b32 v50, 16, v241
  v_and_b32 v51, 0xffff0000, v241
  v_lshlrev_b32 v52, 16, v242
  v_and_b32 v53, 0xffff0000, v242
  v_lshlrev_b32 v54, 16, v243
  v_and_b32 v55, 0xffff0000, v243
  v_add_f32 v48, v48, v16
  v_add_f32 v49, v49, v20
  v_add_f32 v50, v50, v24
  v_add_f32 v51, v51, v28
  v_add_f32 v52, v52, v32
  v_add_f32 v53, v53, v36
  v_add_f32 v54, v54, v40
  v_add_f32 v55, v55, v44
  v_mul_f32 v56, v48, v48
  v_mul_f32 v57, v49, v49
  v_mul_f32 v58, v50, v50
  v_mul_f32 v59, v51, v51
  v_mul_f32 v60, v52, v52
  v_mul_f32 v61, v53, v53
  v_mul_f32 v62, v54, v54
  v_mul_f32 v63, v55, v55
  v_fma_f32 v56, v56, v5, s26
  v_fma_f32 v57, v57, v5, s26
  v_fma_f32 v58, v58, v5, s26
  v_fma_f32 v59, v59, v5, s26
  v_fma_f32 v60, v60, v5, s26
  v_fma_f32 v61, v61, v5, s26
  v_fma_f32 v62, v62, v5, s26
  v_fma_f32 v63, v63, v5, s26
  v_mul_f32 v56, v56, v48
  v_mul_f32 v57, v57, v49
  v_mul_f32 v58, v58, v50
  v_mul_f32 v59, v59, v51
  v_mul_f32 v60, v60, v52
  v_mul_f32 v61, v61, v53
  v_mul_f32 v62, v62, v54
  v_mul_f32 v63, v63, v55
  v_exp_f32 v56, v56
  v_exp_f32 v57, v57
  v_exp_f32 v58, v58
  v_exp_f32 v59, v59
  v_exp_f32 v60, v60
  v_exp_f32 v61, v61
  v_exp_f32 v62, v62
  v_exp_f32 v63, v63
  v_add_f32 v56, 1.0, v56
  v_add_f32 v57, 1.0, v57
  v_add_f32 v58, 1.0, v58
  v_add_f32 v59, 1.0, v59
  v_add_f32 v60, 1.0, v60
  v_add_f32 v61, 1.0, v61
  v_add_f32 v62, 1.0, v62
  v_add_f32 v63, 1.0, v63
  v_rcp_f32 v56, v56
  v_rcp_f32 v57, v57
  v_rcp_f32 v58, v58
  v_rcp_f32 v59, v59
  v_rcp_f32 v60, v60
  v_rcp_f32 v61, v61
  v_rcp_f32 v62, v62
  v_rcp_f32 v63, v63
  v_mul_f32 v48, v48, v56
  v_mul_f32 v49, v49, v57
  v_mul_f32 v50, v50, v58
  v_mul_f32 v51, v51, v59
  v_mul_f32 v52, v52, v60
  v_mul_f32 v53, v53, v61
  v_mul_f32 v54, v54, v62
  v_mul_f32 v55, v55, v63
  v_cvt_pk_bf16_f32 v64, v48, v49
  v_cvt_pk_bf16_f32 v65, v50, v51
  v_cvt_pk_bf16_f32 v66, v52, v53
  v_cvt_pk_bf16_f32 v67, v54, v55
  buffer_store_dwordx4 v[64:67], v1, s[4:7], s24 offen offset:0 sc1
  v_lshlrev_b32 v48, 16, v244
  v_and_b32 v49, 0xffff0000, v244
  v_lshlrev_b32 v50, 16, v245
  v_and_b32 v51, 0xffff0000, v245
  v_lshlrev_b32 v52, 16, v246
  v_and_b32 v53, 0xffff0000, v246
  v_lshlrev_b32 v54, 16, v247
  v_and_b32 v55, 0xffff0000, v247
  v_add_f32 v48, v48, v17
  v_add_f32 v49, v49, v21
  v_add_f32 v50, v50, v25
  v_add_f32 v51, v51, v29
  v_add_f32 v52, v52, v33
  v_add_f32 v53, v53, v37
  v_add_f32 v54, v54, v41
  v_add_f32 v55, v55, v45
  v_mul_f32 v56, v48, v48
  v_mul_f32 v57, v49, v49
  v_mul_f32 v58, v50, v50
  v_mul_f32 v59, v51, v51
  v_mul_f32 v60, v52, v52
  v_mul_f32 v61, v53, v53
  v_mul_f32 v62, v54, v54
  v_mul_f32 v63, v55, v55
  v_fma_f32 v56, v56, v5, s26
  v_fma_f32 v57, v57, v5, s26
  v_fma_f32 v58, v58, v5, s26
  v_fma_f32 v59, v59, v5, s26
  v_fma_f32 v60, v60, v5, s26
  v_fma_f32 v61, v61, v5, s26
  v_fma_f32 v62, v62, v5, s26
  v_fma_f32 v63, v63, v5, s26
  v_mul_f32 v56, v56, v48
  v_mul_f32 v57, v57, v49
  v_mul_f32 v58, v58, v50
  v_mul_f32 v59, v59, v51
  v_mul_f32 v60, v60, v52
  v_mul_f32 v61, v61, v53
  v_mul_f32 v62, v62, v54
  v_mul_f32 v63, v63, v55
  v_exp_f32 v56, v56
  v_exp_f32 v57, v57
  v_exp_f32 v58, v58
  v_exp_f32 v59, v59
  v_exp_f32 v60, v60
  v_exp_f32 v61, v61
  v_exp_f32 v62, v62
  v_exp_f32 v63, v63
  v_add_f32 v56, 1.0, v56
  v_add_f32 v57, 1.0, v57
  v_add_f32 v58, 1.0, v58
  v_add_f32 v59, 1.0, v59
  v_add_f32 v60, 1.0, v60
  v_add_f32 v61, 1.0, v61
  v_add_f32 v62, 1.0, v62
  v_add_f32 v63, 1.0, v63
  v_rcp_f32 v56, v56
  v_rcp_f32 v57, v57
  v_rcp_f32 v58, v58
  v_rcp_f32 v59, v59
  v_rcp_f32 v60, v60
  v_rcp_f32 v61, v61
  v_rcp_f32 v62, v62
  v_rcp_f32 v63, v63
  v_mul_f32 v48, v48, v56
  v_mul_f32 v49, v49, v57
  v_mul_f32 v50, v50, v58
  v_mul_f32 v51, v51, v59
  v_mul_f32 v52, v52, v60
  v_mul_f32 v53, v53, v61
  v_mul_f32 v54, v54, v62
  v_mul_f32 v55, v55, v63
  v_cvt_pk_bf16_f32 v68, v48, v49
  v_cvt_pk_bf16_f32 v69, v50, v51
  v_cvt_pk_bf16_f32 v70, v52, v53
  v_cvt_pk_bf16_f32 v71, v54, v55
  buffer_store_dwordx4 v[68:71], v1, s[4:7], s24 offen offset:1024 sc1
  v_lshlrev_b32 v48, 16, v248
  v_and_b32 v49, 0xffff0000, v248
  v_lshlrev_b32 v50, 16, v249
  v_and_b32 v51, 0xffff0000, v249
  v_lshlrev_b32 v52, 16, v250
  v_and_b32 v53, 0xffff0000, v250
  v_lshlrev_b32 v54, 16, v251
  v_and_b32 v55, 0xffff0000, v251
  v_add_f32 v48, v48, v18
  v_add_f32 v49, v49, v22
  v_add_f32 v50, v50, v26
  v_add_f32 v51, v51, v30
  v_add_f32 v52, v52, v34
  v_add_f32 v53, v53, v38
  v_add_f32 v54, v54, v42
  v_add_f32 v55, v55, v46
  v_mul_f32 v56, v48, v48
  v_mul_f32 v57, v49, v49
  v_mul_f32 v58, v50, v50
  v_mul_f32 v59, v51, v51
  v_mul_f32 v60, v52, v52
  v_mul_f32 v61, v53, v53
  v_mul_f32 v62, v54, v54
  v_mul_f32 v63, v55, v55
  v_fma_f32 v56, v56, v5, s26
  v_fma_f32 v57, v57, v5, s26
  v_fma_f32 v58, v58, v5, s26
  v_fma_f32 v59, v59, v5, s26
  v_fma_f32 v60, v60, v5, s26
  v_fma_f32 v61, v61, v5, s26
  v_fma_f32 v62, v62, v5, s26
  v_fma_f32 v63, v63, v5, s26
  v_mul_f32 v56, v56, v48
  v_mul_f32 v57, v57, v49
  v_mul_f32 v58, v58, v50
  v_mul_f32 v59, v59, v51
  v_mul_f32 v60, v60, v52
  v_mul_f32 v61, v61, v53
  v_mul_f32 v62, v62, v54
  v_mul_f32 v63, v63, v55
  v_exp_f32 v56, v56
  v_exp_f32 v57, v57
  v_exp_f32 v58, v58
  v_exp_f32 v59, v59
  v_exp_f32 v60, v60
  v_exp_f32 v61, v61
  v_exp_f32 v62, v62
  v_exp_f32 v63, v63
  v_add_f32 v56, 1.0, v56
  v_add_f32 v57, 1.0, v57
  v_add_f32 v58, 1.0, v58
  v_add_f32 v59, 1.0, v59
  v_add_f32 v60, 1.0, v60
  v_add_f32 v61, 1.0, v61
  v_add_f32 v62, 1.0, v62
  v_add_f32 v63, 1.0, v63
  v_rcp_f32 v56, v56
  v_rcp_f32 v57, v57
  v_rcp_f32 v58, v58
  v_rcp_f32 v59, v59
  v_rcp_f32 v60, v60
  v_rcp_f32 v61, v61
  v_rcp_f32 v62, v62
  v_rcp_f32 v63, v63
  v_mul_f32 v48, v48, v56
  v_mul_f32 v49, v49, v57
  v_mul_f32 v50, v50, v58
  v_mul_f32 v51, v51, v59
  v_mul_f32 v52, v52, v60
  v_mul_f32 v53, v53, v61
  v_mul_f32 v54, v54, v62
  v_mul_f32 v55, v55, v63
  v_cvt_pk_bf16_f32 v72, v48, v49
  v_cvt_pk_bf16_f32 v73, v50, v51
  v_cvt_pk_bf16_f32 v74, v52, v53
  v_cvt_pk_bf16_f32 v75, v54, v55
  buffer_store_dwordx4 v[72:75], v1, s[4:7], s24 offen offset:2048 sc1
  v_lshlrev_b32 v48, 16, v252
  v_and_b32 v49, 0xffff0000, v252
  v_lshlrev_b32 v50, 16, v253
  v_and_b32 v51, 0xffff0000, v253
  v_lshlrev_b32 v52, 16, v254
  v_and_b32 v53, 0xffff0000, v254
  v_lshlrev_b32 v54, 16, v255
  v_and_b32 v55, 0xffff0000, v255
  v_add_f32 v48, v48, v19
  v_add_f32 v49, v49, v23
  v_add_f32 v50, v50, v27
  v_add_f32 v51, v51, v31
  v_add_f32 v52, v52, v35
  v_add_f32 v53, v53, v39
  v_add_f32 v54, v54, v43
  v_add_f32 v55, v55, v47
  v_mul_f32 v56, v48, v48
  v_mul_f32 v57, v49, v49
  v_mul_f32 v58, v50, v50
  v_mul_f32 v59, v51, v51
  v_mul_f32 v60, v52, v52
  v_mul_f32 v61, v53, v53
  v_mul_f32 v62, v54, v54
  v_mul_f32 v63, v55, v55
  v_fma_f32 v56, v56, v5, s26
  v_fma_f32 v57, v57, v5, s26
  v_fma_f32 v58, v58, v5, s26
  v_fma_f32 v59, v59, v5, s26
  v_fma_f32 v60, v60, v5, s26
  v_fma_f32 v61, v61, v5, s26
  v_fma_f32 v62, v62, v5, s26
  v_fma_f32 v63, v63, v5, s26
  v_mul_f32 v56, v56, v48
  v_mul_f32 v57, v57, v49
  v_mul_f32 v58, v58, v50
  v_mul_f32 v59, v59, v51
  v_mul_f32 v60, v60, v52
  v_mul_f32 v61, v61, v53
  v_mul_f32 v62, v62, v54
  v_mul_f32 v63, v63, v55
  v_exp_f32 v56, v56
  v_exp_f32 v57, v57
  v_exp_f32 v58, v58
  v_exp_f32 v59, v59
  v_exp_f32 v60, v60
  v_exp_f32 v61, v61
  v_exp_f32 v62, v62
  v_exp_f32 v63, v63
  v_add_f32 v56, 1.0, v56
  v_add_f32 v57, 1.0, v57
  v_add_f32 v58, 1.0, v58
  v_add_f32 v59, 1.0, v59
  v_add_f32 v60, 1.0, v60
  v_add_f32 v61, 1.0, v61
  v_add_f32 v62, 1.0, v62
  v_add_f32 v63, 1.0, v63
  v_rcp_f32 v56, v56
  v_rcp_f32 v57, v57
  v_rcp_f32 v58, v58
  v_rcp_f32 v59, v59
  v_rcp_f32 v60, v60
  v_rcp_f32 v61, v61
  v_rcp_f32 v62, v62
  v_rcp_f32 v63, v63
  v_mul_f32 v48, v48, v56
  v_mul_f32 v49, v49, v57
  v_mul_f32 v50, v50, v58
  v_mul_f32 v51, v51, v59
  v_mul_f32 v52, v52, v60
  v_mul_f32 v53, v53, v61
  v_mul_f32 v54, v54, v62
  v_mul_f32 v55, v55, v63
  v_cvt_pk_bf16_f32 v76, v48, v49
  v_cvt_pk_bf16_f32 v77, v50, v51
  v_cvt_pk_bf16_f32 v78, v52, v53
  v_cvt_pk_bf16_f32 v79, v54, v55
  buffer_store_dwordx4 v[76:79], v1, s[4:7], s24 offen offset:3072 sc1
  s_waitcnt vmcnt(0)
  s_barrier
  s_cmp_eq_u32 s13, 0
  s_cbranch_scc0 L_arr_74
  v_lshlrev_b32 v5, 10, v0
  v_mov_b32 v6, 1
  buffer_atomic_add v6, v5, s[36:39], 0 offen offset:168 sc0
  s_waitcnt vmcnt(0)
  v_readfirstlane_b32 vcc_lo, v6
  v_mov_b32 v6, 1
  s_cmp_eq_u32 vcc_lo, 111
  s_cbranch_scc0 L_arr_74
  buffer_atomic_add v6, v5, s[36:39], 0 offen offset:40
L_arr_74:
  s_cmp_lt_u32 s12, 16
  s_cselect_b32 s24, 96, 0
  s_add_u32 s12, s12, s24
  s_cmp_lg_u32 s24, 0
  s_cbranch_scc1 L_g1_67
  s_cmp_ge_u32 s12, 96
  s_cselect_b32 s24, 96, 0
  s_sub_u32 s12, s12, s24
  s_sub_u32 s24, s12, 16
  s_cmp_lt_u32 s24, 64
  s_cselect_b32 s25, s13, 0
  s_cmp_eq_u32 s25, 1
  s_cbranch_scc0 L_g1b_75
  s_lshl_b32 s24, s24, 13
  v_lshlrev_b32 v5, 3, v1
  buffer_load_dword v16, v5, s[60:63], s24 offen
  s_add_u32 s24, s24, 524288
  s_waitcnt vmcnt(0)
  buffer_load_dword v16, v5, s[60:63], s24 offen
  s_add_u32 s24, s24, 524288
  s_waitcnt vmcnt(0)
  buffer_load_dword v16, v5, s[60:63], s24 offen
  s_add_u32 s24, s24, 524288
  s_waitcnt vmcnt(0)
  buffer_load_dword v16, v5, s[60:63], s24 offen
  s_add_u32 s24, s24, 524288
  s_waitcnt vmcnt(0)
  buffer_load_dword v16, v5, s[60:63], s24 offen
  s_add_u32 s24, s24, 524288
  s_waitcnt vmcnt(0)
  buffer_load_dword v16, v5, s[60:63], s24 offen
  s_add_u32 s24, s24, 524288
  s_waitcnt vmcnt(0)
  buffer_load_dword v16, v5, s[60:63], s24 offen
  s_add_u32 s24, s24, 524288
  s_waitcnt vmcnt(0)
  buffer_load_dword v16, v5, s[60:63], s24 offen
  s_add_u32 s24, s24, 524288
  s_waitcnt vmcnt(0)
  buffer_load_dword v16, v5, s[60:63], s24 offen
  s_add_u32 s24, s24, 524288
  s_waitcnt vmcnt(0)
  buffer_load_dword v16, v5, s[60:63], s24 offen
  s_add_u32 s24, s24, 524288
  s_waitcnt vmcnt(0)
  buffer_load_dword v16, v5, s[60:63], s24 offen
  s_add_u32 s24, s24, 524288
  s_waitcnt vmcnt(0)
  buffer_load_dword v16, v5, s[60:63], s24 offen
  s_add_u32 s24, s24, 524288
  s_waitcnt vmcnt(0)
  buffer_load_dword v16, v5, s[60:63], s24 offen
  s_add_u32 s24, s24, 524288
  s_waitcnt vmcnt(0)
  buffer_load_dword v16, v5, s[60:63], s24 offen
  s_add_u32 s24, s24, 524288
  s_waitcnt vmcnt(0)
L_g1b_75:
  s_cmp_eq_u32 s13, 0
  s_cbranch_scc0 L_cntx_77
L_cnt_76:
  s_sub_u32 s33, s33, 1
  s_cbranch_scc1 L_done
  buffer_load_dword v5, off, s[36:39], 0 offset:40 sc1
  s_waitcnt vmcnt(0)
  v_cmp_gt_u32 vcc, 1, v5
  s_cbranch_vccz L_cntx_77
  s_sleep 8
  s_branch L_cnt_76
L_cntx_77:
  s_barrier
L_g2_68:
  v_lshlrev_b32 v4, 17, v3
  v_lshl_add_u32 v4, v2, 4, v4
  s_lshr_b32 s24, s12, 3
  s_lshl_b32 s24, s24, 8
  v_add_u32 v4, s24, v4
  s_lshl_b32 s25, s13, 2
  s_add_u32 s24, s24, s25
  v_lshlrev_b32 v5, 4, v2
  buffer_load_dword v240, v5, s[64:67], s24 offen
  s_mul_i32 s14, s13, 14
  s_and_b32 s24, s12, 7
  s_mul_i32 s15, s24, 229376
  s_mul_i32 s24, s13, 14336
  s_add_u32 s15, s15, s24
  s_add_u32 s15, s15, 4194304
  s_mov_b32 s26, 57344
  s_mov_b32 s19, 0
  s_cmp_ge_u32 s19, 14
  s_cselect_b32 s24, 14, 0
  s_sub_u32 s19, s19, s24
  s_add_u32 s19, s19, 1
  s_cmp_eq_u32 s19, 14
  s_cselect_b32 s19, 0, s19
  s_add_u32 s27, s14, s19
  s_lshr_b32 s24, s27, 2
  s_lshl_b32 s24, s24, 19
  s_and_b32 s27, s27, 3
  s_lshl_b32 s27, s27, 15
  s_add_u32 s24, s24, s27
  s_lshl_b32 s25, s19, 10
  s_add_u32 s25, s25, s15
  buffer_load_dwordx4 v[16:19], v4, s[60:63], s24 offen
  s_add_u32 s24, s24, 4096
  buffer_load_dwordx4 v[20:23], v4, s[60:63], s24 offen
  s_add_u32 s24, s24, 4096
  buffer_load_dwordx4 v[24:27], v4, s[60:63], s24 offen
  s_add_u32 s24, s24, 4096
  buffer_load_dwordx4 v[28:31], v4, s[60:63], s24 offen
  s_add_u32 s24, s24, 4096
  buffer_load_dwordx4 v[32:35], v4, s[60:63], s24 offen
  s_add_u32 s24, s24, 4096
  buffer_load_dwordx4 v[36:39], v4, s[60:63], s24 offen
  s_add_u32 s24, s24, 4096
  buffer_load_dwordx4 v[40:43], v4, s[60:63], s24 offen
  s_add_u32 s24, s24, 4096
  buffer_load_dwordx4 v[44:47], v4, s[60:63], s24 offen
  buffer_load_dwordx4 v[112:115], v1, s[4:7], s25 offen sc1
  s_add_u32 s25, s25, s26
  buffer_load_dwordx4 v[116:119], v1, s[4:7], s25 offen sc1
  s_add_u32 s25, s25, s26
  buffer_load_dwordx4 v[120:123], v1, s[4:7], s25 offen sc1
  s_add_u32 s25, s25, s26
  buffer_load_dwordx4 v[124:127], v1, s[4:7], s25 offen sc1
  s_add_u32 s19, s19, 1
  s_cmp_eq_u32 s19, 14
  s_cselect_b32 s19, 0, s19
  s_add_u32 s27, s14, s19
  s_lshr_b32 s24, s27, 2
  s_lshl_b32 s24, s24, 19
  s_and_b32 s27, s27, 3
  s_lshl_b32 s27, s27, 15
  s_add_u32 s24, s24, s27
  s_lshl_b32 s25, s19, 10
  s_add_u32 s25, s25, s15
  buffer_load_dwordx4 v[48:51], v4, s[60:63], s24 offen
  s_add_u32 s24, s24, 4096
  buffer_load_dwordx4 v[52:55], v4, s[60:63], s24 offen
  s_add_u32 s24, s24, 4096
  buffer_load_dwordx4 v[56:59], v4, s[60:63], s24 offen
  s_add_u32 s24, s24, 4096
  buffer_load_dwordx4 v[60:63], v4, s[60:63], s24 offen
  s_add_u32 s24, s24, 4096
  buffer_load_dwordx4 v[64:67], v4, s[60:63], s24 offen
  s_add_u32 s24, s24, 4096
  buffer_load_dwordx4 v[68:71], v4, s[60:63], s24 offen
  s_add_u32 s24, s24, 4096
  buffer_load_dwordx4 v[72:75], v4, s[60:63], s24 offen
  s_add_u32 s24, s24, 4096
  buffer_load_dwordx4 v[76:79], v4, s[60:63], s24 offen
  buffer_load_dwordx4 v[128:131], v1, s[4:7], s25 offen sc1
  s_add_u32 s25, s25, s26
  buffer_load_dwordx4 v[132:135], v1, s[4:7], s25 offen sc1
  s_add_u32 s25, s25, s26
  buffer_load_dwordx4 v[136:139], v1, s[4:7], s25 offen sc1
  s_add_u32 s25, s25, s26
  buffer_load_dwordx4 v[140:143], v1, s[4:7], s25 offen sc1
  s_add_u32 s19, s19, 1
  s_cmp_eq_u32 s19, 14
  s_cselect_b32 s19, 0, s19
  s_add_u32 s27, s14, s19
  s_lshr_b32 s24, s27, 2
  s_lshl_b32 s24, s24, 19
  s_and_b32 s27, s27, 3
  s_lshl_b32 s27, s27, 15
  s_add_u32 s24, s24, s27
  s_lshl_b32 s25, s19, 10
  s_add_u32 s25, s25, s15
  buffer_load_dwordx4 v[80:83], v4, s[60:63], s24 offen
  s_add_u32 s24, s24, 4096
  buffer_load_dwordx4 v[84:87], v4, s[60:63], s24 offen
  s_add_u32 s24, s24, 4096
  buffer_load_dwordx4 v[88:91], v4, s[60:63], s24 offen
  s_add_u32 s24, s24, 4096
  buffer_load_dwordx4 v[92:95], v4, s[60:63], s24 offen
  s_add_u32 s24, s24, 4096
  buffer_load_dwordx4 v[96:99], v4, s[60:63], s24 offen
  s_add_u32 s24, s24, 4096
  buffer_load_dwordx4 v[100:103], v4, s[60:63], s24 offen
  s_add_u32 s24, s24, 4096
  buffer_load_dwordx4 v[104:107], v4, s[60:63], s24 offen
  s_add_u32 s24, s24, 4096
  buffer_load_dwordx4 v[108:111], v4, s[60:63], s24 offen
  buffer_load_dwordx4 v[144:147], v1, s[4:7], s25 offen sc1
  s_add_u32 s25, s25, s26
  buffer_load_dwordx4 v[148:151], v1, s[4:7], s25 offen sc1
  s_add_u32 s25, s25, s26
  buffer_load_dwordx4 v[152:155], v1, s[4:7], s25 offen sc1
  s_add_u32 s25, s25, s26
  buffer_load_dwordx4 v[156:159], v1, s[4:7], s25 offen sc1
  s_waitcnt vmcnt(28)
  v_perm_b32 v176, v20, v16, s28
  v_perm_b32 v177, v28, v24, s28
  v_perm_b32 v178, v36, v32, s28
  v_perm_b32 v179, v44, v40, s28
  v_perm_b32 v180, v20, v16, s29
  v_perm_b32 v181, v28, v24, s29
  v_perm_b32 v182, v36, v32, s29
  v_perm_b32 v183, v44, v40, s29
  v_perm_b32 v184, v21, v17, s28
  v_perm_b32 v185, v29, v25, s28
  v_perm_b32 v186, v37, v33, s28
  v_perm_b32 v187, v45, v41, s28
  v_perm_b32 v188, v21, v17, s29
  v_perm_b32 v189, v29, v25, s29
  v_perm_b32 v190, v37, v33, s29
  v_perm_b32 v191, v45, v41, s29
  v_perm_b32 v192, v22, v18, s28
  v_perm_b32 v193, v30, v26, s28
  v_perm_b32 v194, v38, v34, s28
  v_perm_b32 v195, v46, v42, s28
  v_perm_b32 v196, v22, v18, s29
  v_perm_b32 v197, v30, v26, s29
  v_perm_b32 v198, v38, v34, s29
  v_perm_b32 v199, v46, v42, s29
  v_perm_b32 v200, v23, v19, s28
  v_perm_b32 v201, v31, v27, s28
  v_perm_b32 v202, v39, v35, s28
  v_perm_b32 v203, v47, v43, s28
  v_perm_b32 v204, v23, v19, s29
  v_perm_b32 v205, v31, v27, s29
  v_perm_b32 v206, v39, v35, s29
  v_perm_b32 v207, v47, v43, s29
  s_waitcnt vmcnt(16)
  v_mfma_f32_16x16x32_bf16 a[0:3], v[112:115], v[176:179], 0
  s_add_u32 s19, s19, 1
  v_perm_b32 v208, v52, v48, s28
  v_mfma_f32_16x16x32_bf16 a[4:7], v[116:119], v[176:179], 0
  s_cmp_eq_u32 s19, 14
  v_perm_b32 v209, v60, v56, s28
  v_mfma_f32_16x16x32_bf16 a[8:11], v[120:123], v[176:179], 0
  s_cselect_b32 s19, 0, s19
  v_perm_b32 v210, v68, v64, s28
  v_mfma_f32_16x16x32_bf16 a[12:15], v[124:127], v[176:179], 0
  s_add_u32 s27, s14, s19
  v_perm_b32 v211, v76, v72, s28
  v_mfma_f32_16x16x32_bf16 a[16:19], v[112:115], v[180:183], 0
  s_lshr_b32 s24, s27, 2
  v_perm_b32 v212, v52, v48, s29
  v_mfma_f32_16x16x32_bf16 a[20:23], v[116:119], v[180:183], 0
  s_lshl_b32 s24, s24, 19
  v_perm_b32 v213, v60, v56, s29
  v_mfma_f32_16x16x32_bf16 a[24:27], v[120:123], v[180:183], 0
  s_and_b32 s27, s27, 3
  v_perm_b32 v214, v68, v64, s29
  v_mfma_f32_16x16x32_bf16 a[28:31], v[124:127], v[180:183], 0
  s_lshl_b32 s27, s27, 15
  v_perm_b32 v215, v76, v72, s29
  v_mfma_f32_16x16x32_bf16 a[32:35], v[112:115], v[184:187], 0
  s_add_u32 s24, s24, s27
  v_perm_b32 v216, v53, v49, s28
  v_mfma_f32_16x16x32_bf16 a[36:39], v[116:119], v[184:187], 0
  s_lshl_b32 s25, s19, 10
  v_perm_b32 v217, v61, v57, s28
  v_mfma_f32_16x16x32_bf16 a[40:43], v[120:123], v[184:187], 0
  s_add_u32 s25, s25, s15
  v_perm_b32 v218, v69, v65, s28
  v_mfma_f32_16x16x32_bf16 a[44:47], v[124:127], v[184:187], 0
  buffer_load_dwordx4 v[16:19], v4, s[60:63], s24 offen
  v_perm_b32 v219, v77, v73, s28
  v_mfma_f32_16x16x32_bf16 a[48:51], v[112:115], v[188:191], 0
  s_add_u32 s24, s24, 4096
  v_perm_b32 v220, v53, v49, s29
  v_mfma_f32_16x16x32_bf16 a[52:55], v[116:119], v[188:191], 0
  buffer_load_dwordx4 v[20:23], v4, s[60:63], s24 offen
  v_perm_b32 v221, v61, v57, s29
  v_mfma_f32_16x16x32_bf16 a[56:59], v[120:123], v[188:191], 0
  s_add_u32 s24, s24, 4096
  v_perm_b32 v222, v69, v65, s29
  v_mfma_f32_16x16x32_bf16 a[60:63], v[124:127], v[188:191], 0
  buffer_load_dwordx4 v[24:27], v4, s[60:63], s24 offen
  v_perm_b32 v223, v77, v73, s29
  v_mfma_f32_16x16x32_bf16 a[64:67], v[112:115], v[192:195], 0
  s_add_u32 s24, s24, 4096
  v_perm_b32 v224, v54, v50, s28
  v_mfma_f32_16x16x32_bf16 a[68:71], v[116:119], v[192:195], 0
  buffer_load_dwordx4 v[28:31], v4, s[60:63], s24 offen
  v_perm_b32 v225, v62, v58, s28
  v_mfma_f32_16x16x32_bf16 a[72:75], v[120:123], v[192:195], 0
  s_add_u32 s24, s24, 4096
  v_perm_b32 v226, v70, v66, s28
  v_mfma_f32_16x16x32_bf16 a[76:79], v[124:127], v[192:195], 0
  buffer_load_dwordx4 v[32:35], v4, s[60:63], s24 offen
  v_perm_b32 v227, v78, v74, s28
  v_mfma_f32_16x16x32_bf16 a[80:83], v[112:115], v[196:199], 0
  s_add_u32 s24, s24, 4096
  v_perm_b32 v228, v54, v50, s29
  v_mfma_f32_16x16x32_bf16 a[84:87], v[116:119], v[196:199], 0
  buffer_load_dwordx4 v[36:39], v4, s[60:63], s24 offen
  v_perm_b32 v229, v62, v58, s29
  v_mfma_f32_16x16x32_bf16 a[88:91], v[120:123], v[196:199], 0
  s_add_u32 s24, s24, 4096
  v_perm_b32 v230, v70, v66, s29
  v_mfma_f32_16x16x32_bf16 a[92:95], v[124:127], v[196:199], 0
  buffer_load_dwordx4 v[40:43], v4, s[60:63], s24 offen
  v_perm_b32 v231, v78, v74, s29
  v_mfma_f32_16x16x32_bf16 a[96:99], v[112:115], v[200:203], 0
  s_add_u32 s24, s24, 4096
  v_perm_b32 v232, v55, v51, s28
  v_mfma_f32_16x16x32_bf16 a[100:103], v[116:119], v[200:203], 0
  buffer_load_dwordx4 v[44:47], v4, s[60:63], s24 offen
  v_perm_b32 v233, v63, v59, s28
  v_mfma_f32_16x16x32_bf16 a[104:107], v[120:123], v[200:203], 0
  buffer_load_dwordx4 v[160:163], v1, s[4:7], s25 offen sc1
  v_perm_b32 v234, v71, v67, s28
  v_mfma_f32_16x16x32_bf16 a[108:111], v[124:127], v[200:203], 0
  s_add_u32 s25, s25, s26
  v_perm_b32 v235, v79, v75, s28
  v_mfma_f32_16x16x32_bf16 a[112:115], v[112:115], v[204:207], 0
  buffer_load_dwordx4 v[164:167], v1, s[4:7], s25 offen sc1
  v_perm_b32 v236, v55, v51, s29
  v_mfma_f32_16x16x32_bf16 a[116:119], v[116:119], v[204:207], 0
  s_add_u32 s25, s25, s26
  v_perm_b32 v237, v63, v59, s29
  v_mfma_f32_16x16x32_bf16 a[120:123], v[120:123], v[204:207], 0
  buffer_load_dwordx4 v[168:171], v1, s[4:7], s25 offen sc1
  v_perm_b32 v238, v71, v67, s29
  v_mfma_f32_16x16x32_bf16 a[124:127], v[124:127], v[204:207], 0
  s_add_u32 s25, s25, s26
  v_perm_b32 v239, v79, v75, s29
  buffer_load_dwordx4 v[172:175], v1, s[4:7], s25 offen sc1
  s_waitcnt vmcnt(16)
  v_mfma_f32_16x16x32_bf16 a[0:3], v[128:131], v[208:211], a[0:3]
  s_add_u32 s19, s19, 1
  v_perm_b32 v176, v84, v80, s28
  v_mfma_f32_16x16x32_bf16 a[4:7], v[132:135], v[208:211], a[4:7]
  s_cmp_eq_u32 s19, 14
  v_perm_b32 v177, v92, v88, s28
  v_mfma_f32_16x16x32_bf16 a[8:11], v[136:139], v[208:211], a[8:11]
  s_cselect_b32 s19, 0, s19
  v_perm_b32 v178, v100, v96, s28
  v_mfma_f32_16x16x32_bf16 a[12:15], v[140:143], v[208:211], a[12:15]
  s_add_u32 s27, s14, s19
  v_perm_b32 v179, v108, v104, s28
  v_mfma_f32_16x16x32_bf16 a[16:19], v[128:131], v[212:215], a[16:19]
  s_lshr_b32 s24, s27, 2
  v_perm_b32 v180, v84, v80, s29
  v_mfma_f32_16x16x32_bf16 a[20:23], v[132:135], v[212:215], a[20:23]
  s_lshl_b32 s24, s24, 19
  v_perm_b32 v181, v92, v88, s29
  v_mfma_f32_16x16x32_bf16 a[24:27], v[136:139], v[212:215], a[24:27]
  s_and_b32 s27, s27, 3
  v_perm_b32 v182, v100, v96, s29
  v_mfma_f32_16x16x32_bf16 a[28:31], v[140:143], v[212:215], a[28:31]
  s_lshl_b32 s27, s27, 15
  v_perm_b32 v183, v108, v104, s29
  v_mfma_f32_16x16x32_bf16 a[32:35], v[128:131], v[216:219], a[32:35]
  s_add_u32 s24, s24, s27
  v_perm_b32 v184, v85, v81, s28
  v_mfma_f32_16x16x32_bf16 a[36:39], v[132:135], v[216:219], a[36:39]
  s_lshl_b32 s25, s19, 10
  v_perm_b32 v185, v93, v89, s28
  v_mfma_f32_16x16x32_bf16 a[40:43], v[136:139], v[216:219], a[40:43]
  s_add_u32 s25, s25, s15
  v_perm_b32 v186, v101, v97, s28
  v_mfma_f32_16x16x32_bf16 a[44:47], v[140:143], v[216:219], a[44:47]
  buffer_load_dwordx4 v[48:51], v4, s[60:63], s24 offen
  v_perm_b32 v187, v109, v105, s28
  v_mfma_f32_16x16x32_bf16 a[48:51], v[128:131], v[220:223], a[48:51]
  s_add_u32 s24, s24, 4096
  v_perm_b32 v188, v85, v81, s29
  v_mfma_f32_16x16x32_bf16 a[52:55], v[132:135], v[220:223], a[52:55]
  buffer_load_dwordx4 v[52:55], v4, s[60:63], s24 offen
  v_perm_b32 v189, v93, v89, s29
  v_mfma_f32_16x16x32_bf16 a[56:59], v[136:139], v[220:223], a[56:59]
  s_add_u32 s24, s24, 4096
  v_perm_b32 v190, v101, v97, s29
  v_mfma_f32_16x16x32_bf16 a[60:63], v[140:143], v[220:223], a[60:63]
  buffer_load_dwordx4 v[56:59], v4, s[60:63], s24 offen
  v_perm_b32 v191, v109, v105, s29
  v_mfma_f32_16x16x32_bf16 a[64:67], v[128:131], v[224:227], a[64:67]
  s_add_u32 s24, s24, 4096
  v_perm_b32 v192, v86, v82, s28
  v_mfma_f32_16x16x32_bf16 a[68:71], v[132:135], v[224:227], a[68:71]
  buffer_load_dwordx4 v[60:63], v4, s[60:63], s24 offen
  v_perm_b32 v193, v94, v90, s28
  v_mfma_f32_16x16x32_bf16 a[72:75], v[136:139], v[224:227], a[72:75]
  s_add_u32 s24, s24, 4096
  v_perm_b32 v194, v102, v98, s28
  v_mfma_f32_16x16x32_bf16 a[76:79], v[140:143], v[224:227], a[76:79]
  buffer_load_dwordx4 v[64:67], v4, s[60:63], s24 offen
  v_perm_b32 v195, v110, v106, s28
  v_mfma_f32_16x16x32_bf16 a[80:83], v[128:131], v[228:231], a[80:83]
  s_add_u32 s24, s24, 4096
  v_perm_b32 v196, v86, v82, s29
  v_mfma_f32_16x16x32_bf16 a[84:87], v[132:135], v[228:231], a[84:87]
  buffer_load_dwordx4 v[68:71], v4, s[60:63], s24 offen
  v_perm_b32 v197, v94, v90, s29
  v_mfma_f32_16x16x32_bf16 a[88:91], v[136:139], v[228:231], a[88:91]
  s_add_u32 s24, s24, 4096
  v_perm_b32 v198, v102, v98, s29
  v_mfma_f32_16x16x32_bf16 a[92:95], v[140:143], v[228:231], a[92:95]
  buffer_load_dwordx4 v[72:75], v4, s[60:63], s24 offen
  v_perm_b32 v199, v110, v106, s29
  v_mfma_f32_16x16x32_bf16 a[96:99], v[128:131], v[232:235], a[96:99]
  s_add_u32 s24, s24, 4096
  v_perm_b32 v200, v87, v83, s28
  v_mfma_f32_16x16x32_bf16 a[100:103], v[132:135], v[232:235], a[100:103]
  buffer_load_dwordx4 v[76:79], v4, s[60:63], s24 offen
  v_perm_b32 v201, v95, v91, s28
  v_mfma_f32_16x16x32_bf16 a[104:107], v[136:139], v[232:235], a[104:107]
  buffer_load_dwordx4 v[112:115], v1, s[4:7], s25 offen sc1
  v_perm_b32 v202, v103, v99, s28
  v_mfma_f32_16x16x32_bf16 a[108:111], v[140:143], v[232:235], a[108:111]
  s_add_u32 s25, s25, s26
  v_perm_b32 v203, v111, v107, s28
  v_mfma_f32_16x16x32_bf16 a[112:115], v[128:131], v[236:239], a[112:115]
  buffer_load_dwordx4 v[116:119], v1, s[4:7], s25 offen sc1
  v_perm_b32 v204, v87, v83, s29
  v_mfma_f32_16x16x32_bf16 a[116:119], v[132:135], v[236:239], a[116:119]
  s_add_u32 s25, s25, s26
  v_perm_b32 v205, v95, v91, s29
  v_mfma_f32_16x16x32_bf16 a[120:123], v[136:139], v[236:239], a[120:123]
  buffer_load_dwordx4 v[120:123], v1, s[4:7], s25 offen sc1
  v_perm_b32 v206, v103, v99, s29
  v_mfma_f32_16x16x32_bf16 a[124:127], v[140:143], v[236:239], a[124:127]
  s_add_u32 s25, s25, s26
  v_perm_b32 v207, v111, v107, s29
  buffer_load_dwordx4 v[124:127], v1, s[4:7], s25 offen sc1
  s_waitcnt vmcnt(16)
  v_mfma_f32_16x16x32_bf16 a[0:3], v[144:147], v[176:179], a[0:3]
  s_add_u32 s19, s19, 1
  v_perm_b32 v208, v20, v16, s28
  v_mfma_f32_16x16x32_bf16 a[4:7], v[148:151], v[176:179], a[4:7]
  s_cmp_eq_u32 s19, 14
  v_perm_b32 v209, v28, v24, s28
  v_mfma_f32_16x16x32_bf16 a[8:11], v[152:155], v[176:179], a[8:11]
  s_cselect_b32 s19, 0, s19
  v_perm_b32 v210, v36, v32, s28
  v_mfma_f32_16x16x32_bf16 a[12:15], v[156:159], v[176:179], a[12:15]
  s_add_u32 s27, s14, s19
  v_perm_b32 v211, v44, v40, s28
  v_mfma_f32_16x16x32_bf16 a[16:19], v[144:147], v[180:183], a[16:19]
  s_lshr_b32 s24, s27, 2
  v_perm_b32 v212, v20, v16, s29
  v_mfma_f32_16x16x32_bf16 a[20:23], v[148:151], v[180:183], a[20:23]
  s_lshl_b32 s24, s24, 19
  v_perm_b32 v213, v28, v24, s29
  v_mfma_f32_16x16x32_bf16 a[24:27], v[152:155], v[180:183], a[24:27]
  s_and_b32 s27, s27, 3
  v_perm_b32 v214, v36, v32, s29
  v_mfma_f32_16x16x32_bf16 a[28:31], v[156:159], v[180:183], a[28:31]
  s_lshl_b32 s27, s27, 15
  v_perm_b32 v215, v44, v40, s29
  v_mfma_f32_16x16x32_bf16 a[32:35], v[144:147], v[184:187], a[32:35]
  s_add_u32 s24, s24, s27
  v_perm_b32 v216, v21, v17, s28
  v_mfma_f32_16x16x32_bf16 a[36:39], v[148:151], v[184:187], a[36:39]
  s_lshl_b32 s25, s19, 10
  v_perm_b32 v217, v29, v25, s28
  v_mfma_f32_16x16x32_bf16 a[40:43], v[152:155], v[184:187], a[40:43]
  s_add_u32 s25, s25, s15
  v_perm_b32 v218, v37, v33, s28
  v_mfma_f32_16x16x32_bf16 a[44:47], v[156:159], v[184:187], a[44:47]
  buffer_load_dwordx4 v[80:83], v4, s[60:63], s24 offen
  v_perm_b32 v219, v45, v41, s28
  v_mfma_f32_16x16x32_bf16 a[48:51], v[144:147], v[188:191], a[48:51]
  s_add_u32 s24, s24, 4096
  v_perm_b32 v220, v21, v17, s29
  v_mfma_f32_16x16x32_bf16 a[52:55], v[148:151], v[188:191], a[52:55]
  buffer_load_dwordx4 v[84:87], v4, s[60:63], s24 offen
  v_perm_b32 v221, v29, v25, s29
  v_mfma_f32_16x16x32_bf16 a[56:59], v[152:155], v[188:191], a[56:59]
  s_add_u32 s24, s24, 4096
  v_perm_b32 v222, v37, v33, s29
  v_mfma_f32_16x16x32_bf16 a[60:63], v[156:159], v[188:191], a[60:63]
  buffer_load_dwordx4 v[88:91], v4, s[60:63], s24 offen
  v_perm_b32 v223, v45, v41, s29
  v_mfma_f32_16x16x32_bf16 a[64:67], v[144:147], v[192:195], a[64:67]
  s_add_u32 s24, s24, 4096
  v_perm_b32 v224, v22, v18, s28
  v_mfma_f32_16x16x32_bf16 a[68:71], v[148:151], v[192:195], a[68:71]
  buffer_load_dwordx4 v[92:95], v4, s[60:63], s24 offen
  v_perm_b32 v225, v30, v26, s28
  v_mfma_f32_16x16x32_bf16 a[72:75], v[152:155], v[192:195], a[72:75]
  s_add_u32 s24, s24, 4096
  v_perm_b32 v226, v38, v34, s28
  v_mfma_f32_16x16x32_bf16 a[76:79], v[156:159], v[192:195], a[76:79]
  buffer_load_dwordx4 v[96:99], v4, s[60:63], s24 offen
  v_perm_b32 v227, v46, v42, s28
  v_mfma_f32_16x16x32_bf16 a[80:83], v[144:147], v[196:199], a[80:83]
  s_add_u32 s24, s24, 4096
  v_perm_b32 v228, v22, v18, s29
  v_mfma_f32_16x16x32_bf16 a[84:87], v[148:151], v[196:199], a[84:87]
  buffer_load_dwordx4 v[100:103], v4, s[60:63], s24 offen
  v_perm_b32 v229, v30, v26, s29
  v_mfma_f32_16x16x32_bf16 a[88:91], v[152:155], v[196:199], a[88:91]
  s_add_u32 s24, s24, 4096
  v_perm_b32 v230, v38, v34, s29
  v_mfma_f32_16x16x32_bf16 a[92:95], v[156:159], v[196:199], a[92:95]
  buffer_load_dwordx4 v[104:107], v4, s[60:63], s24 offen
  v_perm_b32 v231, v46, v42, s29
  v_mfma_f32_16x16x32_bf16 a[96:99], v[144:147], v[200:203], a[96:99]
  s_add_u32 s24, s24, 4096
  v_perm_b32 v232, v23, v19, s28
  v_mfma_f32_16x16x32_bf16 a[100:103], v[148:151], v[200:203], a[100:103]
  buffer_load_dwordx4 v[108:111], v4, s[60:63], s24 offen
  v_perm_b32 v233, v31, v27, s28
  v_mfma_f32_16x16x32_bf16 a[104:107], v[152:155], v[200:203], a[104:107]
  buffer_load_dwordx4 v[128:131], v1, s[4:7], s25 offen sc1
  v_perm_b32 v234, v39, v35, s28
  v_mfma_f32_16x16x32_bf16 a[108:111], v[156:159], v[200:203], a[108:111]
  s_add_u32 s25, s25, s26
  v_perm_b32 v235, v47, v43, s28
  v_mfma_f32_16x16x32_bf16 a[112:115], v[144:147], v[204:207], a[112:115]
  buffer_load_dwordx4 v[132:135], v1, s[4:7], s25 offen sc1
  v_perm_b32 v236, v23, v19, s29
  v_mfma_f32_16x16x32_bf16 a[116:119], v[148:151], v[204:207], a[116:119]
  s_add_u32 s25, s25, s26
  v_perm_b32 v237, v31, v27, s29
  v_mfma_f32_16x16x32_bf16 a[120:123], v[152:155], v[204:207], a[120:123]
  buffer_load_dwordx4 v[136:139], v1, s[4:7], s25 offen sc1
  v_perm_b32 v238, v39, v35, s29
  v_mfma_f32_16x16x32_bf16 a[124:127], v[156:159], v[204:207], a[124:127]
  s_add_u32 s25, s25, s26
  v_perm_b32 v239, v47, v43, s29
  buffer_load_dwordx4 v[140:143], v1, s[4:7], s25 offen sc1
  s_waitcnt vmcnt(16)
  v_mfma_f32_16x16x32_bf16 a[0:3], v[160:163], v[208:211], a[0:3]
  s_add_u32 s19, s19, 1
  v_perm_b32 v176, v52, v48, s28
  v_mfma_f32_16x16x32_bf16 a[4:7], v[164:167], v[208:211], a[4:7]
  s_cmp_eq_u32 s19, 14
  v_perm_b32 v177, v60, v56, s28
  v_mfma_f32_16x16x32_bf16 a[8:11], v[168:171], v[208:211], a[8:11]
  s_cselect_b32 s19, 0, s19
  v_perm_b32 v178, v68, v64, s28
  v_mfma_f32_16x16x32_bf16 a[12:15], v[172:175], v[208:211], a[12:15]
  s_add_u32 s27, s14, s19
  v_perm_b32 v179, v76, v72, s28
  v_mfma_f32_16x16x32_bf16 a[16:19], v[160:163], v[212:215], a[16:19]
  s_lshr_b32 s24, s27, 2
  v_perm_b32 v180, v52, v48, s29
  v_mfma_f32_16x16x32_bf16 a[20:23], v[164:167], v[212:215], a[20:23]
  s_lshl_b32 s24, s24, 19
  v_perm_b32 v181, v60, v56, s29
  v_mfma_f32_16x16x32_bf16 a[24:27], v[168:171], v[212:215], a[24:27]
  s_and_b32 s27, s27, 3
  v_perm_b32 v182, v68, v64, s29
  v_mfma_f32_16x16x32_bf16 a[28:31], v[172:175], v[212:215], a[28:31]
  s_lshl_b32 s27, s27, 15
  v_perm_b32 v183, v76, v72, s29
  v_mfma_f32_16x16x32_bf16 a[32:35], v[160:163], v[216:219], a[32:35]
  s_add_u32 s24, s24, s27
  v_perm_b32 v184, v53, v49, s28
  v_mfma_f32_16x16x32_bf16 a[36:39], v[164:167], v[216:219], a[36:39]
  s_lshl_b32 s25, s19, 10
  v_perm_b32 v185, v61, v57, s28
  v_mfma_f32_16x16x32_bf16 a[40:43], v[168:171], v[216:219], a[40:43]
  s_add_u32 s25, s25, s15
  v_perm_b32 v186, v69, v65, s28
  v_mfma_f32_16x16x32_bf16 a[44:47], v[172:175], v[216:219], a[44:47]
  buffer_load_dwordx4 v[16:19], v4, s[60:63], s24 offen
  v_perm_b32 v187, v77, v73, s28
  v_mfma_f32_16x16x32_bf16 a[48:51], v[160:163], v[220:223], a[48:51]
  s_add_u32 s24, s24, 4096
  v_perm_b32 v188, v53, v49, s29
  v_mfma_f32_16x16x32_bf16 a[52:55], v[164:167], v[220:223], a[52:55]
  buffer_load_dwordx4 v[20:23], v4, s[60:63], s24 offen
  v_perm_b32 v189, v61, v57, s29
  v_mfma_f32_16x16x32_bf16 a[56:59], v[168:171], v[220:223], a[56:59]
  s_add_u32 s24, s24, 4096
  v_perm_b32 v190, v69, v65, s29
  v_mfma_f32_16x16x32_bf16 a[60:63], v[172:175], v[220:223], a[60:63]
  buffer_load_dwordx4 v[24:27], v4, s[60:63], s24 offen
  v_perm_b32 v191, v77, v73, s29
  v_mfma_f32_16x16x32_bf16 a[64:67], v[160:163], v[224:227], a[64:67]
  s_add_u32 s24, s24, 4096
  v_perm_b32 v192, v54, v50, s28
  v_mfma_f32_16x16x32_bf16 a[68:71], v[164:167], v[224:227], a[68:71]
  buffer_load_dwordx4 v[28:31], v4, s[60:63], s24 offen
  v_perm_b32 v193, v62, v58, s28
  v_mfma_f32_16x16x32_bf16 a[72:75], v[168:171], v[224:227], a[72:75]
  s_add_u32 s24, s24, 4096
  v_perm_b32 v194, v70, v66, s28
  v_mfma_f32_16x16x32_bf16 a[76:79], v[172:175], v[224:227], a[76:79]
  buffer_load_dwordx4 v[32:35], v4, s[60:63], s24 offen
  v_perm_b32 v195, v78, v74, s28
  v_mfma_f32_16x16x32_bf16 a[80:83], v[160:163], v[228:231], a[80:83]
  s_add_u32 s24, s24, 4096
  v_perm_b32 v196, v54, v50, s29
  v_mfma_f32_16x16x32_bf16 a[84:87], v[164:167], v[228:231], a[84:87]
  buffer_load_dwordx4 v[36:39], v4, s[60:63], s24 offen
  v_perm_b32 v197, v62, v58, s29
  v_mfma_f32_16x16x32_bf16 a[88:91], v[168:171], v[228:231], a[88:91]
  s_add_u32 s24, s24, 4096
  v_perm_b32 v198, v70, v66, s29
  v_mfma_f32_16x16x32_bf16 a[92:95], v[172:175], v[228:231], a[92:95]
  buffer_load_dwordx4 v[40:43], v4, s[60:63], s24 offen
  v_perm_b32 v199, v78, v74, s29
  v_mfma_f32_16x16x32_bf16 a[96:99], v[160:163], v[232:235], a[96:99]
  s_add_u32 s24, s24, 4096
  v_perm_b32 v200, v55, v51, s28
  v_mfma_f32_16x16x32_bf16 a[100:103], v[164:167], v[232:235], a[100:103]
  buffer_load_dwordx4 v[44:47], v4, s[60:63], s24 offen
  v_perm_b32 v201, v63, v59, s28
  v_mfma_f32_16x16x32_bf16 a[104:107], v[168:171], v[232:235], a[104:107]
  buffer_load_dwordx4 v[144:147], v1, s[4:7], s25 offen sc1
  v_perm_b32 v202, v71, v67, s28
  v_mfma_f32_16x16x32_bf16 a[108:111], v[172:175], v[232:235], a[108:111]
  s_add_u32 s25, s25, s26
  v_perm_b32 v203, v79, v75, s28
  v_mfma_f32_16x16x32_bf16 a[112:115], v[160:163], v[236:239], a[112:115]
  buffer_load_dwordx4 v[148:151], v1, s[4:7], s25 offen sc1
  v_perm_b32 v204, v55, v51, s29
  v_mfma_f32_16x16x32_bf16 a[116:119], v[164:167], v[236:239], a[116:119]
  s_add_u32 s25, s25, s26
  v_perm_b32 v205, v63, v59, s29
  v_mfma_f32_16x16x32_bf16 a[120:123], v[168:171], v[236:239], a[120:123]
  buffer_load_dwordx4 v[152:155], v1, s[4:7], s25 offen sc1
  v_perm_b32 v206, v71, v67, s29
  v_mfma_f32_16x16x32_bf16 a[124:127], v[172:175], v[236:239], a[124:127]
  s_add_u32 s25, s25, s26
  v_perm_b32 v207, v79, v75, s29
  buffer_load_dwordx4 v[156:159], v1, s[4:7], s25 offen sc1
  s_waitcnt vmcnt(16)
  v_mfma_f32_16x16x32_bf16 a[0:3], v[112:115], v[176:179], a[0:3]
  s_add_u32 s19, s19, 1
  v_perm_b32 v208, v84, v80, s28
  v_mfma_f32_16x16x32_bf16 a[4:7], v[116:119], v[176:179], a[4:7]
  s_cmp_eq_u32 s19, 14
  v_perm_b32 v209, v92, v88, s28
  v_mfma_f32_16x16x32_bf16 a[8:11], v[120:123], v[176:179], a[8:11]
  s_cselect_b32 s19, 0, s19
  v_perm_b32 v210, v100, v96, s28
  v_mfma_f32_16x16x32_bf16 a[12:15], v[124:127], v[176:179], a[12:15]
  s_add_u32 s27, s14, s19
  v_perm_b32 v211, v108, v104, s28
  v_mfma_f32_16x16x32_bf16 a[16:19], v[112:115], v[180:183], a[16:19]
  s_lshr_b32 s24, s27, 2
  v_perm_b32 v212, v84, v80, s29
  v_mfma_f32_16x16x32_bf16 a[20:23], v[116:119], v[180:183], a[20:23]
  s_lshl_b32 s24, s24, 19
  v_perm_b32 v213, v92, v88, s29
  v_mfma_f32_16x16x32_bf16 a[24:27], v[120:123], v[180:183], a[24:27]
  s_and_b32 s27, s27, 3
  v_perm_b32 v214, v100, v96, s29
  v_mfma_f32_16x16x32_bf16 a[28:31], v[124:127], v[180:183], a[28:31]
  s_lshl_b32 s27, s27, 15
  v_perm_b32 v215, v108, v104, s29
  v_mfma_f32_16x16x32_bf16 a[32:35], v[112:115], v[184:187], a[32:35]
  s_add_u32 s24, s24, s27
  v_perm_b32 v216, v85, v81, s28
  v_mfma_f32_16x16x32_bf16 a[36:39], v[116:119], v[184:187], a[36:39]
  s_lshl_b32 s25, s19, 10
  v_perm_b32 v217, v93, v89, s28
  v_mfma_f32_16x16x32_bf16 a[40:43], v[120:123], v[184:187], a[40:43]
  s_add_u32 s25, s25, s15
  v_perm_b32 v218, v101, v97, s28
  v_mfma_f32_16x16x32_bf16 a[44:47], v[124:127], v[184:187], a[44:47]
  buffer_load_dwordx4 v[48:51], v4, s[60:63], s24 offen
  v_perm_b32 v219, v109, v105, s28
  v_mfma_f32_16x16x32_bf16 a[48:51], v[112:115], v[188:191], a[48:51]
  s_add_u32 s24, s24, 4096
  v_perm_b32 v220, v85, v81, s29
  v_mfma_f32_16x16x32_bf16 a[52:55], v[116:119], v[188:191], a[52:55]
  buffer_load_dwordx4 v[52:55], v4, s[60:63], s24 offen
  v_perm_b32 v221, v93, v89, s29
  v_mfma_f32_16x16x32_bf16 a[56:59], v[120:123], v[188:191], a[56:59]
  s_add_u32 s24, s24, 4096
  v_perm_b32 v222, v101, v97, s29
  v_mfma_f32_16x16x32_bf16 a[60:63], v[124:127], v[188:191], a[60:63]
  buffer_load_dwordx4 v[56:59], v4, s[60:63], s24 offen
  v_perm_b32 v223, v109, v105, s29
  v_mfma_f32_16x16x32_bf16 a[64:67], v[112:115], v[192:195], a[64:67]
  s_add_u32 s24, s24, 4096
  v_perm_b32 v224, v86, v82, s28
  v_mfma_f32_16x16x32_bf16 a[68:71], v[116:119], v[192:195], a[68:71]
  buffer_load_dwordx4 v[60:63], v4, s[60:63], s24 offen
  v_perm_b32 v225, v94, v90, s28
  v_mfma_f32_16x16x32_bf16 a[72:75], v[120:123], v[192:195], a[72:75]
  s_add_u32 s24, s24, 4096
  v_perm_b32 v226, v102, v98, s28
  v_mfma_f32_16x16x32_bf16 a[76:79], v[124:127], v[192:195], a[76:79]
  buffer_load_dwordx4 v[64:67], v4, s[60:63], s24 offen
  v_perm_b32 v227, v110, v106, s28
  v_mfma_f32_16x16x32_bf16 a[80:83], v[112:115], v[196:199], a[80:83]
  s_add_u32 s24, s24, 4096
  v_perm_b32 v228, v86, v82, s29
  v_mfma_f32_16x16x32_bf16 a[84:87], v[116:119], v[196:199], a[84:87]
  buffer_load_dwordx4 v[68:71], v4, s[60:63], s24 offen
  v_perm_b32 v229, v94, v90, s29
  v_mfma_f32_16x16x32_bf16 a[88:91], v[120:123], v[196:199], a[88:91]
  s_add_u32 s24, s24, 4096
  v_perm_b32 v230, v102, v98, s29
  v_mfma_f32_16x16x32_bf16 a[92:95], v[124:127], v[196:199], a[92:95]
  buffer_load_dwordx4 v[72:75], v4, s[60:63], s24 offen
  v_perm_b32 v231, v110, v106, s29
  v_mfma_f32_16x16x32_bf16 a[96:99], v[112:115], v[200:203], a[96:99]
  s_add_u32 s24, s24, 4096
  v_perm_b32 v232, v87, v83, s28
  v_mfma_f32_16x16x32_bf16 a[100:103], v[116:119], v[200:203], a[100:103]
  buffer_load_dwordx4 v[76:79], v4, s[60:63], s24 offen
  v_perm_b32 v233, v95, v91, s28
  v_mfma_f32_16x16x32_bf16 a[104:107], v[120:123], v[200:203], a[104:107]
  buffer_load_dwordx4 v[160:163], v1, s[4:7], s25 offen sc1
  v_perm_b32 v234, v103, v99, s28
  v_mfma_f32_16x16x32_bf16 a[108:111], v[124:127], v[200:203], a[108:111]
  s_add_u32 s25, s25, s26
  v_perm_b32 v235, v111, v107, s28
  v_mfma_f32_16x16x32_bf16 a[112:115], v[112:115], v[204:207], a[112:115]
  buffer_load_dwordx4 v[164:167], v1, s[4:7], s25 offen sc1
  v_perm_b32 v236, v87, v83, s29
  v_mfma_f32_16x16x32_bf16 a[116:119], v[116:119], v[204:207], a[116:119]
  s_add_u32 s25, s25, s26
  v_perm_b32 v237, v95, v91, s29
  v_mfma_f32_16x16x32_bf16 a[120:123], v[120:123], v[204:207], a[120:123]
  buffer_load_dwordx4 v[168:171], v1, s[4:7], s25 offen sc1
  v_perm_b32 v238, v103, v99, s29
  v_mfma_f32_16x16x32_bf16 a[124:127], v[124:127], v[204:207], a[124:127]
  s_add_u32 s25, s25, s26
  v_perm_b32 v239, v111, v107, s29
  buffer_load_dwordx4 v[172:175], v1, s[4:7], s25 offen sc1
  s_waitcnt vmcnt(16)
  v_mfma_f32_16x16x32_bf16 a[0:3], v[128:131], v[208:211], a[0:3]
  s_add_u32 s19, s19, 1
  v_perm_b32 v176, v20, v16, s28
  v_mfma_f32_16x16x32_bf16 a[4:7], v[132:135], v[208:211], a[4:7]
  s_cmp_eq_u32 s19, 14
  v_perm_b32 v177, v28, v24, s28
  v_mfma_f32_16x16x32_bf16 a[8:11], v[136:139], v[208:211], a[8:11]
  s_cselect_b32 s19, 0, s19
  v_perm_b32 v178, v36, v32, s28
  v_mfma_f32_16x16x32_bf16 a[12:15], v[140:143], v[208:211], a[12:15]
  s_add_u32 s27, s14, s19
  v_perm_b32 v179, v44, v40, s28
  v_mfma_f32_16x16x32_bf16 a[16:19], v[128:131], v[212:215], a[16:19]
  s_lshr_b32 s24, s27, 2
  v_perm_b32 v180, v20, v16, s29
  v_mfma_f32_16x16x32_bf16 a[20:23], v[132:135], v[212:215], a[20:23]
  s_lshl_b32 s24, s24, 19
  v_perm_b32 v181, v28, v24, s29
  v_mfma_f32_16x16x32_bf16 a[24:27], v[136:139], v[212:215], a[24:27]
  s_and_b32 s27, s27, 3
  v_perm_b32 v182, v36, v32, s29
  v_mfma_f32_16x16x32_bf16 a[28:31], v[140:143], v[212:215], a[28:31]
  s_lshl_b32 s27, s27, 15
  v_perm_b32 v183, v44, v40, s29
  v_mfma_f32_16x16x32_bf16 a[32:35], v[128:131], v[216:219], a[32:35]
  s_add_u32 s24, s24, s27
  v_perm_b32 v184, v21, v17, s28
  v_mfma_f32_16x16x32_bf16 a[36:39], v[132:135], v[216:219], a[36:39]
  s_lshl_b32 s25, s19, 10
  v_perm_b32 v185, v29, v25, s28
  v_mfma_f32_16x16x32_bf16 a[40:43], v[136:139], v[216:219], a[40:43]
  s_add_u32 s25, s25, s15
  v_perm_b32 v186, v37, v33, s28
  v_mfma_f32_16x16x32_bf16 a[44:47], v[140:143], v[216:219], a[44:47]
  buffer_load_dwordx4 v[80:83], v4, s[60:63], s24 offen
  v_perm_b32 v187, v45, v41, s28
  v_mfma_f32_16x16x32_bf16 a[48:51], v[128:131], v[220:223], a[48:51]
  s_add_u32 s24, s24, 4096
  v_perm_b32 v188, v21, v17, s29
  v_mfma_f32_16x16x32_bf16 a[52:55], v[132:135], v[220:223], a[52:55]
  buffer_load_dwordx4 v[84:87], v4, s[60:63], s24 offen
  v_perm_b32 v189, v29, v25, s29
  v_mfma_f32_16x16x32_bf16 a[56:59], v[136:139], v[220:223], a[56:59]
  s_add_u32 s24, s24, 4096
  v_perm_b32 v190, v37, v33, s29
  v_mfma_f32_16x16x32_bf16 a[60:63], v[140:143], v[220:223], a[60:63]
  buffer_load_dwordx4 v[88:91], v4, s[60:63], s24 offen
  v_perm_b32 v191, v45, v41, s29
  v_mfma_f32_16x16x32_bf16 a[64:67], v[128:131], v[224:227], a[64:67]
  s_add_u32 s24, s24, 4096
  v_perm_b32 v192, v22, v18, s28
  v_mfma_f32_16x16x32_bf16 a[68:71], v[132:135], v[224:227], a[68:71]
  buffer_load_dwordx4 v[92:95], v4, s[60:63], s24 offen
  v_perm_b32 v193, v30, v26, s28
  v_mfma_f32_16x16x32_bf16 a[72:75], v[136:139], v[224:227], a[72:75]
  s_add_u32 s24, s24, 4096
  v_perm_b32 v194, v38, v34, s28
  v_mfma_f32_16x16x32_bf16 a[76:79], v[140:143], v[224:227], a[76:79]
  buffer_load_dwordx4 v[96:99], v4, s[60:63], s24 offen
  v_perm_b32 v195, v46, v42, s28
  v_mfma_f32_16x16x32_bf16 a[80:83], v[128:131], v[228:231], a[80:83]
  s_add_u32 s24, s24, 4096
  v_perm_b32 v196, v22, v18, s29
  v_mfma_f32_16x16x32_bf16 a[84:87], v[132:135], v[228:231], a[84:87]
  buffer_load_dwordx4 v[100:103], v4, s[60:63], s24 offen
  v_perm_b32 v197, v30, v26, s29
  v_mfma_f32_16x16x32_bf16 a[88:91], v[136:139], v[228:231], a[88:91]
  s_add_u32 s24, s24, 4096
  v_perm_b32 v198, v38, v34, s29
  v_mfma_f32_16x16x32_bf16 a[92:95], v[140:143], v[228:231], a[92:95]
  buffer_load_dwordx4 v[104:107], v4, s[60:63], s24 offen
  v_perm_b32 v199, v46, v42, s29
  v_mfma_f32_16x16x32_bf16 a[96:99], v[128:131], v[232:235], a[96:99]
  s_add_u32 s24, s24, 4096
  v_perm_b32 v200, v23, v19, s28
  v_mfma_f32_16x16x32_bf16 a[100:103], v[132:135], v[232:235], a[100:103]
  buffer_load_dwordx4 v[108:111], v4, s[60:63], s24 offen
  v_perm_b32 v201, v31, v27, s28
  v_mfma_f32_16x16x32_bf16 a[104:107], v[136:139], v[232:235], a[104:107]
  buffer_load_dwordx4 v[112:115], v1, s[4:7], s25 offen sc1
  v_perm_b32 v202, v39, v35, s28
  v_mfma_f32_16x16x32_bf16 a[108:111], v[140:143], v[232:235], a[108:111]
  s_add_u32 s25, s25, s26
  v_perm_b32 v203, v47, v43, s28
  v_mfma_f32_16x16x32_bf16 a[112:115], v[128:131], v[236:239], a[112:115]
  buffer_load_dwordx4 v[116:119], v1, s[4:7], s25 offen sc1
  v_perm_b32 v204, v23, v19, s29
  v_mfma_f32_16x16x32_bf16 a[116:119], v[132:135], v[236:239], a[116:119]
  s_add_u32 s25, s25, s26
  v_perm_b32 v205, v31, v27, s29
  v_mfma_f32_16x16x32_bf16 a[120:123], v[136:139], v[236:239], a[120:123]
  buffer_load_dwordx4 v[120:123], v1, s[4:7], s25 offen sc1
  v_perm_b32 v206, v39, v35, s29
  v_mfma_f32_16x16x32_bf16 a[124:127], v[140:143], v[236:239], a[124:127]
  s_add_u32 s25, s25, s26
  v_perm_b32 v207, v47, v43, s29
  buffer_load_dwordx4 v[124:127], v1, s[4:7], s25 offen sc1
  s_waitcnt vmcnt(16)
  v_mfma_f32_16x16x32_bf16 a[0:3], v[144:147], v[176:179], a[0:3]
  s_add_u32 s19, s19, 1
  v_perm_b32 v208, v52, v48, s28
  v_mfma_f32_16x16x32_bf16 a[4:7], v[148:151], v[176:179], a[4:7]
  s_cmp_eq_u32 s19, 14
  v_perm_b32 v209, v60, v56, s28
  v_mfma_f32_16x16x32_bf16 a[8:11], v[152:155], v[176:179], a[8:11]
  s_cselect_b32 s19, 0, s19
  v_perm_b32 v210, v68, v64, s28
  v_mfma_f32_16x16x32_bf16 a[12:15], v[156:159], v[176:179], a[12:15]
  s_add_u32 s27, s14, s19
  v_perm_b32 v211, v76, v72, s28
  v_mfma_f32_16x16x32_bf16 a[16:19], v[144:147], v[180:183], a[16:19]
  s_lshr_b32 s24, s27, 2
  v_perm_b32 v212, v52, v48, s29
  v_mfma_f32_16x16x32_bf16 a[20:23], v[148:151], v[180:183], a[20:23]
  s_lshl_b32 s24, s24, 19
  v_perm_b32 v213, v60, v56, s29
  v_mfma_f32_16x16x32_bf16 a[24:27], v[152:155], v[180:183], a[24:27]
  s_and_b32 s27, s27, 3
  v_perm_b32 v214, v68, v64, s29
  v_mfma_f32_16x16x32_bf16 a[28:31], v[156:159], v[180:183], a[28:31]
  s_lshl_b32 s27, s27, 15
  v_perm_b32 v215, v76, v72, s29
  v_mfma_f32_16x16x32_bf16 a[32:35], v[144:147], v[184:187], a[32:35]
  s_add_u32 s24, s24, s27
  v_perm_b32 v216, v53, v49, s28
  v_mfma_f32_16x16x32_bf16 a[36:39], v[148:151], v[184:187], a[36:39]
  s_lshl_b32 s25, s19, 10
  v_perm_b32 v217, v61, v57, s28
  v_mfma_f32_16x16x32_bf16 a[40:43], v[152:155], v[184:187], a[40:43]
  s_add_u32 s25, s25, s15
  v_perm_b32 v218, v69, v65, s28
  v_mfma_f32_16x16x32_bf16 a[44:47], v[156:159], v[184:187], a[44:47]
  buffer_load_dwordx4 v[16:19], v4, s[60:63], s24 offen
  v_perm_b32 v219, v77, v73, s28
  v_mfma_f32_16x16x32_bf16 a[48:51], v[144:147], v[188:191], a[48:51]
  s_add_u32 s24, s24, 4096
  v_perm_b32 v220, v53, v49, s29
  v_mfma_f32_16x16x32_bf16 a[52:55], v[148:151], v[188:191], a[52:55]
  buffer_load_dwordx4 v[20:23], v4, s[60:63], s24 offen
  v_perm_b32 v221, v61, v57, s29
  v_mfma_f32_16x16x32_bf16 a[56:59], v[152:155], v[188:191], a[56:59]
  s_add_u32 s24, s24, 4096
  v_perm_b32 v222, v69, v65, s29
  v_mfma_f32_16x16x32_bf16 a[60:63], v[156:159], v[188:191], a[60:63]
  buffer_load_dwordx4 v[24:27], v4, s[60:63], s24 offen
  v_perm_b32 v223, v77, v73, s29
  v_mfma_f32_16x16x32_bf16 a[64:67], v[144:147], v[192:195], a[64:67]
  s_add_u32 s24, s24, 4096
  v_perm_b32 v224, v54, v50, s28
  v_mfma_f32_16x16x32_bf16 a[68:71], v[148:151], v[192:195], a[68:71]
  buffer_load_dwordx4 v[28:31], v4, s[60:63], s24 offen
  v_perm_b32 v225, v62, v58, s28
  v_mfma_f32_16x16x32_bf16 a[72:75], v[152:155], v[192:195], a[72:75]
  s_add_u32 s24, s24, 4096
  v_perm_b32 v226, v70, v66, s28
  v_mfma_f32_16x16x32_bf16 a[76:79], v[156:159], v[192:195], a[76:79]
  buffer_load_dwordx4 v[32:35], v4, s[60:63], s24 offen
  v_perm_b32 v227, v78, v74, s28
  v_mfma_f32_16x16x32_bf16 a[80:83], v[144:147], v[196:199], a[80:83]
  s_add_u32 s24, s24, 4096
  v_perm_b32 v228, v54, v50, s29
  v_mfma_f32_16x16x32_bf16 a[84:87], v[148:151], v[196:199], a[84:87]
  buffer_load_dwordx4 v[36:39], v4, s[60:63], s24 offen
  v_perm_b32 v229, v62, v58, s29
  v_mfma_f32_16x16x32_bf16 a[88:91], v[152:155], v[196:199], a[88:91]
  s_add_u32 s24, s24, 4096
  v_perm_b32 v230, v70, v66, s29
  v_mfma_f32_16x16x32_bf16 a[92:95], v[156:159], v[196:199], a[92:95]
  buffer_load_dwordx4 v[40:43], v4, s[60:63], s24 offen
  v_perm_b32 v231, v78, v74, s29
  v_mfma_f32_16x16x32_bf16 a[96:99], v[144:147], v[200:203], a[96:99]
  s_add_u32 s24, s24, 4096
  v_perm_b32 v232, v55, v51, s28
  v_mfma_f32_16x16x32_bf16 a[100:103], v[148:151], v[200:203], a[100:103]
  buffer_load_dwordx4 v[44:47], v4, s[60:63], s24 offen
  v_perm_b32 v233, v63, v59, s28
  v_mfma_f32_16x16x32_bf16 a[104:107], v[152:155], v[200:203], a[104:107]
  buffer_load_dwordx4 v[128:131], v1, s[4:7], s25 offen sc1
  v_perm_b32 v234, v71, v67, s28
  v_mfma_f32_16x16x32_bf16 a[108:111], v[156:159], v[200:203], a[108:111]
  s_add_u32 s25, s25, s26
  v_perm_b32 v235, v79, v75, s28
  v_mfma_f32_16x16x32_bf16 a[112:115], v[144:147], v[204:207], a[112:115]
  buffer_load_dwordx4 v[132:135], v1, s[4:7], s25 offen sc1
  v_perm_b32 v236, v55, v51, s29
  v_mfma_f32_16x16x32_bf16 a[116:119], v[148:151], v[204:207], a[116:119]
  s_add_u32 s25, s25, s26
  v_perm_b32 v237, v63, v59, s29
  v_mfma_f32_16x16x32_bf16 a[120:123], v[152:155], v[204:207], a[120:123]
  buffer_load_dwordx4 v[136:139], v1, s[4:7], s25 offen sc1
  v_perm_b32 v238, v71, v67, s29
  v_mfma_f32_16x16x32_bf16 a[124:127], v[156:159], v[204:207], a[124:127]
  s_add_u32 s25, s25, s26
  v_perm_b32 v239, v79, v75, s29
  buffer_load_dwordx4 v[140:143], v1, s[4:7], s25 offen sc1
  s_waitcnt vmcnt(16)
  v_mfma_f32_16x16x32_bf16 a[0:3], v[160:163], v[208:211], a[0:3]
  s_add_u32 s19, s19, 1
  v_perm_b32 v176, v84, v80, s28
  v_mfma_f32_16x16x32_bf16 a[4:7], v[164:167], v[208:211], a[4:7]
  s_cmp_eq_u32 s19, 14
  v_perm_b32 v177, v92, v88, s28
  v_mfma_f32_16x16x32_bf16 a[8:11], v[168:171], v[208:211], a[8:11]
  s_cselect_b32 s19, 0, s19
  v_perm_b32 v178, v100, v96, s28
  v_mfma_f32_16x16x32_bf16 a[12:15], v[172:175], v[208:211], a[12:15]
  s_add_u32 s27, s14, s19
  v_perm_b32 v179, v108, v104, s28
  v_mfma_f32_16x16x32_bf16 a[16:19], v[160:163], v[212:215], a[16:19]
  s_lshr_b32 s24, s27, 2
  v_perm_b32 v180, v84, v80, s29
  v_mfma_f32_16x16x32_bf16 a[20:23], v[164:167], v[212:215], a[20:23]
  s_lshl_b32 s24, s24, 19
  v_perm_b32 v181, v92, v88, s29
  v_mfma_f32_16x16x32_bf16 a[24:27], v[168:171], v[212:215], a[24:27]
  s_and_b32 s27, s27, 3
  v_perm_b32 v182, v100, v96, s29
  v_mfma_f32_16x16x32_bf16 a[28:31], v[172:175], v[212:215], a[28:31]
  s_lshl_b32 s27, s27, 15
  v_perm_b32 v183, v108, v104, s29
  v_mfma_f32_16x16x32_bf16 a[32:35], v[160:163], v[216:219], a[32:35]
  s_add_u32 s24, s24, s27
  v_perm_b32 v184, v85, v81, s28
  v_mfma_f32_16x16x32_bf16 a[36:39], v[164:167], v[216:219], a[36:39]
  s_lshl_b32 s25, s19, 10
  v_perm_b32 v185, v93, v89, s28
  v_mfma_f32_16x16x32_bf16 a[40:43], v[168:171], v[216:219], a[40:43]
  s_add_u32 s25, s25, s15
  v_perm_b32 v186, v101, v97, s28
  v_mfma_f32_16x16x32_bf16 a[44:47], v[172:175], v[216:219], a[44:47]
  buffer_load_dwordx4 v[48:51], v4, s[60:63], s24 offen
  v_perm_b32 v187, v109, v105, s28
  v_mfma_f32_16x16x32_bf16 a[48:51], v[160:163], v[220:223], a[48:51]
  s_add_u32 s24, s24, 4096
  v_perm_b32 v188, v85, v81, s29
  v_mfma_f32_16x16x32_bf16 a[52:55], v[164:167], v[220:223], a[52:55]
  buffer_load_dwordx4 v[52:55], v4, s[60:63], s24 offen
  v_perm_b32 v189, v93, v89, s29
  v_mfma_f32_16x16x32_bf16 a[56:59], v[168:171], v[220:223], a[56:59]
  s_add_u32 s24, s24, 4096
  v_perm_b32 v190, v101, v97, s29
  v_mfma_f32_16x16x32_bf16 a[60:63], v[172:175], v[220:223], a[60:63]
  buffer_load_dwordx4 v[56:59], v4, s[60:63], s24 offen
  v_perm_b32 v191, v109, v105, s29
  v_mfma_f32_16x16x32_bf16 a[64:67], v[160:163], v[224:227], a[64:67]
  s_add_u32 s24, s24, 4096
  v_perm_b32 v192, v86, v82, s28
  v_mfma_f32_16x16x32_bf16 a[68:71], v[164:167], v[224:227], a[68:71]
  buffer_load_dwordx4 v[60:63], v4, s[60:63], s24 offen
  v_perm_b32 v193, v94, v90, s28
  v_mfma_f32_16x16x32_bf16 a[72:75], v[168:171], v[224:227], a[72:75]
  s_add_u32 s24, s24, 4096
  v_perm_b32 v194, v102, v98, s28
  v_mfma_f32_16x16x32_bf16 a[76:79], v[172:175], v[224:227], a[76:79]
  buffer_load_dwordx4 v[64:67], v4, s[60:63], s24 offen
  v_perm_b32 v195, v110, v106, s28
  v_mfma_f32_16x16x32_bf16 a[80:83], v[160:163], v[228:231], a[80:83]
  s_add_u32 s24, s24, 4096
  v_perm_b32 v196, v86, v82, s29
  v_mfma_f32_16x16x32_bf16 a[84:87], v[164:167], v[228:231], a[84:87]
  buffer_load_dwordx4 v[68:71], v4, s[60:63], s24 offen
  v_perm_b32 v197, v94, v90, s29
  v_mfma_f32_16x16x32_bf16 a[88:91], v[168:171], v[228:231], a[88:91]
  s_add_u32 s24, s24, 4096
  v_perm_b32 v198, v102, v98, s29
  v_mfma_f32_16x16x32_bf16 a[92:95], v[172:175], v[228:231], a[92:95]
  buffer_load_dwordx4 v[72:75], v4, s[60:63], s24 offen
  v_perm_b32 v199, v110, v106, s29
  v_mfma_f32_16x16x32_bf16 a[96:99], v[160:163], v[232:235], a[96:99]
  s_add_u32 s24, s24, 4096
  v_perm_b32 v200, v87, v83, s28
  v_mfma_f32_16x16x32_bf16 a[100:103], v[164:167], v[232:235], a[100:103]
  buffer_load_dwordx4 v[76:79], v4, s[60:63], s24 offen
  v_perm_b32 v201, v95, v91, s28
  v_mfma_f32_16x16x32_bf16 a[104:107], v[168:171], v[232:235], a[104:107]
  buffer_load_dwordx4 v[144:147], v1, s[4:7], s25 offen sc1
  v_perm_b32 v202, v103, v99, s28
  v_mfma_f32_16x16x32_bf16 a[108:111], v[172:175], v[232:235], a[108:111]
  s_add_u32 s25, s25, s26
  v_perm_b32 v203, v111, v107, s28
  v_mfma_f32_16x16x32_bf16 a[112:115], v[160:163], v[236:239], a[112:115]
  buffer_load_dwordx4 v[148:151], v1, s[4:7], s25 offen sc1
  v_perm_b32 v204, v87, v83, s29
  v_mfma_f32_16x16x32_bf16 a[116:119], v[164:167], v[236:239], a[116:119]
  s_add_u32 s25, s25, s26
  v_perm_b32 v205, v95, v91, s29
  v_mfma_f32_16x16x32_bf16 a[120:123], v[168:171], v[236:239], a[120:123]
  buffer_load_dwordx4 v[152:155], v1, s[4:7], s25 offen sc1
  v_perm_b32 v206, v103, v99, s29
  v_mfma_f32_16x16x32_bf16 a[124:127], v[172:175], v[236:239], a[124:127]
  s_add_u32 s25, s25, s26
  v_perm_b32 v207, v111, v107, s29
  buffer_load_dwordx4 v[156:159], v1, s[4:7], s25 offen sc1
  s_waitcnt vmcnt(16)
  v_mfma_f32_16x16x32_bf16 a[0:3], v[112:115], v[176:179], a[0:3]
  s_add_u32 s19, s19, 1
  v_perm_b32 v208, v20, v16, s28
  v_mfma_f32_16x16x32_bf16 a[4:7], v[116:119], v[176:179], a[4:7]
  s_cmp_eq_u32 s19, 14
  v_perm_b32 v209, v28, v24, s28
  v_mfma_f32_16x16x32_bf16 a[8:11], v[120:123], v[176:179], a[8:11]
  s_cselect_b32 s19, 0, s19
  v_perm_b32 v210, v36, v32, s28
  v_mfma_f32_16x16x32_bf16 a[12:15], v[124:127], v[176:179], a[12:15]
  s_add_u32 s27, s14, s19
  v_perm_b32 v211, v44, v40, s28
  v_mfma_f32_16x16x32_bf16 a[16:19], v[112:115], v[180:183], a[16:19]
  s_lshr_b32 s24, s27, 2
  v_perm_b32 v212, v20, v16, s29
  v_mfma_f32_16x16x32_bf16 a[20:23], v[116:119], v[180:183], a[20:23]
  s_lshl_b32 s24, s24, 19
  v_perm_b32 v213, v28, v24, s29
  v_mfma_f32_16x16x32_bf16 a[24:27], v[120:123], v[180:183], a[24:27]
  s_and_b32 s27, s27, 3
  v_perm_b32 v214, v36, v32, s29
  v_mfma_f32_16x16x32_bf16 a[28:31], v[124:127], v[180:183], a[28:31]
  s_lshl_b32 s27, s27, 15
  v_perm_b32 v215, v44, v40, s29
  v_mfma_f32_16x16x32_bf16 a[32:35], v[112:115], v[184:187], a[32:35]
  s_add_u32 s24, s24, s27
  v_perm_b32 v216, v21, v17, s28
  v_mfma_f32_16x16x32_bf16 a[36:39], v[116:119], v[184:187], a[36:39]
  s_lshl_b32 s25, s19, 10
  v_perm_b32 v217, v29, v25, s28
  v_mfma_f32_16x16x32_bf16 a[40:43], v[120:123], v[184:187], a[40:43]
  s_add_u32 s25, s25, s15
  v_perm_b32 v218, v37, v33, s28
  v_mfma_f32_16x16x32_bf16 a[44:47], v[124:127], v[184:187], a[44:47]
  buffer_load_dwordx4 v[80:83], v4, s[60:63], s24 offen
  v_perm_b32 v219, v45, v41, s28
  v_mfma_f32_16x16x32_bf16 a[48:51], v[112:115], v[188:191], a[48:51]
  s_add_u32 s24, s24, 4096
  v_perm_b32 v220, v21, v17, s29
  v_mfma_f32_16x16x32_bf16 a[52:55], v[116:119], v[188:191], a[52:55]
  buffer_load_dwordx4 v[84:87], v4, s[60:63], s24 offen
  v_perm_b32 v221, v29, v25, s29
  v_mfma_f32_16x16x32_bf16 a[56:59], v[120:123], v[188:191], a[56:59]
  s_add_u32 s24, s24, 4096
  v_perm_b32 v222, v37, v33, s29
  v_mfma_f32_16x16x32_bf16 a[60:63], v[124:127], v[188:191], a[60:63]
  buffer_load_dwordx4 v[88:91], v4, s[60:63], s24 offen
  v_perm_b32 v223, v45, v41, s29
  v_mfma_f32_16x16x32_bf16 a[64:67], v[112:115], v[192:195], a[64:67]
  s_add_u32 s24, s24, 4096
  v_perm_b32 v224, v22, v18, s28
  v_mfma_f32_16x16x32_bf16 a[68:71], v[116:119], v[192:195], a[68:71]
  buffer_load_dwordx4 v[92:95], v4, s[60:63], s24 offen
  v_perm_b32 v225, v30, v26, s28
  v_mfma_f32_16x16x32_bf16 a[72:75], v[120:123], v[192:195], a[72:75]
  s_add_u32 s24, s24, 4096
  v_perm_b32 v226, v38, v34, s28
  v_mfma_f32_16x16x32_bf16 a[76:79], v[124:127], v[192:195], a[76:79]
  buffer_load_dwordx4 v[96:99], v4, s[60:63], s24 offen
  v_perm_b32 v227, v46, v42, s28
  v_mfma_f32_16x16x32_bf16 a[80:83], v[112:115], v[196:199], a[80:83]
  s_add_u32 s24, s24, 4096
  v_perm_b32 v228, v22, v18, s29
  v_mfma_f32_16x16x32_bf16 a[84:87], v[116:119], v[196:199], a[84:87]
  buffer_load_dwordx4 v[100:103], v4, s[60:63], s24 offen
  v_perm_b32 v229, v30, v26, s29
  v_mfma_f32_16x16x32_bf16 a[88:91], v[120:123], v[196:199], a[88:91]
  s_add_u32 s24, s24, 4096
  v_perm_b32 v230, v38, v34, s29
  v_mfma_f32_16x16x32_bf16 a[92:95], v[124:127], v[196:199], a[92:95]
  buffer_load_dwordx4 v[104:107], v4, s[60:63], s24 offen
  v_perm_b32 v231, v46, v42, s29
  v_mfma_f32_16x16x32_bf16 a[96:99], v[112:115], v[200:203], a[96:99]
  s_add_u32 s24, s24, 4096
  v_perm_b32 v232, v23, v19, s28
  v_mfma_f32_16x16x32_bf16 a[100:103], v[116:119], v[200:203], a[100:103]
  buffer_load_dwordx4 v[108:111], v4, s[60:63], s24 offen
  v_perm_b32 v233, v31, v27, s28
  v_mfma_f32_16x16x32_bf16 a[104:107], v[120:123], v[200:203], a[104:107]
  buffer_load_dwordx4 v[160:163], v1, s[4:7], s25 offen sc1
  v_perm_b32 v234, v39, v35, s28
  v_mfma_f32_16x16x32_bf16 a[108:111], v[124:127], v[200:203], a[108:111]
  s_add_u32 s25, s25, s26
  v_perm_b32 v235, v47, v43, s28
  v_mfma_f32_16x16x32_bf16 a[112:115], v[112:115], v[204:207], a[112:115]
  buffer_load_dwordx4 v[164:167], v1, s[4:7], s25 offen sc1
  v_perm_b32 v236, v23, v19, s29
  v_mfma_f32_16x16x32_bf16 a[116:119], v[116:119], v[204:207], a[116:119]
  s_add_u32 s25, s25, s26
  v_perm_b32 v237, v31, v27, s29
  v_mfma_f32_16x16x32_bf16 a[120:123], v[120:123], v[204:207], a[120:123]
  buffer_load_dwordx4 v[168:171], v1, s[4:7], s25 offen sc1
  v_perm_b32 v238, v39, v35, s29
  v_mfma_f32_16x16x32_bf16 a[124:127], v[124:127], v[204:207], a[124:127]
  s_add_u32 s25, s25, s26
  v_perm_b32 v239, v47, v43, s29
  buffer_load_dwordx4 v[172:175], v1, s[4:7], s25 offen sc1
  s_waitcnt vmcnt(16)
  v_mfma_f32_16x16x32_bf16 a[0:3], v[128:131], v[208:211], a[0:3]
  s_add_u32 s19, s19, 1
  v_perm_b32 v176, v52, v48, s28
  v_mfma_f32_16x16x32_bf16 a[4:7], v[132:135], v[208:211], a[4:7]
  s_cmp_eq_u32 s19, 14
  v_perm_b32 v177, v60, v56, s28
  v_mfma_f32_16x16x32_bf16 a[8:11], v[136:139], v[208:211], a[8:11]
  s_cselect_b32 s19, 0, s19
  v_perm_b32 v178, v68, v64, s28
  v_mfma_f32_16x16x32_bf16 a[12:15], v[140:143], v[208:211], a[12:15]
  s_add_u32 s27, s14, s19
  v_perm_b32 v179, v76, v72, s28
  v_mfma_f32_16x16x32_bf16 a[16:19], v[128:131], v[212:215], a[16:19]
  s_lshr_b32 s24, s27, 2
  v_perm_b32 v180, v52, v48, s29
  v_mfma_f32_16x16x32_bf16 a[20:23], v[132:135], v[212:215], a[20:23]
  s_lshl_b32 s24, s24, 19
  v_perm_b32 v181, v60, v56, s29
  v_mfma_f32_16x16x32_bf16 a[24:27], v[136:139], v[212:215], a[24:27]
  s_and_b32 s27, s27, 3
  v_perm_b32 v182, v68, v64, s29
  v_mfma_f32_16x16x32_bf16 a[28:31], v[140:143], v[212:215], a[28:31]
  s_lshl_b32 s27, s27, 15
  v_perm_b32 v183, v76, v72, s29
  v_mfma_f32_16x16x32_bf16 a[32:35], v[128:131], v[216:219], a[32:35]
  s_add_u32 s24, s24, s27
  v_perm_b32 v184, v53, v49, s28
  v_mfma_f32_16x16x32_bf16 a[36:39], v[132:135], v[216:219], a[36:39]
  s_lshl_b32 s25, s19, 10
  v_perm_b32 v185, v61, v57, s28
  v_mfma_f32_16x16x32_bf16 a[40:43], v[136:139], v[216:219], a[40:43]
  s_add_u32 s25, s25, s15
  v_perm_b32 v186, v69, v65, s28
  v_mfma_f32_16x16x32_bf16 a[44:47], v[140:143], v[216:219], a[44:47]
  buffer_load_dwordx4 v[16:19], v4, s[60:63], s24 offen
  v_perm_b32 v187, v77, v73, s28
  v_mfma_f32_16x16x32_bf16 a[48:51], v[128:131], v[220:223], a[48:51]
  s_add_u32 s24, s24, 4096
  v_perm_b32 v188, v53, v49, s29
  v_mfma_f32_16x16x32_bf16 a[52:55], v[132:135], v[220:223], a[52:55]
  buffer_load_dwordx4 v[20:23], v4, s[60:63], s24 offen
  v_perm_b32 v189, v61, v57, s29
  v_mfma_f32_16x16x32_bf16 a[56:59], v[136:139], v[220:223], a[56:59]
  s_add_u32 s24, s24, 4096
  v_perm_b32 v190, v69, v65, s29
  v_mfma_f32_16x16x32_bf16 a[60:63], v[140:143], v[220:223], a[60:63]
  buffer_load_dwordx4 v[24:27], v4, s[60:63], s24 offen
  v_perm_b32 v191, v77, v73, s29
  v_mfma_f32_16x16x32_bf16 a[64:67], v[128:131], v[224:227], a[64:67]
  s_add_u32 s24, s24, 4096
  v_perm_b32 v192, v54, v50, s28
  v_mfma_f32_16x16x32_bf16 a[68:71], v[132:135], v[224:227], a[68:71]
  buffer_load_dwordx4 v[28:31], v4, s[60:63], s24 offen
  v_perm_b32 v193, v62, v58, s28
  v_mfma_f32_16x16x32_bf16 a[72:75], v[136:139], v[224:227], a[72:75]
  s_add_u32 s24, s24, 4096
  v_perm_b32 v194, v70, v66, s28
  v_mfma_f32_16x16x32_bf16 a[76:79], v[140:143], v[224:227], a[76:79]
  buffer_load_dwordx4 v[32:35], v4, s[60:63], s24 offen
  v_perm_b32 v195, v78, v74, s28
  v_mfma_f32_16x16x32_bf16 a[80:83], v[128:131], v[228:231], a[80:83]
  s_add_u32 s24, s24, 4096
  v_perm_b32 v196, v54, v50, s29
  v_mfma_f32_16x16x32_bf16 a[84:87], v[132:135], v[228:231], a[84:87]
  buffer_load_dwordx4 v[36:39], v4, s[60:63], s24 offen
  v_perm_b32 v197, v62, v58, s29
  v_mfma_f32_16x16x32_bf16 a[88:91], v[136:139], v[228:231], a[88:91]
  s_add_u32 s24, s24, 4096
  v_perm_b32 v198, v70, v66, s29
  v_mfma_f32_16x16x32_bf16 a[92:95], v[140:143], v[228:231], a[92:95]
  buffer_load_dwordx4 v[40:43], v4, s[60:63], s24 offen
  v_perm_b32 v199, v78, v74, s29
  v_mfma_f32_16x16x32_bf16 a[96:99], v[128:131], v[232:235], a[96:99]
  s_add_u32 s24, s24, 4096
  v_perm_b32 v200, v55, v51, s28
  v_mfma_f32_16x16x32_bf16 a[100:103], v[132:135], v[232:235], a[100:103]
  buffer_load_dwordx4 v[44:47], v4, s[60:63], s24 offen
  v_perm_b32 v201, v63, v59, s28
  v_mfma_f32_16x16x32_bf16 a[104:107], v[136:139], v[232:235], a[104:107]
  buffer_load_dwordx4 v[112:115], v1, s[4:7], s25 offen sc1
  v_perm_b32 v202, v71, v67, s28
  v_mfma_f32_16x16x32_bf16 a[108:111], v[140:143], v[232:235], a[108:111]
  s_add_u32 s25, s25, s26
  v_perm_b32 v203, v79, v75, s28
  v_mfma_f32_16x16x32_bf16 a[112:115], v[128:131], v[236:239], a[112:115]
  buffer_load_dwordx4 v[116:119], v1, s[4:7], s25 offen sc1
  v_perm_b32 v204, v55, v51, s29
  v_mfma_f32_16x16x32_bf16 a[116:119], v[132:135], v[236:239], a[116:119]
  s_add_u32 s25, s25, s26
  v_perm_b32 v205, v63, v59, s29
  v_mfma_f32_16x16x32_bf16 a[120:123], v[136:139], v[236:239], a[120:123]
  buffer_load_dwordx4 v[120:123], v1, s[4:7], s25 offen sc1
  v_perm_b32 v206, v71, v67, s29
  v_mfma_f32_16x16x32_bf16 a[124:127], v[140:143], v[236:239], a[124:127]
  s_add_u32 s25, s25, s26
  v_perm_b32 v207, v79, v75, s29
  buffer_load_dwordx4 v[124:127], v1, s[4:7], s25 offen sc1
  s_waitcnt vmcnt(16)
  v_mfma_f32_16x16x32_bf16 a[0:3], v[144:147], v[176:179], a[0:3]
  s_add_u32 s19, s19, 1
  v_perm_b32 v208, v84, v80, s28
  v_mfma_f32_16x16x32_bf16 a[4:7], v[148:151], v[176:179], a[4:7]
  s_cmp_eq_u32 s19, 14
  v_perm_b32 v209, v92, v88, s28
  v_mfma_f32_16x16x32_bf16 a[8:11], v[152:155], v[176:179], a[8:11]
  s_cselect_b32 s19, 0, s19
  v_perm_b32 v210, v100, v96, s28
  v_mfma_f32_16x16x32_bf16 a[12:15], v[156:159], v[176:179], a[12:15]
  s_add_u32 s27, s14, s19
  v_perm_b32 v211, v108, v104, s28
  v_mfma_f32_16x16x32_bf16 a[16:19], v[144:147], v[180:183], a[16:19]
  s_lshr_b32 s24, s27, 2
  v_perm_b32 v212, v84, v80, s29
  v_mfma_f32_16x16x32_bf16 a[20:23], v[148:151], v[180:183], a[20:23]
  s_lshl_b32 s24, s24, 19
  v_perm_b32 v213, v92, v88, s29
  v_mfma_f32_16x16x32_bf16 a[24:27], v[152:155], v[180:183], a[24:27]
  s_and_b32 s27, s27, 3
  v_perm_b32 v214, v100, v96, s29
  v_mfma_f32_16x16x32_bf16 a[28:31], v[156:159], v[180:183], a[28:31]
  s_lshl_b32 s27, s27, 15
  v_perm_b32 v215, v108, v104, s29
  v_mfma_f32_16x16x32_bf16 a[32:35], v[144:147], v[184:187], a[32:35]
  s_add_u32 s24, s24, s27
  v_perm_b32 v216, v85, v81, s28
  v_mfma_f32_16x16x32_bf16 a[36:39], v[148:151], v[184:187], a[36:39]
  s_lshl_b32 s25, s19, 10
  v_perm_b32 v217, v93, v89, s28
  v_mfma_f32_16x16x32_bf16 a[40:43], v[152:155], v[184:187], a[40:43]
  s_add_u32 s25, s25, s15
  v_perm_b32 v218, v101, v97, s28
  v_mfma_f32_16x16x32_bf16 a[44:47], v[156:159], v[184:187], a[44:47]
  buffer_load_dwordx4 v[48:51], v4, s[60:63], s24 offen
  v_perm_b32 v219, v109, v105, s28
  v_mfma_f32_16x16x32_bf16 a[48:51], v[144:147], v[188:191], a[48:51]
  s_add_u32 s24, s24, 4096
  v_perm_b32 v220, v85, v81, s29
  v_mfma_f32_16x16x32_bf16 a[52:55], v[148:151], v[188:191], a[52:55]
  buffer_load_dwordx4 v[52:55], v4, s[60:63], s24 offen
  v_perm_b32 v221, v93, v89, s29
  v_mfma_f32_16x16x32_bf16 a[56:59], v[152:155], v[188:191], a[56:59]
  s_add_u32 s24, s24, 4096
  v_perm_b32 v222, v101, v97, s29
  v_mfma_f32_16x16x32_bf16 a[60:63], v[156:159], v[188:191], a[60:63]
  buffer_load_dwordx4 v[56:59], v4, s[60:63], s24 offen
  v_perm_b32 v223, v109, v105, s29
  v_mfma_f32_16x16x32_bf16 a[64:67], v[144:147], v[192:195], a[64:67]
  s_add_u32 s24, s24, 4096
  v_perm_b32 v224, v86, v82, s28
  v_mfma_f32_16x16x32_bf16 a[68:71], v[148:151], v[192:195], a[68:71]
  buffer_load_dwordx4 v[60:63], v4, s[60:63], s24 offen
  v_perm_b32 v225, v94, v90, s28
  v_mfma_f32_16x16x32_bf16 a[72:75], v[152:155], v[192:195], a[72:75]
  s_add_u32 s24, s24, 4096
  v_perm_b32 v226, v102, v98, s28
  v_mfma_f32_16x16x32_bf16 a[76:79], v[156:159], v[192:195], a[76:79]
  buffer_load_dwordx4 v[64:67], v4, s[60:63], s24 offen
  v_perm_b32 v227, v110, v106, s28
  v_mfma_f32_16x16x32_bf16 a[80:83], v[144:147], v[196:199], a[80:83]
  s_add_u32 s24, s24, 4096
  v_perm_b32 v228, v86, v82, s29
  v_mfma_f32_16x16x32_bf16 a[84:87], v[148:151], v[196:199], a[84:87]
  buffer_load_dwordx4 v[68:71], v4, s[60:63], s24 offen
  v_perm_b32 v229, v94, v90, s29
  v_mfma_f32_16x16x32_bf16 a[88:91], v[152:155], v[196:199], a[88:91]
  s_add_u32 s24, s24, 4096
  v_perm_b32 v230, v102, v98, s29
  v_mfma_f32_16x16x32_bf16 a[92:95], v[156:159], v[196:199], a[92:95]
  buffer_load_dwordx4 v[72:75], v4, s[60:63], s24 offen
  v_perm_b32 v231, v110, v106, s29
  v_mfma_f32_16x16x32_bf16 a[96:99], v[144:147], v[200:203], a[96:99]
  s_add_u32 s24, s24, 4096
  v_perm_b32 v232, v87, v83, s28
  v_mfma_f32_16x16x32_bf16 a[100:103], v[148:151], v[200:203], a[100:103]
  buffer_load_dwordx4 v[76:79], v4, s[60:63], s24 offen
  v_perm_b32 v233, v95, v91, s28
  v_mfma_f32_16x16x32_bf16 a[104:107], v[152:155], v[200:203], a[104:107]
  buffer_load_dwordx4 v[128:131], v1, s[4:7], s25 offen sc1
  v_perm_b32 v234, v103, v99, s28
  v_mfma_f32_16x16x32_bf16 a[108:111], v[156:159], v[200:203], a[108:111]
  s_add_u32 s25, s25, s26
  v_perm_b32 v235, v111, v107, s28
  v_mfma_f32_16x16x32_bf16 a[112:115], v[144:147], v[204:207], a[112:115]
  buffer_load_dwordx4 v[132:135], v1, s[4:7], s25 offen sc1
  v_perm_b32 v236, v87, v83, s29
  v_mfma_f32_16x16x32_bf16 a[116:119], v[148:151], v[204:207], a[116:119]
  s_add_u32 s25, s25, s26
  v_perm_b32 v237, v95, v91, s29
  v_mfma_f32_16x16x32_bf16 a[120:123], v[152:155], v[204:207], a[120:123]
  buffer_load_dwordx4 v[136:139], v1, s[4:7], s25 offen sc1
  v_perm_b32 v238, v103, v99, s29
  v_mfma_f32_16x16x32_bf16 a[124:127], v[156:159], v[204:207], a[124:127]
  s_add_u32 s25, s25, s26
  v_perm_b32 v239, v111, v107, s29
  buffer_load_dwordx4 v[140:143], v1, s[4:7], s25 offen sc1
  s_waitcnt vmcnt(16)
  v_mfma_f32_16x16x32_bf16 a[0:3], v[160:163], v[208:211], a[0:3]
  v_perm_b32 v176, v20, v16, s28
  v_mfma_f32_16x16x32_bf16 a[4:7], v[164:167], v[208:211], a[4:7]
  v_perm_b32 v177, v28, v24, s28
  v_mfma_f32_16x16x32_bf16 a[8:11], v[168:171], v[208:211], a[8:11]
  v_perm_b32 v178, v36, v32, s28
  v_mfma_f32_16x16x32_bf16 a[12:15], v[172:175], v[208:211], a[12:15]
  v_perm_b32 v179, v44, v40, s28
  v_mfma_f32_16x16x32_bf16 a[16:19], v[160:163], v[212:215], a[16:19]
  v_perm_b32 v180, v20, v16, s29
  v_mfma_f32_16x16x32_bf16 a[20:23], v[164:167], v[212:215], a[20:23]
  v_perm_b32 v181, v28, v24, s29
  v_mfma_f32_16x16x32_bf16 a[24:27], v[168:171], v[212:215], a[24:27]
  v_perm_b32 v182, v36, v32, s29
  v_mfma_f32_16x16x32_bf16 a[28:31], v[172:175], v[212:215], a[28:31]
  v_perm_b32 v183, v44, v40, s29
  v_mfma_f32_16x16x32_bf16 a[32:35], v[160:163], v[216:219], a[32:35]
  v_perm_b32 v184, v21, v17, s28
  v_mfma_f32_16x16x32_bf16 a[36:39], v[164:167], v[216:219], a[36:39]
  v_perm_b32 v185, v29, v25, s28
  v_mfma_f32_16x16x32_bf16 a[40:43], v[168:171], v[216:219], a[40:43]
  v_perm_b32 v186, v37, v33, s28
  v_mfma_f32_16x16x32_bf16 a[44:47], v[172:175], v[216:219], a[44:47]
  v_perm_b32 v187, v45, v41, s28
  v_mfma_f32_16x16x32_bf16 a[48:51], v[160:163], v[220:223], a[48:51]
  v_perm_b32 v188, v21, v17, s29
  v_mfma_f32_16x16x32_bf16 a[52:55], v[164:167], v[220:223], a[52:55]
  v_perm_b32 v189, v29, v25, s29
  v_mfma_f32_16x16x32_bf16 a[56:59], v[168:171], v[220:223], a[56:59]
  v_perm_b32 v190, v37, v33, s29
  v_mfma_f32_16x16x32_bf16 a[60:63], v[172:175], v[220:223], a[60:63]
  v_perm_b32 v191, v45, v41, s29
  v_mfma_f32_16x16x32_bf16 a[64:67], v[160:163], v[224:227], a[64:67]
  v_perm_b32 v192, v22, v18, s28
  v_mfma_f32_16x16x32_bf16 a[68:71], v[164:167], v[224:227], a[68:71]
  v_perm_b32 v193, v30, v26, s28
  v_mfma_f32_16x16x32_bf16 a[72:75], v[168:171], v[224:227], a[72:75]
  v_perm_b32 v194, v38, v34, s28
  v_mfma_f32_16x16x32_bf16 a[76:79], v[172:175], v[224:227], a[76:79]
  v_perm_b32 v195, v46, v42, s28
  v_mfma_f32_16x16x32_bf16 a[80:83], v[160:163], v[228:231], a[80:83]
  v_perm_b32 v196, v22, v18, s29
  v_mfma_f32_16x16x32_bf16 a[84:87], v[164:167], v[228:231], a[84:87]
  v_perm_b32 v197, v30, v26, s29
  v_mfma_f32_16x16x32_bf16 a[88:91], v[168:171], v[228:231], a[88:91]
  v_perm_b32 v198, v38, v34, s29
  v_mfma_f32_16x16x32_bf16 a[92:95], v[172:175], v[228:231], a[92:95]
  v_perm_b32 v199, v46, v42, s29
  v_mfma_f32_16x16x32_bf16 a[96:99], v[160:163], v[232:235], a[96:99]
  v_perm_b32 v200, v23, v19, s28
  v_mfma_f32_16x16x32_bf16 a[100:103], v[164:167], v[232:235], a[100:103]
  v_perm_b32 v201, v31, v27, s28
  v_mfma_f32_16x16x32_bf16 a[104:107], v[168:171], v[232:235], a[104:107]
  v_perm_b32 v202, v39, v35, s28
  v_mfma_f32_16x16x32_bf16 a[108:111], v[172:175], v[232:235], a[108:111]
  v_perm_b32 v203, v47, v43, s28
  v_mfma_f32_16x16x32_bf16 a[112:115], v[160:163], v[236:239], a[112:115]
  v_perm_b32 v204, v23, v19, s29
  v_mfma_f32_16x16x32_bf16 a[116:119], v[164:167], v[236:239], a[116:119]
  v_perm_b32 v205, v31, v27, s29
  v_mfma_f32_16x16x32_bf16 a[120:123], v[168:171], v[236:239], a[120:123]
  v_perm_b32 v206, v39, v35, s29
  v_mfma_f32_16x16x32_bf16 a[124:127], v[172:175], v[236:239], a[124:127]
  v_perm_b32 v207, v47, v43, s29
  s_waitcnt vmcnt(4)
  v_mfma_f32_16x16x32_bf16 a[0:3], v[112:115], v[176:179], a[0:3]
  v_perm_b32 v208, v52, v48, s28
  v_mfma_f32_16x16x32_bf16 a[4:7], v[116:119], v[176:179], a[4:7]
  v_perm_b32 v209, v60, v56, s28
  v_mfma_f32_16x16x32_bf16 a[8:11], v[120:123], v[176:179], a[8:11]
  v_perm_b32 v210, v68, v64, s28
  v_mfma_f32_16x16x32_bf16 a[12:15], v[124:127], v[176:179], a[12:15]
  v_perm_b32 v211, v76, v72, s28
  v_mfma_f32_16x16x32_bf16 a[16:19], v[112:115], v[180:183], a[16:19]
  v_perm_b32 v212, v52, v48, s29
  v_mfma_f32_16x16x32_bf16 a[20:23], v[116:119], v[180:183], a[20:23]
  v_perm_b32 v213, v60, v56, s29
  v_mfma_f32_16x16x32_bf16 a[24:27], v[120:123], v[180:183], a[24:27]
  v_perm_b32 v214, v68, v64, s29
  v_mfma_f32_16x16x32_bf16 a[28:31], v[124:127], v[180:183], a[28:31]
  v_perm_b32 v215, v76, v72, s29
  v_mfma_f32_16x16x32_bf16 a[32:35], v[112:115], v[184:187], a[32:35]
  v_perm_b32 v216, v53, v49, s28
  v_mfma_f32_16x16x32_bf16 a[36:39], v[116:119], v[184:187], a[36:39]
  v_perm_b32 v217, v61, v57, s28
  v_mfma_f32_16x16x32_bf16 a[40:43], v[120:123], v[184:187], a[40:43]
  v_perm_b32 v218, v69, v65, s28
  v_mfma_f32_16x16x32_bf16 a[44:47], v[124:127], v[184:187], a[44:47]
  v_perm_b32 v219, v77, v73, s28
  v_mfma_f32_16x16x32_bf16 a[48:51], v[112:115], v[188:191], a[48:51]
  v_perm_b32 v220, v53, v49, s29
  v_mfma_f32_16x16x32_bf16 a[52:55], v[116:119], v[188:191], a[52:55]
  v_perm_b32 v221, v61, v57, s29
  v_mfma_f32_16x16x32_bf16 a[56:59], v[120:123], v[188:191], a[56:59]
  v_perm_b32 v222, v69, v65, s29
  v_mfma_f32_16x16x32_bf16 a[60:63], v[124:127], v[188:191], a[60:63]
  v_perm_b32 v223, v77, v73, s29
  v_mfma_f32_16x16x32_bf16 a[64:67], v[112:115], v[192:195], a[64:67]
  v_perm_b32 v224, v54, v50, s28
  v_mfma_f32_16x16x32_bf16 a[68:71], v[116:119], v[192:195], a[68:71]
  v_perm_b32 v225, v62, v58, s28
  v_mfma_f32_16x16x32_bf16 a[72:75], v[120:123], v[192:195], a[72:75]
  v_perm_b32 v226, v70, v66, s28
  v_mfma_f32_16x16x32_bf16 a[76:79], v[124:127], v[192:195], a[76:79]
  v_perm_b32 v227, v78, v74, s28
  v_mfma_f32_16x16x32_bf16 a[80:83], v[112:115], v[196:199], a[80:83]
  v_perm_b32 v228, v54, v50, s29
  v_mfma_f32_16x16x32_bf16 a[84:87], v[116:119], v[196:199], a[84:87]
  v_perm_b32 v229, v62, v58, s29
  v_mfma_f32_16x16x32_bf16 a[88:91], v[120:123], v[196:199], a[88:91]
  v_perm_b32 v230, v70, v66, s29
  v_mfma_f32_16x16x32_bf16 a[92:95], v[124:127], v[196:199], a[92:95]
  v_perm_b32 v231, v78, v74, s29
  v_mfma_f32_16x16x32_bf16 a[96:99], v[112:115], v[200:203], a[96:99]
  v_perm_b32 v232, v55, v51, s28
  v_mfma_f32_16x16x32_bf16 a[100:103], v[116:119], v[200:203], a[100:103]
  v_perm_b32 v233, v63, v59, s28
  v_mfma_f32_16x16x32_bf16 a[104:107], v[120:123], v[200:203], a[104:107]
  v_perm_b32 v234, v71, v67, s28
  v_mfma_f32_16x16x32_bf16 a[108:111], v[124:127], v[200:203], a[108:111]
  v_perm_b32 v235, v79, v75, s28
  v_mfma_f32_16x16x32_bf16 a[112:115], v[112:115], v[204:207], a[112:115]
  v_perm_b32 v236, v55, v51, s29
  v_mfma_f32_16x16x32_bf16 a[116:119], v[116:119], v[204:207], a[116:119]
  v_perm_b32 v237, v63, v59, s29
  v_mfma_f32_16x16x32_bf16 a[120:123], v[120:123], v[204:207], a[120:123]
  v_perm_b32 v238, v71, v67, s29
  v_mfma_f32_16x16x32_bf16 a[124:127], v[124:127], v[204:207], a[124:127]
  v_perm_b32 v239, v79, v75, s29
  s_waitcnt vmcnt(0)
  v_mfma_f32_16x16x32_bf16 a[0:3], v[128:131], v[208:211], a[0:3]
  v_mfma_f32_16x16x32_bf16 a[4:7], v[132:135], v[208:211], a[4:7]
  v_mfma_f32_16x16x32_bf16 a[8:11], v[136:139], v[208:211], a[8:11]
  v_mfma_f32_16x16x32_bf16 a[12:15], v[140:143], v[208:211], a[12:15]
  v_mfma_f32_16x16x32_bf16 a[16:19], v[128:131], v[212:215], a[16:19]
  v_mfma_f32_16x16x32_bf16 a[20:23], v[132:135], v[212:215], a[20:23]
  v_mfma_f32_16x16x32_bf16 a[24:27], v[136:139], v[212:215], a[24:27]
  v_mfma_f32_16x16x32_bf16 a[28:31], v[140:143], v[212:215], a[28:31]
  v_mfma_f32_16x16x32_bf16 a[32:35], v[128:131], v[216:219], a[32:35]
  v_mfma_f32_16x16x32_bf16 a[36:39], v[132:135], v[216:219], a[36:39]
  v_mfma_f32_16x16x32_bf16 a[40:43], v[136:139], v[216:219], a[40:43]
  v_mfma_f32_16x16x32_bf16 a[44:47], v[140:143], v[216:219], a[44:47]
  v_mfma_f32_16x16x32_bf16 a[48:51], v[128:131], v[220:223], a[48:51]
  v_mfma_f32_16x16x32_bf16 a[52:55], v[132:135], v[220:223], a[52:55]
  v_mfma_f32_16x16x32_bf16 a[56:59], v[136:139], v[220:223], a[56:59]
  v_mfma_f32_16x16x32_bf16 a[60:63], v[140:143], v[220:223], a[60:63]
  v_mfma_f32_16x16x32_bf16 a[64:67], v[128:131], v[224:227], a[64:67]
  v_mfma_f32_16x16x32_bf16 a[68:71], v[132:135], v[224:227], a[68:71]
  v_mfma_f32_16x16x32_bf16 a[72:75], v[136:139], v[224:227], a[72:75]
  v_mfma_f32_16x16x32_bf16 a[76:79], v[140:143], v[224:227], a[76:79]
  v_mfma_f32_16x16x32_bf16 a[80:83], v[128:131], v[228:231], a[80:83]
  v_mfma_f32_16x16x32_bf16 a[84:87], v[132:135], v[228:231], a[84:87]
  v_mfma_f32_16x16x32_bf16 a[88:91], v[136:139], v[228:231], a[88:91]
  v_mfma_f32_16x16x32_bf16 a[92:95], v[140:143], v[228:231], a[92:95]
  v_mfma_f32_16x16x32_bf16 a[96:99], v[128:131], v[232:235], a[96:99]
  v_mfma_f32_16x16x32_bf16 a[100:103], v[132:135], v[232:235], a[100:103]
  v_mfma_f32_16x16x32_bf16 a[104:107], v[136:139], v[232:235], a[104:107]
  v_mfma_f32_16x16x32_bf16 a[108:111], v[140:143], v[232:235], a[108:111]
  v_mfma_f32_16x16x32_bf16 a[112:115], v[128:131], v[236:239], a[112:115]
  v_mfma_f32_16x16x32_bf16 a[116:119], v[132:135], v[236:239], a[116:119]
  v_mfma_f32_16x16x32_bf16 a[120:123], v[136:139], v[236:239], a[120:123]
  v_mfma_f32_16x16x32_bf16 a[124:127], v[140:143], v[236:239], a[124:127]
  s_lshl_b32 s24, s13, 13
  v_add_u32 v8, s24, v1
  v_add_u32 v9, 0x10000, v8
  s_lshl_b32 s24, s13, 15
  v_add_u32 v10, s24, v1
  ds_write_b128 v8, a[0:3] offset:0
  ds_write_b128 v8, a[4:7] offset:1024
  ds_write_b128 v8, a[8:11] offset:2048
  ds_write_b128 v8, a[12:15] offset:3072
  ds_write_b128 v8, a[16:19] offset:4096
  ds_write_b128 v8, a[20:23] offset:5120
  ds_write_b128 v8, a[24:27] offset:6144
  ds_write_b128 v8, a[28:31] offset:7168
  s_waitcnt lgkmcnt(0)
  ds_write_b128 v8, a[32:35] offset:32768
  ds_write_b128 v8, a[36:39] offset:33792
  ds_write_b128 v8, a[40:43] offset:34816
  ds_write_b128 v8, a[44:47] offset:35840
  ds_write_b128 v8, a[48:51] offset:36864
  ds_write_b128 v8, a[52:55] offset:37888
  ds_write_b128 v8, a[56:59] offset:38912
  ds_write_b128 v8, a[60:63] offset:39936
  s_waitcnt lgkmcnt(0)
  ds_write_b128 v9, a[64:67] offset:0
  ds_write_b128 v9, a[68:71] offset:1024
  ds_write_b128 v9, a[72:75] offset:2048
  ds_write_b128 v9, a[76:79] offset:3072
  ds_write_b128 v9, a[80:83] offset:4096
  ds_write_b128 v9, a[84:87] offset:5120
  ds_write_b128 v9, a[88:91] offset:6144
  ds_write_b128 v9, a[92:95] offset:7168
  s_waitcnt lgkmcnt(0)
  ds_write_b128 v9, a[96:99] offset:32768
  ds_write_b128 v9, a[100:103] offset:33792
  ds_write_b128 v9, a[104:107] offset:34816
  ds_write_b128 v9, a[108:111] offset:35840
  ds_write_b128 v9, a[112:115] offset:36864
  ds_write_b128 v9, a[116:119] offset:37888
  ds_write_b128 v9, a[120:123] offset:38912
  ds_write_b128 v9, a[124:127] offset:39936
  s_waitcnt lgkmcnt(0)
  s_barrier
  ds_read_b128 v[16:19], v10 offset:0
  ds_read_b128 v[20:23], v10 offset:1024
  ds_read_b128 v[24:27], v10 offset:2048
  ds_read_b128 v[28:31], v10 offset:3072
  ds_read_b128 v[32:35], v10 offset:4096
  ds_read_b128 v[36:39], v10 offset:5120
  ds_read_b128 v[40:43], v10 offset:6144
  ds_read_b128 v[44:47], v10 offset:7168
  s_waitcnt lgkmcnt(0)
  ds_read_b128 v[48:51], v10 offset:8192
  ds_read_b128 v[52:55], v10 offset:9216
  ds_read_b128 v[56:59], v10 offset:10240
  ds_read_b128 v[60:63], v10 offset:11264
  ds_read_b128 v[64:67], v10 offset:12288
  ds_read_b128 v[68:71], v10 offset:13312
  ds_read_b128 v[72:75], v10 offset:14336
  ds_read_b128 v[76:79], v10 offset:15360
  s_waitcnt lgkmcnt(0)
  ds_read_b128 v[80:83], v10 offset:16384
  ds_read_b128 v[84:87], v10 offset:17408
  ds_read_b128 v[88:91], v10 offset:18432
  ds_read_b128 v[92:95], v10 offset:19456
  ds_read_b128 v[96:99], v10 offset:20480
  ds_read_b128 v[100:103], v10 offset:21504
  ds_read_b128 v[104:107], v10 offset:22528
  ds_read_b128 v[108:111], v10 offset:23552
  s_waitcnt lgkmcnt(0)
  ds_read_b128 v[112:115], v10 offset:24576
  ds_read_b128 v[116:119], v10 offset:25600
  ds_read_b128 v[120:123], v10 offset:26624
  ds_read_b128 v[124:127], v10 offset:27648
  ds_read_b128 v[128:131], v10 offset:28672
  ds_read_b128 v[132:135], v10 offset:29696
  ds_read_b128 v[136:139], v10 offset:30720
  ds_read_b128 v[140:143], v10 offset:31744
  s_waitcnt lgkmcnt(0)
  v_add_f32 v16, v16, v48
  v_add_f32 v80, v80, v112
  v_add_f32 v16, v16, v80
  v_add_f32 v17, v17, v49
  v_add_f32 v81, v81, v113
  v_add_f32 v17, v17, v81
  v_add_f32 v18, v18, v50
  v_add_f32 v82, v82, v114
  v_add_f32 v18, v18, v82
  v_add_f32 v19, v19, v51
  v_add_f32 v83, v83, v115
  v_add_f32 v19, v19, v83
  v_add_f32 v20, v20, v52
  v_add_f32 v84, v84, v116
  v_add_f32 v20, v20, v84
  v_add_f32 v21, v21, v53
  v_add_f32 v85, v85, v117
  v_add_f32 v21, v21, v85
  v_add_f32 v22, v22, v54
  v_add_f32 v86, v86, v118
  v_add_f32 v22, v22, v86
  v_add_f32 v23, v23, v55
  v_add_f32 v87, v87, v119
  v_add_f32 v23, v23, v87
  v_add_f32 v24, v24, v56
  v_add_f32 v88, v88, v120
  v_add_f32 v24, v24, v88
  v_add_f32 v25, v25, v57
  v_add_f32 v89, v89, v121
  v_add_f32 v25, v25, v89
  v_add_f32 v26, v26, v58
  v_add_f32 v90, v90, v122
  v_add_f32 v26, v26, v90
  v_add_f32 v27, v27, v59
  v_add_f32 v91, v91, v123
  v_add_f32 v27, v27, v91
  v_add_f32 v28, v28, v60
  v_add_f32 v92, v92, v124
  v_add_f32 v28, v28, v92
  v_add_f32 v29, v29, v61
  v_add_f32 v93, v93, v125
  v_add_f32 v29, v29, v93
  v_add_f32 v30, v30, v62
  v_add_f32 v94, v94, v126
  v_add_f32 v30, v30, v94
  v_add_f32 v31, v31, v63
  v_add_f32 v95, v95, v127
  v_add_f32 v31, v31, v95
  v_add_f32 v32, v32, v64
  v_add_f32 v96, v96, v128
  v_add_f32 v32, v32, v96
  v_add_f32 v33, v33, v65
  v_add_f32 v97, v97, v129
  v_add_f32 v33, v33, v97
  v_add_f32 v34, v34, v66
  v_add_f32 v98, v98, v130
  v_add_f32 v34, v34, v98
  v_add_f32 v35, v35, v67
  v_add_f32 v99, v99, v131
  v_add_f32 v35, v35, v99
  v_add_f32 v36, v36, v68
  v_add_f32 v100, v100, v132
  v_add_f32 v36, v36, v100
  v_add_f32 v37, v37, v69
  v_add_f32 v101, v101, v133
  v_add_f32 v37, v37, v101
  v_add_f32 v38, v38, v70
  v_add_f32 v102, v102, v134
  v_add_f32 v38, v38, v102
  v_add_f32 v39, v39, v71
  v_add_f32 v103, v103, v135
  v_add_f32 v39, v39, v103
  v_add_f32 v40, v40, v72
  v_add_f32 v104, v104, v136
  v_add_f32 v40, v40, v104
  v_add_f32 v41, v41, v73
  v_add_f32 v105, v105, v137
  v_add_f32 v41, v41, v105
  v_add_f32 v42, v42, v74
  v_add_f32 v106, v106, v138
  v_add_f32 v42, v42, v106
  v_add_f32 v43, v43, v75
  v_add_f32 v107, v107, v139
  v_add_f32 v43, v43, v107
  v_add_f32 v44, v44, v76
  v_add_f32 v108, v108, v140
  v_add_f32 v44, v44, v108
  v_add_f32 v45, v45, v77
  v_add_f32 v109, v109, v141
  v_add_f32 v45, v45, v109
  v_add_f32 v46, v46, v78
  v_add_f32 v110, v110, v142
  v_add_f32 v46, v46, v110
  v_add_f32 v47, v47, v79
  v_add_f32 v111, v111, v143
  v_add_f32 v47, v47, v111
  v_lshlrev_b32 v48, 16, v240
  v_and_b32 v49, 0xffff0000, v240
  s_lshl_b32 s24, s12, 14
  s_lshl_b32 s25, s13, 12
  s_add_u32 s24, s24, s25
  s_add_u32 s24, s24, 6291456
  v_add_f32 v16, v16, v48
  v_add_f32 v17, v17, v48
  v_add_f32 v18, v18, v48
  v_add_f32 v19, v19, v48
  v_add_f32 v20, v20, v48
  v_add_f32 v21, v21, v48
  v_add_f32 v22, v22, v48
  v_add_f32 v23, v23, v48
  v_add_f32 v24, v24, v48
  v_add_f32 v25, v25, v48
  v_add_f32 v26, v26, v48
  v_add_f32 v27, v27, v48
  v_add_f32 v28, v28, v48
  v_add_f32 v29, v29, v48
  v_add_f32 v30, v30, v48
  v_add_f32 v31, v31, v48
  v_cvt_pk_bf16_f32 v56, v16, v17
  v_cvt_pk_bf16_f32 v57, v18, v19
  v_cvt_pk_bf16_f32 v58, v20, v21
  v_cvt_pk_bf16_f32 v59, v22, v23
  v_cvt_pk_bf16_f32 v60, v24, v25
  v_cvt_pk_bf16_f32 v61, v26, v27
  v_cvt_pk_bf16_f32 v62, v28, v29
  v_cvt_pk_bf16_f32 v63, v30, v31
  buffer_store_dwordx4 v[56:59], v1, s[4:7], s24 offen offset:0 sc1
  buffer_store_dwordx4 v[60:63], v1, s[4:7], s24 offen offset:1024 sc1
  v_add_f32 v32, v32, v49
  v_add_f32 v33, v33, v49
  v_add_f32 v34, v34, v49
  v_add_f32 v35, v35, v49
  v_add_f32 v36, v36, v49
  v_add_f32 v37, v37, v49
  v_add_f32 v38, v38, v49
  v_add_f32 v39, v39, v49
  v_add_f32 v40, v40, v49
  v_add_f32 v41, v41, v49
  v_add_f32 v42, v42, v49
  v_add_f32 v43, v43, v49
  v_add_f32 v44, v44, v49
  v_add_f32 v45, v45, v49
  v_add_f32 v46, v46, v49
  v_add_f32 v47, v47, v49
  v_cvt_pk_bf16_f32 v64, v32, v33
  v_cvt_pk_bf16_f32 v65, v34, v35
  v_cvt_pk_bf16_f32 v66, v36, v37
  v_cvt_pk_bf16_f32 v67, v38, v39
  v_cvt_pk_bf16_f32 v68, v40, v41
  v_cvt_pk_bf16_f32 v69, v42, v43
  v_cvt_pk_bf16_f32 v70, v44, v45
  v_cvt_pk_bf16_f32 v71, v46, v47
  buffer_store_dwordx4 v[64:67], v1, s[4:7], s24 offen offset:2048 sc1
  buffer_store_dwordx4 v[68:71], v1, s[4:7], s24 offen offset:3072 sc1
  s_waitcnt vmcnt(0)
  s_barrier
  s_cmp_ge_u32 s12, 96
  s_cbranch_scc1 L_g2b_78
  s_cmp_eq_u32 s13, 0
  s_cbranch_scc0 L_arr_80
  v_lshlrev_b32 v5, 10, v0
  v_mov_b32 v6, 1
  buffer_atomic_add v6, v5, s[36:39], 0 offen offset:172 sc0
  s_waitcnt vmcnt(0)
  v_readfirstlane_b32 vcc_lo, v6
  v_mov_b32 v6, 1
  s_cmp_eq_u32 vcc_lo, 95
  s_cbranch_scc0 L_arr_80
  buffer_atomic_add v6, v5, s[36:39], 0 offen offset:44
L_arr_80:
  s_cmp_ge_u32 s12, 64
  s_cbranch_scc0 L_o_79
  s_add_u32 s12, s12, 32
  s_branch L_g2_68
L_g2b_78:
  s_cmp_eq_u32 s13, 0
  s_cbranch_scc0 L_arr_81
  v_lshlrev_b32 v5, 10, v0
  v_mov_b32 v6, 1
  buffer_atomic_add v6, v5, s[36:39], 0 offen offset:176 sc0
  s_waitcnt vmcnt(0)
  v_readfirstlane_b32 vcc_lo, v6
  v_mov_b32 v6, 1
  s_cmp_eq_u32 vcc_lo, 31
  s_cbranch_scc0 L_arr_81
  buffer_atomic_add v6, v5, s[36:39], 0 offen offset:48
L_arr_81:
  s_sub_u32 s12, s12, 32
L_o_79:
  s_and_b32 s16, s12, 7
  s_lshr_b32 s17, s12, 3
  s_cmp_ge_u32 s17, 8
  s_cselect_b32 s24, 32, 0
  s_add_u32 s17, s17, s24
  v_lshlrev_b32 v4, 12, v3
  v_lshl_add_u32 v4, v2, 3, v4
  s_lshl_b32 s19, s13, 3
  s_and_b32 s24, s16, 7
  s_add_u32 s19, s19, s24
  s_lshl_b32 s24, s16, 7
  s_lshl_b32 s25, s19, 17
  s_add_u32 s14, s24, s25
  s_lshl_b32 s24, s13, 15
  v_add_u32 v14, s24, v1
  s_xor_b32 s24, s14, 0
  buffer_load_dwordx2 v[16:17], v4, s[68:71], s24 offen offset:0
  buffer_load_dwordx2 v[18:19], v4, s[68:71], s24 offen offset:1024
  buffer_load_dwordx2 v[20:21], v4, s[68:71], s24 offen offset:2048
  buffer_load_dwordx2 v[22:23], v4, s[68:71], s24 offen offset:3072
  s_xor_b32 s24, s14, 16384
  buffer_load_dwordx2 v[24:25], v4, s[68:71], s24 offen offset:0
  buffer_load_dwordx2 v[26:27], v4, s[68:71], s24 offen offset:1024
  buffer_load_dwordx2 v[28:29], v4, s[68:71], s24 offen offset:2048
  buffer_load_dwordx2 v[30:31], v4, s[68:71], s24 offen offset:3072
  s_xor_b32 s24, s14, 32768
  buffer_load_dwordx2 v[32:33], v4, s[68:71], s24 offen offset:0
  buffer_load_dwordx2 v[34:35], v4, s[68:71], s24 offen offset:1024
  buffer_load_dwordx2 v[36:37], v4, s[68:71], s24 offen offset:2048
  buffer_load_dwordx2 v[38:39], v4, s[68:71], s24 offen offset:3072
  s_xor_b32 s24, s14, 49152
  buffer_load_dwordx2 v[40:41], v4, s[68:71], s24 offen offset:0
  buffer_load_dwordx2 v[42:43], v4, s[68:71], s24 offen offset:1024
  buffer_load_dwordx2 v[44:45], v4, s[68:71], s24 offen offset:2048
  buffer_load_dwordx2 v[46:47], v4, s[68:71], s24 offen offset:3072
  s_xor_b32 s24, s14, 65536
  buffer_load_dwordx2 v[48:49], v4, s[68:71], s24 offen offset:0
  buffer_load_dwordx2 v[50:51], v4, s[68:71], s24 offen offset:1024
  buffer_load_dwordx2 v[52:53], v4, s[68:71], s24 offen offset:2048
  buffer_load_dwordx2 v[54:55], v4, s[68:71], s24 offen offset:3072
  s_xor_b32 s24, s14, 81920
  buffer_load_dwordx2 v[56:57], v4, s[68:71], s24 offen offset:0
  buffer_load_dwordx2 v[58:59], v4, s[68:71], s24 offen offset:1024
  buffer_load_dwordx2 v[60:61], v4, s[68:71], s24 offen offset:2048
  buffer_load_dwordx2 v[62:63], v4, s[68:71], s24 offen offset:3072
  s_xor_b32 s24, s14, 98304
  buffer_load_dwordx2 v[64:65], v4, s[68:71], s24 offen offset:0
  buffer_load_dwordx2 v[66:67], v4, s[68:71], s24 offen offset:1024
  buffer_load_dwordx2 v[68:69], v4, s[68:71], s24 offen offset:2048
  buffer_load_dwordx2 v[70:71], v4, s[68:71], s24 offen offset:3072
  s_xor_b32 s24, s14, 114688
  buffer_load_dwordx2 v[72:73], v4, s[68:71], s24 offen offset:0
  buffer_load_dwordx2 v[74:75], v4, s[68:71], s24 offen offset:1024
  buffer_load_dwordx2 v[76:77], v4, s[68:71], s24 offen offset:2048
  buffer_load_dwordx2 v[78:79], v4, s[68:71], s24 offen offset:3072
  s_xor_b32 s24, s14, 131072
  buffer_load_dwordx2 v[80:81], v4, s[68:71], s24 offen offset:0
  buffer_load_dwordx2 v[82:83], v4, s[68:71], s24 offen offset:1024
  buffer_load_dwordx2 v[84:85], v4, s[68:71], s24 offen offset:2048
  buffer_load_dwordx2 v[86:87], v4, s[68:71], s24 offen offset:3072
  s_xor_b32 s24, s14, 147456
  buffer_load_dwordx2 v[88:89], v4, s[68:71], s24 offen offset:0
  buffer_load_dwordx2 v[90:91], v4, s[68:71], s24 offen offset:1024
  buffer_load_dwordx2 v[92:93], v4, s[68:71], s24 offen offset:2048
  buffer_load_dwordx2 v[94:95], v4, s[68:71], s24 offen offset:3072
  s_waitcnt vmcnt(32)
  s_xor_b32 s24, s14, 163840
  buffer_load_dwordx2 v[96:97], v4, s[68:71], s24 offen offset:0
  buffer_load_dwordx2 v[98:99], v4, s[68:71], s24 offen offset:1024
  buffer_load_dwordx2 v[100:101], v4, s[68:71], s24 offen offset:2048
  buffer_load_dwordx2 v[102:103], v4, s[68:71], s24 offen offset:3072
  s_xor_b32 s24, s14, 180224
  buffer_load_dwordx2 v[104:105], v4, s[68:71], s24 offen offset:0
  buffer_load_dwordx2 v[106:107], v4, s[68:71], s24 offen offset:1024
  buffer_load_dwordx2 v[108:109], v4, s[68:71], s24 offen offset:2048
  buffer_load_dwordx2 v[110:111], v4, s[68:71], s24 offen offset:3072
  v_perm_b32 v112, v18, v16, s28
  v_accvgpr_write_b32 a0, v112
  v_perm_b32 v113, v22, v20, s28
  v_accvgpr_write_b32 a1, v113
  v_perm_b32 v114, v26, v24, s28
  v_accvgpr_write_b32 a2, v114
  v_perm_b32 v115, v30, v28, s28
  v_accvgpr_write_b32 a3, v115
  v_perm_b32 v116, v18, v16, s29
  v_accvgpr_write_b32 a4, v116
  v_perm_b32 v117, v22, v20, s29
  v_accvgpr_write_b32 a5, v117
  v_perm_b32 v118, v26, v24, s29
  v_accvgpr_write_b32 a6, v118
  v_perm_b32 v119, v30, v28, s29
  v_accvgpr_write_b32 a7, v119
  v_perm_b32 v128, v19, v17, s28
  v_perm_b32 v129, v23, v21, s28
  v_perm_b32 v130, v27, v25, s28
  v_perm_b32 v131, v31, v29, s28
  v_perm_b32 v120, v19, v17, s29
  v_perm_b32 v121, v23, v21, s29
  v_perm_b32 v122, v27, v25, s29
  v_perm_b32 v123, v31, v29, s29
  ds_write_b128 v14, v[120:123] offset:0
  s_waitcnt vmcnt(32)
  s_xor_b32 s24, s14, 196608
  buffer_load_dwordx2 v[16:17], v4, s[68:71], s24 offen offset:0
  buffer_load_dwordx2 v[18:19], v4, s[68:71], s24 offen offset:1024
  buffer_load_dwordx2 v[20:21], v4, s[68:71], s24 offen offset:2048
  buffer_load_dwordx2 v[22:23], v4, s[68:71], s24 offen offset:3072
  s_xor_b32 s24, s14, 212992
  buffer_load_dwordx2 v[24:25], v4, s[68:71], s24 offen offset:0
  buffer_load_dwordx2 v[26:27], v4, s[68:71], s24 offen offset:1024
  buffer_load_dwordx2 v[28:29], v4, s[68:71], s24 offen offset:2048
  buffer_load_dwordx2 v[30:31], v4, s[68:71], s24 offen offset:3072
  v_perm_b32 v112, v34, v32, s28
  v_accvgpr_write_b32 a8, v112
  v_perm_b32 v113, v38, v36, s28
  v_accvgpr_write_b32 a9, v113
  v_perm_b32 v114, v42, v40, s28
  v_accvgpr_write_b32 a10, v114
  v_perm_b32 v115, v46, v44, s28
  v_accvgpr_write_b32 a11, v115
  v_perm_b32 v116, v34, v32, s29
  v_accvgpr_write_b32 a12, v116
  v_perm_b32 v117, v38, v36, s29
  v_accvgpr_write_b32 a13, v117
  v_perm_b32 v118, v42, v40, s29
  v_accvgpr_write_b32 a14, v118
  v_perm_b32 v119, v46, v44, s29
  v_accvgpr_write_b32 a15, v119
  v_perm_b32 v132, v35, v33, s28
  v_perm_b32 v133, v39, v37, s28
  v_perm_b32 v134, v43, v41, s28
  v_perm_b32 v135, v47, v45, s28
  v_perm_b32 v124, v35, v33, s29
  v_perm_b32 v125, v39, v37, s29
  v_perm_b32 v126, v43, v41, s29
  v_perm_b32 v127, v47, v45, s29
  ds_write_b128 v14, v[124:127] offset:1024
  s_waitcnt vmcnt(32)
  s_xor_b32 s24, s14, 229376
  buffer_load_dwordx2 v[32:33], v4, s[68:71], s24 offen offset:0
  buffer_load_dwordx2 v[34:35], v4, s[68:71], s24 offen offset:1024
  buffer_load_dwordx2 v[36:37], v4, s[68:71], s24 offen offset:2048
  buffer_load_dwordx2 v[38:39], v4, s[68:71], s24 offen offset:3072
  s_xor_b32 s24, s14, 245760
  buffer_load_dwordx2 v[40:41], v4, s[68:71], s24 offen offset:0
  buffer_load_dwordx2 v[42:43], v4, s[68:71], s24 offen offset:1024
  buffer_load_dwordx2 v[44:45], v4, s[68:71], s24 offen offset:2048
  buffer_load_dwordx2 v[46:47], v4, s[68:71], s24 offen offset:3072
  v_perm_b32 v112, v50, v48, s28
  v_accvgpr_write_b32 a16, v112
  v_perm_b32 v113, v54, v52, s28
  v_accvgpr_write_b32 a17, v113
  v_perm_b32 v114, v58, v56, s28
  v_accvgpr_write_b32 a18, v114
  v_perm_b32 v115, v62, v60, s28
  v_accvgpr_write_b32 a19, v115
  v_perm_b32 v116, v50, v48, s29
  v_accvgpr_write_b32 a20, v116
  v_perm_b32 v117, v54, v52, s29
  v_accvgpr_write_b32 a21, v117
  v_perm_b32 v118, v58, v56, s29
  v_accvgpr_write_b32 a22, v118
  v_perm_b32 v119, v62, v60, s29
  v_accvgpr_write_b32 a23, v119
  v_perm_b32 v136, v51, v49, s28
  v_perm_b32 v137, v55, v53, s28
  v_perm_b32 v138, v59, v57, s28
  v_perm_b32 v139, v63, v61, s28
  v_perm_b32 v120, v51, v49, s29
  v_perm_b32 v121, v55, v53, s29
  v_perm_b32 v122, v59, v57, s29
  v_perm_b32 v123, v63, v61, s29
  ds_write_b128 v14, v[120:123] offset:2048
  s_waitcnt vmcnt(32)
  s_xor_b32 s24, s14, 262144
  buffer_load_dwordx2 v[48:49], v4, s[68:71], s24 offen offset:0
  buffer_load_dwordx2 v[50:51], v4, s[68:71], s24 offen offset:1024
  buffer_load_dwordx2 v[52:53], v4, s[68:71], s24 offen offset:2048
  buffer_load_dwordx2 v[54:55], v4, s[68:71], s24 offen offset:3072
  s_xor_b32 s24, s14, 278528
  buffer_load_dwordx2 v[56:57], v4, s[68:71], s24 offen offset:0
  buffer_load_dwordx2 v[58:59], v4, s[68:71], s24 offen offset:1024
  buffer_load_dwordx2 v[60:61], v4, s[68:71], s24 offen offset:2048
  buffer_load_dwordx2 v[62:63], v4, s[68:71], s24 offen offset:3072
  v_perm_b32 v112, v66, v64, s28
  v_accvgpr_write_b32 a24, v112
  v_perm_b32 v113, v70, v68, s28
  v_accvgpr_write_b32 a25, v113
  v_perm_b32 v114, v74, v72, s28
  v_accvgpr_write_b32 a26, v114
  v_perm_b32 v115, v78, v76, s28
  v_accvgpr_write_b32 a27, v115
  v_perm_b32 v116, v66, v64, s29
  v_accvgpr_write_b32 a28, v116
  v_perm_b32 v117, v70, v68, s29
  v_accvgpr_write_b32 a29, v117
  v_perm_b32 v118, v74, v72, s29
  v_accvgpr_write_b32 a30, v118
  v_perm_b32 v119, v78, v76, s29
  v_accvgpr_write_b32 a31, v119
  v_perm_b32 v140, v67, v65, s28
  v_perm_b32 v141, v71, v69, s28
  v_perm_b32 v142, v75, v73, s28
  v_perm_b32 v143, v79, v77, s28
  v_perm_b32 v124, v67, v65, s29
  v_perm_b32 v125, v71, v69, s29
  v_perm_b32 v126, v75, v73, s29
  v_perm_b32 v127, v79, v77, s29
  ds_write_b128 v14, v[124:127] offset:3072
  s_waitcnt vmcnt(32)
  s_xor_b32 s24, s14, 294912
  buffer_load_dwordx2 v[64:65], v4, s[68:71], s24 offen offset:0
  buffer_load_dwordx2 v[66:67], v4, s[68:71], s24 offen offset:1024
  buffer_load_dwordx2 v[68:69], v4, s[68:71], s24 offen offset:2048
  buffer_load_dwordx2 v[70:71], v4, s[68:71], s24 offen offset:3072
  s_xor_b32 s24, s14, 311296
  buffer_load_dwordx2 v[72:73], v4, s[68:71], s24 offen offset:0
  buffer_load_dwordx2 v[74:75], v4, s[68:71], s24 offen offset:1024
  buffer_load_dwordx2 v[76:77], v4, s[68:71], s24 offen offset:2048
  buffer_load_dwordx2 v[78:79], v4, s[68:71], s24 offen offset:3072
  v_perm_b32 v112, v82, v80, s28
  v_accvgpr_write_b32 a32, v112
  v_perm_b32 v113, v86, v84, s28
  v_accvgpr_write_b32 a33, v113
  v_perm_b32 v114, v90, v88, s28
  v_accvgpr_write_b32 a34, v114
  v_perm_b32 v115, v94, v92, s28
  v_accvgpr_write_b32 a35, v115
  v_perm_b32 v116, v82, v80, s29
  v_accvgpr_write_b32 a36, v116
  v_perm_b32 v117, v86, v84, s29
  v_accvgpr_write_b32 a37, v117
  v_perm_b32 v118, v90, v88, s29
  v_accvgpr_write_b32 a38, v118
  v_perm_b32 v119, v94, v92, s29
  v_accvgpr_write_b32 a39, v119
  v_perm_b32 v144, v83, v81, s28
  v_perm_b32 v145, v87, v85, s28
  v_perm_b32 v146, v91, v89, s28
  v_perm_b32 v147, v95, v93, s28
  v_perm_b32 v120, v83, v81, s29
  v_perm_b32 v121, v87, v85, s29
  v_perm_b32 v122, v91, v89, s29
  v_perm_b32 v123, v95, v93, s29
  ds_write_b128 v14, v[120:123] offset:4096
  s_waitcnt vmcnt(32)
  s_xor_b32 s24, s14, 327680
  buffer_load_dwordx2 v[80:81], v4, s[68:71], s24 offen offset:0
  buffer_load_dwordx2 v[82:83], v4, s[68:71], s24 offen offset:1024
  buffer_load_dwordx2 v[84:85], v4, s[68:71], s24 offen offset:2048
  buffer_load_dwordx2 v[86:87], v4, s[68:71], s24 offen offset:3072
  s_xor_b32 s24, s14, 344064
  buffer_load_dwordx2 v[88:89], v4, s[68:71], s24 offen offset:0
  buffer_load_dwordx2 v[90:91], v4, s[68:71], s24 offen offset:1024
  buffer_load_dwordx2 v[92:93], v4, s[68:71], s24 offen offset:2048
  buffer_load_dwordx2 v[94:95], v4, s[68:71], s24 offen offset:3072
  v_perm_b32 v112, v98, v96, s28
  v_accvgpr_write_b32 a40, v112
  v_perm_b32 v113, v102, v100, s28
  v_accvgpr_write_b32 a41, v113
  v_perm_b32 v114, v106, v104, s28
  v_accvgpr_write_b32 a42, v114
  v_perm_b32 v115, v110, v108, s28
  v_accvgpr_write_b32 a43, v115
  v_perm_b32 v116, v98, v96, s29
  v_accvgpr_write_b32 a44, v116
  v_perm_b32 v117, v102, v100, s29
  v_accvgpr_write_b32 a45, v117
  v_perm_b32 v118, v106, v104, s29
  v_accvgpr_write_b32 a46, v118
  v_perm_b32 v119, v110, v108, s29
  v_accvgpr_write_b32 a47, v119
  v_perm_b32 v148, v99, v97, s28
  v_perm_b32 v149, v103, v101, s28
  v_perm_b32 v150, v107, v105, s28
  v_perm_b32 v151, v111, v109, s28
  v_perm_b32 v124, v99, v97, s29
  v_perm_b32 v125, v103, v101, s29
  v_perm_b32 v126, v107, v105, s29
  v_perm_b32 v127, v111, v109, s29
  ds_write_b128 v14, v[124:127] offset:5120
  s_waitcnt vmcnt(32)
  s_xor_b32 s24, s14, 360448
  buffer_load_dwordx2 v[96:97], v4, s[68:71], s24 offen offset:0
  buffer_load_dwordx2 v[98:99], v4, s[68:71], s24 offen offset:1024
  buffer_load_dwordx2 v[100:101], v4, s[68:71], s24 offen offset:2048
  buffer_load_dwordx2 v[102:103], v4, s[68:71], s24 offen offset:3072
  s_xor_b32 s24, s14, 376832
  buffer_load_dwordx2 v[104:105], v4, s[68:71], s24 offen offset:0
  buffer_load_dwordx2 v[106:107], v4, s[68:71], s24 offen offset:1024
  buffer_load_dwordx2 v[108:109], v4, s[68:71], s24 offen offset:2048
  buffer_load_dwordx2 v[110:111], v4, s[68:71], s24 offen offset:3072
  v_perm_b32 v112, v18, v16, s28
  v_accvgpr_write_b32 a48, v112
  v_perm_b32 v113, v22, v20, s28
  v_accvgpr_write_b32 a49, v113
  v_perm_b32 v114, v26, v24, s28
  v_accvgpr_write_b32 a50, v114
  v_perm_b32 v115, v30, v28, s28
  v_accvgpr_write_b32 a51, v115
  v_perm_b32 v116, v18, v16, s29
  v_accvgpr_write_b32 a52, v116
  v_perm_b32 v117, v22, v20, s29
  v_accvgpr_write_b32 a53, v117
  v_perm_b32 v118, v26, v24, s29
  v_accvgpr_write_b32 a54, v118
  v_perm_b32 v119, v30, v28, s29
  v_accvgpr_write_b32 a55, v119
  v_perm_b32 v152, v19, v17, s28
  v_perm_b32 v153, v23, v21, s28
  v_perm_b32 v154, v27, v25, s28
  v_perm_b32 v155, v31, v29, s28
  v_perm_b32 v120, v19, v17, s29
  v_perm_b32 v121, v23, v21, s29
  v_perm_b32 v122, v27, v25, s29
  v_perm_b32 v123, v31, v29, s29
  ds_write_b128 v14, v[120:123] offset:6144
  s_waitcnt vmcnt(32)
  s_xor_b32 s24, s14, 393216
  buffer_load_dwordx2 v[16:17], v4, s[68:71], s24 offen offset:0
  buffer_load_dwordx2 v[18:19], v4, s[68:71], s24 offen offset:1024
  buffer_load_dwordx2 v[20:21], v4, s[68:71], s24 offen offset:2048
  buffer_load_dwordx2 v[22:23], v4, s[68:71], s24 offen offset:3072
  s_xor_b32 s24, s14, 409600
  buffer_load_dwordx2 v[24:25], v4, s[68:71], s24 offen offset:0
  buffer_load_dwordx2 v[26:27], v4, s[68:71], s24 offen offset:1024
  buffer_load_dwordx2 v[28:29], v4, s[68:71], s24 offen offset:2048
  buffer_load_dwordx2 v[30:31], v4, s[68:71], s24 offen offset:3072
  v_perm_b32 v112, v34, v32, s28
  v_accvgpr_write_b32 a56, v112
  v_perm_b32 v113, v38, v36, s28
  v_accvgpr_write_b32 a57, v113
  v_perm_b32 v114, v42, v40, s28
  v_accvgpr_write_b32 a58, v114
  v_perm_b32 v115, v46, v44, s28
  v_accvgpr_write_b32 a59, v115
  v_perm_b32 v116, v34, v32, s29
  v_accvgpr_write_b32 a60, v116
  v_perm_b32 v117, v38, v36, s29
  v_accvgpr_write_b32 a61, v117
  v_perm_b32 v118, v42, v40, s29
  v_accvgpr_write_b32 a62, v118
  v_perm_b32 v119, v46, v44, s29
  v_accvgpr_write_b32 a63, v119
  v_perm_b32 v156, v35, v33, s28
  v_perm_b32 v157, v39, v37, s28
  v_perm_b32 v158, v43, v41, s28
  v_perm_b32 v159, v47, v45, s28
  v_perm_b32 v124, v35, v33, s29
  v_perm_b32 v125, v39, v37, s29
  v_perm_b32 v126, v43, v41, s29
  v_perm_b32 v127, v47, v45, s29
  ds_write_b128 v14, v[124:127] offset:7168
  s_waitcnt lgkmcnt(0)
  s_waitcnt vmcnt(32)
  s_xor_b32 s24, s14, 425984
  buffer_load_dwordx2 v[32:33], v4, s[68:71], s24 offen offset:0
  buffer_load_dwordx2 v[34:35], v4, s[68:71], s24 offen offset:1024
  buffer_load_dwordx2 v[36:37], v4, s[68:71], s24 offen offset:2048
  buffer_load_dwordx2 v[38:39], v4, s[68:71], s24 offen offset:3072
  s_xor_b32 s24, s14, 442368
  buffer_load_dwordx2 v[40:41], v4, s[68:71], s24 offen offset:0
  buffer_load_dwordx2 v[42:43], v4, s[68:71], s24 offen offset:1024
  buffer_load_dwordx2 v[44:45], v4, s[68:71], s24 offen offset:2048
  buffer_load_dwordx2 v[46:47], v4, s[68:71], s24 offen offset:3072
  v_perm_b32 v112, v50, v48, s28
  v_accvgpr_write_b32 a64, v112
  v_perm_b32 v113, v54, v52, s28
  v_accvgpr_write_b32 a65, v113
  v_perm_b32 v114, v58, v56, s28
  v_accvgpr_write_b32 a66, v114
  v_perm_b32 v115, v62, v60, s28
  v_accvgpr_write_b32 a67, v115
  v_perm_b32 v116, v50, v48, s29
  v_accvgpr_write_b32 a68, v116
  v_perm_b32 v117, v54, v52, s29
  v_accvgpr_write_b32 a69, v117
  v_perm_b32 v118, v58, v56, s29
  v_accvgpr_write_b32 a70, v118
  v_perm_b32 v119, v62, v60, s29
  v_accvgpr_write_b32 a71, v119
  v_perm_b32 v160, v51, v49, s28
  v_perm_b32 v161, v55, v53, s28
  v_perm_b32 v162, v59, v57, s28
  v_perm_b32 v163, v63, v61, s28
  v_perm_b32 v120, v51, v49, s29
  v_perm_b32 v121, v55, v53, s29
  v_perm_b32 v122, v59, v57, s29
  v_perm_b32 v123, v63, v61, s29
  ds_write_b128 v14, v[120:123] offset:8192
  s_waitcnt vmcnt(32)
  s_xor_b32 s24, s14, 458752
  buffer_load_dwordx2 v[48:49], v4, s[68:71], s24 offen offset:0
  buffer_load_dwordx2 v[50:51], v4, s[68:71], s24 offen offset:1024
  buffer_load_dwordx2 v[52:53], v4, s[68:71], s24 offen offset:2048
  buffer_load_dwordx2 v[54:55], v4, s[68:71], s24 offen offset:3072
  s_xor_b32 s24, s14, 475136
  buffer_load_dwordx2 v[56:57], v4, s[68:71], s24 offen offset:0
  buffer_load_dwordx2 v[58:59], v4, s[68:71], s24 offen offset:1024
  buffer_load_dwordx2 v[60:61], v4, s[68:71], s24 offen offset:2048
  buffer_load_dwordx2 v[62:63], v4, s[68:71], s24 offen offset:3072
  v_perm_b32 v112, v66, v64, s28
  v_accvgpr_write_b32 a72, v112
  v_perm_b32 v113, v70, v68, s28
  v_accvgpr_write_b32 a73, v113
  v_perm_b32 v114, v74, v72, s28
  v_accvgpr_write_b32 a74, v114
  v_perm_b32 v115, v78, v76, s28
  v_accvgpr_write_b32 a75, v115
  v_perm_b32 v116, v66, v64, s29
  v_accvgpr_write_b32 a76, v116
  v_perm_b32 v117, v70, v68, s29
  v_accvgpr_write_b32 a77, v117
  v_perm_b32 v118, v74, v72, s29
  v_accvgpr_write_b32 a78, v118
  v_perm_b32 v119, v78, v76, s29
  v_accvgpr_write_b32 a79, v119
  v_perm_b32 v164, v67, v65, s28
  v_perm_b32 v165, v71, v69, s28
  v_perm_b32 v166, v75, v73, s28
  v_perm_b32 v167, v79, v77, s28
  v_perm_b32 v124, v67, v65, s29
  v_perm_b32 v125, v71, v69, s29
  v_perm_b32 v126, v75, v73, s29
  v_perm_b32 v127, v79, v77, s29
  ds_write_b128 v14, v[124:127] offset:9216
  s_waitcnt vmcnt(32)
  s_xor_b32 s24, s14, 491520
  buffer_load_dwordx2 v[64:65], v4, s[68:71], s24 offen offset:0
  buffer_load_dwordx2 v[66:67], v4, s[68:71], s24 offen offset:1024
  buffer_load_dwordx2 v[68:69], v4, s[68:71], s24 offen offset:2048
  buffer_load_dwordx2 v[70:71], v4, s[68:71], s24 offen offset:3072
  s_xor_b32 s24, s14, 507904
  buffer_load_dwordx2 v[72:73], v4, s[68:71], s24 offen offset:0
  buffer_load_dwordx2 v[74:75], v4, s[68:71], s24 offen offset:1024
  buffer_load_dwordx2 v[76:77], v4, s[68:71], s24 offen offset:2048
  buffer_load_dwordx2 v[78:79], v4, s[68:71], s24 offen offset:3072
  v_perm_b32 v112, v82, v80, s28
  v_accvgpr_write_b32 a80, v112
  v_perm_b32 v113, v86, v84, s28
  v_accvgpr_write_b32 a81, v113
  v_perm_b32 v114, v90, v88, s28
  v_accvgpr_write_b32 a82, v114
  v_perm_b32 v115, v94, v92, s28
  v_accvgpr_write_b32 a83, v115
  v_perm_b32 v116, v82, v80, s29
  v_accvgpr_write_b32 a84, v116
  v_perm_b32 v117, v86, v84, s29
  v_accvgpr_write_b32 a85, v117
  v_perm_b32 v118, v90, v88, s29
  v_accvgpr_write_b32 a86, v118
  v_perm_b32 v119, v94, v92, s29
  v_accvgpr_write_b32 a87, v119
  v_perm_b32 v168, v83, v81, s28
  v_perm_b32 v169, v87, v85, s28
  v_perm_b32 v170, v91, v89, s28
  v_perm_b32 v171, v95, v93, s28
  v_perm_b32 v120, v83, v81, s29
  v_perm_b32 v121, v87, v85, s29
  v_perm_b32 v122, v91, v89, s29
  v_perm_b32 v123, v95, v93, s29
  ds_write_b128 v14, v[120:123] offset:10240
  s_waitcnt vmcnt(32)
  s_xor_b32 s24, s14, 524288
  buffer_load_dwordx2 v[80:81], v4, s[68:71], s24 offen offset:0
  buffer_load_dwordx2 v[82:83], v4, s[68:71], s24 offen offset:1024
  buffer_load_dwordx2 v[84:85], v4, s[68:71], s24 offen offset:2048
  buffer_load_dwordx2 v[86:87], v4, s[68:71], s24 offen offset:3072
  s_xor_b32 s24, s14, 540672
  buffer_load_dwordx2 v[88:89], v4, s[68:71], s24 offen offset:0
  buffer_load_dwordx2 v[90:91], v4, s[68:71], s24 offen offset:1024
  buffer_load_dwordx2 v[92:93], v4, s[68:71], s24 offen offset:2048
  buffer_load_dwordx2 v[94:95], v4, s[68:71], s24 offen offset:3072
  v_perm_b32 v112, v98, v96, s28
  v_accvgpr_write_b32 a88, v112
  v_perm_b32 v113, v102, v100, s28
  v_accvgpr_write_b32 a89, v113
  v_perm_b32 v114, v106, v104, s28
  v_accvgpr_write_b32 a90, v114
  v_perm_b32 v115, v110, v108, s28
  v_accvgpr_write_b32 a91, v115
  v_perm_b32 v116, v98, v96, s29
  v_accvgpr_write_b32 a92, v116
  v_perm_b32 v117, v102, v100, s29
  v_accvgpr_write_b32 a93, v117
  v_perm_b32 v118, v106, v104, s29
  v_accvgpr_write_b32 a94, v118
  v_perm_b32 v119, v110, v108, s29
  v_accvgpr_write_b32 a95, v119
  v_perm_b32 v172, v99, v97, s28
  v_perm_b32 v173, v103, v101, s28
  v_perm_b32 v174, v107, v105, s28
  v_perm_b32 v175, v111, v109, s28
  v_perm_b32 v124, v99, v97, s29
  v_perm_b32 v125, v103, v101, s29
  v_perm_b32 v126, v107, v105, s29
  v_perm_b32 v127, v111, v109, s29
  ds_write_b128 v14, v[124:127] offset:11264
  s_waitcnt vmcnt(32)
  s_xor_b32 s24, s14, 557056
  buffer_load_dwordx2 v[96:97], v4, s[68:71], s24 offen offset:0
  buffer_load_dwordx2 v[98:99], v4, s[68:71], s24 offen offset:1024
  buffer_load_dwordx2 v[100:101], v4, s[68:71], s24 offen offset:2048
  buffer_load_dwordx2 v[102:103], v4, s[68:71], s24 offen offset:3072
  s_xor_b32 s24, s14, 573440
  buffer_load_dwordx2 v[104:105], v4, s[68:71], s24 offen offset:0
  buffer_load_dwordx2 v[106:107], v4, s[68:71], s24 offen offset:1024
  buffer_load_dwordx2 v[108:109], v4, s[68:71], s24 offen offset:2048
  buffer_load_dwordx2 v[110:111], v4, s[68:71], s24 offen offset:3072
  v_perm_b32 v112, v18, v16, s28
  v_accvgpr_write_b32 a96, v112
  v_perm_b32 v113, v22, v20, s28
  v_accvgpr_write_b32 a97, v113
  v_perm_b32 v114, v26, v24, s28
  v_accvgpr_write_b32 a98, v114
  v_perm_b32 v115, v30, v28, s28
  v_accvgpr_write_b32 a99, v115
  v_perm_b32 v116, v18, v16, s29
  v_accvgpr_write_b32 a100, v116
  v_perm_b32 v117, v22, v20, s29
  v_accvgpr_write_b32 a101, v117
  v_perm_b32 v118, v26, v24, s29
  v_accvgpr_write_b32 a102, v118
  v_perm_b32 v119, v30, v28, s29
  v_accvgpr_write_b32 a103, v119
  v_perm_b32 v176, v19, v17, s28
  v_perm_b32 v177, v23, v21, s28
  v_perm_b32 v178, v27, v25, s28
  v_perm_b32 v179, v31, v29, s28
  v_perm_b32 v120, v19, v17, s29
  v_perm_b32 v121, v23, v21, s29
  v_perm_b32 v122, v27, v25, s29
  v_perm_b32 v123, v31, v29, s29
  ds_write_b128 v14, v[120:123] offset:12288
  s_waitcnt vmcnt(32)
  s_xor_b32 s24, s14, 589824
  buffer_load_dwordx2 v[16:17], v4, s[68:71], s24 offen offset:0
  buffer_load_dwordx2 v[18:19], v4, s[68:71], s24 offen offset:1024
  buffer_load_dwordx2 v[20:21], v4, s[68:71], s24 offen offset:2048
  buffer_load_dwordx2 v[22:23], v4, s[68:71], s24 offen offset:3072
  s_xor_b32 s24, s14, 606208
  buffer_load_dwordx2 v[24:25], v4, s[68:71], s24 offen offset:0
  buffer_load_dwordx2 v[26:27], v4, s[68:71], s24 offen offset:1024
  buffer_load_dwordx2 v[28:29], v4, s[68:71], s24 offen offset:2048
  buffer_load_dwordx2 v[30:31], v4, s[68:71], s24 offen offset:3072
  v_perm_b32 v112, v34, v32, s28
  v_accvgpr_write_b32 a104, v112
  v_perm_b32 v113, v38, v36, s28
  v_accvgpr_write_b32 a105, v113
  v_perm_b32 v114, v42, v40, s28
  v_accvgpr_write_b32 a106, v114
  v_perm_b32 v115, v46, v44, s28
  v_accvgpr_write_b32 a107, v115
  v_perm_b32 v116, v34, v32, s29
  v_accvgpr_write_b32 a108, v116
  v_perm_b32 v117, v38, v36, s29
  v_accvgpr_write_b32 a109, v117
  v_perm_b32 v118, v42, v40, s29
  v_accvgpr_write_b32 a110, v118
  v_perm_b32 v119, v46, v44, s29
  v_accvgpr_write_b32 a111, v119
  v_perm_b32 v180, v35, v33, s28
  v_perm_b32 v181, v39, v37, s28
  v_perm_b32 v182, v43, v41, s28
  v_perm_b32 v183, v47, v45, s28
  v_perm_b32 v124, v35, v33, s29
  v_perm_b32 v125, v39, v37, s29
  v_perm_b32 v126, v43, v41, s29
  v_perm_b32 v127, v47, v45, s29
  ds_write_b128 v14, v[124:127] offset:13312
  s_waitcnt vmcnt(32)
  s_xor_b32 s24, s14, 622592
  buffer_load_dwordx2 v[32:33], v4, s[68:71], s24 offen offset:0
  buffer_load_dwordx2 v[34:35], v4, s[68:71], s24 offen offset:1024
  buffer_load_dwordx2 v[36:37], v4, s[68:71], s24 offen offset:2048
  buffer_load_dwordx2 v[38:39], v4, s[68:71], s24 offen offset:3072
  s_xor_b32 s24, s14, 638976
  buffer_load_dwordx2 v[40:41], v4, s[68:71], s24 offen offset:0
  buffer_load_dwordx2 v[42:43], v4, s[68:71], s24 offen offset:1024
  buffer_load_dwordx2 v[44:45], v4, s[68:71], s24 offen offset:2048
  buffer_load_dwordx2 v[46:47], v4, s[68:71], s24 offen offset:3072
  v_perm_b32 v112, v50, v48, s28
  v_accvgpr_write_b32 a112, v112
  v_perm_b32 v113, v54, v52, s28
  v_accvgpr_write_b32 a113, v113
  v_perm_b32 v114, v58, v56, s28
  v_accvgpr_write_b32 a114, v114
  v_perm_b32 v115, v62, v60, s28
  v_accvgpr_write_b32 a115, v115
  v_perm_b32 v116, v50, v48, s29
  v_accvgpr_write_b32 a116, v116
  v_perm_b32 v117, v54, v52, s29
  v_accvgpr_write_b32 a117, v117
  v_perm_b32 v118, v58, v56, s29
  v_accvgpr_write_b32 a118, v118
  v_perm_b32 v119, v62, v60, s29
  v_accvgpr_write_b32 a119, v119
  v_perm_b32 v184, v51, v49, s28
  v_perm_b32 v185, v55, v53, s28
  v_perm_b32 v186, v59, v57, s28
  v_perm_b32 v187, v63, v61, s28
  v_perm_b32 v120, v51, v49, s29
  v_perm_b32 v121, v55, v53, s29
  v_perm_b32 v122, v59, v57, s29
  v_perm_b32 v123, v63, v61, s29
  ds_write_b128 v14, v[120:123] offset:14336
  s_waitcnt vmcnt(32)
  s_xor_b32 s24, s14, 655360
  buffer_load_dwordx2 v[48:49], v4, s[68:71], s24 offen offset:0
  buffer_load_dwordx2 v[50:51], v4, s[68:71], s24 offen offset:1024
  buffer_load_dwordx2 v[52:53], v4, s[68:71], s24 offen offset:2048
  buffer_load_dwordx2 v[54:55], v4, s[68:71], s24 offen offset:3072
  s_xor_b32 s24, s14, 671744
  buffer_load_dwordx2 v[56:57], v4, s[68:71], s24 offen offset:0
  buffer_load_dwordx2 v[58:59], v4, s[68:71], s24 offen offset:1024
  buffer_load_dwordx2 v[60:61], v4, s[68:71], s24 offen offset:2048
  buffer_load_dwordx2 v[62:63], v4, s[68:71], s24 offen offset:3072
  v_perm_b32 v112, v66, v64, s28
  v_accvgpr_write_b32 a120, v112
  v_perm_b32 v113, v70, v68, s28
  v_accvgpr_write_b32 a121, v113
  v_perm_b32 v114, v74, v72, s28
  v_accvgpr_write_b32 a122, v114
  v_perm_b32 v115, v78, v76, s28
  v_accvgpr_write_b32 a123, v115
  v_perm_b32 v116, v66, v64, s29
  v_accvgpr_write_b32 a124, v116
  v_perm_b32 v117, v70, v68, s29
  v_accvgpr_write_b32 a125, v117
  v_perm_b32 v118, v74, v72, s29
  v_accvgpr_write_b32 a126, v118
  v_perm_b32 v119, v78, v76, s29
  v_accvgpr_write_b32 a127, v119
  v_perm_b32 v188, v67, v65, s28
  v_perm_b32 v189, v71, v69, s28
  v_perm_b32 v190, v75, v73, s28
  v_perm_b32 v191, v79, v77, s28
  v_perm_b32 v124, v67, v65, s29
  v_perm_b32 v125, v71, v69, s29
  v_perm_b32 v126, v75, v73, s29
  v_perm_b32 v127, v79, v77, s29
  ds_write_b128 v14, v[124:127] offset:15360
  s_waitcnt lgkmcnt(0)
  s_waitcnt vmcnt(32)
  s_xor_b32 s24, s14, 688128
  buffer_load_dwordx2 v[64:65], v4, s[68:71], s24 offen offset:0
  buffer_load_dwordx2 v[66:67], v4, s[68:71], s24 offen offset:1024
  buffer_load_dwordx2 v[68:69], v4, s[68:71], s24 offen offset:2048
  buffer_load_dwordx2 v[70:71], v4, s[68:71], s24 offen offset:3072
  s_xor_b32 s24, s14, 704512
  buffer_load_dwordx2 v[72:73], v4, s[68:71], s24 offen offset:0
  buffer_load_dwordx2 v[74:75], v4, s[68:71], s24 offen offset:1024
  buffer_load_dwordx2 v[76:77], v4, s[68:71], s24 offen offset:2048
  buffer_load_dwordx2 v[78:79], v4, s[68:71], s24 offen offset:3072
  v_perm_b32 v112, v82, v80, s28
  v_accvgpr_write_b32 a128, v112
  v_perm_b32 v113, v86, v84, s28
  v_accvgpr_write_b32 a129, v113
  v_perm_b32 v114, v90, v88, s28
  v_accvgpr_write_b32 a130, v114
  v_perm_b32 v115, v94, v92, s28
  v_accvgpr_write_b32 a131, v115
  v_perm_b32 v116, v82, v80, s29
  v_accvgpr_write_b32 a132, v116
  v_perm_b32 v117, v86, v84, s29
  v_accvgpr_write_b32 a133, v117
  v_perm_b32 v118, v90, v88, s29
  v_accvgpr_write_b32 a134, v118
  v_perm_b32 v119, v94, v92, s29
  v_accvgpr_write_b32 a135, v119
  v_perm_b32 v192, v83, v81, s28
  v_perm_b32 v193, v87, v85, s28
  v_perm_b32 v194, v91, v89, s28
  v_perm_b32 v195, v95, v93, s28
  v_perm_b32 v120, v83, v81, s29
  v_perm_b32 v121, v87, v85, s29
  v_perm_b32 v122, v91, v89, s29
  v_perm_b32 v123, v95, v93, s29
  ds_write_b128 v14, v[120:123] offset:16384
  s_waitcnt vmcnt(32)
  s_xor_b32 s24, s14, 720896
  buffer_load_dwordx2 v[80:81], v4, s[68:71], s24 offen offset:0
  buffer_load_dwordx2 v[82:83], v4, s[68:71], s24 offen offset:1024
  buffer_load_dwordx2 v[84:85], v4, s[68:71], s24 offen offset:2048
  buffer_load_dwordx2 v[86:87], v4, s[68:71], s24 offen offset:3072
  s_xor_b32 s24, s14, 737280
  buffer_load_dwordx2 v[88:89], v4, s[68:71], s24 offen offset:0
  buffer_load_dwordx2 v[90:91], v4, s[68:71], s24 offen offset:1024
  buffer_load_dwordx2 v[92:93], v4, s[68:71], s24 offen offset:2048
  buffer_load_dwordx2 v[94:95], v4, s[68:71], s24 offen offset:3072
  v_perm_b32 v112, v98, v96, s28
  v_accvgpr_write_b32 a136, v112
  v_perm_b32 v113, v102, v100, s28
  v_accvgpr_write_b32 a137, v113
  v_perm_b32 v114, v106, v104, s28
  v_accvgpr_write_b32 a138, v114
  v_perm_b32 v115, v110, v108, s28
  v_accvgpr_write_b32 a139, v115
  v_perm_b32 v116, v98, v96, s29
  v_accvgpr_write_b32 a140, v116
  v_perm_b32 v117, v102, v100, s29
  v_accvgpr_write_b32 a141, v117
  v_perm_b32 v118, v106, v104, s29
  v_accvgpr_write_b32 a142, v118
  v_perm_b32 v119, v110, v108, s29
  v_accvgpr_write_b32 a143, v119
  v_perm_b32 v196, v99, v97, s28
  v_perm_b32 v197, v103, v101, s28
  v_perm_b32 v198, v107, v105, s28
  v_perm_b32 v199, v111, v109, s28
  v_perm_b32 v124, v99, v97, s29
  v_perm_b32 v125, v103, v101, s29
  v_perm_b32 v126, v107, v105, s29
  v_perm_b32 v127, v111, v109, s29
  ds_write_b128 v14, v[124:127] offset:17408
  s_waitcnt vmcnt(32)
  s_xor_b32 s24, s14, 753664
  buffer_load_dwordx2 v[96:97], v4, s[68:71], s24 offen offset:0
  buffer_load_dwordx2 v[98:99], v4, s[68:71], s24 offen offset:1024
  buffer_load_dwordx2 v[100:101], v4, s[68:71], s24 offen offset:2048
  buffer_load_dwordx2 v[102:103], v4, s[68:71], s24 offen offset:3072
  s_xor_b32 s24, s14, 770048
  buffer_load_dwordx2 v[104:105], v4, s[68:71], s24 offen offset:0
  buffer_load_dwordx2 v[106:107], v4, s[68:71], s24 offen offset:1024
  buffer_load_dwordx2 v[108:109], v4, s[68:71], s24 offen offset:2048
  buffer_load_dwordx2 v[110:111], v4, s[68:71], s24 offen offset:3072
  v_perm_b32 v112, v18, v16, s28
  v_accvgpr_write_b32 a144, v112
  v_perm_b32 v113, v22, v20, s28
  v_accvgpr_write_b32 a145, v113
  v_perm_b32 v114, v26, v24, s28
  v_accvgpr_write_b32 a146, v114
  v_perm_b32 v115, v30, v28, s28
  v_accvgpr_write_b32 a147, v115
  v_perm_b32 v116, v18, v16, s29
  v_accvgpr_write_b32 a148, v116
  v_perm_b32 v117, v22, v20, s29
  v_accvgpr_write_b32 a149, v117
  v_perm_b32 v118, v26, v24, s29
  v_accvgpr_write_b32 a150, v118
  v_perm_b32 v119, v30, v28, s29
  v_accvgpr_write_b32 a151, v119
  v_perm_b32 v200, v19, v17, s28
  v_perm_b32 v201, v23, v21, s28
  v_perm_b32 v202, v27, v25, s28
  v_perm_b32 v203, v31, v29, s28
  v_perm_b32 v120, v19, v17, s29
  v_perm_b32 v121, v23, v21, s29
  v_perm_b32 v122, v27, v25, s29
  v_perm_b32 v123, v31, v29, s29
  ds_write_b128 v14, v[120:123] offset:18432
  s_waitcnt vmcnt(32)
  s_xor_b32 s24, s14, 786432
  buffer_load_dwordx2 v[16:17], v4, s[68:71], s24 offen offset:0
  buffer_load_dwordx2 v[18:19], v4, s[68:71], s24 offen offset:1024
  buffer_load_dwordx2 v[20:21], v4, s[68:71], s24 offen offset:2048
  buffer_load_dwordx2 v[22:23], v4, s[68:71], s24 offen offset:3072
  s_xor_b32 s24, s14, 802816
  buffer_load_dwordx2 v[24:25], v4, s[68:71], s24 offen offset:0
  buffer_load_dwordx2 v[26:27], v4, s[68:71], s24 offen offset:1024
  buffer_load_dwordx2 v[28:29], v4, s[68:71], s24 offen offset:2048
  buffer_load_dwordx2 v[30:31], v4, s[68:71], s24 offen offset:3072
  v_perm_b32 v112, v34, v32, s28
  v_accvgpr_write_b32 a152, v112
  v_perm_b32 v113, v38, v36, s28
  v_accvgpr_write_b32 a153, v113
  v_perm_b32 v114, v42, v40, s28
  v_accvgpr_write_b32 a154, v114
  v_perm_b32 v115, v46, v44, s28
  v_accvgpr_write_b32 a155, v115
  v_perm_b32 v116, v34, v32, s29
  v_accvgpr_write_b32 a156, v116
  v_perm_b32 v117, v38, v36, s29
  v_accvgpr_write_b32 a157, v117
  v_perm_b32 v118, v42, v40, s29
  v_accvgpr_write_b32 a158, v118
  v_perm_b32 v119, v46, v44, s29
  v_accvgpr_write_b32 a159, v119
  v_perm_b32 v204, v35, v33, s28
  v_perm_b32 v205, v39, v37, s28
  v_perm_b32 v206, v43, v41, s28
  v_perm_b32 v207, v47, v45, s28
  v_perm_b32 v124, v35, v33, s29
  v_perm_b32 v125, v39, v37, s29
  v_perm_b32 v126, v43, v41, s29
  v_perm_b32 v127, v47, v45, s29
  ds_write_b128 v14, v[124:127] offset:19456
  s_waitcnt vmcnt(32)
  s_xor_b32 s24, s14, 819200
  buffer_load_dwordx2 v[32:33], v4, s[68:71], s24 offen offset:0
  buffer_load_dwordx2 v[34:35], v4, s[68:71], s24 offen offset:1024
  buffer_load_dwordx2 v[36:37], v4, s[68:71], s24 offen offset:2048
  buffer_load_dwordx2 v[38:39], v4, s[68:71], s24 offen offset:3072
  s_xor_b32 s24, s14, 835584
  buffer_load_dwordx2 v[40:41], v4, s[68:71], s24 offen offset:0
  buffer_load_dwordx2 v[42:43], v4, s[68:71], s24 offen offset:1024
  buffer_load_dwordx2 v[44:45], v4, s[68:71], s24 offen offset:2048
  buffer_load_dwordx2 v[46:47], v4, s[68:71], s24 offen offset:3072
  v_perm_b32 v112, v50, v48, s28
  v_accvgpr_write_b32 a160, v112
  v_perm_b32 v113, v54, v52, s28
  v_accvgpr_write_b32 a161, v113
  v_perm_b32 v114, v58, v56, s28
  v_accvgpr_write_b32 a162, v114
  v_perm_b32 v115, v62, v60, s28
  v_accvgpr_write_b32 a163, v115
  v_perm_b32 v116, v50, v48, s29
  v_accvgpr_write_b32 a164, v116
  v_perm_b32 v117, v54, v52, s29
  v_accvgpr_write_b32 a165, v117
  v_perm_b32 v118, v58, v56, s29
  v_accvgpr_write_b32 a166, v118
  v_perm_b32 v119, v62, v60, s29
  v_accvgpr_write_b32 a167, v119
  v_perm_b32 v208, v51, v49, s28
  v_perm_b32 v209, v55, v53, s28
  v_perm_b32 v210, v59, v57, s28
  v_perm_b32 v211, v63, v61, s28
  v_perm_b32 v120, v51, v49, s29
  v_perm_b32 v121, v55, v53, s29
  v_perm_b32 v122, v59, v57, s29
  v_perm_b32 v123, v63, v61, s29
  ds_write_b128 v14, v[120:123] offset:20480
  s_waitcnt vmcnt(32)
  s_xor_b32 s24, s14, 851968
  buffer_load_dwordx2 v[48:49], v4, s[68:71], s24 offen offset:0
  buffer_load_dwordx2 v[50:51], v4, s[68:71], s24 offen offset:1024
  buffer_load_dwordx2 v[52:53], v4, s[68:71], s24 offen offset:2048
  buffer_load_dwordx2 v[54:55], v4, s[68:71], s24 offen offset:3072
  s_xor_b32 s24, s14, 868352
  buffer_load_dwordx2 v[56:57], v4, s[68:71], s24 offen offset:0
  buffer_load_dwordx2 v[58:59], v4, s[68:71], s24 offen offset:1024
  buffer_load_dwordx2 v[60:61], v4, s[68:71], s24 offen offset:2048
  buffer_load_dwordx2 v[62:63], v4, s[68:71], s24 offen offset:3072
  v_perm_b32 v112, v66, v64, s28
  v_accvgpr_write_b32 a168, v112
  v_perm_b32 v113, v70, v68, s28
  v_accvgpr_write_b32 a169, v113
  v_perm_b32 v114, v74, v72, s28
  v_accvgpr_write_b32 a170, v114
  v_perm_b32 v115, v78, v76, s28
  v_accvgpr_write_b32 a171, v115
  v_perm_b32 v116, v66, v64, s29
  v_accvgpr_write_b32 a172, v116
  v_perm_b32 v117, v70, v68, s29
  v_accvgpr_write_b32 a173, v117
  v_perm_b32 v118, v74, v72, s29
  v_accvgpr_write_b32 a174, v118
  v_perm_b32 v119, v78, v76, s29
  v_accvgpr_write_b32 a175, v119
  v_perm_b32 v212, v67, v65, s28
  v_perm_b32 v213, v71, v69, s28
  v_perm_b32 v214, v75, v73, s28
  v_perm_b32 v215, v79, v77, s28
  v_perm_b32 v124, v67, v65, s29
  v_perm_b32 v125, v71, v69, s29
  v_perm_b32 v126, v75, v73, s29
  v_perm_b32 v127, v79, v77, s29
  ds_write_b128 v14, v[124:127] offset:21504
  s_waitcnt vmcnt(32)
  s_xor_b32 s24, s14, 884736
  buffer_load_dwordx2 v[64:65], v4, s[68:71], s24 offen offset:0
  buffer_load_dwordx2 v[66:67], v4, s[68:71], s24 offen offset:1024
  buffer_load_dwordx2 v[68:69], v4, s[68:71], s24 offen offset:2048
  buffer_load_dwordx2 v[70:71], v4, s[68:71], s24 offen offset:3072
  s_xor_b32 s24, s14, 901120
  buffer_load_dwordx2 v[72:73], v4, s[68:71], s24 offen offset:0
  buffer_load_dwordx2 v[74:75], v4, s[68:71], s24 offen offset:1024
  buffer_load_dwordx2 v[76:77], v4, s[68:71], s24 offen offset:2048
  buffer_load_dwordx2 v[78:79], v4, s[68:71], s24 offen offset:3072
  v_perm_b32 v112, v82, v80, s28
  v_accvgpr_write_b32 a176, v112
  v_perm_b32 v113, v86, v84, s28
  v_accvgpr_write_b32 a177, v113
  v_perm_b32 v114, v90, v88, s28
  v_accvgpr_write_b32 a178, v114
  v_perm_b32 v115, v94, v92, s28
  v_accvgpr_write_b32 a179, v115
  v_perm_b32 v116, v82, v80, s29
  v_accvgpr_write_b32 a180, v116
  v_perm_b32 v117, v86, v84, s29
  v_accvgpr_write_b32 a181, v117
  v_perm_b32 v118, v90, v88, s29
  v_accvgpr_write_b32 a182, v118
  v_perm_b32 v119, v94, v92, s29
  v_accvgpr_write_b32 a183, v119
  v_perm_b32 v216, v83, v81, s28
  v_perm_b32 v217, v87, v85, s28
  v_perm_b32 v218, v91, v89, s28
  v_perm_b32 v219, v95, v93, s28
  v_perm_b32 v120, v83, v81, s29
  v_perm_b32 v121, v87, v85, s29
  v_perm_b32 v122, v91, v89, s29
  v_perm_b32 v123, v95, v93, s29
  ds_write_b128 v14, v[120:123] offset:22528
  s_waitcnt vmcnt(32)
  s_xor_b32 s24, s14, 917504
  buffer_load_dwordx2 v[80:81], v4, s[68:71], s24 offen offset:0
  buffer_load_dwordx2 v[82:83], v4, s[68:71], s24 offen offset:1024
  buffer_load_dwordx2 v[84:85], v4, s[68:71], s24 offen offset:2048
  buffer_load_dwordx2 v[86:87], v4, s[68:71], s24 offen offset:3072
  s_xor_b32 s24, s14, 933888
  buffer_load_dwordx2 v[88:89], v4, s[68:71], s24 offen offset:0
  buffer_load_dwordx2 v[90:91], v4, s[68:71], s24 offen offset:1024
  buffer_load_dwordx2 v[92:93], v4, s[68:71], s24 offen offset:2048
  buffer_load_dwordx2 v[94:95], v4, s[68:71], s24 offen offset:3072
  v_perm_b32 v112, v98, v96, s28
  v_accvgpr_write_b32 a184, v112
  v_perm_b32 v113, v102, v100, s28
  v_accvgpr_write_b32 a185, v113
  v_perm_b32 v114, v106, v104, s28
  v_accvgpr_write_b32 a186, v114
  v_perm_b32 v115, v110, v108, s28
  v_accvgpr_write_b32 a187, v115
  v_perm_b32 v116, v98, v96, s29
  v_accvgpr_write_b32 a188, v116
  v_perm_b32 v117, v102, v100, s29
  v_accvgpr_write_b32 a189, v117
  v_perm_b32 v118, v106, v104, s29
  v_accvgpr_write_b32 a190, v118
  v_perm_b32 v119, v110, v108, s29
  v_accvgpr_write_b32 a191, v119
  v_perm_b32 v220, v99, v97, s28
  v_perm_b32 v221, v103, v101, s28
  v_perm_b32 v222, v107, v105, s28
  v_perm_b32 v223, v111, v109, s28
  v_perm_b32 v124, v99, v97, s29
  v_perm_b32 v125, v103, v101, s29
  v_perm_b32 v126, v107, v105, s29
  v_perm_b32 v127, v111, v109, s29
  ds_write_b128 v14, v[124:127] offset:23552
  s_waitcnt lgkmcnt(0)
  s_waitcnt vmcnt(32)
  s_xor_b32 s24, s14, 950272
  buffer_load_dwordx2 v[96:97], v4, s[68:71], s24 offen offset:0
  buffer_load_dwordx2 v[98:99], v4, s[68:71], s24 offen offset:1024
  buffer_load_dwordx2 v[100:101], v4, s[68:71], s24 offen offset:2048
  buffer_load_dwordx2 v[102:103], v4, s[68:71], s24 offen offset:3072
  s_xor_b32 s24, s14, 966656
  buffer_load_dwordx2 v[104:105], v4, s[68:71], s24 offen offset:0
  buffer_load_dwordx2 v[106:107], v4, s[68:71], s24 offen offset:1024
  buffer_load_dwordx2 v[108:109], v4, s[68:71], s24 offen offset:2048
  buffer_load_dwordx2 v[110:111], v4, s[68:71], s24 offen offset:3072
  v_perm_b32 v112, v18, v16, s28
  v_accvgpr_write_b32 a192, v112
  v_perm_b32 v113, v22, v20, s28
  v_accvgpr_write_b32 a193, v113
  v_perm_b32 v114, v26, v24, s28
  v_accvgpr_write_b32 a194, v114
  v_perm_b32 v115, v30, v28, s28
  v_accvgpr_write_b32 a195, v115
  v_perm_b32 v116, v18, v16, s29
  v_accvgpr_write_b32 a196, v116
  v_perm_b32 v117, v22, v20, s29
  v_accvgpr_write_b32 a197, v117
  v_perm_b32 v118, v26, v24, s29
  v_accvgpr_write_b32 a198, v118
  v_perm_b32 v119, v30, v28, s29
  v_accvgpr_write_b32 a199, v119
  v_perm_b32 v224, v19, v17, s28
  v_perm_b32 v225, v23, v21, s28
  v_perm_b32 v226, v27, v25, s28
  v_perm_b32 v227, v31, v29, s28
  v_perm_b32 v120, v19, v17, s29
  v_perm_b32 v121, v23, v21, s29
  v_perm_b32 v122, v27, v25, s29
  v_perm_b32 v123, v31, v29, s29
  ds_write_b128 v14, v[120:123] offset:24576
  s_waitcnt vmcnt(32)
  s_xor_b32 s24, s14, 983040
  buffer_load_dwordx2 v[16:17], v4, s[68:71], s24 offen offset:0
  buffer_load_dwordx2 v[18:19], v4, s[68:71], s24 offen offset:1024
  buffer_load_dwordx2 v[20:21], v4, s[68:71], s24 offen offset:2048
  buffer_load_dwordx2 v[22:23], v4, s[68:71], s24 offen offset:3072
  s_xor_b32 s24, s14, 999424
  buffer_load_dwordx2 v[24:25], v4, s[68:71], s24 offen offset:0
  buffer_load_dwordx2 v[26:27], v4, s[68:71], s24 offen offset:1024
  buffer_load_dwordx2 v[28:29], v4, s[68:71], s24 offen offset:2048
  buffer_load_dwordx2 v[30:31], v4, s[68:71], s24 offen offset:3072
  v_perm_b32 v112, v34, v32, s28
  v_accvgpr_write_b32 a200, v112
  v_perm_b32 v113, v38, v36, s28
  v_accvgpr_write_b32 a201, v113
  v_perm_b32 v114, v42, v40, s28
  v_accvgpr_write_b32 a202, v114
  v_perm_b32 v115, v46, v44, s28
  v_accvgpr_write_b32 a203, v115
  v_perm_b32 v116, v34, v32, s29
  v_accvgpr_write_b32 a204, v116
  v_perm_b32 v117, v38, v36, s29
  v_accvgpr_write_b32 a205, v117
  v_perm_b32 v118, v42, v40, s29
  v_accvgpr_write_b32 a206, v118
  v_perm_b32 v119, v46, v44, s29
  v_accvgpr_write_b32 a207, v119
  v_perm_b32 v228, v35, v33, s28
  v_perm_b32 v229, v39, v37, s28
  v_perm_b32 v230, v43, v41, s28
  v_perm_b32 v231, v47, v45, s28
  v_perm_b32 v124, v35, v33, s29
  v_perm_b32 v125, v39, v37, s29
  v_perm_b32 v126, v43, v41, s29
  v_perm_b32 v127, v47, v45, s29
  ds_write_b128 v14, v[124:127] offset:25600
  s_waitcnt vmcnt(32)
  s_xor_b32 s24, s14, 1015808
  buffer_load_dwordx2 v[32:33], v4, s[68:71], s24 offen offset:0
  buffer_load_dwordx2 v[34:35], v4, s[68:71], s24 offen offset:1024
  buffer_load_dwordx2 v[36:37], v4, s[68:71], s24 offen offset:2048
  buffer_load_dwordx2 v[38:39], v4, s[68:71], s24 offen offset:3072
  s_xor_b32 s24, s14, 1032192
  buffer_load_dwordx2 v[40:41], v4, s[68:71], s24 offen offset:0
  buffer_load_dwordx2 v[42:43], v4, s[68:71], s24 offen offset:1024
  buffer_load_dwordx2 v[44:45], v4, s[68:71], s24 offen offset:2048
  buffer_load_dwordx2 v[46:47], v4, s[68:71], s24 offen offset:3072
  v_perm_b32 v112, v50, v48, s28
  v_accvgpr_write_b32 a208, v112
  v_perm_b32 v113, v54, v52, s28
  v_accvgpr_write_b32 a209, v113
  v_perm_b32 v114, v58, v56, s28
  v_accvgpr_write_b32 a210, v114
  v_perm_b32 v115, v62, v60, s28
  v_accvgpr_write_b32 a211, v115
  v_perm_b32 v116, v50, v48, s29
  v_accvgpr_write_b32 a212, v116
  v_perm_b32 v117, v54, v52, s29
  v_accvgpr_write_b32 a213, v117
  v_perm_b32 v118, v58, v56, s29
  v_accvgpr_write_b32 a214, v118
  v_perm_b32 v119, v62, v60, s29
  v_accvgpr_write_b32 a215, v119
  v_perm_b32 v232, v51, v49, s28
  v_perm_b32 v233, v55, v53, s28
  v_perm_b32 v234, v59, v57, s28
  v_perm_b32 v235, v63, v61, s28
  v_perm_b32 v120, v51, v49, s29
  v_perm_b32 v121, v55, v53, s29
  v_perm_b32 v122, v59, v57, s29
  v_perm_b32 v123, v63, v61, s29
  ds_write_b128 v14, v[120:123] offset:26624
  s_waitcnt vmcnt(32)
  v_perm_b32 v112, v66, v64, s28
  v_accvgpr_write_b32 a216, v112
  v_perm_b32 v113, v70, v68, s28
  v_accvgpr_write_b32 a217, v113
  v_perm_b32 v114, v74, v72, s28
  v_accvgpr_write_b32 a218, v114
  v_perm_b32 v115, v78, v76, s28
  v_accvgpr_write_b32 a219, v115
  v_perm_b32 v116, v66, v64, s29
  v_accvgpr_write_b32 a220, v116
  v_perm_b32 v117, v70, v68, s29
  v_accvgpr_write_b32 a221, v117
  v_perm_b32 v118, v74, v72, s29
  v_accvgpr_write_b32 a222, v118
  v_perm_b32 v119, v78, v76, s29
  v_accvgpr_write_b32 a223, v119
  v_perm_b32 v236, v67, v65, s28
  v_perm_b32 v237, v71, v69, s28
  v_perm_b32 v238, v75, v73, s28
  v_perm_b32 v239, v79, v77, s28
  v_perm_b32 v124, v67, v65, s29
  v_perm_b32 v125, v71, v69, s29
  v_perm_b32 v126, v75, v73, s29
  v_perm_b32 v127, v79, v77, s29
  ds_write_b128 v14, v[124:127] offset:27648
  s_waitcnt vmcnt(24)
  v_perm_b32 v112, v82, v80, s28
  v_accvgpr_write_b32 a224, v112
  v_perm_b32 v113, v86, v84, s28
  v_accvgpr_write_b32 a225, v113
  v_perm_b32 v114, v90, v88, s28
  v_accvgpr_write_b32 a226, v114
  v_perm_b32 v115, v94, v92, s28
  v_accvgpr_write_b32 a227, v115
  v_perm_b32 v116, v82, v80, s29
  v_accvgpr_write_b32 a228, v116
  v_perm_b32 v117, v86, v84, s29
  v_accvgpr_write_b32 a229, v117
  v_perm_b32 v118, v90, v88, s29
  v_accvgpr_write_b32 a230, v118
  v_perm_b32 v119, v94, v92, s29
  v_accvgpr_write_b32 a231, v119
  v_perm_b32 v240, v83, v81, s28
  v_perm_b32 v241, v87, v85, s28
  v_perm_b32 v242, v91, v89, s28
  v_perm_b32 v243, v95, v93, s28
  v_perm_b32 v120, v83, v81, s29
  v_perm_b32 v121, v87, v85, s29
  v_perm_b32 v122, v91, v89, s29
  v_perm_b32 v123, v95, v93, s29
  ds_write_b128 v14, v[120:123] offset:28672
  s_waitcnt vmcnt(16)
  v_perm_b32 v112, v98, v96, s28
  v_accvgpr_write_b32 a232, v112
  v_perm_b32 v113, v102, v100, s28
  v_accvgpr_write_b32 a233, v113
  v_perm_b32 v114, v106, v104, s28
  v_accvgpr_write_b32 a234, v114
  v_perm_b32 v115, v110, v108, s28
  v_accvgpr_write_b32 a235, v115
  v_perm_b32 v116, v98, v96, s29
  v_accvgpr_write_b32 a236, v116
  v_perm_b32 v117, v102, v100, s29
  v_accvgpr_write_b32 a237, v117
  v_perm_b32 v118, v106, v104, s29
  v_accvgpr_write_b32 a238, v118
  v_perm_b32 v119, v110, v108, s29
  v_accvgpr_write_b32 a239, v119
  v_perm_b32 v244, v99, v97, s28
  v_perm_b32 v245, v103, v101, s28
  v_perm_b32 v246, v107, v105, s28
  v_perm_b32 v247, v111, v109, s28
  v_perm_b32 v124, v99, v97, s29
  v_perm_b32 v125, v103, v101, s29
  v_perm_b32 v126, v107, v105, s29
  v_perm_b32 v127, v111, v109, s29
  ds_write_b128 v14, v[124:127] offset:29696
  s_waitcnt vmcnt(8)
  v_perm_b32 v112, v18, v16, s28
  v_accvgpr_write_b32 a240, v112
  v_perm_b32 v113, v22, v20, s28
  v_accvgpr_write_b32 a241, v113
  v_perm_b32 v114, v26, v24, s28
  v_accvgpr_write_b32 a242, v114
  v_perm_b32 v115, v30, v28, s28
  v_accvgpr_write_b32 a243, v115
  v_perm_b32 v116, v18, v16, s29
  v_accvgpr_write_b32 a244, v116
  v_perm_b32 v117, v22, v20, s29
  v_accvgpr_write_b32 a245, v117
  v_perm_b32 v118, v26, v24, s29
  v_accvgpr_write_b32 a246, v118
  v_perm_b32 v119, v30, v28, s29
  v_accvgpr_write_b32 a247, v119
  v_perm_b32 v248, v19, v17, s28
  v_perm_b32 v249, v23, v21, s28
  v_perm_b32 v250, v27, v25, s28
  v_perm_b32 v251, v31, v29, s28
  v_perm_b32 v120, v19, v17, s29
  v_perm_b32 v121, v23, v21, s29
  v_perm_b32 v122, v27, v25, s29
  v_perm_b32 v123, v31, v29, s29
  ds_write_b128 v14, v[120:123] offset:30720
  s_waitcnt vmcnt(0)
  v_perm_b32 v112, v34, v32, s28
  v_accvgpr_write_b32 a248, v112
  v_perm_b32 v113, v38, v36, s28
  v_accvgpr_write_b32 a249, v113
  v_perm_b32 v114, v42, v40, s28
  v_accvgpr_write_b32 a250, v114
  v_perm_b32 v115, v46, v44, s28
  v_accvgpr_write_b32 a251, v115
  v_perm_b32 v116, v34, v32, s29
  v_accvgpr_write_b32 a252, v116
  v_perm_b32 v117, v38, v36, s29
  v_accvgpr_write_b32 a253, v117
  v_perm_b32 v118, v42, v40, s29
  v_accvgpr_write_b32 a254, v118
  v_perm_b32 v119, v46, v44, s29
  v_accvgpr_write_b32 a255, v119
  v_perm_b32 v252, v35, v33, s28
  v_perm_b32 v253, v39, v37, s28
  v_perm_b32 v254, v43, v41, s28
  v_perm_b32 v255, v47, v45, s28
  v_perm_b32 v124, v35, v33, s29
  v_perm_b32 v125, v39, v37, s29
  v_perm_b32 v126, v43, v41, s29
  v_perm_b32 v127, v47, v45, s29
  ds_write_b128 v14, v[124:127] offset:31744
  s_waitcnt lgkmcnt(0)
  v_and_b32 v8, 7, v2
  v_lshlrev_b32 v8, 2, v8
  s_lshl_b32 s24, s13, 7
  v_add_u32 v8, s24, v8
  s_lshl_b32 s24, s13, 2
  v_add_u32 v5, s24, v3
  v_lshlrev_b32 v9, 10, v5
  v_lshl_add_u32 v9, v2, 3, v9
  v_lshlrev_b32 v10, 2, v5
  v_lshrrev_b32 v6, 2, v2
  v_lshlrev_b32 v13, 8, v6
  v_lshl_add_u32 v12, v5, 4, v13
  v_and_b32 v6, 3, v2
  v_lshl_add_u32 v12, v6, 2, v12
  v_add_u32 v12, 0x20000, v12
  s_lshl_b32 s24, s13, 12
  s_add_u32 s24, s24, 0x20000
  v_add_u32 v11, s24, v1
  v_lshl_add_u32 v13, v3, 11, v13
  v_bfe_u32 v6, v2, 1, 1
  v_lshl_add_u32 v13, v6, 10, v13
  v_and_b32 v6, 1, v2
  v_lshl_add_u32 v13, v6, 3, v13
  s_lshl_b32 s24, s16, 14
  s_and_b32 s25, s13, 1
  s_lshl_b32 s25, s25, 13
  s_add_u32 s24, s24, s25
  s_lshr_b32 s25, s13, 1
  s_lshl_b32 s25, s25, 4
  s_add_u32 s24, s24, s25
  v_add_u32 v13, s24, v13
  s_cmp_eq_u32 s13, 0
  s_cbranch_scc0 L_cntx_83
L_cnt_82:
  s_sub_u32 s33, s33, 1
  s_cbranch_scc1 L_done
  buffer_load_dword v5, off, s[36:39], 0 offset:44 sc1
  s_waitcnt vmcnt(0)
  v_cmp_gt_u32 vcc, 1, v5
  s_cbranch_vccz L_cntx_83
  s_sleep 8
  s_branch L_cnt_82
L_cntx_83:
  s_barrier
  v_mov_b32 v7, 0
L_unit_84:
  s_sub_u32 s24, s17, 96
  s_cmp_lt_u32 s24, 12
  s_cbranch_scc0 L_onb_89
  s_cmp_eq_u32 s13, 0
  s_cbranch_scc0 L_cntx_91
L_cnt_90:
  s_sub_u32 s33, s33, 1
  s_cbranch_scc1 L_done
  buffer_load_dword v5, off, s[36:39], 0 offset:48 sc1
  s_waitcnt vmcnt(0)
  v_cmp_gt_u32 vcc, 1, v5
  s_cbranch_vccz L_cntx_91
  s_sleep 8
  s_branch L_cnt_90
L_cntx_91:
  s_barrier
L_onb_89:
  s_mov_b32 s20, s15
  s_lshl_b32 s24, s17, 14
  s_lshl_b32 s25, s16, 7
  s_add_u32 s15, s24, s25
  s_lshr_b32 s24, s17, 3
  s_lshl_b32 s24, s24, 17
  s_and_b32 s25, s17, 7
  s_lshl_b32 s25, s25, 5
  s_add_u32 s25, s25, s24
  s_add_u32 s25, s25, 6291456
  s_lshl_b32 s24, s17, 6
  s_add_u32 s24, s24, 1245184
  buffer_load_dwordx2 v[92:93], v13, s[4:7], s25 offen sc1
  buffer_load_dword v94, v10, s[4:7], s24 offen sc1
  s_lshl_b32 s25, s17, 17
  s_lshl_b32 s26, s19, 12
  s_add_u32 s25, s25, s26
  s_add_u32 s25, s25, 16777216
  s_lshr_b32 s24, s17, 1
  s_lshl_b32 s24, s24, 9
  s_add_u32 s24, s24, 1146880
L_opoll_85:
  v_cmp_eq_u32 vcc, 0, v7
  s_cbranch_vccz L_ogot_86
  s_sub_u32 s33, s33, 1
  s_cbranch_scc1 L_done
  s_cmp_ge_u32 s17, 126
  s_cbranch_scc1 L_opoll_85_n
  s_sleep 16
L_opoll_85_n:
  buffer_load_dword v7, v8, s[4:7], s24 offen sc1
  s_waitcnt vmcnt(0)
  s_branch L_opoll_85
L_ogot_86:
  s_xor_b32 s26, s25, 0
  buffer_load_dwordx4 v[16:19], v1, s[4:7], s26 offen offset:0 sc1
  buffer_load_dwordx4 v[20:23], v1, s[4:7], s26 offen offset:1024 sc1
  buffer_load_dwordx4 v[24:27], v1, s[4:7], s26 offen offset:2048 sc1
  buffer_load_dwordx4 v[28:31], v1, s[4:7], s26 offen offset:3072 sc1
  s_xor_b32 s26, s25, 4096
  buffer_load_dwordx4 v[32:35], v1, s[4:7], s26 offen offset:0 sc1
  buffer_load_dwordx4 v[36:39], v1, s[4:7], s26 offen offset:1024 sc1
  buffer_load_dwordx4 v[40:43], v1, s[4:7], s26 offen offset:2048 sc1
  buffer_load_dwordx4 v[44:47], v1, s[4:7], s26 offen offset:3072 sc1
  ds_read_b128 v[64:67], v14 offset:0
  ds_read_b128 v[68:71], v14 offset:1024
  s_waitcnt vmcnt(7)
  v_mfma_f32_16x16x32_bf16 v[76:79], a[0:3], v[16:19], 0
  s_xor_b32 s26, s25, 8192
  buffer_load_dwordx4 v[48:51], v1, s[4:7], s26 offen offset:0 sc1
  v_mfma_f32_16x16x32_bf16 v[80:83], a[4:7], v[16:19], 0
  ds_read_b128 v[72:75], v14 offset:2048
  v_mfma_f32_16x16x32_bf16 v[84:87], v[128:131], v[16:19], 0
  s_waitcnt lgkmcnt(2)
  v_mfma_f32_16x16x32_bf16 v[88:91], v[64:67], v[16:19], 0
  v_lshlrev_b32 v96, 16, v92
  v_and_b32 v97, 0xffff0000, v92
  v_lshlrev_b32 v98, 16, v93
  v_and_b32 v99, 0xffff0000, v93
  v_mov_b32 v100, v94
  s_waitcnt vmcnt(7)
  v_mfma_f32_16x16x32_bf16 v[76:79], a[8:11], v[20:23], v[76:79]
  buffer_load_dwordx4 v[52:55], v1, s[4:7], s26 offen offset:1024 sc1
  v_mfma_f32_16x16x32_bf16 v[80:83], a[12:15], v[20:23], v[80:83]
  ds_read_b128 v[64:67], v14 offset:3072
  v_mfma_f32_16x16x32_bf16 v[84:87], v[132:135], v[20:23], v[84:87]
  s_waitcnt lgkmcnt(2)
  v_mfma_f32_16x16x32_bf16 v[88:91], v[68:71], v[20:23], v[88:91]
  s_waitcnt vmcnt(7)
  v_mfma_f32_16x16x32_bf16 v[76:79], a[16:19], v[24:27], v[76:79]
  buffer_load_dwordx4 v[56:59], v1, s[4:7], s26 offen offset:2048 sc1
  v_mfma_f32_16x16x32_bf16 v[80:83], a[20:23], v[24:27], v[80:83]
  ds_read_b128 v[68:71], v14 offset:4096
  v_mfma_f32_16x16x32_bf16 v[84:87], v[136:139], v[24:27], v[84:87]
  s_waitcnt lgkmcnt(2)
  v_mfma_f32_16x16x32_bf16 v[88:91], v[72:75], v[24:27], v[88:91]
  s_waitcnt vmcnt(7)
  v_mfma_f32_16x16x32_bf16 v[76:79], a[24:27], v[28:31], v[76:79]
  buffer_load_dwordx4 v[60:63], v1, s[4:7], s26 offen offset:3072 sc1
  v_mfma_f32_16x16x32_bf16 v[80:83], a[28:31], v[28:31], v[80:83]
  ds_read_b128 v[72:75], v14 offset:5120
  v_mfma_f32_16x16x32_bf16 v[84:87], v[140:143], v[28:31], v[84:87]
  s_waitcnt lgkmcnt(2)
  v_mfma_f32_16x16x32_bf16 v[88:91], v[64:67], v[28:31], v[88:91]
  s_waitcnt vmcnt(7)
  v_mfma_f32_16x16x32_bf16 v[76:79], a[32:35], v[32:35], v[76:79]
  s_xor_b32 s26, s25, 12288
  buffer_load_dwordx4 v[16:19], v1, s[4:7], s26 offen offset:0 sc1
  v_mfma_f32_16x16x32_bf16 v[80:83], a[36:39], v[32:35], v[80:83]
  ds_read_b128 v[64:67], v14 offset:6144
  v_mfma_f32_16x16x32_bf16 v[84:87], v[144:147], v[32:35], v[84:87]
  s_waitcnt lgkmcnt(2)
  v_mfma_f32_16x16x32_bf16 v[88:91], v[68:71], v[32:35], v[88:91]
  s_waitcnt vmcnt(7)
  v_mfma_f32_16x16x32_bf16 v[76:79], a[40:43], v[36:39], v[76:79]
  buffer_load_dwordx4 v[20:23], v1, s[4:7], s26 offen offset:1024 sc1
  v_mfma_f32_16x16x32_bf16 v[80:83], a[44:47], v[36:39], v[80:83]
  ds_read_b128 v[68:71], v14 offset:7168
  v_mfma_f32_16x16x32_bf16 v[84:87], v[148:151], v[36:39], v[84:87]
  s_waitcnt lgkmcnt(2)
  v_mfma_f32_16x16x32_bf16 v[88:91], v[72:75], v[36:39], v[88:91]
  s_waitcnt vmcnt(7)
  v_mfma_f32_16x16x32_bf16 v[76:79], a[48:51], v[40:43], v[76:79]
  buffer_load_dwordx4 v[24:27], v1, s[4:7], s26 offen offset:2048 sc1
  v_mfma_f32_16x16x32_bf16 v[80:83], a[52:55], v[40:43], v[80:83]
  ds_read_b128 v[72:75], v14 offset:8192
  v_mfma_f32_16x16x32_bf16 v[84:87], v[152:155], v[40:43], v[84:87]
  s_waitcnt lgkmcnt(2)
  v_mfma_f32_16x16x32_bf16 v[88:91], v[64:67], v[40:43], v[88:91]
  s_waitcnt vmcnt(7)
  v_mfma_f32_16x16x32_bf16 v[76:79], a[56:59], v[44:47], v[76:79]
  buffer_load_dwordx4 v[28:31], v1, s[4:7], s26 offen offset:3072 sc1
  v_mfma_f32_16x16x32_bf16 v[80:83], a[60:63], v[44:47], v[80:83]
  ds_read_b128 v[64:67], v14 offset:9216
  v_mfma_f32_16x16x32_bf16 v[84:87], v[156:159], v[44:47], v[84:87]
  s_waitcnt lgkmcnt(2)
  v_mfma_f32_16x16x32_bf16 v[88:91], v[68:71], v[44:47], v[88:91]
  s_waitcnt vmcnt(7)
  v_mfma_f32_16x16x32_bf16 v[76:79], a[64:67], v[48:51], v[76:79]
  s_xor_b32 s26, s25, 16384
  buffer_load_dwordx4 v[32:35], v1, s[4:7], s26 offen offset:0 sc1
  v_mfma_f32_16x16x32_bf16 v[80:83], a[68:71], v[48:51], v[80:83]
  ds_read_b128 v[68:71], v14 offset:10240
  v_mfma_f32_16x16x32_bf16 v[84:87], v[160:163], v[48:51], v[84:87]
  s_waitcnt lgkmcnt(2)
  v_mfma_f32_16x16x32_bf16 v[88:91], v[72:75], v[48:51], v[88:91]
  s_waitcnt vmcnt(7)
  v_mfma_f32_16x16x32_bf16 v[76:79], a[72:75], v[52:55], v[76:79]
  buffer_load_dwordx4 v[36:39], v1, s[4:7], s26 offen offset:1024 sc1
  v_mfma_f32_16x16x32_bf16 v[80:83], a[76:79], v[52:55], v[80:83]
  ds_read_b128 v[72:75], v14 offset:11264
  v_mfma_f32_16x16x32_bf16 v[84:87], v[164:167], v[52:55], v[84:87]
  s_waitcnt lgkmcnt(2)
  v_mfma_f32_16x16x32_bf16 v[88:91], v[64:67], v[52:55], v[88:91]
  s_waitcnt vmcnt(7)
  v_mfma_f32_16x16x32_bf16 v[76:79], a[80:83], v[56:59], v[76:79]
  buffer_load_dwordx4 v[40:43], v1, s[4:7], s26 offen offset:2048 sc1
  v_mfma_f32_16x16x32_bf16 v[80:83], a[84:87], v[56:59], v[80:83]
  ds_read_b128 v[64:67], v14 offset:12288
  v_mfma_f32_16x16x32_bf16 v[84:87], v[168:171], v[56:59], v[84:87]
  s_waitcnt lgkmcnt(2)
  v_mfma_f32_16x16x32_bf16 v[88:91], v[68:71], v[56:59], v[88:91]
  s_waitcnt vmcnt(7)
  v_mfma_f32_16x16x32_bf16 v[76:79], a[88:91], v[60:63], v[76:79]
  buffer_load_dwordx4 v[44:47], v1, s[4:7], s26 offen offset:3072 sc1
  v_mfma_f32_16x16x32_bf16 v[80:83], a[92:95], v[60:63], v[80:83]
  ds_read_b128 v[68:71], v14 offset:13312
  v_mfma_f32_16x16x32_bf16 v[84:87], v[172:175], v[60:63], v[84:87]
  s_waitcnt lgkmcnt(2)
  v_mfma_f32_16x16x32_bf16 v[88:91], v[72:75], v[60:63], v[88:91]
  s_waitcnt vmcnt(7)
  v_mfma_f32_16x16x32_bf16 v[76:79], a[96:99], v[16:19], v[76:79]
  s_xor_b32 s26, s25, 20480
  buffer_load_dwordx4 v[48:51], v1, s[4:7], s26 offen offset:0 sc1
  v_mfma_f32_16x16x32_bf16 v[80:83], a[100:103], v[16:19], v[80:83]
  ds_read_b128 v[72:75], v14 offset:14336
  v_mfma_f32_16x16x32_bf16 v[84:87], v[176:179], v[16:19], v[84:87]
  s_waitcnt lgkmcnt(2)
  v_mfma_f32_16x16x32_bf16 v[88:91], v[64:67], v[16:19], v[88:91]
  s_waitcnt vmcnt(7)
  v_mfma_f32_16x16x32_bf16 v[76:79], a[104:107], v[20:23], v[76:79]
  buffer_load_dwordx4 v[52:55], v1, s[4:7], s26 offen offset:1024 sc1
  v_mfma_f32_16x16x32_bf16 v[80:83], a[108:111], v[20:23], v[80:83]
  ds_read_b128 v[64:67], v14 offset:15360
  v_mfma_f32_16x16x32_bf16 v[84:87], v[180:183], v[20:23], v[84:87]
  s_waitcnt lgkmcnt(2)
  v_mfma_f32_16x16x32_bf16 v[88:91], v[68:71], v[20:23], v[88:91]
  s_waitcnt vmcnt(7)
  v_mfma_f32_16x16x32_bf16 v[76:79], a[112:115], v[24:27], v[76:79]
  buffer_load_dwordx4 v[56:59], v1, s[4:7], s26 offen offset:2048 sc1
  v_mfma_f32_16x16x32_bf16 v[80:83], a[116:119], v[24:27], v[80:83]
  ds_read_b128 v[68:71], v14 offset:16384
  v_mfma_f32_16x16x32_bf16 v[84:87], v[184:187], v[24:27], v[84:87]
  s_waitcnt lgkmcnt(2)
  v_mfma_f32_16x16x32_bf16 v[88:91], v[72:75], v[24:27], v[88:91]
  s_waitcnt vmcnt(7)
  v_mfma_f32_16x16x32_bf16 v[76:79], a[120:123], v[28:31], v[76:79]
  buffer_load_dwordx4 v[60:63], v1, s[4:7], s26 offen offset:3072 sc1
  v_mfma_f32_16x16x32_bf16 v[80:83], a[124:127], v[28:31], v[80:83]
  ds_read_b128 v[72:75], v14 offset:17408
  v_mfma_f32_16x16x32_bf16 v[84:87], v[188:191], v[28:31], v[84:87]
  s_waitcnt lgkmcnt(2)
  v_mfma_f32_16x16x32_bf16 v[88:91], v[64:67], v[28:31], v[88:91]
  s_waitcnt vmcnt(7)
  v_mfma_f32_16x16x32_bf16 v[76:79], a[128:131], v[32:35], v[76:79]
  s_xor_b32 s26, s25, 24576
  buffer_load_dwordx4 v[16:19], v1, s[4:7], s26 offen offset:0 sc1
  s_cmp_lt_u32 s17, 32
  s_cselect_b32 s24, 8, 12
  s_add_u32 s17, s17, s24
  s_lshr_b32 s24, s17, 1
  s_lshl_b32 s24, s24, 9
  s_add_u32 s24, s24, 1146880
  buffer_load_dword v7, v8, s[4:7], s24 offen sc1
  v_mfma_f32_16x16x32_bf16 v[80:83], a[132:135], v[32:35], v[80:83]
  ds_read_b128 v[64:67], v14 offset:18432
  v_mfma_f32_16x16x32_bf16 v[84:87], v[192:195], v[32:35], v[84:87]
  s_waitcnt lgkmcnt(2)
  v_mfma_f32_16x16x32_bf16 v[88:91], v[68:71], v[32:35], v[88:91]
  s_waitcnt vmcnt(8)
  v_mfma_f32_16x16x32_bf16 v[76:79], a[136:139], v[36:39], v[76:79]
  buffer_load_dwordx4 v[20:23], v1, s[4:7], s26 offen offset:1024 sc1
  v_mfma_f32_16x16x32_bf16 v[80:83], a[140:143], v[36:39], v[80:83]
  ds_read_b128 v[68:71], v14 offset:19456
  v_mfma_f32_16x16x32_bf16 v[84:87], v[196:199], v[36:39], v[84:87]
  s_waitcnt lgkmcnt(2)
  v_mfma_f32_16x16x32_bf16 v[88:91], v[72:75], v[36:39], v[88:91]
  s_waitcnt vmcnt(8)
  v_mfma_f32_16x16x32_bf16 v[76:79], a[144:147], v[40:43], v[76:79]
  buffer_load_dwordx4 v[24:27], v1, s[4:7], s26 offen offset:2048 sc1
  v_mfma_f32_16x16x32_bf16 v[80:83], a[148:151], v[40:43], v[80:83]
  ds_read_b128 v[72:75], v14 offset:20480
  v_mfma_f32_16x16x32_bf16 v[84:87], v[200:203], v[40:43], v[84:87]
  s_waitcnt lgkmcnt(2)
  v_mfma_f32_16x16x32_bf16 v[88:91], v[64:67], v[40:43], v[88:91]
  s_waitcnt vmcnt(8)
  v_mfma_f32_16x16x32_bf16 v[76:79], a[152:155], v[44:47], v[76:79]
  buffer_load_dwordx4 v[28:31], v1, s[4:7], s26 offen offset:3072 sc1
  v_mfma_f32_16x16x32_bf16 v[80:83], a[156:159], v[44:47], v[80:83]
  ds_read_b128 v[64:67], v14 offset:21504
  v_mfma_f32_16x16x32_bf16 v[84:87], v[204:207], v[44:47], v[84:87]
  s_waitcnt lgkmcnt(2)
  v_mfma_f32_16x16x32_bf16 v[88:91], v[68:71], v[44:47], v[88:91]
  s_waitcnt vmcnt(8)
  v_mfma_f32_16x16x32_bf16 v[76:79], a[160:163], v[48:51], v[76:79]
  s_xor_b32 s26, s25, 28672
  buffer_load_dwordx4 v[32:35], v1, s[4:7], s26 offen offset:0 sc1
  v_mfma_f32_16x16x32_bf16 v[80:83], a[164:167], v[48:51], v[80:83]
  ds_read_b128 v[68:71], v14 offset:22528
  v_mfma_f32_16x16x32_bf16 v[84:87], v[208:211], v[48:51], v[84:87]
  s_waitcnt lgkmcnt(2)
  v_mfma_f32_16x16x32_bf16 v[88:91], v[72:75], v[48:51], v[88:91]
  s_waitcnt vmcnt(8)
  v_mfma_f32_16x16x32_bf16 v[76:79], a[168:171], v[52:55], v[76:79]
  buffer_load_dwordx4 v[36:39], v1, s[4:7], s26 offen offset:1024 sc1
  v_mfma_f32_16x16x32_bf16 v[80:83], a[172:175], v[52:55], v[80:83]
  ds_read_b128 v[72:75], v14 offset:23552
  v_mfma_f32_16x16x32_bf16 v[84:87], v[212:215], v[52:55], v[84:87]
  s_waitcnt lgkmcnt(2)
  v_mfma_f32_16x16x32_bf16 v[88:91], v[64:67], v[52:55], v[88:91]
  s_waitcnt vmcnt(8)
  v_mfma_f32_16x16x32_bf16 v[76:79], a[176:179], v[56:59], v[76:79]
  buffer_load_dwordx4 v[40:43], v1, s[4:7], s26 offen offset:2048 sc1
  v_mfma_f32_16x16x32_bf16 v[80:83], a[180:183], v[56:59], v[80:83]
  ds_read_b128 v[64:67], v14 offset:24576
  v_mfma_f32_16x16x32_bf16 v[84:87], v[216:219], v[56:59], v[84:87]
  s_waitcnt lgkmcnt(2)
  v_mfma_f32_16x16x32_bf16 v[88:91], v[68:71], v[56:59], v[88:91]
  s_waitcnt vmcnt(8)
  v_mfma_f32_16x16x32_bf16 v[76:79], a[184:187], v[60:63], v[76:79]
  buffer_load_dwordx4 v[44:47], v1, s[4:7], s26 offen offset:3072 sc1
  v_mfma_f32_16x16x32_bf16 v[80:83], a[188:191], v[60:63], v[80:83]
  ds_read_b128 v[68:71], v14 offset:25600
  v_mfma_f32_16x16x32_bf16 v[84:87], v[220:223], v[60:63], v[84:87]
  s_waitcnt lgkmcnt(2)
  v_mfma_f32_16x16x32_bf16 v[88:91], v[72:75], v[60:63], v[88:91]
  s_waitcnt vmcnt(8)
  v_mfma_f32_16x16x32_bf16 v[76:79], a[192:195], v[16:19], v[76:79]
  v_mfma_f32_16x16x32_bf16 v[80:83], a[196:199], v[16:19], v[80:83]
  ds_read_b128 v[72:75], v14 offset:26624
  v_mfma_f32_16x16x32_bf16 v[84:87], v[224:227], v[16:19], v[84:87]
  s_waitcnt lgkmcnt(2)
  v_mfma_f32_16x16x32_bf16 v[88:91], v[64:67], v[16:19], v[88:91]
  s_waitcnt vmcnt(6)
  v_mfma_f32_16x16x32_bf16 v[76:79], a[200:203], v[20:23], v[76:79]
  v_mfma_f32_16x16x32_bf16 v[80:83], a[204:207], v[20:23], v[80:83]
  ds_read_b128 v[64:67], v14 offset:27648
  v_mfma_f32_16x16x32_bf16 v[84:87], v[228:231], v[20:23], v[84:87]
  s_waitcnt lgkmcnt(2)
  v_mfma_f32_16x16x32_bf16 v[88:91], v[68:71], v[20:23], v[88:91]
  s_waitcnt vmcnt(5)
  v_mfma_f32_16x16x32_bf16 v[76:79], a[208:211], v[24:27], v[76:79]
  v_mfma_f32_16x16x32_bf16 v[80:83], a[212:215], v[24:27], v[80:83]
  ds_read_b128 v[68:71], v14 offset:28672
  v_mfma_f32_16x16x32_bf16 v[84:87], v[232:235], v[24:27], v[84:87]
  s_waitcnt lgkmcnt(2)
  v_mfma_f32_16x16x32_bf16 v[88:91], v[72:75], v[24:27], v[88:91]
  s_waitcnt vmcnt(4)
  v_mfma_f32_16x16x32_bf16 v[76:79], a[216:219], v[28:31], v[76:79]
  v_mfma_f32_16x16x32_bf16 v[80:83], a[220:223], v[28:31], v[80:83]
  ds_read_b128 v[72:75], v14 offset:29696
  v_mfma_f32_16x16x32_bf16 v[84:87], v[236:239], v[28:31], v[84:87]
  s_waitcnt lgkmcnt(2)
  v_mfma_f32_16x16x32_bf16 v[88:91], v[64:67], v[28:31], v[88:91]
  s_waitcnt vmcnt(3)
  v_mfma_f32_16x16x32_bf16 v[76:79], a[224:227], v[32:35], v[76:79]
  v_mfma_f32_16x16x32_bf16 v[80:83], a[228:231], v[32:35], v[80:83]
  ds_read_b128 v[64:67], v14 offset:30720
  v_mfma_f32_16x16x32_bf16 v[84:87], v[240:243], v[32:35], v[84:87]
  s_waitcnt lgkmcnt(2)
  v_mfma_f32_16x16x32_bf16 v[88:91], v[68:71], v[32:35], v[88:91]
  s_waitcnt vmcnt(2)
  v_mfma_f32_16x16x32_bf16 v[76:79], a[232:235], v[36:39], v[76:79]
  v_mfma_f32_16x16x32_bf16 v[80:83], a[236:239], v[36:39], v[80:83]
  ds_read_b128 v[68:71], v14 offset:31744
  v_mfma_f32_16x16x32_bf16 v[84:87], v[244:247], v[36:39], v[84:87]
  s_waitcnt lgkmcnt(2)
  v_mfma_f32_16x16x32_bf16 v[88:91], v[72:75], v[36:39], v[88:91]
  s_waitcnt vmcnt(1)
  v_mfma_f32_16x16x32_bf16 v[76:79], a[240:243], v[40:43], v[76:79]
  v_mfma_f32_16x16x32_bf16 v[80:83], a[244:247], v[40:43], v[80:83]
  v_mfma_f32_16x16x32_bf16 v[84:87], v[248:251], v[40:43], v[84:87]
  s_waitcnt lgkmcnt(1)
  v_mfma_f32_16x16x32_bf16 v[88:91], v[64:67], v[40:43], v[88:91]
  s_waitcnt vmcnt(0)
  v_mfma_f32_16x16x32_bf16 v[76:79], a[248:251], v[44:47], v[76:79]
  v_mfma_f32_16x16x32_bf16 v[80:83], a[252:255], v[44:47], v[80:83]
  v_mfma_f32_16x16x32_bf16 v[84:87], v[252:255], v[44:47], v[84:87]
  s_waitcnt lgkmcnt(0)
  v_mfma_f32_16x16x32_bf16 v[88:91], v[68:71], v[44:47], v[88:91]
  v_cmp_eq_u32 vcc, 0, v7
  s_sub_u32 s24, s17, 96
  s_cmp_lt_u32 s24, 12
  s_cselect_b32 s24, 128, s17
  s_cmp_ge_u32 s24, 128
  ds_write_b128 v11, v[76:79] offset:0
  ds_write_b128 v11, v[80:83] offset:1024
  ds_write_b128 v11, v[84:87] offset:2048
  ds_write_b128 v11, v[88:91] offset:3072
L_onext_87:
  s_cbranch_scc1 L_oslow_88
  s_cbranch_vccnz L_oslow_88
  s_mov_b32 s20, s15
  s_lshl_b32 s24, s17, 14
  s_lshl_b32 s25, s16, 7
  s_add_u32 s15, s24, s25
  s_lshr_b32 s24, s17, 3
  s_lshl_b32 s24, s24, 17
  s_and_b32 s25, s17, 7
  s_lshl_b32 s25, s25, 5
  s_add_u32 s25, s25, s24
  s_add_u32 s25, s25, 6291456
  s_lshl_b32 s24, s17, 6
  s_add_u32 s24, s24, 1245184
  buffer_load_dwordx2 v[92:93], v13, s[4:7], s25 offen sc1
  buffer_load_dword v94, v10, s[4:7], s24 offen sc1
  s_lshl_b32 s25, s17, 17
  s_lshl_b32 s26, s19, 12
  s_add_u32 s25, s25, s26
  s_add_u32 s25, s25, 16777216
  s_xor_b32 s26, s25, 0
  buffer_load_dwordx4 v[16:19], v1, s[4:7], s26 offen offset:0 sc1
  buffer_load_dwordx4 v[20:23], v1, s[4:7], s26 offen offset:1024 sc1
  buffer_load_dwordx4 v[24:27], v1, s[4:7], s26 offen offset:2048 sc1
  s_waitcnt lgkmcnt(0)
  s_barrier
  ds_read2st64_b32 v[104:105], v12 offset0:0 offset1:4
  ds_read2st64_b32 v[106:107], v12 offset0:8 offset1:12
  ds_read2st64_b32 v[108:109], v12 offset0:16 offset1:20
  ds_read2st64_b32 v[110:111], v12 offset0:24 offset1:28
  ds_read2st64_b32 v[112:113], v12 offset0:32 offset1:36
  ds_read2st64_b32 v[114:115], v12 offset0:40 offset1:44
  ds_read2st64_b32 v[116:117], v12 offset0:48 offset1:52
  ds_read2st64_b32 v[118:119], v12 offset0:56 offset1:60
  v_xor_b32 v11, 0x4000, v11
  v_xor_b32 v12, 0x4000, v12
  buffer_load_dwordx4 v[28:31], v1, s[4:7], s26 offen offset:3072 sc1
  s_xor_b32 s26, s25, 4096
  buffer_load_dwordx4 v[32:35], v1, s[4:7], s26 offen offset:0 sc1
  buffer_load_dwordx4 v[36:39], v1, s[4:7], s26 offen offset:1024 sc1
  s_waitcnt lgkmcnt(0)
  v_add_f32 v104, v104, v108
  v_add_f32 v112, v112, v116
  v_add_f32 v104, v104, v112
  v_sub_f32 v104, v104, v96
  v_fma_f32 v104, v104, v100, v96
  v_add_f32 v105, v105, v109
  v_add_f32 v113, v113, v117
  v_add_f32 v105, v105, v113
  v_sub_f32 v105, v105, v97
  v_fma_f32 v105, v105, v100, v97
  v_add_f32 v106, v106, v110
  v_add_f32 v114, v114, v118
  v_add_f32 v106, v106, v114
  v_sub_f32 v106, v106, v98
  v_fma_f32 v106, v106, v100, v98
  v_add_f32 v107, v107, v111
  v_add_f32 v115, v115, v119
  v_add_f32 v107, v107, v115
  v_sub_f32 v107, v107, v99
  v_fma_f32 v107, v107, v100, v99
  v_cvt_pk_bf16_f32 v120, v104, v105
  v_cvt_pk_bf16_f32 v121, v106, v107
  buffer_store_dwordx2 v[120:121], v9, s[72:75], s20 offen nt
  buffer_load_dwordx4 v[40:43], v1, s[4:7], s26 offen offset:2048 sc1
  buffer_load_dwordx4 v[44:47], v1, s[4:7], s26 offen offset:3072 sc1
  ds_read_b128 v[64:67], v14 offset:0
  ds_read_b128 v[68:71], v14 offset:1024
  s_waitcnt vmcnt(8)
  v_mfma_f32_16x16x32_bf16 v[76:79], a[0:3], v[16:19], 0
  s_xor_b32 s26, s25, 8192
  buffer_load_dwordx4 v[48:51], v1, s[4:7], s26 offen offset:0 sc1
  v_mfma_f32_16x16x32_bf16 v[80:83], a[4:7], v[16:19], 0
  ds_read_b128 v[72:75], v14 offset:2048
  v_mfma_f32_16x16x32_bf16 v[84:87], v[128:131], v[16:19], 0
  s_waitcnt lgkmcnt(2)
  v_mfma_f32_16x16x32_bf16 v[88:91], v[64:67], v[16:19], 0
  v_lshlrev_b32 v96, 16, v92
  v_and_b32 v97, 0xffff0000, v92
  v_lshlrev_b32 v98, 16, v93
  v_and_b32 v99, 0xffff0000, v93
  v_mov_b32 v100, v94
  s_waitcnt vmcnt(8)
  v_mfma_f32_16x16x32_bf16 v[76:79], a[8:11], v[20:23], v[76:79]
  buffer_load_dwordx4 v[52:55], v1, s[4:7], s26 offen offset:1024 sc1
  v_mfma_f32_16x16x32_bf16 v[80:83], a[12:15], v[20:23], v[80:83]
  ds_read_b128 v[64:67], v14 offset:3072
  v_mfma_f32_16x16x32_bf16 v[84:87], v[132:135], v[20:23], v[84:87]
  s_waitcnt lgkmcnt(2)
  v_mfma_f32_16x16x32_bf16 v[88:91], v[68:71], v[20:23], v[88:91]
  s_waitcnt vmcnt(8)
  v_mfma_f32_16x16x32_bf16 v[76:79], a[16:19], v[24:27], v[76:79]
  buffer_load_dwordx4 v[56:59], v1, s[4:7], s26 offen offset:2048 sc1
  v_mfma_f32_16x16x32_bf16 v[80:83], a[20:23], v[24:27], v[80:83]
  ds_read_b128 v[68:71], v14 offset:4096
  v_mfma_f32_16x16x32_bf16 v[84:87], v[136:139], v[24:27], v[84:87]
  s_waitcnt lgkmcnt(2)
  v_mfma_f32_16x16x32_bf16 v[88:91], v[72:75], v[24:27], v[88:91]
  s_waitcnt vmcnt(8)
  v_mfma_f32_16x16x32_bf16 v[76:79], a[24:27], v[28:31], v[76:79]
  buffer_load_dwordx4 v[60:63], v1, s[4:7], s26 offen offset:3072 sc1
  v_mfma_f32_16x16x32_bf16 v[80:83], a[28:31], v[28:31], v[80:83]
  ds_read_b128 v[72:75], v14 offset:5120
  v_mfma_f32_16x16x32_bf16 v[84:87], v[140:143], v[28:31], v[84:87]
  s_waitcnt lgkmcnt(2)
  v_mfma_f32_16x16x32_bf16 v[88:91], v[64:67], v[28:31], v[88:91]
  s_waitcnt vmcnt(8)
  v_mfma_f32_16x16x32_bf16 v[76:79], a[32:35], v[32:35], v[76:79]
  s_xor_b32 s26, s25, 12288
  buffer_load_dwordx4 v[16:19], v1, s[4:7], s26 offen offset:0 sc1
  v_mfma_f32_16x16x32_bf16 v[80:83], a[36:39], v[32:35], v[80:83]
  ds_read_b128 v[64:67], v14 offset:6144
  v_mfma_f32_16x16x32_bf16 v[84:87], v[144:147], v[32:35], v[84:87]
  s_waitcnt lgkmcnt(2)
  v_mfma_f32_16x16x32_bf16 v[88:91], v[68:71], v[32:35], v[88:91]
  s_waitcnt vmcnt(8)
  v_mfma_f32_16x16x32_bf16 v[76:79], a[40:43], v[36:39], v[76:79]
  buffer_load_dwordx4 v[20:23], v1, s[4:7], s26 offen offset:1024 sc1
  v_mfma_f32_16x16x32_bf16 v[80:83], a[44:47], v[36:39], v[80:83]
  ds_read_b128 v[68:71], v14 offset:7168
  v_mfma_f32_16x16x32_bf16 v[84:87], v[148:151], v[36:39], v[84:87]
  s_waitcnt lgkmcnt(2)
  v_mfma_f32_16x16x32_bf16 v[88:91], v[72:75], v[36:39], v[88:91]
  s_waitcnt vmcnt(7)
  v_mfma_f32_16x16x32_bf16 v[76:79], a[48:51], v[40:43], v[76:79]
  buffer_load_dwordx4 v[24:27], v1, s[4:7], s26 offen offset:2048 sc1
  v_mfma_f32_16x16x32_bf16 v[80:83], a[52:55], v[40:43], v[80:83]
  ds_read_b128 v[72:75], v14 offset:8192
  v_mfma_f32_16x16x32_bf16 v[84:87], v[152:155], v[40:43], v[84:87]
  s_waitcnt lgkmcnt(2)
  v_mfma_f32_16x16x32_bf16 v[88:91], v[64:67], v[40:43], v[88:91]
  s_waitcnt vmcnt(7)
  v_mfma_f32_16x16x32_bf16 v[76:79], a[56:59], v[44:47], v[76:79]
  buffer_load_dwordx4 v[28:31], v1, s[4:7], s26 offen offset:3072 sc1
  v_mfma_f32_16x16x32_bf16 v[80:83], a[60:63], v[44:47], v[80:83]
  ds_read_b128 v[64:67], v14 offset:9216
  v_mfma_f32_16x16x32_bf16 v[84:87], v[156:159], v[44:47], v[84:87]
  s_waitcnt lgkmcnt(2)
  v_mfma_f32_16x16x32_bf16 v[88:91], v[68:71], v[44:47], v[88:91]
  s_waitcnt vmcnt(7)
  v_mfma_f32_16x16x32_bf16 v[76:79], a[64:67], v[48:51], v[76:79]
  s_xor_b32 s26, s25, 16384
  buffer_load_dwordx4 v[32:35], v1, s[4:7], s26 offen offset:0 sc1
  v_mfma_f32_16x16x32_bf16 v[80:83], a[68:71], v[48:51], v[80:83]
  ds_read_b128 v[68:71], v14 offset:10240
  v_mfma_f32_16x16x32_bf16 v[84:87], v[160:163], v[48:51], v[84:87]
  s_waitcnt lgkmcnt(2)
  v_mfma_f32_16x16x32_bf16 v[88:91], v[72:75], v[48:51], v[88:91]
  s_waitcnt vmcnt(7)
  v_mfma_f32_16x16x32_bf16 v[76:79], a[72:75], v[52:55], v[76:79]
  buffer_load_dwordx4 v[36:39], v1, s[4:7], s26 offen offset:1024 sc1
  v_mfma_f32_16x16x32_bf16 v[80:83], a[76:79], v[52:55], v[80:83]
  ds_read_b128 v[72:75], v14 offset:11264
  v_mfma_f32_16x16x32_bf16 v[84:87], v[164:167], v[52:55], v[84:87]
  s_waitcnt lgkmcnt(2)
  v_mfma_f32_16x16x32_bf16 v[88:91], v[64:67], v[52:55], v[88:91]
  s_waitcnt vmcnt(7)
  v_mfma_f32_16x16x32_bf16 v[76:79], a[80:83], v[56:59], v[76:79]
  buffer_load_dwordx4 v[40:43], v1, s[4:7], s26 offen offset:2048 sc1
  v_mfma_f32_16x16x32_bf16 v[80:83], a[84:87], v[56:59], v[80:83]
  ds_read_b128 v[64:67], v14 offset:12288
  v_mfma_f32_16x16x32_bf16 v[84:87], v[168:171], v[56:59], v[84:87]
  s_waitcnt lgkmcnt(2)
  v_mfma_f32_16x16x32_bf16 v[88:91], v[68:71], v[56:59], v[88:91]
  s_waitcnt vmcnt(7)
  v_mfma_f32_16x16x32_bf16 v[76:79], a[88:91], v[60:63], v[76:79]
  buffer_load_dwordx4 v[44:47], v1, s[4:7], s26 offen offset:3072 sc1
  v_mfma_f32_16x16x32_bf16 v[80:83], a[92:95], v[60:63], v[80:83]
  ds_read_b128 v[68:71], v14 offset:13312
  v_mfma_f32_16x16x32_bf16 v[84:87], v[172:175], v[60:63], v[84:87]
  s_waitcnt lgkmcnt(2)
  v_mfma_f32_16x16x32_bf16 v[88:91], v[72:75], v[60:63], v[88:91]
  s_waitcnt vmcnt(7)
  v_mfma_f32_16x16x32_bf16 v[76:79], a[96:99], v[16:19], v[76:79]
  s_xor_b32 s26, s25, 20480
  buffer_load_dwordx4 v[48:51], v1, s[4:7], s26 offen offset:0 sc1
  v_mfma_f32_16x16x32_bf16 v[80:83], a[100:103], v[16:19], v[80:83]
  ds_read_b128 v[72:75], v14 offset:14336
  v_mfma_f32_16x16x32_bf16 v[84:87], v[176:179], v[16:19], v[84:87]
  s_waitcnt lgkmcnt(2)
  v_mfma_f32_16x16x32_bf16 v[88:91], v[64:67], v[16:19], v[88:91]
  s_waitcnt vmcnt(7)
  v_mfma_f32_16x16x32_bf16 v[76:79], a[104:107], v[20:23], v[76:79]
  buffer_load_dwordx4 v[52:55], v1, s[4:7], s26 offen offset:1024 sc1
  v_mfma_f32_16x16x32_bf16 v[80:83], a[108:111], v[20:23], v[80:83]
  ds_read_b128 v[64:67], v14 offset:15360
  v_mfma_f32_16x16x32_bf16 v[84:87], v[180:183], v[20:23], v[84:87]
  s_waitcnt lgkmcnt(2)
  v_mfma_f32_16x16x32_bf16 v[88:91], v[68:71], v[20:23], v[88:91]
  s_waitcnt vmcnt(7)
  v_mfma_f32_16x16x32_bf16 v[76:79], a[112:115], v[24:27], v[76:79]
  buffer_load_dwordx4 v[56:59], v1, s[4:7], s26 offen offset:2048 sc1
  v_mfma_f32_16x16x32_bf16 v[80:83], a[116:119], v[24:27], v[80:83]
  ds_read_b128 v[68:71], v14 offset:16384
  v_mfma_f32_16x16x32_bf16 v[84:87], v[184:187], v[24:27], v[84:87]
  s_waitcnt lgkmcnt(2)
  v_mfma_f32_16x16x32_bf16 v[88:91], v[72:75], v[24:27], v[88:91]
  s_waitcnt vmcnt(7)
  v_mfma_f32_16x16x32_bf16 v[76:79], a[120:123], v[28:31], v[76:79]
  buffer_load_dwordx4 v[60:63], v1, s[4:7], s26 offen offset:3072 sc1
  v_mfma_f32_16x16x32_bf16 v[80:83], a[124:127], v[28:31], v[80:83]
  ds_read_b128 v[72:75], v14 offset:17408
  v_mfma_f32_16x16x32_bf16 v[84:87], v[188:191], v[28:31], v[84:87]
  s_waitcnt lgkmcnt(2)
  v_mfma_f32_16x16x32_bf16 v[88:91], v[64:67], v[28:31], v[88:91]
  s_waitcnt vmcnt(7)
  v_mfma_f32_16x16x32_bf16 v[76:79], a[128:131], v[32:35], v[76:79]
  s_xor_b32 s26, s25, 24576
  buffer_load_dwordx4 v[16:19], v1, s[4:7], s26 offen offset:0 sc1
  s_cmp_lt_u32 s17, 32
  s_cselect_b32 s24, 8, 12
  s_add_u32 s17, s17, s24
  s_lshr_b32 s24, s17, 1
  s_lshl_b32 s24, s24, 9
  s_add_u32 s24, s24, 1146880
  buffer_load_dword v7, v8, s[4:7], s24 offen sc1
  v_mfma_f32_16x16x32_bf16 v[80:83], a[132:135], v[32:35], v[80:83]
  ds_read_b128 v[64:67], v14 offset:18432
  v_mfma_f32_16x16x32_bf16 v[84:87], v[192:195], v[32:35], v[84:87]
  s_waitcnt lgkmcnt(2)
  v_mfma_f32_16x16x32_bf16 v[88:91], v[68:71], v[32:35], v[88:91]
  s_waitcnt vmcnt(8)
  v_mfma_f32_16x16x32_bf16 v[76:79], a[136:139], v[36:39], v[76:79]
  buffer_load_dwordx4 v[20:23], v1, s[4:7], s26 offen offset:1024 sc1
  v_mfma_f32_16x16x32_bf16 v[80:83], a[140:143], v[36:39], v[80:83]
  ds_read_b128 v[68:71], v14 offset:19456
  v_mfma_f32_16x16x32_bf16 v[84:87], v[196:199], v[36:39], v[84:87]
  s_waitcnt lgkmcnt(2)
  v_mfma_f32_16x16x32_bf16 v[88:91], v[72:75], v[36:39], v[88:91]
  s_waitcnt vmcnt(8)
  v_mfma_f32_16x16x32_bf16 v[76:79], a[144:147], v[40:43], v[76:79]
  buffer_load_dwordx4 v[24:27], v1, s[4:7], s26 offen offset:2048 sc1
  v_mfma_f32_16x16x32_bf16 v[80:83], a[148:151], v[40:43], v[80:83]
  ds_read_b128 v[72:75], v14 offset:20480
  v_mfma_f32_16x16x32_bf16 v[84:87], v[200:203], v[40:43], v[84:87]
  s_waitcnt lgkmcnt(2)
  v_mfma_f32_16x16x32_bf16 v[88:91], v[64:67], v[40:43], v[88:91]
  s_waitcnt vmcnt(8)
  v_mfma_f32_16x16x32_bf16 v[76:79], a[152:155], v[44:47], v[76:79]
  buffer_load_dwordx4 v[28:31], v1, s[4:7], s26 offen offset:3072 sc1
  v_mfma_f32_16x16x32_bf16 v[80:83], a[156:159], v[44:47], v[80:83]
  ds_read_b128 v[64:67], v14 offset:21504
  v_mfma_f32_16x16x32_bf16 v[84:87], v[204:207], v[44:47], v[84:87]
  s_waitcnt lgkmcnt(2)
  v_mfma_f32_16x16x32_bf16 v[88:91], v[68:71], v[44:47], v[88:91]
  s_waitcnt vmcnt(8)
  v_mfma_f32_16x16x32_bf16 v[76:79], a[160:163], v[48:51], v[76:79]
  s_xor_b32 s26, s25, 28672
  buffer_load_dwordx4 v[32:35], v1, s[4:7], s26 offen offset:0 sc1
  v_mfma_f32_16x16x32_bf16 v[80:83], a[164:167], v[48:51], v[80:83]
  ds_read_b128 v[68:71], v14 offset:22528
  v_mfma_f32_16x16x32_bf16 v[84:87], v[208:211], v[48:51], v[84:87]
  s_waitcnt lgkmcnt(2)
  v_mfma_f32_16x16x32_bf16 v[88:91], v[72:75], v[48:51], v[88:91]
  s_waitcnt vmcnt(8)
  v_mfma_f32_16x16x32_bf16 v[76:79], a[168:171], v[52:55], v[76:79]
  buffer_load_dwordx4 v[36:39], v1, s[4:7], s26 offen offset:1024 sc1
  v_mfma_f32_16x16x32_bf16 v[80:83], a[172:175], v[52:55], v[80:83]
  ds_read_b128 v[72:75], v14 offset:23552
  v_mfma_f32_16x16x32_bf16 v[84:87], v[212:215], v[52:55], v[84:87]
  s_waitcnt lgkmcnt(2)
  v_mfma_f32_16x16x32_bf16 v[88:91], v[64:67], v[52:55], v[88:91]
  s_waitcnt vmcnt(8)
  v_mfma_f32_16x16x32_bf16 v[76:79], a[176:179], v[56:59], v[76:79]
  buffer_load_dwordx4 v[40:43], v1, s[4:7], s26 offen offset:2048 sc1
  v_mfma_f32_16x16x32_bf16 v[80:83], a[180:183], v[56:59], v[80:83]
  ds_read_b128 v[64:67], v14 offset:24576
  v_mfma_f32_16x16x32_bf16 v[84:87], v[216:219], v[56:59], v[84:87]
  s_waitcnt lgkmcnt(2)
  v_mfma_f32_16x16x32_bf16 v[88:91], v[68:71], v[56:59], v[88:91]
  s_waitcnt vmcnt(8)
  v_mfma_f32_16x16x32_bf16 v[76:79], a[184:187], v[60:63], v[76:79]
  buffer_load_dwordx4 v[44:47], v1, s[4:7], s26 offen offset:3072 sc1
  v_mfma_f32_16x16x32_bf16 v[80:83], a[188:191], v[60:63], v[80:83]
  ds_read_b128 v[68:71], v14 offset:25600
  v_mfma_f32_16x16x32_bf16 v[84:87], v[220:223], v[60:63], v[84:87]
  s_waitcnt lgkmcnt(2)
  v_mfma_f32_16x16x32_bf16 v[88:91], v[72:75], v[60:63], v[88:91]
  s_waitcnt vmcnt(8)
  v_mfma_f32_16x16x32_bf16 v[76:79], a[192:195], v[16:19], v[76:79]
  v_mfma_f32_16x16x32_bf16 v[80:83], a[196:199], v[16:19], v[80:83]
  ds_read_b128 v[72:75], v14 offset:26624
  v_mfma_f32_16x16x32_bf16 v[84:87], v[224:227], v[16:19], v[84:87]
  s_waitcnt lgkmcnt(2)
  v_mfma_f32_16x16x32_bf16 v[88:91], v[64:67], v[16:19], v[88:91]
  s_waitcnt vmcnt(6)
  v_mfma_f32_16x16x32_bf16 v[76:79], a[200:203], v[20:23], v[76:79]
  v_mfma_f32_16x16x32_bf16 v[80:83], a[204:207], v[20:23], v[80:83]
  ds_read_b128 v[64:67], v14 offset:27648
  v_mfma_f32_16x16x32_bf16 v[84:87], v[228:231], v[20:23], v[84:87]
  s_waitcnt lgkmcnt(2)
  v_mfma_f32_16x16x32_bf16 v[88:91], v[68:71], v[20:23], v[88:91]
  s_waitcnt vmcnt(5)
  v_mfma_f32_16x16x32_bf16 v[76:79], a[208:211], v[24:27], v[76:79]
  v_mfma_f32_16x16x32_bf16 v[80:83], a[212:215], v[24:27], v[80:83]
  ds_read_b128 v[68:71], v14 offset:28672
  v_mfma_f32_16x16x32_bf16 v[84:87], v[232:235], v[24:27], v[84:87]
  s_waitcnt lgkmcnt(2)
  v_mfma_f32_16x16x32_bf16 v[88:91], v[72:75], v[24:27], v[88:91]
  s_waitcnt vmcnt(4)
  v_mfma_f32_16x16x32_bf16 v[76:79], a[216:219], v[28:31], v[76:79]
  v_mfma_f32_16x16x32_bf16 v[80:83], a[220:223], v[28:31], v[80:83]
  ds_read_b128 v[72:75], v14 offset:29696
  v_mfma_f32_16x16x32_bf16 v[84:87], v[236:239], v[28:31], v[84:87]
  s_waitcnt lgkmcnt(2)
  v_mfma_f32_16x16x32_bf16 v[88:91], v[64:67], v[28:31], v[88:91]
  s_waitcnt vmcnt(3)
  v_mfma_f32_16x16x32_bf16 v[76:79], a[224:227], v[32:35], v[76:79]
  v_mfma_f32_16x16x32_bf16 v[80:83], a[228:231], v[32:35], v[80:83]
  ds_read_b128 v[64:67], v14 offset:30720
  v_mfma_f32_16x16x32_bf16 v[84:87], v[240:243], v[32:35], v[84:87]
  s_waitcnt lgkmcnt(2)
  v_mfma_f32_16x16x32_bf16 v[88:91], v[68:71], v[32:35], v[88:91]
  s_waitcnt vmcnt(2)
  v_mfma_f32_16x16x32_bf16 v[76:79], a[232:235], v[36:39], v[76:79]
  v_mfma_f32_16x16x32_bf16 v[80:83], a[236:239], v[36:39], v[80:83]
  ds_read_b128 v[68:71], v14 offset:31744
  v_mfma_f32_16x16x32_bf16 v[84:87], v[244:247], v[36:39], v[84:87]
  s_waitcnt lgkmcnt(2)
  v_mfma_f32_16x16x32_bf16 v[88:91], v[72:75], v[36:39], v[88:91]
  s_waitcnt vmcnt(1)
  v_mfma_f32_16x16x32_bf16 v[76:79], a[240:243], v[40:43], v[76:79]
  v_mfma_f32_16x16x32_bf16 v[80:83], a[244:247], v[40:43], v[80:83]
  v_mfma_f32_16x16x32_bf16 v[84:87], v[248:251], v[40:43], v[84:87]
  s_waitcnt lgkmcnt(1)
  v_mfma_f32_16x16x32_bf16 v[88:91], v[64:67], v[40:43], v[88:91]
  s_waitcnt vmcnt(0)
  v_mfma_f32_16x16x32_bf16 v[76:79], a[248:251], v[44:47], v[76:79]
  v_mfma_f32_16x16x32_bf16 v[80:83], a[252:255], v[44:47], v[80:83]
  v_mfma_f32_16x16x32_bf16 v[84:87], v[252:255], v[44:47], v[84:87]
  s_waitcnt lgkmcnt(0)
  v_mfma_f32_16x16x32_bf16 v[88:91], v[68:71], v[44:47], v[88:91]
  v_cmp_eq_u32 vcc, 0, v7
  s_sub_u32 s24, s17, 96
  s_cmp_lt_u32 s24, 12
  s_cselect_b32 s24, 128, s17
  s_cmp_ge_u32 s24, 128
  ds_write_b128 v11, v[76:79] offset:0
  ds_write_b128 v11, v[80:83] offset:1024
  ds_write_b128 v11, v[84:87] offset:2048
  ds_write_b128 v11, v[88:91] offset:3072
  s_branch L_onext_87
L_oslow_88:
  s_waitcnt lgkmcnt(0)
  s_barrier
  ds_read2st64_b32 v[104:105], v12 offset0:0 offset1:4
  ds_read2st64_b32 v[106:107], v12 offset0:8 offset1:12
  ds_read2st64_b32 v[108:109], v12 offset0:16 offset1:20
  ds_read2st64_b32 v[110:111], v12 offset0:24 offset1:28
  ds_read2st64_b32 v[112:113], v12 offset0:32 offset1:36
  ds_read2st64_b32 v[114:115], v12 offset0:40 offset1:44
  ds_read2st64_b32 v[116:117], v12 offset0:48 offset1:52
  ds_read2st64_b32 v[118:119], v12 offset0:56 offset1:60
  v_xor_b32 v11, 0x4000, v11
  v_xor_b32 v12, 0x4000, v12
  s_waitcnt lgkmcnt(0)
  v_add_f32 v104, v104, v108
  v_add_f32 v112, v112, v116
  v_add_f32 v104, v104, v112
  v_sub_f32 v104, v104, v96
  v_fma_f32 v104, v104, v100, v96
  v_add_f32 v105, v105, v109
  v_add_f32 v113, v113, v117
  v_add_f32 v105, v105, v113
  v_sub_f32 v105, v105, v97
  v_fma_f32 v105, v105, v100, v97
  v_add_f32 v106, v106, v110
  v_add_f32 v114, v114, v118
  v_add_f32 v106, v106, v114
  v_sub_f32 v106, v106, v98
  v_fma_f32 v106, v106, v100, v98
  v_add_f32 v107, v107, v111
  v_add_f32 v115, v115, v119
  v_add_f32 v107, v107, v115
  v_sub_f32 v107, v107, v99
  v_fma_f32 v107, v107, v100, v99
  v_cvt_pk_bf16_f32 v120, v104, v105
  v_cvt_pk_bf16_f32 v121, v106, v107
  buffer_store_dwordx2 v[120:121], v9, s[72:75], s15 offen nt
  s_cmp_lt_u32 s17, 128
  s_cbranch_scc1 L_unit_84
  s_branch L_done
L_Aslow:
  s_cmp_eq_u32 s13, 1
  s_cbranch_scc1 L_wave1_93
  s_cmp_eq_u32 s13, 2
  s_cbranch_scc1 L_wave2_94
  s_cmp_eq_u32 s13, 3
  s_cbranch_scc1 L_wave3_95
L_wave0_92:
  s_branch L_got_97
L_top_96:
  s_barrier
  v_mov_b64 v[32:33], v[128:129]
  v_mov_b64 v[34:35], v[130:131]
  v_mov_b64 v[36:37], v[132:133]
  v_mov_b64 v[38:39], v[134:135]
  ds_read_b128 v[128:131], v6 offset:16384
  buffer_load_dwordx4 v[48:51], v2, s[4:7], s15 offen sc1
  ds_read_b128 v[132:135], v6 offset:17408
  v_mov_b64 v[40:41], v[136:137]
  v_mov_b64 v[42:43], v[138:139]
  v_mov_b64 v[44:45], v[140:141]
  v_mov_b64 v[46:47], v[142:143]
  ds_read_b128 v[136:139], v6 offset:18432
  ds_read_b128 v[140:143], v6 offset:19456
  buffer_load_dwordx4 v[52:55], v2, s[4:7], s23 offen sc1
  v_mov_b64 v[80:81], 0
  v_mov_b64 v[82:83], 0
  v_mov_b64 v[84:85], 0
  v_mov_b64 v[86:87], 0
  v_mov_b64 v[88:89], 0
  v_mov_b64 v[90:91], 0
  v_mov_b64 v[92:93], 0
  v_mov_b64 v[94:95], 0
  v_mov_b64_e64 v[96:97], 0
  v_mov_b64_e64 v[98:99], 0
  v_mov_b64_e64 v[100:101], 0
  v_mov_b64_e64 v[102:103], 0
  v_add_u32_e64 v14, s40, v2
  v_xor_b32 v16, 0x40004000, v16
  buffer_load_dwordx4 v[48:51], v2, s[4:7], s15 offen sc1
  v_xor_b32 v17, 0x40004000, v17
  v_xor_b32 v18, 0x40004000, v18
  v_xor_b32 v19, 0x40004000, v19
  s_xor_b32 s89, s89, 0x40004000
  s_nop 5
  buffer_load_dwordx4 v[52:55], v2, s[4:7], s23 offen sc1
  s_waitcnt lgkmcnt(0)
L_got_97_w:
  s_waitcnt vmcnt(3)
L_got_97:
  v_cmp_eq_u32_e64 vcc, -1, v51
  v_smfmac_f32_16x16x64_bf16 v[88:91], v[48:51], v[56:63], v1
  ds_write_b128 v14, v[48:51] offset:0
  v_smfmac_f32_16x16x64_bf16 v[92:95], v[48:51], v[64:71], v1
  s_cbranch_vccnz L_re_101
  s_waitcnt vmcnt(2)
  v_cmp_eq_u32_e64 vcc, -1, v55
  v_smfmac_f32_16x16x64_bf16 v[80:83], v[48:51], v[72:79], v1
  v_smfmac_f32_16x16x64_bf16 v[84:87], v[48:51], v[104:111], v1
  s_cbranch_vccnz L_rl_102
L_rl_102_b:
  v_smfmac_f32_16x16x64_bf16 v[88:91], v[52:55], v[112:119], v1
  ds_write_b128 v14, v[52:55] offset:4096
  v_smfmac_f32_16x16x64_bf16 v[92:95], v[52:55], v[120:127], v1
  s_waitcnt lgkmcnt(1)
  s_barrier
  ds_read_b128 v[56:59], v25 offset:0
  v_smfmac_f32_16x16x64_bf16 v[80:83], v[52:55], v[128:135], v1
  ds_read_b128 v[60:63], v26 offset:0
  v_smfmac_f32_16x16x64_bf16 v[84:87], v[52:55], v[136:143], v1
  ds_read_b128 v[64:67], v27 offset:0
  buffer_load_dwordx4 v[136:139], v2, s[4:7], s30 offen offset:0 sc1
  s_waitcnt lgkmcnt(2)
  v_smfmac_f32_16x16x64_bf16 v[88:91], v[56:59], a[32:39], v1
  s_barrier
  v_smfmac_f32_16x16x64_bf16 v[92:95], v[56:59], a[40:47], v1
  ds_read_b128 v[68:71], v25 offset:4096
  s_waitcnt lgkmcnt(2)
  v_smfmac_f32_16x16x64_bf16 v[88:91], v[60:63], a[48:55], v1
  ds_read_b128 v[72:75], v26 offset:4096
  v_smfmac_f32_16x16x64_bf16 v[92:95], v[60:63], a[56:63], v1
  ds_read_b128 v[76:79], v27 offset:4096
  s_waitcnt lgkmcnt(3)
  v_smfmac_f32_16x16x64_bf16 v[88:91], v[64:67], a[64:71], v1
  ds_read_b128 v[104:107], v6 offset:8192
  v_smfmac_f32_16x16x64_bf16 v[92:95], v[64:67], a[72:79], v1
  ds_read_b128 v[108:111], v6 offset:9216
  s_waitcnt lgkmcnt(4)
  v_smfmac_f32_16x16x64_bf16 v[88:91], v[68:71], a[80:87], v1
  ds_read_b128 v[112:115], v6 offset:10240
  v_smfmac_f32_16x16x64_bf16 v[92:95], v[68:71], a[88:95], v1
  ds_read_b128 v[116:119], v6 offset:11264
  s_waitcnt lgkmcnt(4)
  v_smfmac_f32_16x16x64_bf16 v[88:91], v[72:75], a[96:103], v1
  buffer_load_dwordx4 v[140:143], v2, s[4:7], s30 offen offset:1024 sc1
  v_smfmac_f32_16x16x64_bf16 v[88:91], v[76:79], a[112:119], v1
  s_nop 0
  ds_read_b128 v[120:123], v6 offset:20480
  v_smfmac_f32_16x16x64_bf16 v[92:95], v[72:75], a[104:111], v1
  buffer_load_dwordx4 v[128:131], v2, s[4:7], s65 offen offset:0 sc1
  v_smfmac_f32_16x16x64_bf16 v[92:95], v[76:79], a[120:127], v1
  s_waitcnt lgkmcnt(1)
  s_nop 1
  v_add_f32 v88, v88, v89
  v_smfmac_f32_16x16x64_bf16 v[80:83], v[56:59], v[104:111], v1
  ds_read_b128 v[124:127], v6 offset:21504
  v_add_f32 v90, v90, v91
  v_smfmac_f32_16x16x64_bf16 v[84:87], v[56:59], v[112:119], v1
  ds_read_b128 v[104:107], v6 offset:22528
  v_add_f32 v92, v92, v93
  v_smfmac_f32_16x16x64_bf16 v[80:83], v[60:63], v[224:231], v1
  ds_read_b128 v[108:111], v6 offset:23552
  v_add_f32 v94, v94, v95
  v_smfmac_f32_16x16x64_bf16 v[84:87], v[60:63], v[232:239], v1
  v_cvt_pk_bf16_f32 v28, v88, v92
  v_cvt_pk_bf16_f32 v29, v90, v94
  v_smfmac_f32_16x16x64_bf16 v[80:83], v[64:67], v[240:247], v1
  ds_write_b64 v7, v[28:29] offset:8192
  v_smfmac_f32_16x16x64_bf16 v[84:87], v[64:67], v[248:255], v1
  buffer_store_dword v15, v24, s[4:7], s31 offen sc1
  v_smfmac_f32_16x16x64_bf16 v[80:83], v[72:75], a[0:7], v1
  ds_read_b128 v[112:115], v6 offset:24576
  v_smfmac_f32_16x16x64_bf16 v[84:87], v[72:75], a[8:15], v1
  ds_read_b128 v[116:119], v6 offset:25600
  s_waitcnt lgkmcnt(3)
  v_smfmac_f32_16x16x64_bf16 v[80:83], v[68:71], v[120:127], v1
  s_waitcnt lgkmcnt(2)
  s_barrier
  v_smfmac_f32_16x16x64_bf16 v[80:83], v[76:79], a[16:23], v1
  s_nop 0
  ds_read_b64_tr_b16 v[88:89], v8 offset:8192
  v_smfmac_f32_16x16x64_bf16 v[84:87], v[68:71], v[104:111], v1
  ds_read_b64_tr_b16 v[90:91], v8 offset:8704
  v_smfmac_f32_16x16x64_bf16 v[84:87], v[76:79], a[24:31], v1
  ds_read_b64_tr_b16 v[92:93], v8 offset:9216
  v_smfmac_f32_16x16x64_bf16 v[96:99], v[48:51], a[128:135], v1
  ds_read_b64_tr_b16 v[94:95], v8 offset:9728
  v_add_f32 v80, v80, v81
  v_smfmac_f32_16x16x64_bf16 v[100:103], v[48:51], a[136:143], v1
  ds_read_b128 v[120:123], v6 offset:26624
  v_add_f32 v82, v82, v83
  v_smfmac_f32_16x16x64_bf16 v[96:99], v[52:55], a[144:151], v1
  v_add_f32 v84, v84, v85
  v_add_f32 v86, v86, v87
  v_cvt_pk_bf16_f32 v22, v80, v84
  v_cvt_pk_bf16_f32 v23, v82, v86
  v_smfmac_f32_16x16x64_bf16 v[100:103], v[52:55], a[152:159], v1
  ds_write_b64 v7, v[22:23] offset:10240
  s_waitcnt lgkmcnt(2)
  v_mfma_f32_16x16x32_bf16 v[28:31], v[40:43], v[88:91], 0
  buffer_load_dwordx4 v[132:135], v2, s[4:7], s65 offen offset:1024 sc1
  v_mfma_f32_16x16x32_bf16 v[28:31], v[44:47], v[92:95], v[28:31]
  s_nop 0
  ds_read_b128 v[124:127], v6 offset:27648
  v_smfmac_f32_16x16x64_bf16 v[96:99], v[56:59], a[160:167], v1
  buffer_load_dword v0, v12, s[4:7], s32 offen sc1
  v_smfmac_f32_16x16x64_bf16 v[100:103], v[56:59], a[168:175], v1
  s_waitcnt lgkmcnt(1)
  s_barrier
  s_nop 0
  v_add_f32_dpp v14, v29, v28 quad_perm:[1,1,3,3] row_mask:0xf bank_mask:0xf
  v_smfmac_f32_16x16x64_bf16 v[96:99], v[60:63], a[176:183], v1
  ds_read_b64_tr_b16 v[80:81], v8 offset:10240
  v_add_f32_dpp v15, v31, v30 quad_perm:[1,1,3,3] row_mask:0xf bank_mask:0xf
  v_smfmac_f32_16x16x64_bf16 v[100:103], v[60:63], a[184:191], v1
  ds_read_b64_tr_b16 v[82:83], v8 offset:10752
  v_exp_f32 v28, v14
  v_smfmac_f32_16x16x64_bf16 v[96:99], v[64:67], a[192:199], v1
  ds_read_b64_tr_b16 v[84:85], v8 offset:11264
  v_exp_f32 v29, v15
  v_smfmac_f32_16x16x64_bf16 v[100:103], v[64:67], a[200:207], v1
  ds_read_b64_tr_b16 v[86:87], v8 offset:11776
  v_cvt_pk_bf16_f32 v30, v28, v29
  v_smfmac_f32_16x16x64_bf16 v[96:99], v[68:71], a[208:215], v1
  ds_write_b32 v13, v30 offset:14336
  v_smfmac_f32_16x16x64_bf16 v[100:103], v[68:71], a[216:223], v1
  ds_read_b128 v[104:107], v6 offset:28672
  s_waitcnt lgkmcnt(2)
  v_mfma_f32_16x16x32_bf16 v[44:47], v[80:83], v[88:91], 0
  ds_read_b128 v[108:111], v6 offset:29696
  v_mfma_f32_16x16x32_bf16 v[44:47], v[84:87], v[92:95], v[44:47]
  s_nop 0
  s_waitcnt vmcnt(6)
  v_mov_b64 v[48:49], 0
  v_smfmac_f32_16x16x64_bf16 v[96:99], v[72:75], a[224:231], v1
  s_waitcnt lgkmcnt(2)
  s_barrier
  v_smfmac_f32_16x16x64_bf16 v[96:99], v[76:79], a[240:247], v1
  ds_read_b128 v[28:31], v9 offset:14336
  v_add_f32_dpp v44, v45, v44 quad_perm:[1,1,3,3] row_mask:0xf bank_mask:0xf
  v_add_f32_dpp v46, v47, v46 quad_perm:[1,1,3,3] row_mask:0xf bank_mask:0xf
  v_smfmac_f32_16x16x64_bf16 v[100:103], v[72:75], a[232:239], v1
  ds_read_b128 v[40:43], v10 offset:14336
  v_mul_f32 v44, s64, v44
  v_mul_f32 v46, s64, v46
  v_smfmac_f32_16x16x64_bf16 v[100:103], v[76:79], a[248:255], v1
  ds_read_b128 v[64:67], v6 offset:30720
  v_add_f32 v96, v96, v97
  v_exp_f32_dpp v45, v44 quad_perm:[0,0,2,2] row_mask:0xf bank_mask:0xf
  v_exp_f32_dpp v47, v46 quad_perm:[0,0,2,2] row_mask:0xf bank_mask:0xf
  s_waitcnt lgkmcnt(2)
  v_mfma_f32_16x16x32_bf16 v[88:91], v[16:19], v[28:31], 0
  v_cvt_pk_bf16_f32 v23, v45, v47
  v_cndmask_b32 v22, 0, v23, s[66:67]
  v_mfma_f32_16x16x32_bf16 v[84:87], v[32:35], v[28:31], 0
  s_waitcnt lgkmcnt(1)
  v_cndmask_b32 v23, v23, 0, s[66:67]
  v_add_f32 v98, v98, v99
  v_mfma_f32_16x16x32_bf16 v[84:87], v[36:39], v[40:43], v[84:87]
  v_add_f32 v100, v100, v101
  v_add_f32 v102, v102, v103
  v_cvt_pk_bf16_f32 v21, v100, v102
  v_cvt_pk_bf16_f32 v20, v96, v98
  v_mfma_f32_16x16x16_bf16 v[88:91], v[16:17], v[22:23], v[88:91]
  v_mov_b64 v[50:51], 0
  v_mov_b64 v[52:53], 0
  v_mfma_f32_16x16x16_bf16 v[84:87], v[20:21], v[22:23], v[84:87]
  v_mov_b64 v[54:55], 0
  v_mov_b64 v[56:57], 0
  v_mov_b64 v[58:59], 0
  v_mov_b64 v[60:61], 0
  v_mov_b64 v[62:63], 0
  v_rcp_f32_dpp v96, v88 quad_perm:[0,0,2,2] row_mask:0xf bank_mask:0xf
  s_nop 0
  v_subrev_u32 v97, s29, v96
  v_cmp_lt_u32 vcc, s90, v97
  v_mul_f32 v84, v84, v96
  v_mul_f32 v85, v85, v96
  v_mul_f32 v86, v86, v96
  v_mul_f32_e64 v87, v87, v96
  v_cvt_pk_bf16_f32 v98, v84, v85
  v_cvt_pk_bf16_f32 v99, v86, v87
  ds_write_b64 v7, v[98:99] offset:12288
  s_cbranch_vccnz L_slow_98
L_back_99:
  v_mov_b32_dpp v80, v98 quad_perm:[0,0,2,2] row_mask:0xf bank_mask:0xf
  v_mov_b32_dpp v81, v99 quad_perm:[0,0,2,2] row_mask:0xf bank_mask:0xf
  v_mov_b32_dpp v82, v98 quad_perm:[1,1,3,3] row_mask:0xf bank_mask:0xf
  v_mov_b32_dpp v83, v99 quad_perm:[1,1,3,3] row_mask:0xf bank_mask:0xf
  s_nop 1
  v_smfmac_f32_16x16x64_bf16 v[48:51], v[80:83], v[144:151], v1
  s_waitcnt lgkmcnt(0)
  s_barrier
  ds_read_b128 v[92:95], v3 offset:12288
  v_smfmac_f32_16x16x64_bf16 v[52:55], v[80:83], v[152:159], v1
  ds_read_b128 v[28:31], v4 offset:12288
  v_smfmac_f32_16x16x64_bf16 v[56:59], v[80:83], v[160:167], v1
  ds_read_b128 v[40:43], v5 offset:12288
  v_smfmac_f32_16x16x64_bf16 v[60:63], v[80:83], v[168:175], v1
  ds_read_b128 v[68:71], v6 offset:31744
  s_waitcnt lgkmcnt(3)
  v_smfmac_f32_16x16x64_bf16 v[48:51], v[92:95], v[176:183], v1
  ds_read_b128 v[72:75], v6 offset:32768
  s_waitcnt lgkmcnt(3)
  v_smfmac_f32_16x16x64_bf16 v[48:51], v[28:31], v[192:199], v1
  ds_read_b128 v[76:79], v6 offset:33792
  s_waitcnt lgkmcnt(3)
  v_smfmac_f32_16x16x64_bf16 v[48:51], v[40:43], v[208:215], v1
  s_nop 0
  ds_read_b128 v[32:35], v6 offset:34816
  v_smfmac_f32_16x16x64_bf16 v[52:55], v[92:95], v[184:191], v1
  s_nop 0
  ds_read_b128 v[36:39], v6 offset:35840
  v_smfmac_f32_16x16x64_bf16 v[52:55], v[28:31], v[200:207], v1
  s_nop 1
  v_cvt_pk_bf16_f32 v96, v48, v49
  v_smfmac_f32_16x16x64_bf16 v[52:55], v[40:43], v[216:223], v1
  s_nop 0
  s_waitcnt lgkmcnt(12)
  v_cvt_pk_bf16_f32 v97, v50, v51
  v_smfmac_f32_16x16x64_bf16 v[56:59], v[92:95], v[112:119], v1
  buffer_store_dwordx2 v[96:97], v11, s[4:7], s18 offen offset:0 sc1
  v_smfmac_f32_16x16x64_bf16 v[56:59], v[28:31], v[120:127], v1
  s_nop 1
  v_cvt_pk_bf16_f32 v98, v52, v53
  v_smfmac_f32_16x16x64_bf16 v[56:59], v[40:43], v[104:111], v1
  s_nop 0
  s_waitcnt lgkmcnt(0)
  v_cvt_pk_bf16_f32 v99, v54, v55
  v_smfmac_f32_16x16x64_bf16 v[60:63], v[92:95], v[64:71], v1
  buffer_store_dwordx2 v[98:99], v11, s[4:7], s18 offen offset:2048 sc1
  v_smfmac_f32_16x16x64_bf16 v[60:63], v[28:31], v[72:79], v1
  s_nop 1
  v_cvt_pk_bf16_f32 v100, v56, v57
  v_smfmac_f32_16x16x64_bf16 v[60:63], v[40:43], v[32:39], v1
  v_cvt_pk_bf16_f32 v101, v58, v59
  buffer_store_dwordx2 v[100:101], v11, s[4:7], s19 offen offset:0 sc1
  s_add_u32 s14, s14, 1
  s_and_b32 s24, s14, 3
  s_lshl_b32 s24, s24, 13
  s_add_u32 s24, s24, 1048576
  v_mov_b32 v15, -1
  s_nop 0
  v_cvt_pk_bf16_f32 v102, v60, v61
  v_cvt_pk_bf16_f32 v103, v62, v63
  buffer_store_dwordx2 v[102:103], v11, s[4:7], s19 offen offset:2048 sc1
  buffer_store_dword v15, v24, s[4:7], s28 offen sc1
  ds_read_b128 v[88:91], v2 offset:15360
  v_and_b32 v14, v96, v97
  v_bitop3_b32 v14, v14, v98, v99 bitop3:0x80
  v_bitop3_b32 v14, v14, v100, v101 bitop3:0x80
  v_bitop3_b32 v14, v14, v102, v103 bitop3:0x80
  v_bfi_b32 v14, v14, 0, s89
  v_cmp_lt_u32 vcc, 0xffff, v14
  ds_read_b128 v[56:59], v6 offset:0
  ds_read_b128 v[60:63], v6 offset:1024
  ds_read_b128 v[64:67], v6 offset:2048
  ds_read_b128 v[68:71], v6 offset:3072
  s_cbranch_vccnz L_fix_103
L_fix_103_b:
  ds_read_b128 v[72:75], v6 offset:4096
  ds_read_b128 v[76:79], v6 offset:5120
  ds_read_b128 v[104:107], v6 offset:6144
  ds_read_b128 v[108:111], v6 offset:7168
  ds_read_b128 v[112:115], v6 offset:12288
  ds_read_b128 v[116:119], v6 offset:13312
  ds_read_b128 v[120:123], v6 offset:14336
  ds_read_b128 v[124:127], v6 offset:15360
  s_waitcnt vmcnt(3)
  buffer_load_dwordx4 v[80:83], v2, s[4:7], s22 offen offset:0 sc1
  buffer_load_dwordx4 v[84:87], v2, s[4:7], s22 offen offset:1024 sc1
  s_mov_b32 s28, s17
  s_add_u32 s17, s24, s87
  s_add_u32 s15, s24, s40
  s_add_u32 s23, s24, s16
  s_lshl_b32 s31, s14, 13
  s_add_u32 s31, s31, s87
  s_add_u32 s31, s31, 1310720
  s_xor_b32 s29, s29, 0x40000000
  s_mov_b32 s91, 0
  s_add_u32 s30, s30, 524288
  s_add_u32 s65, s65, 524288
  s_add_u32 s26, s14, 1
  s_and_b32 s26, s26, 63
  s_waitcnt lgkmcnt(12)
  v_bfi_b32 v88, s89, 0, v88
  v_bfi_b32 v89, s89, 0, v89
  v_bfi_b32 v90, s89, 0, v90
  v_bfi_b32 v91, s89, 0, v91
  s_waitcnt vmcnt(1)
L_red_100_b:
  s_nop 0
  v_mfma_f32_16x16x32_bf16 v[92:95], v[88:91], v[80:83], 0
  v_bitop3_b32 v29, v80, v81, s89 bitop3:0x7e
  v_bitop3_b32 v30, v82, v83, s89 bitop3:0x7e
  v_or_b32 v14, v29, v30
  s_waitcnt vmcnt(0)
  v_mfma_f32_16x16x32_bf16 v[92:95], v[88:91], v[84:87], v[92:95]
  v_bitop3_b32 v29, v84, v85, s89 bitop3:0x7e
  v_bitop3_b32 v30, v86, v87, s89 bitop3:0x7e
  v_or3_b32 v14, v14, v29, v30
  v_lshlrev_b32 v14, 1, v14
  v_cmp_gt_i32 vcc, 0, v14
  v_cmp_ne_u32 s[34:35], 0, v0
  s_nop 1
  v_add_f32_dpp v92, v92, v92 row_ror:4 row_mask:0xf bank_mask:0xf
  v_add_f32_dpp v93, v93, v93 row_ror:4 row_mask:0xf bank_mask:0xf
  s_cbranch_vccnz L_red_100
  v_add_f32_dpp v92, v92, v92 row_ror:8 row_mask:0xf bank_mask:0xf
  v_add_f32_dpp v93, v93, v93 row_ror:8 row_mask:0xf bank_mask:0xf
  v_cvt_pk_bf16_f32 v15, v92, v93
  buffer_store_dword v15, v24, s[4:7], s17 offen sc1
  s_bitset0_b64 s[34:35], 0
  s_bitcmp1_b64 s[34:35], s26
  s_cbranch_scc1 L_top_96
  s_cmp_eq_u32 s14, 63
  s_cbranch_scc1 L_end_104
L_flag_105:
  s_sub_u32 s33, s33, 1
  s_cbranch_scc1 L_done
  v_lshrrev_b32 v0, 2, v2
  buffer_load_dword v0, v0, s[4:7], s32 offen sc1
  s_waitcnt vmcnt(0)
  v_cmp_ne_u32 s[34:35], 0, v0
  s_nop 3
  s_bitcmp1_b64 s[34:35], s26
  s_cbranch_scc0 L_flag_105
  s_branch L_top_96
L_end_104:
  buffer_store_dword v15, v24, s[4:7], s31 offen sc1
  s_branch L_done
L_fix_103:
  v_or_b32 v96, 0x40000000, v96
  v_or_b32 v97, 0x40000000, v97
  v_or_b32 v98, 0x40000000, v98
  v_or_b32 v99, 0x40000000, v99
  v_or_b32 v100, 0x40000000, v100
  v_or_b32 v101, 0x40000000, v101
  v_or_b32 v102, 0x40000000, v102
  v_or_b32 v103, 0x40000000, v103
  buffer_store_dwordx2 v[96:97], v11, s[4:7], s18 offen offset:0 sc1
  buffer_store_dwordx2 v[98:99], v11, s[4:7], s18 offen offset:2048 sc1
  buffer_store_dwordx2 v[100:101], v11, s[4:7], s19 offen offset:0 sc1
  buffer_store_dwordx2 v[102:103], v11, s[4:7], s19 offen offset:2048 sc1
  s_branch L_fix_103_b
L_red_100:
  buffer_load_dwordx4 v[80:83], v2, s[4:7], s22 offen offset:0 sc1
  buffer_load_dwordx4 v[84:87], v2, s[4:7], s22 offen offset:1024 sc1
  s_sub_u32 s33, s33, 1
  s_cbranch_scc1 L_done
  s_waitcnt vmcnt(0)
  s_branch L_red_100_b
L_re_101:
  buffer_load_dwordx4 v[48:51], v2, s[4:7], s15 offen sc1
  s_sub_u32 s33, s33, 1
  buffer_load_dwordx4 v[52:55], v2, s[4:7], s23 offen sc1
  s_nop 1
  v_mov_b64 v[88:89], 0
  v_mov_b64 v[90:91], 0
  v_mov_b64 v[92:93], 0
  v_mov_b64 v[94:95], 0
  s_cbranch_scc0 L_got_97_w
  s_branch L_done
L_rl_102:
  buffer_load_dwordx4 v[52:55], v2, s[4:7], s23 offen sc1
  s_waitcnt vmcnt(1)
  v_cmp_eq_u32 vcc, -1, v55
  s_cbranch_vccz L_rl_102_b
  s_sub_u32 s33, s33, 1
  s_cbranch_scc1 L_done
  s_branch L_rl_102
L_slow_98:
  v_cmp_u_f32 vcc, v96, v96
  s_cbranch_vccz L_slow_98_m
  s_bitcmp1_b32 s91, 0
  s_cbranch_scc1 L_slow_98_m
  s_mov_b32 s91, 1
  s_sub_u32 s24, s30, 524288
  buffer_load_dwordx4 v[40:43], v2, s[4:7], s24 offen offset:0 sc1
  buffer_load_dwordx4 v[44:47], v2, s[4:7], s24 offen offset:1024 sc1
L_slow_98_f:
  buffer_load_dwordx4 v[48:51], v2, s[4:7], s15 offen sc1
  buffer_load_dwordx4 v[52:55], v2, s[4:7], s23 offen sc1
  s_sub_u32 s33, s33, 1
  s_cbranch_scc1 L_done
  s_waitcnt vmcnt(0)
  v_max3_u32 v22, v48, v49, v50
  v_max_u32 v22, v22, v51
  v_max3_u32 v23, v52, v53, v54
  v_max_u32 v23, v23, v55
  v_max_u32 v22, v22, v23
  v_cmp_eq_u32 vcc, -1, v22
  s_cbranch_vccnz L_slow_98_f
  s_waitcnt lgkmcnt(0)
  ds_read_b128 v[56:59], v6 offset:0
  ds_read_b128 v[60:63], v6 offset:1024
  ds_read_b128 v[64:67], v6 offset:2048
  ds_read_b128 v[68:71], v6 offset:3072
  ds_read_b128 v[72:75], v6 offset:4096
  ds_read_b128 v[76:79], v6 offset:5120
  ds_read_b128 v[104:107], v6 offset:6144
  ds_read_b128 v[108:111], v6 offset:7168
  s_waitcnt lgkmcnt(0)
  ds_read_b128 v[112:115], v6 offset:12288
  ds_read_b128 v[116:119], v6 offset:13312
  ds_read_b128 v[120:123], v6 offset:14336
  ds_read_b128 v[124:127], v6 offset:15360
  ds_read_b128 v[128:131], v6 offset:16384
  ds_read_b128 v[132:135], v6 offset:17408
  ds_read_b128 v[136:139], v6 offset:18432
  ds_read_b128 v[140:143], v6 offset:19456
  v_mov_b64 v[80:81], 0
  v_mov_b64 v[82:83], 0
  v_mov_b64 v[84:85], 0
  v_mov_b64 v[86:87], 0
  v_mov_b64 v[88:89], 0
  v_mov_b64 v[90:91], 0
  v_mov_b64 v[92:93], 0
  v_mov_b64 v[94:95], 0
  v_mov_b64 v[96:97], 0
  v_mov_b64 v[98:99], 0
  v_mov_b64 v[100:101], 0
  v_mov_b64 v[102:103], 0
  v_add_u32 v14, s40, v2
  s_mov_b32 s31, 1835008
  s_waitcnt lgkmcnt(0)
  s_barrier
  s_branch L_got_97
L_slow_98_m:
  v_max3_f32 v96, v14, v15, v44
  v_max_f32 v96, v96, v46
  v_mov_b32 v97, v96
  s_nop 1
  v_permlane32_swap_b32 v96, v97
  v_max_f32 v96, v96, v97
  v_mov_b32 v97, v96
  s_nop 1
  v_permlane16_swap_b32 v96, v97
  v_max_f32 v96, v96, v97
  s_barrier
  ds_write_b32 v13, v96 offset:14336
  s_waitcnt lgkmcnt(0)
  s_barrier
  ds_read_b128 v[28:31], v9 offset:14336
  s_waitcnt lgkmcnt(0)
  s_barrier
  v_max3_f32 v96, v28, v29, v30
  v_max_f32 v96, v96, v31
  v_sub_f32 v14, v14, v96
  v_sub_f32 v15, v15, v96
  v_sub_f32 v44, v44, v96
  v_sub_f32 v46, v46, v96
  v_exp_f32 v28, v14
  v_exp_f32 v29, v15
  v_exp_f32_dpp v45, v44 quad_perm:[0,0,2,2] row_mask:0xf bank_mask:0xf
  v_exp_f32_dpp v47, v46 quad_perm:[0,0,2,2] row_mask:0xf bank_mask:0xf
  v_cvt_pk_bf16_f32 v30, v28, v29
  v_cvt_pk_bf16_f32 v23, v45, v47
  v_cndmask_b32 v22, 0, v23, s[66:67]
  v_cndmask_b32 v23, v23, 0, s[66:67]
  ds_write_b32 v13, v30 offset:14336
  s_waitcnt lgkmcnt(0)
  s_barrier
  ds_read_b128 v[28:31], v9 offset:14336
  ds_read_b128 v[40:43], v10 offset:14336
  s_waitcnt lgkmcnt(0)
  v_mfma_f32_16x16x32_bf16 v[88:91], v[16:19], v[28:31], 0
  s_nop 2
  v_mfma_f32_16x16x32_bf16 v[84:87], v[32:35], v[28:31], 0
  s_nop 0
  v_mfma_f32_16x16x32_bf16 v[84:87], v[36:39], v[40:43], v[84:87]
  s_nop 2
  v_mfma_f32_16x16x16_bf16 v[88:91], v[16:17], v[22:23], v[88:91]
  s_nop 2
  v_mfma_f32_16x16x16_bf16 v[84:87], v[20:21], v[22:23], v[84:87]
  s_nop 3
  v_rcp_f32_dpp v96, v88 quad_perm:[0,0,2,2] row_mask:0xf bank_mask:0xf
  s_nop 2
  v_mul_f32 v84, v84, v96
  v_mul_f32 v85, v85, v96
  v_mul_f32 v86, v86, v96
  v_mul_f32 v87, v87, v96
  v_cvt_pk_bf16_f32 v98, v84, v85
  v_cvt_pk_bf16_f32 v99, v86, v87
  ds_write_b64 v7, v[98:99] offset:12288
  s_branch L_back_99
L_wave1_93:
  s_branch L_got_107
  s_nop 0
  s_nop 0
  s_nop 0
  s_nop 0
  s_nop 0
  s_nop 0
  s_nop 0
L_top_106:
  s_barrier
  v_mov_b64 v[32:33], v[128:129]
  v_mov_b64 v[34:35], v[130:131]
  v_mov_b64 v[36:37], v[132:133]
  v_mov_b64 v[38:39], v[134:135]
  ds_read_b128 v[128:131], v6 offset:16384
  buffer_load_dwordx4 v[48:51], v2, s[4:7], s15 offen sc1
  ds_read_b128 v[132:135], v6 offset:17408
  v_mov_b64 v[40:41], v[136:137]
  v_mov_b64 v[42:43], v[138:139]
  v_mov_b64 v[44:45], v[140:141]
  v_mov_b64 v[46:47], v[142:143]
  ds_read_b128 v[136:139], v6 offset:18432
  ds_read_b128 v[140:143], v6 offset:19456
  buffer_load_dwordx4 v[52:55], v2, s[4:7], s23 offen sc1
  v_mov_b64 v[80:81], 0
  v_mov_b64 v[82:83], 0
  v_mov_b64 v[84:85], 0
  v_mov_b64 v[86:87], 0
  v_mov_b64 v[88:89], 0
  v_mov_b64 v[90:91], 0
  v_mov_b64 v[92:93], 0
  v_mov_b64 v[94:95], 0
  v_mov_b64_e64 v[96:97], 0
  v_mov_b64_e64 v[98:99], 0
  v_mov_b64_e64 v[100:101], 0
  v_mov_b64_e64 v[102:103], 0
  v_add_u32_e64 v14, s40, v2
  v_xor_b32 v16, 0x40004000, v16
  buffer_load_dwordx4 v[48:51], v2, s[4:7], s15 offen sc1
  v_xor_b32 v17, 0x40004000, v17
  v_xor_b32 v18, 0x40004000, v18
  v_xor_b32 v19, 0x40004000, v19
  s_xor_b32 s89, s89, 0x40004000
  s_nop 5
  buffer_load_dwordx4 v[52:55], v2, s[4:7], s23 offen sc1
  s_waitcnt lgkmcnt(0)
L_got_107_w:
  s_waitcnt vmcnt(3)
L_got_107:
  v_cmp_eq_u32_e64 vcc, -1, v51
  v_smfmac_f32_16x16x64_bf16 v[88:91], v[48:51], v[56:63], v1
  ds_write_b128 v14, v[48:51] offset:0
  v_smfmac_f32_16x16x64_bf16 v[92:95], v[48:51], v[64:71], v1
  s_cbranch_vccnz L_re_111
  s_waitcnt vmcnt(2)
  v_cmp_eq_u32_e64 vcc, -1, v55
  v_smfmac_f32_16x16x64_bf16 v[80:83], v[48:51], v[72:79], v1
  v_smfmac_f32_16x16x64_bf16 v[84:87], v[48:51], v[104:111], v1
  s_cbranch_vccnz L_rl_112
L_rl_112_b:
  v_smfmac_f32_16x16x64_bf16 v[88:91], v[52:55], v[112:119], v1
  ds_write_b128 v14, v[52:55] offset:4096
  v_smfmac_f32_16x16x64_bf16 v[92:95], v[52:55], v[120:127], v1
  s_waitcnt lgkmcnt(1)
  s_barrier
  ds_read_b128 v[56:59], v25 offset:0
  v_smfmac_f32_16x16x64_bf16 v[80:83], v[52:55], v[128:135], v1
  ds_read_b128 v[60:63], v26 offset:0
  v_smfmac_f32_16x16x64_bf16 v[84:87], v[52:55], v[136:143], v1
  ds_read_b128 v[64:67], v27 offset:0
  buffer_load_dwordx4 v[136:139], v2, s[4:7], s30 offen offset:0 sc1
  s_waitcnt lgkmcnt(2)
  v_smfmac_f32_16x16x64_bf16 v[88:91], v[56:59], a[32:39], v1
  s_barrier
  v_smfmac_f32_16x16x64_bf16 v[92:95], v[56:59], a[40:47], v1
  ds_read_b128 v[68:71], v25 offset:4096
  s_waitcnt lgkmcnt(2)
  v_smfmac_f32_16x16x64_bf16 v[88:91], v[60:63], a[48:55], v1
  ds_read_b128 v[72:75], v26 offset:4096
  v_smfmac_f32_16x16x64_bf16 v[92:95], v[60:63], a[56:63], v1
  ds_read_b128 v[76:79], v27 offset:4096
  s_waitcnt lgkmcnt(3)
  v_smfmac_f32_16x16x64_bf16 v[88:91], v[64:67], a[64:71], v1
  buffer_load_dwordx4 v[140:143], v2, s[4:7], s30 offen offset:1024 sc1
  v_smfmac_f32_16x16x64_bf16 v[92:95], v[64:67], a[72:79], v1
  ds_read_b128 v[104:107], v6 offset:8192
  s_waitcnt lgkmcnt(3)
  v_smfmac_f32_16x16x64_bf16 v[88:91], v[68:71], a[80:87], v1
  ds_read_b128 v[108:111], v6 offset:9216
  v_smfmac_f32_16x16x64_bf16 v[92:95], v[68:71], a[88:95], v1
  ds_read_b128 v[112:115], v6 offset:10240
  s_waitcnt lgkmcnt(3)
  v_smfmac_f32_16x16x64_bf16 v[88:91], v[72:75], a[96:103], v1
  ds_read_b128 v[116:119], v6 offset:11264
  v_smfmac_f32_16x16x64_bf16 v[88:91], v[76:79], a[112:119], v1
  buffer_load_dwordx4 v[128:131], v2, s[4:7], s65 offen offset:0 sc1
  v_smfmac_f32_16x16x64_bf16 v[92:95], v[72:75], a[104:111], v1
  s_nop 0
  ds_read_b128 v[120:123], v6 offset:20480
  v_smfmac_f32_16x16x64_bf16 v[92:95], v[76:79], a[120:127], v1
  s_waitcnt lgkmcnt(1)
  s_nop 1
  v_add_f32 v88, v88, v89
  v_smfmac_f32_16x16x64_bf16 v[80:83], v[56:59], v[104:111], v1
  ds_read_b128 v[124:127], v6 offset:21504
  v_add_f32 v90, v90, v91
  v_smfmac_f32_16x16x64_bf16 v[84:87], v[56:59], v[112:119], v1
  ds_read_b128 v[104:107], v6 offset:22528
  v_add_f32 v92, v92, v93
  v_smfmac_f32_16x16x64_bf16 v[80:83], v[60:63], v[224:231], v1
  ds_read_b128 v[108:111], v6 offset:23552
  v_add_f32 v94, v94, v95
  v_smfmac_f32_16x16x64_bf16 v[84:87], v[60:63], v[232:239], v1
  v_cvt_pk_bf16_f32 v28, v88, v92
  v_cvt_pk_bf16_f32 v29, v90, v94
  v_smfmac_f32_16x16x64_bf16 v[80:83], v[64:67], v[240:247], v1
  ds_write_b64 v7, v[28:29] offset:8192
  v_smfmac_f32_16x16x64_bf16 v[84:87], v[64:67], v[248:255], v1
  ds_read_b128 v[112:115], v6 offset:24576
  v_smfmac_f32_16x16x64_bf16 v[80:83], v[72:75], a[0:7], v1
  buffer_store_dword v15, v24, s[4:7], s31 offen sc1
  v_smfmac_f32_16x16x64_bf16 v[84:87], v[72:75], a[8:15], v1
  ds_read_b128 v[116:119], v6 offset:25600
  s_waitcnt lgkmcnt(3)
  v_smfmac_f32_16x16x64_bf16 v[80:83], v[68:71], v[120:127], v1
  s_waitcnt lgkmcnt(2)
  s_barrier
  v_smfmac_f32_16x16x64_bf16 v[80:83], v[76:79], a[16:23], v1
  s_nop 0
  ds_read_b64_tr_b16 v[88:89], v8 offset:8192
  v_smfmac_f32_16x16x64_bf16 v[84:87], v[68:71], v[104:111], v1
  ds_read_b64_tr_b16 v[90:91], v8 offset:8704
  v_smfmac_f32_16x16x64_bf16 v[84:87], v[76:79], a[24:31], v1
  ds_read_b64_tr_b16 v[92:93], v8 offset:9216
  v_smfmac_f32_16x16x64_bf16 v[96:99], v[48:51], a[128:135], v1
  ds_read_b64_tr_b16 v[94:95], v8 offset:9728
  v_add_f32 v80, v80, v81
  v_smfmac_f32_16x16x64_bf16 v[100:103], v[48:51], a[136:143], v1
  ds_read_b128 v[120:123], v6 offset:26624
  v_add_f32 v82, v82, v83
  v_smfmac_f32_16x16x64_bf16 v[96:99], v[52:55], a[144:151], v1
  v_add_f32 v84, v84, v85
  v_add_f32 v86, v86, v87
  v_cvt_pk_bf16_f32 v22, v80, v84
  v_cvt_pk_bf16_f32 v23, v82, v86
  v_smfmac_f32_16x16x64_bf16 v[100:103], v[52:55], a[152:159], v1
  ds_write_b64 v7, v[22:23] offset:10240
  s_waitcnt lgkmcnt(2)
  v_mfma_f32_16x16x32_bf16 v[28:31], v[40:43], v[88:91], 0
  ds_read_b128 v[124:127], v6 offset:27648
  v_mfma_f32_16x16x32_bf16 v[28:31], v[44:47], v[92:95], v[28:31]
  buffer_load_dwordx4 v[132:135], v2, s[4:7], s65 offen offset:1024 sc1
  v_smfmac_f32_16x16x64_bf16 v[96:99], v[56:59], a[160:167], v1
  s_nop 0
  ds_read_b128 v[104:107], v6 offset:28672
  v_smfmac_f32_16x16x64_bf16 v[100:103], v[56:59], a[168:175], v1
  s_waitcnt lgkmcnt(2)
  s_barrier
  s_nop 0
  v_add_f32_dpp v14, v29, v28 quad_perm:[1,1,3,3] row_mask:0xf bank_mask:0xf
  v_smfmac_f32_16x16x64_bf16 v[96:99], v[60:63], a[176:183], v1
  ds_read_b64_tr_b16 v[80:81], v8 offset:10240
  v_add_f32_dpp v15, v31, v30 quad_perm:[1,1,3,3] row_mask:0xf bank_mask:0xf
  v_smfmac_f32_16x16x64_bf16 v[100:103], v[60:63], a[184:191], v1
  ds_read_b64_tr_b16 v[82:83], v8 offset:10752
  v_exp_f32 v28, v14
  v_smfmac_f32_16x16x64_bf16 v[96:99], v[64:67], a[192:199], v1
  ds_read_b64_tr_b16 v[84:85], v8 offset:11264
  v_exp_f32 v29, v15
  v_smfmac_f32_16x16x64_bf16 v[100:103], v[64:67], a[200:207], v1
  ds_read_b64_tr_b16 v[86:87], v8 offset:11776
  v_cvt_pk_bf16_f32 v30, v28, v29
  v_smfmac_f32_16x16x64_bf16 v[96:99], v[68:71], a[208:215], v1
  ds_write_b32 v13, v30 offset:14336
  v_smfmac_f32_16x16x64_bf16 v[100:103], v[68:71], a[216:223], v1
  ds_read_b128 v[108:111], v6 offset:29696
  s_waitcnt lgkmcnt(2)
  v_mfma_f32_16x16x32_bf16 v[44:47], v[80:83], v[88:91], 0
  ds_read_b128 v[64:67], v6 offset:30720
  v_mfma_f32_16x16x32_bf16 v[44:47], v[84:87], v[92:95], v[44:47]
  s_nop 0
  s_waitcnt vmcnt(5)
  v_mov_b64 v[48:49], 0
  v_smfmac_f32_16x16x64_bf16 v[96:99], v[72:75], a[224:231], v1
  s_waitcnt lgkmcnt(2)
  s_barrier
  v_smfmac_f32_16x16x64_bf16 v[96:99], v[76:79], a[240:247], v1
  ds_read_b128 v[28:31], v9 offset:14336
  v_add_f32_dpp v44, v45, v44 quad_perm:[1,1,3,3] row_mask:0xf bank_mask:0xf
  v_add_f32_dpp v46, v47, v46 quad_perm:[1,1,3,3] row_mask:0xf bank_mask:0xf
  v_smfmac_f32_16x16x64_bf16 v[100:103], v[72:75], a[232:239], v1
  ds_read_b128 v[40:43], v10 offset:14336
  v_mul_f32 v44, s64, v44
  v_mul_f32 v46, s64, v46
  v_smfmac_f32_16x16x64_bf16 v[100:103], v[76:79], a[248:255], v1
  ds_read_b128 v[68:71], v6 offset:31744
  v_add_f32 v96, v96, v97
  v_exp_f32_dpp v45, v44 quad_perm:[0,0,2,2] row_mask:0xf bank_mask:0xf
  v_exp_f32_dpp v47, v46 quad_perm:[0,0,2,2] row_mask:0xf bank_mask:0xf
  s_waitcnt lgkmcnt(2)
  v_mfma_f32_16x16x32_bf16 v[88:91], v[16:19], v[28:31], 0
  v_cvt_pk_bf16_f32 v23, v45, v47
  v_cndmask_b32 v22, 0, v23, s[66:67]
  v_mfma_f32_16x16x32_bf16 v[84:87], v[32:35], v[28:31], 0
  s_waitcnt lgkmcnt(1)
  v_cndmask_b32 v23, v23, 0, s[66:67]
  v_add_f32 v98, v98, v99
  v_mfma_f32_16x16x32_bf16 v[84:87], v[36:39], v[40:43], v[84:87]
  v_add_f32 v100, v100, v101
  v_add_f32 v102, v102, v103
  v_cvt_pk_bf16_f32 v21, v100, v102
  v_cvt_pk_bf16_f32 v20, v96, v98
  v_mfma_f32_16x16x16_bf16 v[88:91], v[16:17], v[22:23], v[88:91]
  v_mov_b64 v[50:51], 0
  v_mov_b64 v[52:53], 0
  v_mfma_f32_16x16x16_bf16 v[84:87], v[20:21], v[22:23], v[84:87]
  v_mov_b64 v[54:55], 0
  v_mov_b64 v[56:57], 0
  v_mov_b64 v[58:59], 0
  v_mov_b64 v[60:61], 0
  v_mov_b64 v[62:63], 0
  v_rcp_f32_dpp v96, v88 quad_perm:[0,0,2,2] row_mask:0xf bank_mask:0xf
  s_nop 0
  v_subrev_u32 v97, s29, v96
  v_cmp_lt_u32 vcc, s90, v97
  v_mul_f32 v84, v84, v96
  v_mul_f32 v85, v85, v96
  v_mul_f32 v86, v86, v96
  v_mul_f32_e64 v87, v87, v96
  v_cvt_pk_bf16_f32 v98, v84, v85
  v_cvt_pk_bf16_f32 v99, v86, v87
  ds_write_b64 v7, v[98:99] offset:12288
  s_cbranch_vccnz L_slow_108
L_back_109:
  v_mov_b32_dpp v80, v98 quad_perm:[0,0,2,2] row_mask:0xf bank_mask:0xf
  v_mov_b32_dpp v81, v99 quad_perm:[0,0,2,2] row_mask:0xf bank_mask:0xf
  v_mov_b32_dpp v82, v98 quad_perm:[1,1,3,3] row_mask:0xf bank_mask:0xf
  v_mov_b32_dpp v83, v99 quad_perm:[1,1,3,3] row_mask:0xf bank_mask:0xf
  s_nop 1
  v_smfmac_f32_16x16x64_bf16 v[48:51], v[80:83], v[144:151], v1
  s_waitcnt lgkmcnt(0)
  s_barrier
  ds_read_b128 v[92:95], v3 offset:12288
  v_smfmac_f32_16x16x64_bf16 v[52:55], v[80:83], v[152:159], v1
  ds_read_b128 v[28:31], v4 offset:12288
  v_smfmac_f32_16x16x64_bf16 v[56:59], v[80:83], v[160:167], v1
  ds_read_b128 v[40:43], v5 offset:12288
  v_smfmac_f32_16x16x64_bf16 v[60:63], v[80:83], v[168:175], v1
  ds_read_b128 v[72:75], v6 offset:32768
  s_waitcnt lgkmcnt(3)
  v_smfmac_f32_16x16x64_bf16 v[48:51], v[92:95], v[176:183], v1
  ds_read_b128 v[76:79], v6 offset:33792
  s_waitcnt lgkmcnt(3)
  v_smfmac_f32_16x16x64_bf16 v[48:51], v[28:31], v[192:199], v1
  ds_read_b128 v[32:35], v6 offset:34816
  s_waitcnt lgkmcnt(3)
  v_smfmac_f32_16x16x64_bf16 v[48:51], v[40:43], v[208:215], v1
  s_nop 0
  ds_read_b128 v[36:39], v6 offset:35840
  v_smfmac_f32_16x16x64_bf16 v[52:55], v[92:95], v[184:191], v1
  s_nop 2
  v_smfmac_f32_16x16x64_bf16 v[52:55], v[28:31], v[200:207], v1
  s_nop 0
  v_cvt_pk_bf16_f32 v96, v48, v49
  v_smfmac_f32_16x16x64_bf16 v[52:55], v[40:43], v[216:223], v1
  s_nop 0
  s_waitcnt lgkmcnt(12)
  v_cvt_pk_bf16_f32 v97, v50, v51
  v_smfmac_f32_16x16x64_bf16 v[56:59], v[92:95], v[112:119], v1
  buffer_store_dwordx2 v[96:97], v11, s[4:7], s18 offen offset:0 sc1
  v_smfmac_f32_16x16x64_bf16 v[56:59], v[28:31], v[120:127], v1
  s_nop 1
  v_cvt_pk_bf16_f32 v98, v52, v53
  v_smfmac_f32_16x16x64_bf16 v[56:59], v[40:43], v[104:111], v1
  s_nop 0
  s_waitcnt lgkmcnt(0)
  v_cvt_pk_bf16_f32 v99, v54, v55
  v_smfmac_f32_16x16x64_bf16 v[60:63], v[92:95], v[64:71], v1
  buffer_store_dwordx2 v[98:99], v11, s[4:7], s18 offen offset:2048 sc1
  v_smfmac_f32_16x16x64_bf16 v[60:63], v[28:31], v[72:79], v1
  s_nop 1
  v_cvt_pk_bf16_f32 v100, v56, v57
  v_smfmac_f32_16x16x64_bf16 v[60:63], v[40:43], v[32:39], v1
  v_cvt_pk_bf16_f32 v101, v58, v59
  buffer_store_dwordx2 v[100:101], v11, s[4:7], s19 offen offset:0 sc1
  s_add_u32 s14, s14, 1
  s_and_b32 s24, s14, 3
  s_lshl_b32 s24, s24, 13
  s_add_u32 s24, s24, 1048576
  v_mov_b32_e64 v15, -1
  s_nop 0
  v_cvt_pk_bf16_f32 v102, v60, v61
  v_cvt_pk_bf16_f32 v103, v62, v63
  buffer_store_dwordx2 v[102:103], v11, s[4:7], s19 offen offset:2048 sc1
  buffer_store_dword v15, v24, s[4:7], s28 offen sc1
  ds_read_b128 v[88:91], v2 offset:15360
  v_and_b32_e64 v14, v96, v97
  v_bitop3_b32 v14, v14, v98, v99 bitop3:0x80
  v_bitop3_b32 v14, v14, v100, v101 bitop3:0x80
  v_bitop3_b32 v14, v14, v102, v103 bitop3:0x80
  v_bfi_b32 v14, v14, 0, s89
  v_cmp_lt_u32 vcc, 0xffff, v14
  ds_read_b128 v[56:59], v6 offset:0
  ds_read_b128 v[60:63], v6 offset:1024
  ds_read_b128 v[64:67], v6 offset:2048
  ds_read_b128 v[68:71], v6 offset:3072
  s_cbranch_vccnz L_fix_113
L_fix_113_b:
  ds_read_b128 v[72:75], v6 offset:4096
  ds_read_b128 v[76:79], v6 offset:5120
  ds_read_b128 v[104:107], v6 offset:6144
  ds_read_b128 v[108:111], v6 offset:7168
  ds_read_b128 v[112:115], v6 offset:12288
  ds_read_b128 v[116:119], v6 offset:13312
  ds_read_b128 v[120:123], v6 offset:14336
  ds_read_b128 v[124:127], v6 offset:15360
  s_waitcnt vmcnt(2)
  buffer_load_dwordx4 v[80:83], v2, s[4:7], s22 offen offset:0 sc1
  buffer_load_dwordx4 v[84:87], v2, s[4:7], s22 offen offset:1024 sc1
  s_mov_b32 s28, s17
  s_add_u32 s17, s24, s87
  s_add_u32 s15, s24, s40
  s_add_u32 s23, s24, s16
  s_lshl_b32 s31, s14, 13
  s_add_u32 s31, s31, s87
  s_add_u32 s31, s31, 1310720
  s_xor_b32 s29, s29, 0x40000000
  s_mov_b32 s91, 0
  s_add_u32 s30, s30, 524288
  s_add_u32 s65, s65, 524288
  s_waitcnt lgkmcnt(12)
  v_bfi_b32 v88, s89, 0, v88
  v_bfi_b32 v89, s89, 0, v89
  v_bfi_b32 v90, s89, 0, v90
  v_bfi_b32 v91, s89, 0, v91
  s_waitcnt vmcnt(1)
L_red_110_b:
  s_nop 0
  v_mfma_f32_16x16x32_bf16 v[92:95], v[88:91], v[80:83], 0
  s_nop 0
  v_bitop3_b32 v29, v80, v81, s89 bitop3:0x7e
  v_bitop3_b32 v30, v82, v83, s89 bitop3:0x7e
  v_or_b32_e64 v14, v29, v30
  s_waitcnt vmcnt(0)
  v_mfma_f32_16x16x32_bf16 v[92:95], v[88:91], v[84:87], v[92:95]
  v_bitop3_b32 v29, v84, v85, s89 bitop3:0x7e
  v_bitop3_b32 v30, v86, v87, s89 bitop3:0x7e
  v_or3_b32 v14, v14, v29, v30
  v_lshlrev_b32_e64 v14, 1, v14
  v_cmp_gt_i32_e64 vcc, 0, v14
  s_nop 2
  v_add_f32_dpp v92, v92, v92 row_ror:4 row_mask:0xf bank_mask:0xf
  v_add_f32_dpp v93, v93, v93 row_ror:4 row_mask:0xf bank_mask:0xf
  s_cbranch_vccnz L_red_110
  v_add_f32_dpp v92, v92, v92 row_ror:8 row_mask:0xf bank_mask:0xf
  v_add_f32_dpp v93, v93, v93 row_ror:8 row_mask:0xf bank_mask:0xf
  v_cvt_pk_bf16_f32 v15, v92, v93
  buffer_store_dword v15, v24, s[4:7], s17 offen sc1
  s_cmp_lt_u32 s14, 63
  s_cbranch_scc1 L_top_106
L_end_114:
  buffer_store_dword v15, v24, s[4:7], s31 offen sc1
  s_branch L_done
L_fix_113:
  v_or_b32 v96, 0x40000000, v96
  v_or_b32 v97, 0x40000000, v97
  v_or_b32 v98, 0x40000000, v98
  v_or_b32 v99, 0x40000000, v99
  v_or_b32 v100, 0x40000000, v100
  v_or_b32 v101, 0x40000000, v101
  v_or_b32 v102, 0x40000000, v102
  v_or_b32 v103, 0x40000000, v103
  buffer_store_dwordx2 v[96:97], v11, s[4:7], s18 offen offset:0 sc1
  buffer_store_dwordx2 v[98:99], v11, s[4:7], s18 offen offset:2048 sc1
  buffer_store_dwordx2 v[100:101], v11, s[4:7], s19 offen offset:0 sc1
  buffer_store_dwordx2 v[102:103], v11, s[4:7], s19 offen offset:2048 sc1
  s_branch L_fix_113_b
L_red_110:
  buffer_load_dwordx4 v[80:83], v2, s[4:7], s22 offen offset:0 sc1
  buffer_load_dwordx4 v[84:87], v2, s[4:7], s22 offen offset:1024 sc1
  s_sub_u32 s33, s33, 1
  s_cbranch_scc1 L_done
  s_waitcnt vmcnt(0)
  s_branch L_red_110_b
L_re_111:
  buffer_load_dwordx4 v[48:51], v2, s[4:7], s15 offen sc1
  s_sub_u32 s33, s33, 1
  buffer_load_dwordx4 v[52:55], v2, s[4:7], s23 offen sc1
  s_nop 1
  v_mov_b64 v[88:89], 0
  v_mov_b64 v[90:91], 0
  v_mov_b64 v[92:93], 0
  v_mov_b64 v[94:95], 0
  s_cbranch_scc0 L_got_107_w
  s_branch L_done
L_rl_112:
  buffer_load_dwordx4 v[52:55], v2, s[4:7], s23 offen sc1
  s_waitcnt vmcnt(1)
  v_cmp_eq_u32 vcc, -1, v55
  s_cbranch_vccz L_rl_112_b
  s_sub_u32 s33, s33, 1
  s_cbranch_scc1 L_done
  s_branch L_rl_112
L_slow_108:
  v_cmp_u_f32 vcc, v96, v96
  s_cbranch_vccz L_slow_108_m
  s_bitcmp1_b32 s91, 0
  s_cbranch_scc1 L_slow_108_m
  s_mov_b32 s91, 1
  s_sub_u32 s24, s30, 524288
  buffer_load_dwordx4 v[40:43], v2, s[4:7], s24 offen offset:0 sc1
  buffer_load_dwordx4 v[44:47], v2, s[4:7], s24 offen offset:1024 sc1
L_slow_108_f:
  buffer_load_dwordx4 v[48:51], v2, s[4:7], s15 offen sc1
  buffer_load_dwordx4 v[52:55], v2, s[4:7], s23 offen sc1
  s_sub_u32 s33, s33, 1
  s_cbranch_scc1 L_done
  s_waitcnt vmcnt(0)
  v_max3_u32 v22, v48, v49, v50
  v_max_u32 v22, v22, v51
  v_max3_u32 v23, v52, v53, v54
  v_max_u32 v23, v23, v55
  v_max_u32 v22, v22, v23
  v_cmp_eq_u32 vcc, -1, v22
  s_cbranch_vccnz L_slow_108_f
  s_waitcnt lgkmcnt(0)
  ds_read_b128 v[56:59], v6 offset:0
  ds_read_b128 v[60:63], v6 offset:1024
  ds_read_b128 v[64:67], v6 offset:2048
  ds_read_b128 v[68:71], v6 offset:3072
  ds_read_b128 v[72:75], v6 offset:4096
  ds_read_b128 v[76:79], v6 offset:5120
  ds_read_b128 v[104:107], v6 offset:6144
  ds_read_b128 v[108:111], v6 offset:7168
  s_waitcnt lgkmcnt(0)
  ds_read_b128 v[112:115], v6 offset:12288
  ds_read_b128 v[116:119], v6 offset:13312
  ds_read_b128 v[120:123], v6 offset:14336
  ds_read_b128 v[124:127], v6 offset:15360
  ds_read_b128 v[128:131], v6 offset:16384
  ds_read_b128 v[132:135], v6 offset:17408
  ds_read_b128 v[136:139], v6 offset:18432
  ds_read_b128 v[140:143], v6 offset:19456
  v_mov_b64 v[80:81], 0
  v_mov_b64 v[82:83], 0
  v_mov_b64 v[84:85], 0
  v_mov_b64 v[86:87], 0
  v_mov_b64 v[88:89], 0
  v_mov_b64 v[90:91], 0
  v_mov_b64 v[92:93], 0
  v_mov_b64 v[94:95], 0
  v_mov_b64 v[96:97], 0
  v_mov_b64 v[98:99], 0
  v_mov_b64 v[100:101], 0
  v_mov_b64 v[102:103], 0
  v_add_u32 v14, s40, v2
  s_mov_b32 s31, 1835008
  s_waitcnt lgkmcnt(0)
  s_barrier
  s_branch L_got_107
L_slow_108_m:
  v_max3_f32 v96, v14, v15, v44
  v_max_f32 v96, v96, v46
  v_mov_b32 v97, v96
  s_nop 1
  v_permlane32_swap_b32 v96, v97
  v_max_f32 v96, v96, v97
  v_mov_b32 v97, v96
  s_nop 1
  v_permlane16_swap_b32 v96, v97
  v_max_f32 v96, v96, v97
  s_barrier
  ds_write_b32 v13, v96 offset:14336
  s_waitcnt lgkmcnt(0)
  s_barrier
  ds_read_b128 v[28:31], v9 offset:14336
  s_waitcnt lgkmcnt(0)
  s_barrier
  v_max3_f32 v96, v28, v29, v30
  v_max_f32 v96, v96, v31
  v_sub_f32 v14, v14, v96
  v_sub_f32 v15, v15, v96
  v_sub_f32 v44, v44, v96
  v_sub_f32 v46, v46, v96
  v_exp_f32 v28, v14
  v_exp_f32 v29, v15
  v_exp_f32_dpp v45, v44 quad_perm:[0,0,2,2] row_mask:0xf bank_mask:0xf
  v_exp_f32_dpp v47, v46 quad_perm:[0,0,2,2] row_mask:0xf bank_mask:0xf
  v_cvt_pk_bf16_f32 v30, v28, v29
  v_cvt_pk_bf16_f32 v23, v45, v47
  v_cndmask_b32 v22, 0, v23, s[66:67]
  v_cndmask_b32 v23, v23, 0, s[66:67]
  ds_write_b32 v13, v30 offset:14336
  s_waitcnt lgkmcnt(0)
  s_barrier
  ds_read_b128 v[28:31], v9 offset:14336
  ds_read_b128 v[40:43], v10 offset:14336
  s_waitcnt lgkmcnt(0)
  v_mfma_f32_16x16x32_bf16 v[88:91], v[16:19], v[28:31], 0
  s_nop 2
  v_mfma_f32_16x16x32_bf16 v[84:87], v[32:35], v[28:31], 0
  s_nop 0
  v_mfma_f32_16x16x32_bf16 v[84:87], v[36:39], v[40:43], v[84:87]
  s_nop 2
  v_mfma_f32_16x16x16_bf16 v[88:91], v[16:17], v[22:23], v[88:91]
  s_nop 2
  v_mfma_f32_16x16x16_bf16 v[84:87], v[20:21], v[22:23], v[84:87]
  s_nop 3
  v_rcp_f32_dpp v96, v88 quad_perm:[0,0,2,2] row_mask:0xf bank_mask:0xf
  s_nop 2
  v_mul_f32 v84, v84, v96
  v_mul_f32 v85, v85, v96
  v_mul_f32 v86, v86, v96
  v_mul_f32 v87, v87, v96
  v_cvt_pk_bf16_f32 v98, v84, v85
  v_cvt_pk_bf16_f32 v99, v86, v87
  ds_write_b64 v7, v[98:99] offset:12288
  s_branch L_back_109
L_wave2_94:
  s_branch L_got_116
  s_nop 0
  s_nop 0
  s_nop 0
  s_nop 0
  s_nop 0
  s_nop 0
L_top_115:
  s_barrier
  v_mov_b64 v[32:33], v[128:129]
  v_mov_b64 v[34:35], v[130:131]
  v_mov_b64 v[36:37], v[132:133]
  v_mov_b64 v[38:39], v[134:135]
  ds_read_b128 v[128:131], v6 offset:16384
  buffer_load_dwordx4 v[48:51], v2, s[4:7], s15 offen sc1
  ds_read_b128 v[132:135], v6 offset:17408
  v_mov_b64 v[40:41], v[136:137]
  v_mov_b64 v[42:43], v[138:139]
  v_mov_b64 v[44:45], v[140:141]
  v_mov_b64 v[46:47], v[142:143]
  ds_read_b128 v[136:139], v6 offset:18432
  ds_read_b128 v[140:143], v6 offset:19456
  buffer_load_dwordx4 v[52:55], v2, s[4:7], s23 offen sc1
  v_mov_b64 v[80:81], 0
  v_mov_b64 v[82:83], 0
  v_mov_b64 v[84:85], 0
  v_mov_b64 v[86:87], 0
  v_mov_b64 v[88:89], 0
  v_mov_b64 v[90:91], 0
  v_mov_b64 v[92:93], 0
  v_mov_b64 v[94:95], 0
  v_mov_b64_e64 v[96:97], 0
  v_mov_b64_e64 v[98:99], 0
  v_mov_b64_e64 v[100:101], 0
  v_mov_b64_e64 v[102:103], 0
  v_add_u32_e64 v14, s40, v2
  v_xor_b32 v16, 0x40004000, v16
  buffer_load_dwordx4 v[48:51], v2, s[4:7], s15 offen sc1
  v_xor_b32 v17, 0x40004000, v17
  v_xor_b32 v18, 0x40004000, v18
  v_xor_b32 v19, 0x40004000, v19
  s_xor_b32 s89, s89, 0x40004000
  s_nop 5
  buffer_load_dwordx4 v[52:55], v2, s[4:7], s23 offen sc1
  s_waitcnt lgkmcnt(0)
L_got_116_w:
  s_waitcnt vmcnt(3)
L_got_116:
  v_cmp_eq_u32_e64 vcc, -1, v51
  v_smfmac_f32_16x16x64_bf16 v[88:91], v[48:51], v[56:63], v1
  ds_write_b128 v14, v[48:51] offset:0
  v_smfmac_f32_16x16x64_bf16 v[92:95], v[48:51], v[64:71], v1
  s_cbranch_vccnz L_re_120
  s_waitcnt vmcnt(2)
  v_cmp_eq_u32_e64 vcc, -1, v55
  v_smfmac_f32_16x16x64_bf16 v[80:83], v[48:51], v[72:79], v1
  v_smfmac_f32_16x16x64_bf16 v[84:87], v[48:51], v[104:111], v1
  s_cbranch_vccnz L_rl_121
L_rl_121_b:
  v_smfmac_f32_16x16x64_bf16 v[88:91], v[52:55], v[112:119], v1
  ds_write_b128 v14, v[52:55] offset:4096
  v_smfmac_f32_16x16x64_bf16 v[92:95], v[52:55], v[120:127], v1
  s_waitcnt lgkmcnt(1)
  s_barrier
  ds_read_b128 v[56:59], v25 offset:0
  v_smfmac_f32_16x16x64_bf16 v[80:83], v[52:55], v[128:135], v1
  ds_read_b128 v[60:63], v26 offset:0
  v_smfmac_f32_16x16x64_bf16 v[84:87], v[52:55], v[136:143], v1
  ds_read_b128 v[64:67], v27 offset:0
  buffer_load_dwordx4 v[136:139], v2, s[4:7], s30 offen offset:0 sc1
  s_waitcnt lgkmcnt(2)
  v_smfmac_f32_16x16x64_bf16 v[88:91], v[56:59], a[32:39], v1
  s_barrier
  v_smfmac_f32_16x16x64_bf16 v[92:95], v[56:59], a[40:47], v1
  ds_read_b128 v[68:71], v25 offset:4096
  s_waitcnt lgkmcnt(2)
  v_smfmac_f32_16x16x64_bf16 v[88:91], v[60:63], a[48:55], v1
  ds_read_b128 v[72:75], v26 offset:4096
  v_smfmac_f32_16x16x64_bf16 v[92:95], v[60:63], a[56:63], v1
  ds_read_b128 v[76:79], v27 offset:4096
  s_waitcnt lgkmcnt(3)
  v_smfmac_f32_16x16x64_bf16 v[88:91], v[64:67], a[64:71], v1
  ds_read_b128 v[104:107], v6 offset:8192
  v_smfmac_f32_16x16x64_bf16 v[92:95], v[64:67], a[72:79], v1
  ds_read_b128 v[108:111], v6 offset:9216
  s_waitcnt lgkmcnt(4)
  v_smfmac_f32_16x16x64_bf16 v[88:91], v[68:71], a[80:87], v1
  ds_read_b128 v[112:115], v6 offset:10240
  v_smfmac_f32_16x16x64_bf16 v[92:95], v[68:71], a[88:95], v1
  ds_read_b128 v[116:119], v6 offset:11264
  s_waitcnt lgkmcnt(4)
  v_smfmac_f32_16x16x64_bf16 v[88:91], v[72:75], a[96:103], v1
  buffer_load_dwordx4 v[140:143], v2, s[4:7], s30 offen offset:1024 sc1
  v_smfmac_f32_16x16x64_bf16 v[88:91], v[76:79], a[112:119], v1
  s_nop 0
  ds_read_b128 v[120:123], v6 offset:20480
  v_smfmac_f32_16x16x64_bf16 v[92:95], v[72:75], a[104:111], v1
  buffer_load_dwordx4 v[128:131], v2, s[4:7], s65 offen offset:0 sc1
  v_smfmac_f32_16x16x64_bf16 v[92:95], v[76:79], a[120:127], v1
  s_waitcnt lgkmcnt(1)
  s_nop 1
  v_add_f32 v88, v88, v89
  v_smfmac_f32_16x16x64_bf16 v[80:83], v[56:59], v[104:111], v1
  ds_read_b128 v[124:127], v6 offset:21504
  v_add_f32 v90, v90, v91
  v_smfmac_f32_16x16x64_bf16 v[84:87], v[56:59], v[112:119], v1
  ds_read_b128 v[104:107], v6 offset:22528
  v_add_f32 v92, v92, v93
  v_smfmac_f32_16x16x64_bf16 v[80:83], v[60:63], v[224:231], v1
  ds_read_b128 v[108:111], v6 offset:23552
  v_add_f32 v94, v94, v95
  v_smfmac_f32_16x16x64_bf16 v[84:87], v[60:63], v[232:239], v1
  v_cvt_pk_bf16_f32 v28, v88, v92
  v_cvt_pk_bf16_f32 v29, v90, v94
  v_smfmac_f32_16x16x64_bf16 v[80:83], v[64:67], v[240:247], v1
  ds_write_b64 v7, v[28:29] offset:8192
  v_smfmac_f32_16x16x64_bf16 v[84:87], v[64:67], v[248:255], v1
  buffer_store_dword v15, v24, s[4:7], s31 offen sc1
  v_smfmac_f32_16x16x64_bf16 v[80:83], v[72:75], a[0:7], v1
  ds_read_b128 v[112:115], v6 offset:24576
  v_smfmac_f32_16x16x64_bf16 v[84:87], v[72:75], a[8:15], v1
  ds_read_b128 v[116:119], v6 offset:25600
  s_waitcnt lgkmcnt(3)
  v_smfmac_f32_16x16x64_bf16 v[80:83], v[68:71], v[120:127], v1
  s_waitcnt lgkmcnt(2)
  s_barrier
  v_smfmac_f32_16x16x64_bf16 v[80:83], v[76:79], a[16:23], v1
  s_nop 0
  ds_read_b64_tr_b16 v[88:89], v8 offset:8192
  v_smfmac_f32_16x16x64_bf16 v[84:87], v[68:71], v[104:111], v1
  ds_read_b64_tr_b16 v[90:91], v8 offset:8704
  v_smfmac_f32_16x16x64_bf16 v[84:87], v[76:79], a[24:31], v1
  ds_read_b64_tr_b16 v[92:93], v8 offset:9216
  v_smfmac_f32_16x16x64_bf16 v[96:99], v[48:51], a[128:135], v1
  ds_read_b64_tr_b16 v[94:95], v8 offset:9728
  v_add_f32 v80, v80, v81
  v_smfmac_f32_16x16x64_bf16 v[100:103], v[48:51], a[136:143], v1
  ds_read_b128 v[120:123], v6 offset:26624
  v_add_f32 v82, v82, v83
  v_smfmac_f32_16x16x64_bf16 v[96:99], v[52:55], a[144:151], v1
  v_add_f32 v84, v84, v85
  v_add_f32 v86, v86, v87
  v_cvt_pk_bf16_f32 v22, v80, v84
  v_cvt_pk_bf16_f32 v23, v82, v86
  v_smfmac_f32_16x16x64_bf16 v[100:103], v[52:55], a[152:159], v1
  ds_write_b64 v7, v[22:23] offset:10240
  s_waitcnt lgkmcnt(2)
  v_mfma_f32_16x16x32_bf16 v[28:31], v[40:43], v[88:91], 0
  buffer_load_dwordx4 v[132:135], v2, s[4:7], s65 offen offset:1024 sc1
  v_mfma_f32_16x16x32_bf16 v[28:31], v[44:47], v[92:95], v[28:31]
  s_nop 0
  ds_read_b128 v[124:127], v6 offset:27648
  v_smfmac_f32_16x16x64_bf16 v[96:99], v[56:59], a[160:167], v1
  s_nop 0
  ds_read_b128 v[104:107], v6 offset:28672
  v_smfmac_f32_16x16x64_bf16 v[100:103], v[56:59], a[168:175], v1
  s_waitcnt lgkmcnt(2)
  s_barrier
  v_add_f32_dpp v14, v29, v28 quad_perm:[1,1,3,3] row_mask:0xf bank_mask:0xf
  v_smfmac_f32_16x16x64_bf16 v[96:99], v[60:63], a[176:183], v1
  ds_read_b64_tr_b16 v[80:81], v8 offset:10240
  v_add_f32_dpp v15, v31, v30 quad_perm:[1,1,3,3] row_mask:0xf bank_mask:0xf
  v_smfmac_f32_16x16x64_bf16 v[100:103], v[60:63], a[184:191], v1
  ds_read_b64_tr_b16 v[82:83], v8 offset:10752
  v_exp_f32 v28, v14
  v_smfmac_f32_16x16x64_bf16 v[96:99], v[64:67], a[192:199], v1
  ds_read_b64_tr_b16 v[84:85], v8 offset:11264
  v_exp_f32 v29, v15
  v_smfmac_f32_16x16x64_bf16 v[100:103], v[64:67], a[200:207], v1
  ds_read_b64_tr_b16 v[86:87], v8 offset:11776
  v_cvt_pk_bf16_f32 v30, v28, v29
  v_smfmac_f32_16x16x64_bf16 v[96:99], v[68:71], a[208:215], v1
  ds_write_b32 v13, v30 offset:14336
  v_smfmac_f32_16x16x64_bf16 v[100:103], v[68:71], a[216:223], v1
  ds_read_b128 v[108:111], v6 offset:29696
  s_waitcnt lgkmcnt(2)
  v_mfma_f32_16x16x32_bf16 v[44:47], v[80:83], v[88:91], 0
  ds_read_b128 v[64:67], v6 offset:30720
  v_mfma_f32_16x16x32_bf16 v[44:47], v[84:87], v[92:95], v[44:47]
  s_nop 0
  s_waitcnt vmcnt(5)
  v_mov_b64 v[48:49], 0
  v_smfmac_f32_16x16x64_bf16 v[96:99], v[72:75], a[224:231], v1
  s_waitcnt lgkmcnt(2)
  s_barrier
  v_smfmac_f32_16x16x64_bf16 v[96:99], v[76:79], a[240:247], v1
  ds_read_b128 v[28:31], v9 offset:14336
  v_add_f32_dpp v44, v45, v44 quad_perm:[1,1,3,3] row_mask:0xf bank_mask:0xf
  v_add_f32_dpp v46, v47, v46 quad_perm:[1,1,3,3] row_mask:0xf bank_mask:0xf
  v_smfmac_f32_16x16x64_bf16 v[100:103], v[72:75], a[232:239], v1
  ds_read_b128 v[40:43], v10 offset:14336
  v_mul_f32 v44, s64, v44
  v_mul_f32 v46, s64, v46
  v_smfmac_f32_16x16x64_bf16 v[100:103], v[76:79], a[248:255], v1
  ds_read_b128 v[68:71], v6 offset:31744
  v_add_f32 v96, v96, v97
  v_exp_f32_dpp v45, v44 quad_perm:[0,0,2,2] row_mask:0xf bank_mask:0xf
  v_exp_f32_dpp v47, v46 quad_perm:[0,0,2,2] row_mask:0xf bank_mask:0xf
  s_waitcnt lgkmcnt(2)
  v_mfma_f32_16x16x32_bf16 v[88:91], v[16:19], v[28:31], 0
  v_cvt_pk_bf16_f32 v23, v45, v47
  v_cndmask_b32 v22, 0, v23, s[66:67]
  v_mfma_f32_16x16x32_bf16 v[84:87], v[32:35], v[28:31], 0
  s_waitcnt lgkmcnt(1)
  v_cndmask_b32 v23, v23, 0, s[66:67]
  v_add_f32 v98, v98, v99
  v_mfma_f32_16x16x32_bf16 v[84:87], v[36:39], v[40:43], v[84:87]
  v_add_f32 v100, v100, v101
  v_add_f32 v102, v102, v103
  v_cvt_pk_bf16_f32 v21, v100, v102
  v_cvt_pk_bf16_f32 v20, v96, v98
  v_mfma_f32_16x16x16_bf16 v[88:91], v[16:17], v[22:23], v[88:91]
  v_mov_b64 v[50:51], 0
  v_mov_b64 v[52:53], 0
  v_mfma_f32_16x16x16_bf16 v[84:87], v[20:21], v[22:23], v[84:87]
  v_mov_b64 v[54:55], 0
  v_mov_b64 v[56:57], 0
  v_mov_b64 v[58:59], 0
  v_mov_b64 v[60:61], 0
  v_mov_b64 v[62:63], 0
  v_rcp_f32_dpp v96, v88 quad_perm:[0,0,2,2] row_mask:0xf bank_mask:0xf
  s_nop 0
  v_subrev_u32 v97, s29, v96
  v_cmp_lt_u32 vcc, s90, v97
  v_mul_f32 v84, v84, v96
  v_mul_f32 v85, v85, v96
  v_mul_f32 v86, v86, v96
  v_mul_f32_e64 v87, v87, v96
  v_cvt_pk_bf16_f32 v98, v84, v85
  v_cvt_pk_bf16_f32 v99, v86, v87
  ds_write_b64 v7, v[98:99] offset:12288
  s_cbranch_vccnz L_slow_117
L_back_118:
  v_mov_b32_dpp v80, v98 quad_perm:[0,0,2,2] row_mask:0xf bank_mask:0xf
  v_mov_b32_dpp v81, v99 quad_perm:[0,0,2,2] row_mask:0xf bank_mask:0xf
  v_mov_b32_dpp v82, v98 quad_perm:[1,1,3,3] row_mask:0xf bank_mask:0xf
  v_mov_b32_dpp v83, v99 quad_perm:[1,1,3,3] row_mask:0xf bank_mask:0xf
  s_nop 1
  v_smfmac_f32_16x16x64_bf16 v[48:51], v[80:83], v[144:151], v1
  s_waitcnt lgkmcnt(0)
  s_barrier
  ds_read_b128 v[92:95], v3 offset:12288
  v_smfmac_f32_16x16x64_bf16 v[52:55], v[80:83], v[152:159], v1
  ds_read_b128 v[28:31], v4 offset:12288
  v_smfmac_f32_16x16x64_bf16 v[56:59], v[80:83], v[160:167], v1
  ds_read_b128 v[40:43], v5 offset:12288
  v_smfmac_f32_16x16x64_bf16 v[60:63], v[80:83], v[168:175], v1
  ds_read_b128 v[72:75], v6 offset:32768
  s_waitcnt lgkmcnt(3)
  v_smfmac_f32_16x16x64_bf16 v[48:51], v[92:95], v[176:183], v1
  ds_read_b128 v[76:79], v6 offset:33792
  s_waitcnt lgkmcnt(3)
  v_smfmac_f32_16x16x64_bf16 v[48:51], v[28:31], v[192:199], v1
  ds_read_b128 v[32:35], v6 offset:34816
  s_waitcnt lgkmcnt(3)
  v_smfmac_f32_16x16x64_bf16 v[48:51], v[40:43], v[208:215], v1
  s_nop 0
  ds_read_b128 v[36:39], v6 offset:35840
  v_smfmac_f32_16x16x64_bf16 v[52:55], v[92:95], v[184:191], v1
  s_nop 2
  v_smfmac_f32_16x16x64_bf16 v[52:55], v[28:31], v[200:207], v1
  s_nop 0
  v_cvt_pk_bf16_f32 v96, v48, v49
  v_smfmac_f32_16x16x64_bf16 v[52:55], v[40:43], v[216:223], v1
  s_nop 0
  s_waitcnt lgkmcnt(12)
  v_cvt_pk_bf16_f32 v97, v50, v51
  v_smfmac_f32_16x16x64_bf16 v[56:59], v[92:95], v[112:119], v1
  buffer_store_dwordx2 v[96:97], v11, s[4:7], s18 offen offset:0 sc1
  v_smfmac_f32_16x16x64_bf16 v[56:59], v[28:31], v[120:127], v1
  s_nop 1
  v_cvt_pk_bf16_f32 v98, v52, v53
  v_smfmac_f32_16x16x64_bf16 v[56:59], v[40:43], v[104:111], v1
  s_nop 0
  s_waitcnt lgkmcnt(0)
  v_cvt_pk_bf16_f32 v99, v54, v55
  v_smfmac_f32_16x16x64_bf16 v[60:63], v[92:95], v[64:71], v1
  buffer_store_dwordx2 v[98:99], v11, s[4:7], s18 offen offset:2048 sc1
  v_smfmac_f32_16x16x64_bf16 v[60:63], v[28:31], v[72:79], v1
  s_nop 1
  v_cvt_pk_bf16_f32 v100, v56, v57
  v_smfmac_f32_16x16x64_bf16 v[60:63], v[40:43], v[32:39], v1
  v_cvt_pk_bf16_f32 v101, v58, v59
  buffer_store_dwordx2 v[100:101], v11, s[4:7], s19 offen offset:0 sc1
  s_add_u32 s14, s14, 1
  s_and_b32 s24, s14, 3
  s_lshl_b32 s24, s24, 13
  s_add_u32 s24, s24, 1048576
  v_mov_b32_e64 v15, -1
  s_nop 0
  v_cvt_pk_bf16_f32 v102, v60, v61
  v_cvt_pk_bf16_f32 v103, v62, v63
  buffer_store_dwordx2 v[102:103], v11, s[4:7], s19 offen offset:2048 sc1
  buffer_store_dword v15, v24, s[4:7], s28 offen sc1
  ds_read_b128 v[88:91], v2 offset:15360
  v_and_b32_e64 v14, v96, v97
  v_bitop3_b32 v14, v14, v98, v99 bitop3:0x80
  v_bitop3_b32 v14, v14, v100, v101 bitop3:0x80
  v_bitop3_b32 v14, v14, v102, v103 bitop3:0x80
  v_bfi_b32 v14, v14, 0, s89
  v_cmp_lt_u32 vcc, 0xffff, v14
  ds_read_b128 v[56:59], v6 offset:0
  ds_read_b128 v[60:63], v6 offset:1024
  ds_read_b128 v[64:67], v6 offset:2048
  ds_read_b128 v[68:71], v6 offset:3072
  s_cbranch_vccnz L_fix_122
L_fix_122_b:
  ds_read_b128 v[72:75], v6 offset:4096
  ds_read_b128 v[76:79], v6 offset:5120
  ds_read_b128 v[104:107], v6 offset:6144
  ds_read_b128 v[108:111], v6 offset:7168
  ds_read_b128 v[112:115], v6 offset:12288
  ds_read_b128 v[116:119], v6 offset:13312
  ds_read_b128 v[120:123], v6 offset:14336
  ds_read_b128 v[124:127], v6 offset:15360
  s_waitcnt vmcnt(1)
  buffer_load_dwordx4 v[80:83], v2, s[4:7], s22 offen offset:0 sc1
  buffer_load_dwordx4 v[84:87], v2, s[4:7], s22 offen offset:1024 sc1
  s_mov_b32 s28, s17
  s_add_u32 s17, s24, s87
  s_add_u32 s15, s24, s40
  s_add_u32 s23, s24, s16
  s_lshl_b32 s31, s14, 13
  s_add_u32 s31, s31, s87
  s_add_u32 s31, s31, 1310720
  s_xor_b32 s29, s29, 0x40000000
  s_mov_b32 s91, 0
  s_add_u32 s30, s30, 524288
  s_add_u32 s65, s65, 524288
  s_waitcnt lgkmcnt(12)
  v_bfi_b32 v88, s89, 0, v88
  v_bfi_b32 v89, s89, 0, v89
  v_bfi_b32 v90, s89, 0, v90
  v_bfi_b32 v91, s89, 0, v91
  s_waitcnt vmcnt(1)
L_red_119_b:
  s_nop 0
  v_mfma_f32_16x16x32_bf16 v[92:95], v[88:91], v[80:83], 0
  s_nop 0
  v_bitop3_b32 v29, v80, v81, s89 bitop3:0x7e
  v_bitop3_b32 v30, v82, v83, s89 bitop3:0x7e
  v_or_b32_e64 v14, v29, v30
  s_waitcnt vmcnt(0)
  v_mfma_f32_16x16x32_bf16 v[92:95], v[88:91], v[84:87], v[92:95]
  v_bitop3_b32 v29, v84, v85, s89 bitop3:0x7e
  v_bitop3_b32 v30, v86, v87, s89 bitop3:0x7e
  v_or3_b32 v14, v14, v29, v30
  v_lshlrev_b32_e64 v14, 1, v14
  v_cmp_gt_i32_e64 vcc, 0, v14
  s_nop 2
  v_add_f32_dpp v92, v92, v92 row_ror:4 row_mask:0xf bank_mask:0xf
  v_add_f32_dpp v93, v93, v93 row_ror:4 row_mask:0xf bank_mask:0xf
  s_cbranch_vccnz L_red_119
  v_add_f32_dpp v92, v92, v92 row_ror:8 row_mask:0xf bank_mask:0xf
  v_add_f32_dpp v93, v93, v93 row_ror:8 row_mask:0xf bank_mask:0xf
  v_cvt_pk_bf16_f32 v15, v92, v93
  buffer_store_dword v15, v24, s[4:7], s17 offen sc1
  s_cmp_lt_u32 s14, 63
  s_cbranch_scc1 L_top_115
L_end_123:
  buffer_store_dword v15, v24, s[4:7], s31 offen sc1
  s_branch L_done
L_fix_122:
  v_or_b32 v96, 0x40000000, v96
  v_or_b32 v97, 0x40000000, v97
  v_or_b32 v98, 0x40000000, v98
  v_or_b32 v99, 0x40000000, v99
  v_or_b32 v100, 0x40000000, v100
  v_or_b32 v101, 0x40000000, v101
  v_or_b32 v102, 0x40000000, v102
  v_or_b32 v103, 0x40000000, v103
  buffer_store_dwordx2 v[96:97], v11, s[4:7], s18 offen offset:0 sc1
  buffer_store_dwordx2 v[98:99], v11, s[4:7], s18 offen offset:2048 sc1
  buffer_store_dwordx2 v[100:101], v11, s[4:7], s19 offen offset:0 sc1
  buffer_store_dwordx2 v[102:103], v11, s[4:7], s19 offen offset:2048 sc1
  s_branch L_fix_122_b
L_red_119:
  buffer_load_dwordx4 v[80:83], v2, s[4:7], s22 offen offset:0 sc1
  buffer_load_dwordx4 v[84:87], v2, s[4:7], s22 offen offset:1024 sc1
  s_sub_u32 s33, s33, 1
  s_cbranch_scc1 L_done
  s_waitcnt vmcnt(0)
  s_branch L_red_119_b
L_re_120:
  buffer_load_dwordx4 v[48:51], v2, s[4:7], s15 offen sc1
  s_sub_u32 s33, s33, 1
  buffer_load_dwordx4 v[52:55], v2, s[4:7], s23 offen sc1
  s_nop 1
  v_mov_b64 v[88:89], 0
  v_mov_b64 v[90:91], 0
  v_mov_b64 v[92:93], 0
  v_mov_b64 v[94:95], 0
  s_cbranch_scc0 L_got_116_w
  s_branch L_done
L_rl_121:
  buffer_load_dwordx4 v[52:55], v2, s[4:7], s23 offen sc1
  s_waitcnt vmcnt(1)
  v_cmp_eq_u32 vcc, -1, v55
  s_cbranch_vccz L_rl_121_b
  s_sub_u32 s33, s33, 1
  s_cbranch_scc1 L_done
  s_branch L_rl_121
L_slow_117:
  v_cmp_u_f32 vcc, v96, v96
  s_cbranch_vccz L_slow_117_m
  s_bitcmp1_b32 s91, 0
  s_cbranch_scc1 L_slow_117_m
  s_mov_b32 s91, 1
  s_sub_u32 s24, s30, 524288
  buffer_load_dwordx4 v[40:43], v2, s[4:7], s24 offen offset:0 sc1
  buffer_load_dwordx4 v[44:47], v2, s[4:7], s24 offen offset:1024 sc1
L_slow_117_f:
  buffer_load_dwordx4 v[48:51], v2, s[4:7], s15 offen sc1
  buffer_load_dwordx4 v[52:55], v2, s[4:7], s23 offen sc1
  s_sub_u32 s33, s33, 1
  s_cbranch_scc1 L_done
  s_waitcnt vmcnt(0)
  v_max3_u32 v22, v48, v49, v50
  v_max_u32 v22, v22, v51
  v_max3_u32 v23, v52, v53, v54
  v_max_u32 v23, v23, v55
  v_max_u32 v22, v22, v23
  v_cmp_eq_u32 vcc, -1, v22
  s_cbranch_vccnz L_slow_117_f
  s_waitcnt lgkmcnt(0)
  ds_read_b128 v[56:59], v6 offset:0
  ds_read_b128 v[60:63], v6 offset:1024
  ds_read_b128 v[64:67], v6 offset:2048
  ds_read_b128 v[68:71], v6 offset:3072
  ds_read_b128 v[72:75], v6 offset:4096
  ds_read_b128 v[76:79], v6 offset:5120
  ds_read_b128 v[104:107], v6 offset:6144
  ds_read_b128 v[108:111], v6 offset:7168
  s_waitcnt lgkmcnt(0)
  ds_read_b128 v[112:115], v6 offset:12288
  ds_read_b128 v[116:119], v6 offset:13312
  ds_read_b128 v[120:123], v6 offset:14336
  ds_read_b128 v[124:127], v6 offset:15360
  ds_read_b128 v[128:131], v6 offset:16384
  ds_read_b128 v[132:135], v6 offset:17408
  ds_read_b128 v[136:139], v6 offset:18432
  ds_read_b128 v[140:143], v6 offset:19456
  v_mov_b64 v[80:81], 0
  v_mov_b64 v[82:83], 0
  v_mov_b64 v[84:85], 0
  v_mov_b64 v[86:87], 0
  v_mov_b64 v[88:89], 0
  v_mov_b64 v[90:91], 0
  v_mov_b64 v[92:93], 0
  v_mov_b64 v[94:95], 0
  v_mov_b64 v[96:97], 0
  v_mov_b64 v[98:99], 0
  v_mov_b64 v[100:101], 0
  v_mov_b64 v[102:103], 0
  v_add_u32 v14, s40, v2
  s_mov_b32 s31, 1835008
  s_waitcnt lgkmcnt(0)
  s_barrier
  s_branch L_got_116
L_slow_117_m:
  v_max3_f32 v96, v14, v15, v44
  v_max_f32 v96, v96, v46
  v_mov_b32 v97, v96
  s_nop 1
  v_permlane32_swap_b32 v96, v97
  v_max_f32 v96, v96, v97
  v_mov_b32 v97, v96
  s_nop 1
  v_permlane16_swap_b32 v96, v97
  v_max_f32 v96, v96, v97
  s_barrier
  ds_write_b32 v13, v96 offset:14336
  s_waitcnt lgkmcnt(0)
  s_barrier
  ds_read_b128 v[28:31], v9 offset:14336
  s_waitcnt lgkmcnt(0)
  s_barrier
  v_max3_f32 v96, v28, v29, v30
  v_max_f32 v96, v96, v31
  v_sub_f32 v14, v14, v96
  v_sub_f32 v15, v15, v96
  v_sub_f32 v44, v44, v96
  v_sub_f32 v46, v46, v96
  v_exp_f32 v28, v14
  v_exp_f32 v29, v15
  v_exp_f32_dpp v45, v44 quad_perm:[0,0,2,2] row_mask:0xf bank_mask:0xf
  v_exp_f32_dpp v47, v46 quad_perm:[0,0,2,2] row_mask:0xf bank_mask:0xf
  v_cvt_pk_bf16_f32 v30, v28, v29
  v_cvt_pk_bf16_f32 v23, v45, v47
  v_cndmask_b32 v22, 0, v23, s[66:67]
  v_cndmask_b32 v23, v23, 0, s[66:67]
  ds_write_b32 v13, v30 offset:14336
  s_waitcnt lgkmcnt(0)
  s_barrier
  ds_read_b128 v[28:31], v9 offset:14336
  ds_read_b128 v[40:43], v10 offset:14336
  s_waitcnt lgkmcnt(0)
  v_mfma_f32_16x16x32_bf16 v[88:91], v[16:19], v[28:31], 0
  s_nop 2
  v_mfma_f32_16x16x32_bf16 v[84:87], v[32:35], v[28:31], 0
  s_nop 0
  v_mfma_f32_16x16x32_bf16 v[84:87], v[36:39], v[40:43], v[84:87]
  s_nop 2
  v_mfma_f32_16x16x16_bf16 v[88:91], v[16:17], v[22:23], v[88:91]
  s_nop 2
  v_mfma_f32_16x16x16_bf16 v[84:87], v[20:21], v[22:23], v[84:87]
  s_nop 3
  v_rcp_f32_dpp v96, v88 quad_perm:[0,0,2,2] row_mask:0xf bank_mask:0xf
  s_nop 2
  v_mul_f32 v84, v84, v96
  v_mul_f32 v85, v85, v96
  v_mul_f32 v86, v86, v96
  v_mul_f32 v87, v87, v96
  v_cvt_pk_bf16_f32 v98, v84, v85
  v_cvt_pk_bf16_f32 v99, v86, v87
  ds_write_b64 v7, v[98:99] offset:12288
  s_branch L_back_118
L_wave3_95:
  s_branch L_got_125
  s_nop 0
  s_nop 0
  s_nop 0
  s_nop 0
  s_nop 0
  s_nop 0
L_top_124:
  s_barrier
  v_mov_b64 v[32:33], v[128:129]
  v_mov_b64 v[34:35], v[130:131]
  v_mov_b64 v[36:37], v[132:133]
  v_mov_b64 v[38:39], v[134:135]
  ds_read_b128 v[128:131], v6 offset:16384
  buffer_load_dwordx4 v[48:51], v2, s[4:7], s15 offen sc1
  ds_read_b128 v[132:135], v6 offset:17408
  v_mov_b64 v[40:41], v[136:137]
  v_mov_b64 v[42:43], v[138:139]
  v_mov_b64 v[44:45], v[140:141]
  v_mov_b64 v[46:47], v[142:143]
  ds_read_b128 v[136:139], v6 offset:18432
  ds_read_b128 v[140:143], v6 offset:19456
  buffer_load_dwordx4 v[52:55], v2, s[4:7], s23 offen sc1
  v_mov_b64 v[80:81], 0
  v_mov_b64 v[82:83], 0
  v_mov_b64 v[84:85], 0
  v_mov_b64 v[86:87], 0
  v_mov_b64 v[88:89], 0
  v_mov_b64 v[90:91], 0
  v_mov_b64 v[92:93], 0
  v_mov_b64 v[94:95], 0
  v_mov_b64_e64 v[96:97], 0
  v_mov_b64_e64 v[98:99], 0
  v_mov_b64_e64 v[100:101], 0
  v_mov_b64_e64 v[102:103], 0
  v_add_u32_e64 v14, s40, v2
  v_xor_b32 v16, 0x40004000, v16
  buffer_load_dwordx4 v[48:51], v2, s[4:7], s15 offen sc1
  v_xor_b32 v17, 0x40004000, v17
  v_xor_b32 v18, 0x40004000, v18
  v_xor_b32 v19, 0x40004000, v19
  s_xor_b32 s89, s89, 0x40004000
  s_nop 5
  buffer_load_dwordx4 v[52:55], v2, s[4:7], s23 offen sc1
  s_waitcnt lgkmcnt(0)
L_got_125_w:
  s_waitcnt vmcnt(3)
L_got_125:
  v_cmp_eq_u32_e64 vcc, -1, v51
  v_smfmac_f32_16x16x64_bf16 v[88:91], v[48:51], v[56:63], v1
  ds_write_b128 v14, v[48:51] offset:0
  v_smfmac_f32_16x16x64_bf16 v[92:95], v[48:51], v[64:71], v1
  s_cbranch_vccnz L_re_129
  s_waitcnt vmcnt(2)
  v_cmp_eq_u32_e64 vcc, -1, v55
  v_smfmac_f32_16x16x64_bf16 v[80:83], v[48:51], v[72:79], v1
  v_smfmac_f32_16x16x64_bf16 v[84:87], v[48:51], v[104:111], v1
  s_cbranch_vccnz L_rl_130
L_rl_130_b:
  v_smfmac_f32_16x16x64_bf16 v[88:91], v[52:55], v[112:119], v1
  ds_write_b128 v14, v[52:55] offset:4096
  v_smfmac_f32_16x16x64_bf16 v[92:95], v[52:55], v[120:127], v1
  s_waitcnt lgkmcnt(1)
  s_barrier
  ds_read_b128 v[56:59], v25 offset:0
  v_smfmac_f32_16x16x64_bf16 v[80:83], v[52:55], v[128:135], v1
  ds_read_b128 v[60:63], v26 offset:0
  v_smfmac_f32_16x16x64_bf16 v[84:87], v[52:55], v[136:143], v1
  ds_read_b128 v[64:67], v27 offset:0
  buffer_load_dwordx4 v[136:139], v2, s[4:7], s30 offen offset:0 sc1
  s_waitcnt lgkmcnt(2)
  v_smfmac_f32_16x16x64_bf16 v[88:91], v[56:59], a[32:39], v1
  s_barrier
  v_smfmac_f32_16x16x64_bf16 v[92:95], v[56:59], a[40:47], v1
  ds_read_b128 v[68:71], v25 offset:4096
  s_waitcnt lgkmcnt(2)
  v_smfmac_f32_16x16x64_bf16 v[88:91], v[60:63], a[48:55], v1
  ds_read_b128 v[72:75], v26 offset:4096
  v_smfmac_f32_16x16x64_bf16 v[92:95], v[60:63], a[56:63], v1
  ds_read_b128 v[76:79], v27 offset:4096
  s_waitcnt lgkmcnt(3)
  v_smfmac_f32_16x16x64_bf16 v[88:91], v[64:67], a[64:71], v1
  buffer_load_dwordx4 v[140:143], v2, s[4:7], s30 offen offset:1024 sc1
  v_smfmac_f32_16x16x64_bf16 v[92:95], v[64:67], a[72:79], v1
  ds_read_b128 v[104:107], v6 offset:8192
  s_waitcnt lgkmcnt(3)
  v_smfmac_f32_16x16x64_bf16 v[88:91], v[68:71], a[80:87], v1
  ds_read_b128 v[108:111], v6 offset:9216
  v_smfmac_f32_16x16x64_bf16 v[92:95], v[68:71], a[88:95], v1
  ds_read_b128 v[112:115], v6 offset:10240
  s_waitcnt lgkmcnt(3)
  v_smfmac_f32_16x16x64_bf16 v[88:91], v[72:75], a[96:103], v1
  ds_read_b128 v[116:119], v6 offset:11264
  v_smfmac_f32_16x16x64_bf16 v[88:91], v[76:79], a[112:119], v1
  buffer_load_dwordx4 v[128:131], v2, s[4:7], s65 offen offset:0 sc1
  v_smfmac_f32_16x16x64_bf16 v[92:95], v[72:75], a[104:111], v1
  s_nop 0
  ds_read_b128 v[120:123], v6 offset:20480
  v_smfmac_f32_16x16x64_bf16 v[92:95], v[76:79], a[120:127], v1
  s_waitcnt lgkmcnt(1)
  s_nop 1
  v_add_f32 v88, v88, v89
  v_smfmac_f32_16x16x64_bf16 v[80:83], v[56:59], v[104:111], v1
  ds_read_b128 v[124:127], v6 offset:21504
  v_add_f32 v90, v90, v91
  v_smfmac_f32_16x16x64_bf16 v[84:87], v[56:59], v[112:119], v1
  ds_read_b128 v[104:107], v6 offset:22528
  v_add_f32 v92, v92, v93
  v_smfmac_f32_16x16x64_bf16 v[80:83], v[60:63], v[224:231], v1
  ds_read_b128 v[108:111], v6 offset:23552
  v_add_f32 v94, v94, v95
  v_smfmac_f32_16x16x64_bf16 v[84:87], v[60:63], v[232:239], v1
  v_cvt_pk_bf16_f32 v28, v88, v92
  v_cvt_pk_bf16_f32 v29, v90, v94
  v_smfmac_f32_16x16x64_bf16 v[80:83], v[64:67], v[240:247], v1
  ds_write_b64 v7, v[28:29] offset:8192
  v_smfmac_f32_16x16x64_bf16 v[84:87], v[64:67], v[248:255], v1
  ds_read_b128 v[112:115], v6 offset:24576
  v_smfmac_f32_16x16x64_bf16 v[80:83], v[72:75], a[0:7], v1
  buffer_store_dword v15, v24, s[4:7], s31 offen sc1
  v_smfmac_f32_16x16x64_bf16 v[84:87], v[72:75], a[8:15], v1
  ds_read_b128 v[116:119], v6 offset:25600
  s_waitcnt lgkmcnt(3)
  v_smfmac_f32_16x16x64_bf16 v[80:83], v[68:71], v[120:127], v1
  s_waitcnt lgkmcnt(2)
  s_barrier
  v_smfmac_f32_16x16x64_bf16 v[80:83], v[76:79], a[16:23], v1
  s_nop 0
  ds_read_b64_tr_b16 v[88:89], v8 offset:8192
  v_smfmac_f32_16x16x64_bf16 v[84:87], v[68:71], v[104:111], v1
  ds_read_b64_tr_b16 v[90:91], v8 offset:8704
  v_smfmac_f32_16x16x64_bf16 v[84:87], v[76:79], a[24:31], v1
  ds_read_b64_tr_b16 v[92:93], v8 offset:9216
  v_smfmac_f32_16x16x64_bf16 v[96:99], v[48:51], a[128:135], v1
  ds_read_b64_tr_b16 v[94:95], v8 offset:9728
  v_add_f32 v80, v80, v81
  v_smfmac_f32_16x16x64_bf16 v[100:103], v[48:51], a[136:143], v1
  ds_read_b128 v[120:123], v6 offset:26624
  v_add_f32 v82, v82, v83
  v_smfmac_f32_16x16x64_bf16 v[96:99], v[52:55], a[144:151], v1
  v_add_f32 v84, v84, v85
  v_add_f32 v86, v86, v87
  v_cvt_pk_bf16_f32 v22, v80, v84
  v_cvt_pk_bf16_f32 v23, v82, v86
  v_smfmac_f32_16x16x64_bf16 v[100:103], v[52:55], a[152:159], v1
  ds_write_b64 v7, v[22:23] offset:10240
  s_waitcnt lgkmcnt(2)
  v_mfma_f32_16x16x32_bf16 v[28:31], v[40:43], v[88:91], 0
  ds_read_b128 v[124:127], v6 offset:27648
  v_mfma_f32_16x16x32_bf16 v[28:31], v[44:47], v[92:95], v[28:31]
  buffer_load_dwordx4 v[132:135], v2, s[4:7], s65 offen offset:1024 sc1
  v_smfmac_f32_16x16x64_bf16 v[96:99], v[56:59], a[160:167], v1
  s_nop 0
  ds_read_b128 v[104:107], v6 offset:28672
  v_smfmac_f32_16x16x64_bf16 v[100:103], v[56:59], a[168:175], v1
  s_waitcnt lgkmcnt(2)
  s_barrier
  s_nop 0
  v_add_f32_dpp v14, v29, v28 quad_perm:[1,1,3,3] row_mask:0xf bank_mask:0xf
  v_smfmac_f32_16x16x64_bf16 v[96:99], v[60:63], a[176:183], v1
  ds_read_b64_tr_b16 v[80:81], v8 offset:10240
  v_add_f32_dpp v15, v31, v30 quad_perm:[1,1,3,3] row_mask:0xf bank_mask:0xf
  v_smfmac_f32_16x16x64_bf16 v[100:103], v[60:63], a[184:191], v1
  ds_read_b64_tr_b16 v[82:83], v8 offset:10752
  v_exp_f32 v28, v14
  v_smfmac_f32_16x16x64_bf16 v[96:99], v[64:67], a[192:199], v1
  ds_read_b64_tr_b16 v[84:85], v8 offset:11264
  v_exp_f32 v29, v15
  v_smfmac_f32_16x16x64_bf16 v[100:103], v[64:67], a[200:207], v1
  ds_read_b64_tr_b16 v[86:87], v8 offset:11776
  v_cvt_pk_bf16_f32 v30, v28, v29
  v_smfmac_f32_16x16x64_bf16 v[96:99], v[68:71], a[208:215], v1
  ds_write_b32 v13, v30 offset:14336
  v_smfmac_f32_16x16x64_bf16 v[100:103], v[68:71], a[216:223], v1
  ds_read_b128 v[108:111], v6 offset:29696
  s_waitcnt lgkmcnt(2)
  v_mfma_f32_16x16x32_bf16 v[44:47], v[80:83], v[88:91], 0
  ds_read_b128 v[64:67], v6 offset:30720
  v_mfma_f32_16x16x32_bf16 v[44:47], v[84:87], v[92:95], v[44:47]
  s_nop 0
  s_waitcnt vmcnt(5)
  v_mov_b64 v[48:49], 0
  v_smfmac_f32_16x16x64_bf16 v[96:99], v[72:75], a[224:231], v1
  s_waitcnt lgkmcnt(2)
  s_barrier
  v_smfmac_f32_16x16x64_bf16 v[96:99], v[76:79], a[240:247], v1
  ds_read_b128 v[28:31], v9 offset:14336
  v_add_f32_dpp v44, v45, v44 quad_perm:[1,1,3,3] row_mask:0xf bank_mask:0xf
  v_add_f32_dpp v46, v47, v46 quad_perm:[1,1,3,3] row_mask:0xf bank_mask:0xf
  v_smfmac_f32_16x16x64_bf16 v[100:103], v[72:75], a[232:239], v1
  ds_read_b128 v[40:43], v10 offset:14336
  v_mul_f32 v44, s64, v44
  v_mul_f32 v46, s64, v46
  v_smfmac_f32_16x16x64_bf16 v[100:103], v[76:79], a[248:255], v1
  ds_read_b128 v[68:71], v6 offset:31744
  v_add_f32 v96, v96, v97
  v_exp_f32_dpp v45, v44 quad_perm:[0,0,2,2] row_mask:0xf bank_mask:0xf
  v_exp_f32_dpp v47, v46 quad_perm:[0,0,2,2] row_mask:0xf bank_mask:0xf
  s_waitcnt lgkmcnt(2)
  v_mfma_f32_16x16x32_bf16 v[88:91], v[16:19], v[28:31], 0
  v_cvt_pk_bf16_f32 v23, v45, v47
  v_cndmask_b32 v22, 0, v23, s[66:67]
  v_mfma_f32_16x16x32_bf16 v[84:87], v[32:35], v[28:31], 0
  s_waitcnt lgkmcnt(1)
  v_cndmask_b32 v23, v23, 0, s[66:67]
  v_add_f32 v98, v98, v99
  v_mfma_f32_16x16x32_bf16 v[84:87], v[36:39], v[40:43], v[84:87]
  v_add_f32 v100, v100, v101
  v_add_f32 v102, v102, v103
  v_cvt_pk_bf16_f32 v21, v100, v102
  v_cvt_pk_bf16_f32 v20, v96, v98
  v_mfma_f32_16x16x16_bf16 v[88:91], v[16:17], v[22:23], v[88:91]
  v_mov_b64 v[50:51], 0
  v_mov_b64 v[52:53], 0
  v_mfma_f32_16x16x16_bf16 v[84:87], v[20:21], v[22:23], v[84:87]
  v_mov_b64 v[54:55], 0
  v_mov_b64 v[56:57], 0
  v_mov_b64 v[58:59], 0
  v_mov_b64 v[60:61], 0
  v_mov_b64 v[62:63], 0
  v_rcp_f32_dpp v96, v88 quad_perm:[0,0,2,2] row_mask:0xf bank_mask:0xf
  s_nop 0
  v_subrev_u32 v97, s29, v96
  v_cmp_lt_u32 vcc, s90, v97
  v_mul_f32 v84, v84, v96
  v_mul_f32 v85, v85, v96
  v_mul_f32 v86, v86, v96
  v_mul_f32_e64 v87, v87, v96
  v_cvt_pk_bf16_f32 v98, v84, v85
  v_cvt_pk_bf16_f32 v99, v86, v87
  ds_write_b64 v7, v[98:99] offset:12288
  s_cbranch_vccnz L_slow_126
L_back_127:
  v_mov_b32_dpp v80, v98 quad_perm:[0,0,2,2] row_mask:0xf bank_mask:0xf
  v_mov_b32_dpp v81, v99 quad_perm:[0,0,2,2] row_mask:0xf bank_mask:0xf
  v_mov_b32_dpp v82, v98 quad_perm:[1,1,3,3] row_mask:0xf bank_mask:0xf
  v_mov_b32_dpp v83, v99 quad_perm:[1,1,3,3] row_mask:0xf bank_mask:0xf
  s_nop 1
  v_smfmac_f32_16x16x64_bf16 v[48:51], v[80:83], v[144:151], v1
  s_waitcnt lgkmcnt(0)
  s_barrier
  ds_read_b128 v[92:95], v3 offset:12288
  v_smfmac_f32_16x16x64_bf16 v[52:55], v[80:83], v[152:159], v1
  ds_read_b128 v[28:31], v4 offset:12288
  v_smfmac_f32_16x16x64_bf16 v[56:59], v[80:83], v[160:167], v1
  ds_read_b128 v[40:43], v5 offset:12288
  v_smfmac_f32_16x16x64_bf16 v[60:63], v[80:83], v[168:175], v1
  ds_read_b128 v[72:75], v6 offset:32768
  s_waitcnt lgkmcnt(3)
  v_smfmac_f32_16x16x64_bf16 v[48:51], v[92:95], v[176:183], v1
  ds_read_b128 v[76:79], v6 offset:33792
  s_waitcnt lgkmcnt(3)
  v_smfmac_f32_16x16x64_bf16 v[48:51], v[28:31], v[192:199], v1
  ds_read_b128 v[32:35], v6 offset:34816
  s_waitcnt lgkmcnt(3)
  v_smfmac_f32_16x16x64_bf16 v[48:51], v[40:43], v[208:215], v1
  s_nop 0
  ds_read_b128 v[36:39], v6 offset:35840
  v_smfmac_f32_16x16x64_bf16 v[52:55], v[92:95], v[184:191], v1
  s_nop 2
  v_smfmac_f32_16x16x64_bf16 v[52:55], v[28:31], v[200:207], v1
  s_nop 0
  v_cvt_pk_bf16_f32 v96, v48, v49
  v_smfmac_f32_16x16x64_bf16 v[52:55], v[40:43], v[216:223], v1
  s_nop 0
  s_waitcnt lgkmcnt(12)
  v_cvt_pk_bf16_f32 v97, v50, v51
  v_smfmac_f32_16x16x64_bf16 v[56:59], v[92:95], v[112:119], v1
  buffer_store_dwordx2 v[96:97], v11, s[4:7], s18 offen offset:0 sc1
  v_smfmac_f32_16x16x64_bf16 v[56:59], v[28:31], v[120:127], v1
  s_nop 1
  v_cvt_pk_bf16_f32 v98, v52, v53
  v_smfmac_f32_16x16x64_bf16 v[56:59], v[40:43], v[104:111], v1
  s_nop 0
  s_waitcnt lgkmcnt(0)
  v_cvt_pk_bf16_f32 v99, v54, v55
  v_smfmac_f32_16x16x64_bf16 v[60:63], v[92:95], v[64:71], v1
  buffer_store_dwordx2 v[98:99], v11, s[4:7], s18 offen offset:2048 sc1
  v_smfmac_f32_16x16x64_bf16 v[60:63], v[28:31], v[72:79], v1
  s_nop 1
  v_cvt_pk_bf16_f32 v100, v56, v57
  v_smfmac_f32_16x16x64_bf16 v[60:63], v[40:43], v[32:39], v1
  v_cvt_pk_bf16_f32 v101, v58, v59
  buffer_store_dwordx2 v[100:101], v11, s[4:7], s19 offen offset:0 sc1
  s_add_u32 s14, s14, 1
  s_and_b32 s24, s14, 3
  s_lshl_b32 s24, s24, 13
  s_add_u32 s24, s24, 1048576
  v_mov_b32_e64 v15, -1
  s_nop 0
  v_cvt_pk_bf16_f32 v102, v60, v61
  v_cvt_pk_bf16_f32 v103, v62, v63
  buffer_store_dwordx2 v[102:103], v11, s[4:7], s19 offen offset:2048 sc1
  buffer_store_dword v15, v24, s[4:7], s28 offen sc1
  ds_read_b128 v[88:91], v2 offset:15360
  v_and_b32_e64 v14, v96, v97
  v_bitop3_b32 v14, v14, v98, v99 bitop3:0x80
  v_bitop3_b32 v14, v14, v100, v101 bitop3:0x80
  v_bitop3_b32 v14, v14, v102, v103 bitop3:0x80
  v_bfi_b32 v14, v14, 0, s89
  v_cmp_lt_u32 vcc, 0xffff, v14
  ds_read_b128 v[56:59], v6 offset:0
  ds_read_b128 v[60:63], v6 offset:1024
  ds_read_b128 v[64:67], v6 offset:2048
  ds_read_b128 v[68:71], v6 offset:3072
  s_cbranch_vccnz L_fix_131
L_fix_131_b:
  ds_read_b128 v[72:75], v6 offset:4096
  ds_read_b128 v[76:79], v6 offset:5120
  ds_read_b128 v[104:107], v6 offset:6144
  ds_read_b128 v[108:111], v6 offset:7168
  ds_read_b128 v[112:115], v6 offset:12288
  ds_read_b128 v[116:119], v6 offset:13312
  ds_read_b128 v[120:123], v6 offset:14336
  ds_read_b128 v[124:127], v6 offset:15360
  s_waitcnt vmcnt(1)
  s_mov_b32 s28, s17
  s_add_u32 s17, s24, s87
  s_add_u32 s15, s24, s40
  s_add_u32 s23, s24, s16
  s_lshl_b32 s31, s14, 13
  s_add_u32 s31, s31, s87
  buffer_load_dwordx4 v[80:83], v2, s[4:7], s22 offen offset:0 sc1
  buffer_load_dwordx4 v[84:87], v2, s[4:7], s22 offen offset:1024 sc1
  s_add_u32 s31, s31, 1310720
  s_xor_b32 s29, s29, 0x40000000
  s_mov_b32 s91, 0
  s_add_u32 s30, s30, 524288
  s_add_u32 s65, s65, 524288
  s_waitcnt lgkmcnt(12)
  v_bfi_b32 v88, s89, 0, v88
  v_bfi_b32 v89, s89, 0, v89
  v_bfi_b32 v90, s89, 0, v90
  v_bfi_b32 v91, s89, 0, v91
  s_waitcnt vmcnt(1)
L_red_128_b:
  s_nop 0
  v_mfma_f32_16x16x32_bf16 v[92:95], v[88:91], v[80:83], 0
  s_nop 0
  v_bitop3_b32 v29, v80, v81, s89 bitop3:0x7e
  v_bitop3_b32 v30, v82, v83, s89 bitop3:0x7e
  v_or_b32_e64 v14, v29, v30
  s_waitcnt vmcnt(0)
  v_mfma_f32_16x16x32_bf16 v[92:95], v[88:91], v[84:87], v[92:95]
  v_bitop3_b32 v29, v84, v85, s89 bitop3:0x7e
  v_bitop3_b32 v30, v86, v87, s89 bitop3:0x7e
  v_or3_b32 v14, v14, v29, v30
  v_lshlrev_b32_e64 v14, 1, v14
  v_cmp_gt_i32_e64 vcc, 0, v14
  s_nop 2
  v_add_f32_dpp v92, v92, v92 row_ror:4 row_mask:0xf bank_mask:0xf
  v_add_f32_dpp v93, v93, v93 row_ror:4 row_mask:0xf bank_mask:0xf
  s_cbranch_vccnz L_red_128
  v_add_f32_dpp v92, v92, v92 row_ror:8 row_mask:0xf bank_mask:0xf
  v_add_f32_dpp v93, v93, v93 row_ror:8 row_mask:0xf bank_mask:0xf
  v_cvt_pk_bf16_f32 v15, v92, v93
  buffer_store_dword v15, v24, s[4:7], s17 offen sc1
  s_cmp_lt_u32 s14, 63
  s_cbranch_scc1 L_top_124
L_end_132:
  buffer_store_dword v15, v24, s[4:7], s31 offen sc1
  s_branch L_done
L_fix_131:
  v_or_b32 v96, 0x40000000, v96
  v_or_b32 v97, 0x40000000, v97
  v_or_b32 v98, 0x40000000, v98
  v_or_b32 v99, 0x40000000, v99
  v_or_b32 v100, 0x40000000, v100
  v_or_b32 v101, 0x40000000, v101
  v_or_b32 v102, 0x40000000, v102
  v_or_b32 v103, 0x40000000, v103
  buffer_store_dwordx2 v[96:97], v11, s[4:7], s18 offen offset:0 sc1
  buffer_store_dwordx2 v[98:99], v11, s[4:7], s18 offen offset:2048 sc1
  buffer_store_dwordx2 v[100:101], v11, s[4:7], s19 offen offset:0 sc1
  buffer_store_dwordx2 v[102:103], v11, s[4:7], s19 offen offset:2048 sc1
  s_branch L_fix_131_b
L_red_128:
  buffer_load_dwordx4 v[80:83], v2, s[4:7], s22 offen offset:0 sc1
  buffer_load_dwordx4 v[84:87], v2, s[4:7], s22 offen offset:1024 sc1
  s_sub_u32 s33, s33, 1
  s_cbranch_scc1 L_done
  s_waitcnt vmcnt(0)
  s_branch L_red_128_b
L_re_129:
  buffer_load_dwordx4 v[48:51], v2, s[4:7], s15 offen sc1
  s_sub_u32 s33, s33, 1
  buffer_load_dwordx4 v[52:55], v2, s[4:7], s23 offen sc1
  s_nop 1
  v_mov_b64 v[88:89], 0
  v_mov_b64 v[90:91], 0
  v_mov_b64 v[92:93], 0
  v_mov_b64 v[94:95], 0
  s_cbranch_scc0 L_got_125_w
  s_branch L_done
L_rl_130:
  buffer_load_dwordx4 v[52:55], v2, s[4:7], s23 offen sc1
  s_waitcnt vmcnt(1)
  v_cmp_eq_u32 vcc, -1, v55
  s_cbranch_vccz L_rl_130_b
  s_sub_u32 s33, s33, 1
  s_cbranch_scc1 L_done
  s_branch L_rl_130
L_slow_126:
  v_cmp_u_f32 vcc, v96, v96
  s_cbranch_vccz L_slow_126_m
  s_bitcmp1_b32 s91, 0
  s_cbranch_scc1 L_slow_126_m
  s_mov_b32 s91, 1
  s_sub_u32 s24, s30, 524288
  buffer_load_dwordx4 v[40:43], v2, s[4:7], s24 offen offset:0 sc1
  buffer_load_dwordx4 v[44:47], v2, s[4:7], s24 offen offset:1024 sc1
L_slow_126_f:
  buffer_load_dwordx4 v[48:51], v2, s[4:7], s15 offen sc1
  buffer_load_dwordx4 v[52:55], v2, s[4:7], s23 offen sc1
  s_sub_u32 s33, s33, 1
  s_cbranch_scc1 L_done
  s_waitcnt vmcnt(0)
  v_max3_u32 v22, v48, v49, v50
  v_max_u32 v22, v22, v51
  v_max3_u32 v23, v52, v53, v54
  v_max_u32 v23, v23, v55
  v_max_u32 v22, v22, v23
  v_cmp_eq_u32 vcc, -1, v22
  s_cbranch_vccnz L_slow_126_f
  s_waitcnt lgkmcnt(0)
  ds_read_b128 v[56:59], v6 offset:0
  ds_read_b128 v[60:63], v6 offset:1024
  ds_read_b128 v[64:67], v6 offset:2048
  ds_read_b128 v[68:71], v6 offset:3072
  ds_read_b128 v[72:75], v6 offset:4096
  ds_read_b128 v[76:79], v6 offset:5120
  ds_read_b128 v[104:107], v6 offset:6144
  ds_read_b128 v[108:111], v6 offset:7168
  s_waitcnt lgkmcnt(0)
  ds_read_b128 v[112:115], v6 offset:12288
  ds_read_b128 v[116:119], v6 offset:13312
  ds_read_b128 v[120:123], v6 offset:14336
  ds_read_b128 v[124:127], v6 offset:15360
  ds_read_b128 v[128:131], v6 offset:16384
  ds_read_b128 v[132:135], v6 offset:17408
  ds_read_b128 v[136:139], v6 offset:18432
  ds_read_b128 v[140:143], v6 offset:19456
  v_mov_b64 v[80:81], 0
  v_mov_b64 v[82:83], 0
  v_mov_b64 v[84:85], 0
  v_mov_b64 v[86:87], 0
  v_mov_b64 v[88:89], 0
  v_mov_b64 v[90:91], 0
  v_mov_b64 v[92:93], 0
  v_mov_b64 v[94:95], 0
  v_mov_b64 v[96:97], 0
  v_mov_b64 v[98:99], 0
  v_mov_b64 v[100:101], 0
  v_mov_b64 v[102:103], 0
  v_add_u32 v14, s40, v2
  s_mov_b32 s31, 1835008
  s_waitcnt lgkmcnt(0)
  s_barrier
  s_branch L_got_125
L_slow_126_m:
  v_max3_f32 v96, v14, v15, v44
  v_max_f32 v96, v96, v46
  v_mov_b32 v97, v96
  s_nop 1
  v_permlane32_swap_b32 v96, v97
  v_max_f32 v96, v96, v97
  v_mov_b32 v97, v96
  s_nop 1
  v_permlane16_swap_b32 v96, v97
  v_max_f32 v96, v96, v97
  s_barrier
  ds_write_b32 v13, v96 offset:14336
  s_waitcnt lgkmcnt(0)
  s_barrier
  ds_read_b128 v[28:31], v9 offset:14336
  s_waitcnt lgkmcnt(0)
  s_barrier
  v_max3_f32 v96, v28, v29, v30
  v_max_f32 v96, v96, v31
  v_sub_f32 v14, v14, v96
  v_sub_f32 v15, v15, v96
  v_sub_f32 v44, v44, v96
  v_sub_f32 v46, v46, v96
  v_exp_f32 v28, v14
  v_exp_f32 v29, v15
  v_exp_f32_dpp v45, v44 quad_perm:[0,0,2,2] row_mask:0xf bank_mask:0xf
  v_exp_f32_dpp v47, v46 quad_perm:[0,0,2,2] row_mask:0xf bank_mask:0xf
  v_cvt_pk_bf16_f32 v30, v28, v29
  v_cvt_pk_bf16_f32 v23, v45, v47
  v_cndmask_b32 v22, 0, v23, s[66:67]
  v_cndmask_b32 v23, v23, 0, s[66:67]
  ds_write_b32 v13, v30 offset:14336
  s_waitcnt lgkmcnt(0)
  s_barrier
  ds_read_b128 v[28:31], v9 offset:14336
  ds_read_b128 v[40:43], v10 offset:14336
  s_waitcnt lgkmcnt(0)
  v_mfma_f32_16x16x32_bf16 v[88:91], v[16:19], v[28:31], 0
  s_nop 2
  v_mfma_f32_16x16x32_bf16 v[84:87], v[32:35], v[28:31], 0
  s_nop 0
  v_mfma_f32_16x16x32_bf16 v[84:87], v[36:39], v[40:43], v[84:87]
  s_nop 2
  v_mfma_f32_16x16x16_bf16 v[88:91], v[16:17], v[22:23], v[88:91]
  s_nop 2
  v_mfma_f32_16x16x16_bf16 v[84:87], v[20:21], v[22:23], v[84:87]
  s_nop 3
  v_rcp_f32_dpp v96, v88 quad_perm:[0,0,2,2] row_mask:0xf bank_mask:0xf
  s_nop 2
  v_mul_f32 v84, v84, v96
  v_mul_f32 v85, v85, v96
  v_mul_f32 v86, v86, v96
  v_mul_f32 v87, v87, v96
  v_cvt_pk_bf16_f32 v98, v84, v85
  v_cvt_pk_bf16_f32 v99, v86, v87
  ds_write_b64 v7, v[98:99] offset:12288
  s_branch L_back_127
L_done:
  s_endpgm
.section .rodata,"a"
.p2align 6
.amdhsa_kernel gated_mix__memory_aug_recurrent_mem_tr__mixer_token_mlp__prompt_kernel
  .amdhsa_next_free_vgpr 512
  .amdhsa_next_free_sgpr 102
  .amdhsa_accum_offset 256
  .amdhsa_group_segment_fixed_size 0
  .amdhsa_kernarg_size 128
  .amdhsa_user_sgpr_count 2
  .amdhsa_user_sgpr_kernarg_segment_ptr 1
  .amdhsa_system_sgpr_workgroup_id_x 1
  .amdhsa_float_denorm_mode_32 3
.end_amdhsa_kernel
```
